```python
import torch

def _softmax(x, axis=-1):
    return torch.softmax(x, dim=axis)
def _gelu(x):
    return torch.nn.functional.gelu(x, approximate="tanh")
def _silu(x):
    return torch.nn.functional.silu(x)
def _sigmoid(x):
    return torch.sigmoid(x)
def _layernorm(x, axis=-1, eps=1e-5):
    m = x.mean(dim=axis, keepdim=True)
    v = x.var(dim=axis, keepdim=True, unbiased=False)
    return (x - m) / torch.sqrt(v + eps)
def _scatter_add(tgt, idx, src, axis=0):
    return tgt.clone().index_add_(axis, idx, src)
def _segment_sum(src, seg, n):
    out = torch.zeros((n,) + src.shape[1:], dtype=src.dtype)
    return out.index_add_(0, seg, src)
def _pad(x, pw):
    flat = tuple(v for pair in reversed(pw) for v in pair)
    return torch.nn.functional.pad(x, flat)

kernel_name = 'interleave_layers__ssm_conv_h3__mixer_s_mlp__prompt'

def setup_inputs():

    _w = (lambda a: (lambda t: t.to(torch.bfloat16) if t.is_floating_point() else t)(torch.as_tensor(a)))
    def _A_setup():
        B, S, D = 1, 2048, 512
        ks = 4
        return {
            "q": _w((lambda *s: torch.randn(*s, dtype=torch.bfloat16) * 0.05)(B, S, D)),
            "k": _w((lambda *s: torch.randn(*s, dtype=torch.bfloat16) * 0.8)(B, S, D)),
            "v": _w((lambda *s: torch.randn(*s, dtype=torch.bfloat16) * 0.8)(B, S, D)),
            "shift_k": _w((lambda *s: torch.randn(*s, dtype=torch.bfloat16) * 0.8)(D, ks) * 0.5),
            "ssm_k": _w((lambda *s: torch.randn(*s, dtype=torch.bfloat16) * 0.8)(D, S) * (1.0 / S ** 0.5)),
            "ssm_D": _w((lambda *s: torch.randn(*s, dtype=torch.bfloat16) * 0.8)(D)),
        }
    _A_in = _A_setup()

    def _B_setup():
        B, S, D, F = 1, 2048, 512, 1792
        return {
            "x":  _w((lambda *s: torch.randn(*s, dtype=torch.bfloat16) * 0.05)(B, S, D)),
            "w1": _w((lambda *s: torch.randn(*s, dtype=torch.bfloat16) * 3.2)(D, D) * (D ** -0.5)),
            "w2": _w((lambda *s: torch.randn(*s, dtype=torch.bfloat16) * 3.2)(D, D) * (D ** -0.5)),
            "w3": _w((lambda *s: torch.randn(*s, dtype=torch.bfloat16) * 3.2)(D, F) * (D ** -0.5)),
            "w4": _w((lambda *s: torch.randn(*s, dtype=torch.bfloat16) * 3.2)(F, D) * (F ** -0.5)),
        }
    _B_in = _B_setup()

    return {
        "A_q": _A_in["q"],
        "A_k": _A_in["k"],
        "A_v": _A_in["v"],
        "A_shift_k": _A_in["shift_k"],
        "A_ssm_k": _A_in["ssm_k"],
        "A_ssm_D": _A_in["ssm_D"],
        "B_x": _B_in["x"],
        "B_w1": _B_in["w1"],
        "B_w2": _B_in["w2"],
        "B_w3": _B_in["w3"],
        "B_w4": _B_in["w4"],
    }

def reference(A_q, A_k, A_v, A_shift_k, A_ssm_k, A_ssm_D, B_x, B_w1, B_w2, B_w3, B_w4):
    def _A_ref(q, k, v, shift_k, ssm_k, ssm_D):
        B, S, D = q.shape
        ks = shift_k.shape[-1]
        k_pad = _pad(k, ((0, 0), (ks - 1, 0), (0, 0)))
        k_shift = torch.zeros_like(k)
        for t in range(ks):
            k_shift = k_shift + k_pad[:, t:t + S, :] * shift_k[:, ks - 1 - t][None, None, :]
        kv = k_shift * v
        L = 2 * S
        kv_pad = _pad(kv, ((0, 0), (0, S), (0, 0)))
        kf_pad = _pad(ssm_k, ((0, 0), (0, S)))
        kv_f = (lambda x, axes=(-2,-1): torch.fft.rfft2(x.float(), dim=axes))(kv_pad[:, None, :, :], axes=(1, 2))
        kf_f = (lambda x, axes=(-2,-1): torch.fft.rfft2(x.float(), dim=axes))(kf_pad[:, None, :], axes=(1, 2))
        kf_f = (lambda x, *d: x.permute(*d))(kf_f, 1, 2, 0)
        y_f = kv_f * kf_f[None, :, :, :]
        y = (lambda x, s, axes=(-2,-1): torch.fft.irfft2(x, s=s, dim=axes).to(torch.bfloat16))(y_f, (1, L), axes=(1, 2))[:, 0, :S, :]
        y = y + kv * ssm_D[None, None, :]
        return q * y

    def _B_ref(x, w1, w2, w3, w4):
        B, S, D = x.shape
        h = _gelu(_layernorm(x, axis=-1) @ w1)
        c = D // 4
        g0 = _pad(h[:, :, 0*c:1*c], ((0, 0), (1, 0), (0, 0)))[:, :S, :]
        g1 = _pad(h[:, :, 1*c:2*c], ((0, 0), (0, 1), (0, 0)))[:, 1:, :]
        g2 = _pad(h[:, :, 2*c:3*c], ((0, 0), (2, 0), (0, 0)))[:, :S, :]
        g3 = _pad(h[:, :, 3*c:   ], ((0, 0), (0, 2), (0, 0)))[:, 2:, :]
        hs = torch.concatenate([g0, g1, g2, g3], axis=-1) @ w2
        x1 = x + hs
        h2 = _gelu(_layernorm(x1, axis=-1) @ w3) @ w4
        return x1 + h2

    x = A_q
    x = x + _A_ref(_layernorm(x, axis=-1), A_k, A_v, A_shift_k, A_ssm_k, A_ssm_D)
    x = x + _B_ref(_layernorm(x, axis=-1), B_w1, B_w2, B_w3, B_w4)
    x = x + _A_ref(_layernorm(x, axis=-1), A_k, A_v, A_shift_k, A_ssm_k, A_ssm_D)
    x = x + _B_ref(_layernorm(x, axis=-1), B_w1, B_w2, B_w3, B_w4)
    return x
```

```asm
; @launch grid=(256,1,1) block=(256,1,1) lds=163840
.amdgcn_target "amdgcn-amd-amdhsa--gfx950"
.text
.globl interleave_layers__ssm_conv_h3__mixer_s_mlp__prompt_kernel
.p2align 12
.p2align 8
.type interleave_layers__ssm_conv_h3__mixer_s_mlp__prompt_kernel,@function
interleave_layers__ssm_conv_h3__mixer_s_mlp__prompt_kernel:
s_cmp_ge_u32 s2, 256
s_cbranch_scc1 end_1
s_load_dwordx2 s[72:73], s[0:1], 8
s_load_dwordx2 s[74:75], s[0:1], 16
s_load_dwordx2 s[4:5], s[0:1], 104
v_lshrrev_b32 v16, 6, v0
s_load_dwordx2 s[98:99], s[0:1], 24
s_load_dwordx2 s[8:9], s[0:1], 32
v_readfirstlane_b32 s12, v16
s_getpc_b64 s[64:65]
pc_here:
v_and_b32 v17, 63, v0
s_lshr_b32 s19, s2, 3
s_lshr_b32 s70, s12, 1
s_and_b32 s71, s12, 1
s_cselect_b32 s60, 31, 3
s_cselect_b32 s61, 8, 0
s_and_b32 s60, s60, s19
s_lshl_b32 s60, s60, 1
s_add_u32 s60, s60, s61
s_add_u32 s60, s60, s70
s_lshl_b32 s60, s60, 10
v_lshlrev_b32 v56, 7, v17
v_add_u32 v79, s60, v56
v_min_u32 v79, fast_end_2-pc_here, v79
s_mov_b64 exec, 0xff
global_load_dword v79, v79, s[64:65]
s_mov_b64 exec, -1
s_load_dwordx2 s[94:95], s[0:1], 0
s_load_dwordx2 s[92:93], s[0:1], 96
s_load_dwordx2 s[16:17], s[0:1], 40
s_load_dwordx2 s[84:85], s[0:1], 56
s_load_dwordx2 s[88:89], s[0:1], 64
s_load_dwordx2 s[56:57], s[0:1], 72
s_load_dwordx2 s[52:53], s[0:1], 80
s_load_dwordx2 s[78:79], s[0:1], 88
v_lshlrev_b32 v1, 4, v17
s_and_b32 s18, s2, 7
v_and_b32 v18, 7, v17
v_lshrrev_b32 v16, 3, v17
v_lshlrev_b32 v20, 10, v16
v_lshl_add_u32 v20, v18, 4, v20
s_lshl_b32 s60, s19, 16
s_lshl_b32 s61, s18, 7
s_add_u32 s60, s60, s61
s_lshl_b32 s61, s12, 14
s_add_u32 s60, s60, s61
v_add_u32 v20, s60, v20
v_add_u32 v21, 0x2000, v20
s_mul_i32 s62, s12, 2080
s_mov_b32 s6, 268435456
s_mov_b32 s7, 0x00020000
s_lshl_b32 s76, s18, 22
s_add_u32 s37, s76, 589824
v_mov_b32 v48, 0
v_mov_b32 v49, 0
v_mov_b32 v50, 0
v_mov_b32 v51, 0
s_lshl_b32 s77, s19, 2
s_add_u32 s77, s77, s12
s_add_u32 m0, s62, 78864
v_lshrrev_b32 v19, 3, v0
s_lshl_b32 s60, s18, 9
v_lshl_add_u32 v23, v19, 4, s60
s_lshl_b32 s60, s18, 2
v_mov_b32 v86, s60
v_mov_b32 v9, 0
s_mov_b32 s86, 524288
s_mov_b32 s87, 0x00020000
s_mov_b32 s90, 524288
s_mov_b32 s91, 0x00020000
s_mov_b32 s54, 1835008
s_mov_b32 s55, 0x00020000
s_mov_b32 s58, 1835008
s_mov_b32 s59, 0x00020000
s_waitcnt lgkmcnt(0)
s_cmp_lg_u32 s77, 0
s_cbranch_scc1 skip_4
global_load_dword v87, v86, s[92:93] sc1
buffer_store_dwordx4 v[48:51], v1, s[4:7], s37 offen
buffer_store_dwordx4 v[48:51], v1, s[4:7], s37 offen offset:1024 sc1
buffer_store_dwordx4 v[48:51], v1, s[4:7], s37 offen offset:2048 sc1
skip_4:
global_load_dwordx4 v[80:83], v23, s[98:99]
global_load_lds_dwordx4 v20, s[72:73] nt
s_add_u32 m0, s62, 87184
v_subrev_u32 v22, 0x6000, v20
global_load_lds_dwordx4 v20, s[74:75] nt
s_add_u32 m0, s62, 79904
s_nop 0
global_load_lds_dwordx4 v21, s[72:73] nt
s_add_u32 m0, s62, 88224
s_nop 0
global_load_lds_dwordx4 v21, s[74:75] nt
s_cmp_lg_u32 s77, 1
s_cbranch_scc1 skip_5
v_add_u32 v21, 77824, v1
ds_write_b128 v21, v[48:51]
skip_5:
s_cmp_eq_u32 s19, 0
s_cselect_b32 s60, 0, s12
s_cmp_lg_u32 s60, 1
s_cbranch_scc1 skip_6
s_mov_b32 m0, 77824
s_mov_b32 exec_lo, 0
s_mov_b32 exec_hi, 0xffffff00
global_load_lds_dwordx4 v22, s[72:73]
s_mov_b64 exec, -1
skip_6:
s_and_b32 s13, s19, 15
s_lshr_b32 s60, s19, 4
s_lshl_b32 s14, s18, 1
s_add_u32 s14, s14, s60
s_lshl_b32 s15, s14, 21
s_add_u32 s15, s15, 0
s_lshl_b32 s47, s12, 11
s_lshr_b32 s20, s13, 3
s_and_b32 s21, s13, 7
s_lshl_b32 s40, s20, 16
s_lshl_b32 s60, s21, 12
s_add_u32 s40, s40, s60
s_add_u32 s40, s40, s15
s_lshl_b32 s67, s70, 15
s_lshl_b32 s60, s71, 11
s_add_u32 s67, s67, s60
s_add_u32 s67, s67, s40
s_add_u32 s67, s67, 393216
s_lshl_b32 s50, s18, 5
s_add_u32 s50, s50, s19
s_lshl_b32 s51, s50, 13
s_add_u32 s51, s51, s47
s_mov_b32 s10, 2097152
s_mov_b32 s11, 0x00020000
s_lshl_b32 s46, s12, 10
s_add_u32 s34, s40, s46
v_mov_b32 v52, -1
v_mov_b32 v53, -1
v_mov_b32 v54, -1
v_mov_b32 v55, -1
s_lshl_b32 s60, s50, 2
s_add_u32 s16, s16, s60
s_addc_u32 s17, s17, 0
v_mov_b32 v186, s16
v_mov_b32 v187, s17
v_mov_b32 v190, s78
v_mov_b32 v191, s79
s_mov_b64 exec, 0xffff
buffer_load_dword v71, v56, s[4:7], s67 offen sc1 nt
s_mov_b64 exec, -1
buffer_load_dwordx4 v[164:167], v1, s[8:11], s51 offen nt
buffer_load_dwordx4 v[172:175], v1, s[8:11], s51 offen offset:1024 nt
v_subrev_u32 v192, 16, v1
v_lshl_add_u32 v192, s71, 11, v192
s_andn2_b32 s61, s51, 0x800
buffer_load_dwordx4 v[160:163], v192, s[8:11], s61 offen nt
buffer_load_dwordx4 v[168:171], v1, s[8:11], s51 offen offset:1008 nt
s_add_u32 s81, s14, 15
s_and_b32 s81, s81, 15
s_lshl_b32 s60, s81, 3
s_lshl_b32 s61, s20, 2
s_add_u32 s60, s60, s61
s_add_u32 s60, s60, s12
s_lshl_b32 s35, s60, 13
s_lshl_b32 s61, s21, 7
s_add_u32 s35, s35, s61
v_lshlrev_b32 v24, 10, v18
v_lshl_add_u32 v24, v16, 4, v24
v_add_u32 v24, s35, v24
v_add_u32 v32, 0x100000, v24
s_getreg_b32 s98, hwreg(HW_REG_XCC_ID)
v_lshlrev_b32 v194, 2, v17
s_and_b32 s98, s98, 7
s_add_u32 s98, s98, 1
v_lshrrev_b32 v23, 5, v17
s_lshl_b32 s43, s20, 12
s_add_u32 s43, s43, s15
s_lshr_b32 s42, s21, 1
s_lshl_b32 s42, s42, 9
s_add_u32 s42, s42, s43
s_and_b32 s60, s21, 1
s_lshl_b32 s60, s60, 3
s_add_u32 s42, s42, s60
s_lshl_b32 s60, s12, 7
v_lshl_add_u32 v8, v18, 4, s60
v_and_b32 v22, 48, v17
v_lshl_add_u32 v7, v22, 5, v8
v_and_or_b32 v7, v17, 8, v7
v_lshl_add_u32 v8, v23, 2, v8
s_mov_b32 s36, 0xffff0000
s_add_u32 s3, s37, 512
s_mov_b32 s101, s37
s_lshr_b32 s60, s19, 4
s_lshl_b32 s60, s60, 8
s_add_u32 s37, s37, s60
s_lshl_b32 s45, s13, 4
s_lshl_b32 s60, s12, 2
s_add_u32 s45, s45, s60
s_add_u32 s45, s45, s37

v_mul_u32_u24 v59, 1040, v18
v_lshl_add_u32 v59, v19, 2, v59
v_add_u32 v84, 87184, v59
v_add_u32 v59, 78464, v59
v_and_b32 v57, 7, v19
v_lshlrev_b32 v57, 12, v57
v_and_b32 v22, 8, v19
v_lshl_add_u32 v57, v22, 13, v57
v_lshlrev_b32 v22, 4, v18
v_sub_u32 v57, v57, v22
s_lshl_b32 s61, s19, 7
s_sub_u32 s60, 4080, s61
v_add_u32 v57, s60, v57
s_lshl_b32 s60, s70, 21
s_add_u32 s76, s76, s60
s_add_u32 s76, s76, 393216
s_add_u32 s68, s76, 32768
s_lshl_b32 s69, s12, 7
s_lshl_b32 s61, s19, 2
s_add_u32 s69, s69, s61
s_add_u32 s69, s69, s3
s_mul_i32 s60, s70, 33280
s_lshl_b32 s61, s71, 11
s_add_u32 s62, s60, s61
v_add_u32 v58, s62, v1
s_mov_b32 s17, 1
v_mov_b32 v195, 1

v_and_b32 v22, 31, v17
v_min_u32 v22, 29, v22
v_lshlrev_b32 v22, 4, v22
v_mul_u32_u24 v21, 4576, v23
v_add_u32 v22, v22, v21
v_add_u32 v22, 66560, v22
ds_write_b128 v22, v[48:51] offset:4096
v_and_b32 v20, 15, v17
v_mul_u32_u24 v22, 4160, v20
ds_write_b128 v22, v[48:51]

v_and_b32 v19, 7, v17
v_lshrrev_b32 v21, 4, v17
v_mul_u32_u24 v40, 4160, v19
v_lshrrev_b32 v22, 3, v20
v_add_u32 v22, v22, v21
v_lshl_add_u32 v40, v22, 4, v40
s_mul_i32 s60, s70, 33280
s_lshl_b32 s61, s71, 8
s_add_u32 s60, s60, s61
v_add_u32 v40, s60, v40
v_lshlrev_b32 v22, 1, v20
v_sub_u32 v22, v21, v22
v_lshlrev_b32 v22, 4, v22
s_mul_i32 s60, s70, 4576
s_add_u32 s60, s60, s61
s_add_u32 s60, s60, 67040
v_add_u32 v44, s60, v22
v_lshrrev_b32 v22, 2, v20
s_lshl_b32 s60, s12, 2
v_add3_u32 v22, v22, s60, 1
v_and_b32 v22, 15, v22
v_lshlrev_b32 v45, 21, v22
v_bfe_u32 v22, v20, 1, 1
v_lshl_add_u32 v45, v22, 16, v45
v_and_b32 v22, 1, v20
v_lshl_add_u32 v45, v22, 6, v45
v_lshl_add_u32 v45, v21, 4, v45
s_lshl_b32 s78, s50, 7
s_add_u32 s78, s78, 1835008
s_add_u32 s79, s78, 32768
v_lshlrev_b32 v85, 3, v17

s_bfe_u32 s61, s13, 0x10002
s_mul_i32 s61, s61, 31
s_lshl_b32 s60, s71, 4
s_add_u32 s60, s60, s81
s_cmp_eq_u32 s61, s60
s_cselect_b32 s72, 0, -1
s_lshl_b32 s73, s13, 11
s_lshl_b32 s61, s70, 10
s_add_u32 s73, s73, s61
s_lshl_b32 s61, s71, 15
s_add_u32 s73, s73, s61
s_add_u32 s73, s73, s15
s_add_u32 s73, s73, 1245184
s_mul_i32 s60, s70, 4576
s_lshl_b32 s61, s71, 11
s_add_u32 s60, s60, s61
s_add_u32 s99, s60, 66560

v_lshlrev_b32 v22, 3, v21
v_add_u32 v22, v22, v20
v_sub_u32 v22, 15, v22
v_and_b32 v189, 1, v22
v_lshlrev_b32 v189, 4, v189
v_ashrrev_i32 v188, 1, v22
v_lshl_or_b32 v188, s71, 4, v188
v_bfe_u32 v22, v17, 2, 3
v_and_b32 v19, 3, v17
v_lshlrev_b32 v42, 6, v23
v_lshl_add_u32 v42, v19, 4, v42
s_lshl_b32 s60, s21, 7
v_add_u32 v42, s60, v42
v_lshl_add_u32 v42, v22, 10, v42
v_and_b32 v22, 12, v17
v_lshlrev_b32 v22, 4, v22
v_lshl_add_u32 v41, v19, 3, v22
v_lshl_add_u32 v43, v19, 4, v22
v_mul_u32_u24 v22, 1056, v23
v_xor_b32 v43, v22, v43
v_and_b32 v22, 16, v17
v_lshl_add_u32 v43, v22, 5, v43
s_lshl2_add_u32 s60, s46, 77824
v_add_u32 v43, s60, v43
v_and_b32 v22, 48, v17
v_lshl_add_u32 v41, v22, 6, v41
s_lshl_b32 s60, s70, 9
s_lshl_b32 s61, s71, 5
s_add_u32 s60, s60, s61
s_add_u32 s60, s60, 98304
v_add_u32 v41, s60, v41
v_and_b32 v22, 16, v17
v_lshlrev_b32 v22, 1, v22
v_xor_b32 v41, v22, v41
s_lshl_b32 s80, s12, 15
s_lshr_b32 s60, s21, 1
s_lshl_b32 s60, s60, 17
s_add_u32 s48, s80, s60
s_lshl_b32 s60, s20, 17
s_add_u32 s80, s80, s60
s_mul_i32 s49, s12, 458752

s_mul_i32 s62, s20, 229376
s_mul_i32 s60, s12, 28672
s_add_u32 s62, s62, s60
s_add_u32 s62, s62, s15
s_add_u32 s62, s62, 1310720
s_lshl_b32 s60, s62, 4
s_sub_u32 s49, s49, s60
s_add_u32 s63, s62, 28672
s_mul_i32 s60, s18, 4096
s_add_u32 s60, s60, s62
s_cmp_lt_u32 s60, s63
s_cselect_b32 s74, s60, s62
s_add_u32 s60, s74, 4096
s_cmp_lt_u32 s60, s63
s_cselect_b32 s0, s60, s62
s_add_u32 s60, s0, 4096
s_cmp_lt_u32 s60, s63
s_cselect_b32 s1, s60, s62
s_add_u32 s60, s1, 4096
s_cmp_lt_u32 s60, s63
s_cselect_b32 s82, s60, s62
s_add_u32 s60, s82, 4096
s_cmp_lt_u32 s60, s63
s_cselect_b32 s83, s60, s62
s_add_u32 s60, s83, 4096
s_cmp_lt_u32 s60, s63
s_cselect_b32 s44, s60, s62
s_add_u32 s60, s44, 4096
s_cmp_lt_u32 s60, s63
s_cselect_b32 s100, s60, s62
s_add_u32 s60, s100, 4096
v_and_b32 v2, 7, v17
v_lshl_add_u32 v2, s12, 3, v2
v_lshlrev_b32 v3, 9, v16
v_lshl_add_u32 v3, v2, 4, v3
v_lshlrev_b32 v47, 9, v16
v_lshl_add_u32 v2, v2, 2, v47
v_add_u32 v2, 151552, v2
s_lshr_b32 s64, s21, 1
s_lshr_b32 s16, s64, 1
s_add_u32 s16, s16, 1
s_sub_u32 s39, 0, s16
s_bitcmp1_b32 s64, 0
s_cselect_b32 s16, s39, s16
s_lshl_b32 s39, s20, 5
s_add_u32 s39, s39, s16
v_and_b32 v46, 31, v17
v_add_u32 v46, s39, v46
v_lshrrev_b32 v47, 5, v46
v_lshlrev_b32 v47, 16, v47
v_and_b32 v22, 31, v46
v_lshl_add_u32 v47, v22, 4, v47
v_lshl_add_u32 v47, v23, 9, v47
v_mov_b32 v15, 2147483648
v_cmp_gt_u32 vcc, 64, v46
v_and_b32 v22, 1, v46
v_lshlrev_b32 v22, 4, v22
v_cndmask_b32 v4, v15, v47, vcc
v_lshl_add_u32 v22, v23, 5, v22
v_cndmask_b32 v5, v22, v15, vcc
s_add_u32 s65, s15, 573440
s_ashr_i32 s16, s16, 31
s_or_b32 s16, s16, 1
s_add_u32 s39, s16, s14
s_and_b32 s39, s39, 15
s_lshr_b32 s27, s39, 1
s_cmp_lg_u32 s27, s18
s_cselect_b32 s27, 1, 0
s_xor_b32 s66, s64, s20
s_and_b32 s27, s27, s66
s_add_u32 s16, s16, s81
s_lshl_b32 s39, s39, 21
s_lshl_b32 s41, s21, 12
s_add_u32 s41, s41, s46
s_add_u32 s39, s39, s41
s_add_u32 s39, s39, 1245184
s_add_u32 s41, s41, s15
s_add_u32 s41, s41, 131072
s_and_b32 s66, s16, 16
s_lshl_b32 s66, s66, 11
s_add_u32 s32, s39, s66
s_xor_b32 s33, s32, 32768
s_cmp_lt_u32 s16, 32
s_cselect_b32 s32, s32, s65
s_add_u32 s16, s16, 16
s_cmp_lt_u32 s16, 32
s_cselect_b32 s33, s33, s65
s_cmp_eq_u32 s20, 0
s_cselect_b32 s30, 3, 0xc0000000
s_lshl_b32 s39, s20, 16
s_sub_u32 s39, 1114112, s39
s_mov_b32 s31, s30
v_and_b32 v22, 1, v17
v_lshl_add_u32 v47, v22, 4, s39
v_lshl_add_u32 v47, v23, 5, v47
v_cndmask_b32 v6, v1, v47, s[30:31]
v_and_b32 v22, 2, v16
v_lshlrev_b32 v22, 6, v22
v_xor_b32 v47, v3, v22
v_add_u32 v12, 114688, v47
s_add_u32 s23, s47, 114688
v_and_b32 v22, 3, v16
v_lshl_add_u32 v0, v22, 2, v1
v_add_u32 v0, s23, v0
s_lshl_b32 s22, s20, 16
s_add_u32 s22, s22, s15
s_add_u32 s22, s22, s47
s_lshl_b32 s47, s64, 13
s_add_u32 s47, s47, s22
s_lshl_b32 s60, s20, 13
s_add_u32 s22, s22, s60
s_lshl_b32 s24, s71, 7
s_add_u32 s24, s24, s46
s_add_u32 s24, s24, 155648
s_and_b32 s25, s21, 1
s_lshl_b32 s25, s25, 12
s_add_u32 s25, s25, s46
s_add_u32 s25, s25, 114688
s_lshl_b32 s26, s12, 6
s_add_u32 s26, s26, 161792
v_lshrrev_b32 v47, 4, v17
v_bfe_u32 v22, v17, 1, 1
v_cmp_eq_u32 s[28:29], s12, v47
v_cmp_eq_u32 vcc, s20, v22
v_bfe_u32 v22, v17, 2, 3
v_lshl_add_u32 v22, v23, 4, v22
v_mul_u32_u24 v22, 224, v22
s_and_b64 s[28:29], s[28:29], vcc
v_and_b32 v15, 15, v17
v_lshlrev_b32 v15, 4, v15
v_lshl_add_u32 v23, v47, 9, v15
v_add_u32 v23, 114688, v23
v_and_b32 v15, 3, v17
v_lshl_add_u32 v22, v15, 3, v22
s_mul_i32 s39, s70, 57344
s_lshl_b32 s60, s71, 7
s_add_u32 s60, s60, s39
s_add_u32 s39, s39, 96
v_add_u32 v13, s60, v22
v_add_u32 v14, s39, v22
v_mul_u32_u24 v47, 4682, v17
v_lshrrev_b32 v47, 16, v47
v_mul_u32_u24 v47, 3360, v47
v_add_u32 v16, v47, v1
s_mul_i32 s16, s70, 57344
s_mul_i32 s60, s71, 14336
s_add_u32 s16, s16, s60
s_mul_i32 s60, s13, 224
s_add_u32 s16, s16, s60
s_mul_i32 s39, s12, 1792
v_xor_b32 v11, 32, v42
v_add_u32 v11, 7168, v11
v_lshlrev_b32 v15, 3, v1
s_add_u32 s63, s34, 1835008
buffer_store_dwordx4 v[52:55], v1, s[4:7], s63 offen sc1
s_add_u32 s63, s34, 1867776
buffer_store_dwordx4 v[52:55], v1, s[4:7], s63 offen sc1
global_load_dwordx4 v[28:31], v24, s[94:95] nt
global_load_dwordx4 v[36:39], v32, s[94:95] nt
s_cmp_lg_u32 s77, 0
s_cbranch_scc1 skip_7
s_waitcnt vmcnt(14)
v_mov_b32 v87, s98
s_mov_b64 exec, 1
global_store_dword v86, v87, s[92:93]
global_store_dword v86, v87, s[92:93] offset:128 sc1
s_mov_b64 exec, 0xff
buffer_load_dword v87, v56, s[4:7], s101 offen sc1
s_mov_b64 exec, -1
skip_7:
s_waitcnt vmcnt(13)
v_lshlrev_b32 v88, 16, v80
v_lshlrev_b32 v89, 16, v82
v_and_b32 v90, s36, v80
v_and_b32 v91, s36, v82
v_lshlrev_b32 v92, 16, v81
v_lshlrev_b32 v93, 16, v83
v_and_b32 v94, s36, v81
v_and_b32 v95, s36, v83
s_mov_b64 exec, 0
s_branch pe_0
pe_back:
s_mov_b64 exec, -1
s_waitcnt vmcnt(9)
s_waitcnt lgkmcnt(0)
s_barrier
ds_read2_b32 v[60:61], v59 offset0:0 offset1:32
ds_read2_b32 v[62:63], v59 offset0:64 offset1:100
ds_read2_b32 v[64:65], v59 offset0:132 offset1:164
ds_read2_b32 v[66:67], v59 offset0:196 offset1:228
ds_read_b32 v68, v59 offset:1040
ds_read_b32 v69, v59 offset:1168
ds_read_b32 v70, v59 offset:1296
ds_read2_b32 v[72:73], v84 offset0:0 offset1:32
ds_read2_b32 v[74:75], v84 offset0:64 offset1:96
ds_read2_b32 v[76:77], v84 offset0:128 offset1:160
ds_read2_b32 v[78:79], v84 offset0:192 offset1:224
s_waitcnt lgkmcnt(10)
v_lshlrev_b32 v96, 16, v60
v_and_b32 v97, s36, v60
v_lshlrev_b32 v98, 16, v61
v_and_b32 v99, s36, v61
s_waitcnt lgkmcnt(9)
v_lshlrev_b32 v100, 16, v62
v_and_b32 v101, s36, v62
v_lshlrev_b32 v102, 16, v63
v_and_b32 v103, s36, v63
s_waitcnt lgkmcnt(8)
v_lshlrev_b32 v104, 16, v64
v_and_b32 v105, s36, v64
v_lshlrev_b32 v106, 16, v65
v_and_b32 v107, s36, v65
s_waitcnt lgkmcnt(7)
v_lshlrev_b32 v108, 16, v66
v_and_b32 v109, s36, v66
v_lshlrev_b32 v110, 16, v67
s_and_b32 s63, s77, 63
s_mul_i32 s63, s63, 768
s_add_u32 s75, s63, s15
s_add_u32 s75, s75, 524288
s_mov_b32 exec_hi, 0xffff
buffer_store_dwordx4 v[52:55], v1, s[4:7], s75 offen sc1
s_mov_b32 exec_hi, -1
v_and_b32 v111, s36, v67
s_waitcnt lgkmcnt(6)
v_lshlrev_b32 v112, 16, v68
v_and_b32 v113, s36, v68
s_waitcnt lgkmcnt(5)
v_lshlrev_b32 v114, 16, v69
v_and_b32 v115, s36, v69
s_waitcnt lgkmcnt(4)
v_lshlrev_b32 v116, 16, v70
v_and_b32 v117, s36, v70
v_pk_mul_f32 v[134:135], v[96:97], v[94:95]
v_pk_fma_f32 v[134:135], v[98:99], v[92:93], v[134:135]
v_pk_fma_f32 v[134:135], v[100:101], v[90:91], v[134:135]
v_pk_fma_f32 v[134:135], v[102:103], v[88:89], v[134:135]
v_pk_mul_f32 v[136:137], v[98:99], v[94:95]
v_pk_fma_f32 v[136:137], v[100:101], v[92:93], v[136:137]
v_pk_fma_f32 v[136:137], v[102:103], v[90:91], v[136:137]
v_pk_fma_f32 v[136:137], v[104:105], v[88:89], v[136:137]
v_pk_mul_f32 v[138:139], v[100:101], v[94:95]
v_mov_b32 v192, s72
s_mov_b32 exec_hi, 0
buffer_store_dword v192, v194, s[4:7], s73 offen sc1
s_mov_b32 exec_hi, -1
v_pk_fma_f32 v[138:139], v[102:103], v[92:93], v[138:139]
v_pk_fma_f32 v[138:139], v[104:105], v[90:91], v[138:139]
v_pk_fma_f32 v[138:139], v[106:107], v[88:89], v[138:139]
v_pk_mul_f32 v[140:141], v[102:103], v[94:95]
v_pk_fma_f32 v[140:141], v[104:105], v[92:93], v[140:141]
v_pk_fma_f32 v[140:141], v[106:107], v[90:91], v[140:141]
v_pk_fma_f32 v[140:141], v[108:109], v[88:89], v[140:141]
v_pk_mul_f32 v[142:143], v[104:105], v[94:95]
v_pk_fma_f32 v[142:143], v[106:107], v[92:93], v[142:143]
v_pk_fma_f32 v[142:143], v[108:109], v[90:91], v[142:143]
v_pk_fma_f32 v[142:143], v[110:111], v[88:89], v[142:143]
v_pk_mul_f32 v[144:145], v[106:107], v[94:95]
v_pk_fma_f32 v[144:145], v[108:109], v[92:93], v[144:145]
v_pk_fma_f32 v[144:145], v[110:111], v[90:91], v[144:145]
v_pk_fma_f32 v[144:145], v[112:113], v[88:89], v[144:145]
v_pk_mul_f32 v[146:147], v[108:109], v[94:95]
global_load_dword v186, v[186:187], off
v_pk_fma_f32 v[146:147], v[110:111], v[92:93], v[146:147]
v_pk_fma_f32 v[146:147], v[112:113], v[90:91], v[146:147]
v_pk_fma_f32 v[146:147], v[114:115], v[88:89], v[146:147]
v_pk_mul_f32 v[148:149], v[110:111], v[94:95]
v_pk_fma_f32 v[148:149], v[112:113], v[92:93], v[148:149]
v_pk_fma_f32 v[148:149], v[114:115], v[90:91], v[148:149]
v_pk_fma_f32 v[148:149], v[116:117], v[88:89], v[148:149]
s_waitcnt lgkmcnt(3)
v_lshlrev_b32 v118, 16, v72
v_and_b32 v119, s36, v72
v_lshlrev_b32 v120, 16, v73
v_and_b32 v121, s36, v73
s_waitcnt lgkmcnt(2)
v_lshlrev_b32 v122, 16, v74
v_and_b32 v123, s36, v74
v_lshlrev_b32 v124, 16, v75
v_and_b32 v125, s36, v75
s_waitcnt lgkmcnt(1)
v_lshlrev_b32 v126, 16, v76
v_lshlrev_b32 v192, 3, v1
s_lshl_b32 s38, s2, 2
s_add_u32 s38, s38, s12
s_mul_i32 s38, s38, 512
s_mov_b64 exec, 0xf
buffer_load_dword v193, v192, s[84:87], s38 offen
s_mov_b64 exec, -1
v_and_b32 v127, s36, v76
pe_0:
s_cbranch_execz pe_back
v_lshlrev_b32 v128, 16, v77
v_and_b32 v129, s36, v77
s_waitcnt lgkmcnt(0)
v_lshlrev_b32 v130, 16, v78
v_and_b32 v131, s36, v78
v_lshlrev_b32 v132, 16, v79
v_and_b32 v133, s36, v79
v_pk_mul_f32 v[134:135], v[134:135], v[118:119]
v_pk_mul_f32 v[136:137], v[136:137], v[120:121]
v_pk_mul_f32 v[138:139], v[138:139], v[122:123]
v_pk_mul_f32 v[140:141], v[140:141], v[124:125]
v_pk_mul_f32 v[142:143], v[142:143], v[126:127]
v_pk_mul_f32 v[144:145], v[144:145], v[128:129]
v_pk_mul_f32 v[146:147], v[146:147], v[130:131]
v_pk_mul_f32 v[148:149], v[148:149], v[132:133]
v_lshlrev_b32 v192, 6, v1
s_sub_u32 s60, 384, s84
s_and_b32 s60, s60, 0x380
s_mul_i32 s38, s77, 4096
s_add_u32 s38, s38, s60
s_mov_b64 exec, 0xf
buffer_load_dword v193, v192, s[84:87], s38 offen
s_mov_b64 exec, -1
v_cvt_pk_bf16_f32 v152, v148, v146
v_cvt_pk_bf16_f32 v153, v144, v142
v_cvt_pk_bf16_f32 v154, v140, v138
v_cvt_pk_bf16_f32 v155, v136, v134
buffer_store_dwordx4 v[152:155], v57, s[4:7], s76 offen
v_cvt_pk_bf16_f32 v156, v149, v147
v_cvt_pk_bf16_f32 v157, v145, v143
v_cvt_pk_bf16_f32 v158, v141, v139
v_cvt_pk_bf16_f32 v159, v137, v135
buffer_store_dwordx4 v[156:159], v57, s[4:7], s68 offen
global_load_dword v148, v86, s[92:93] sc1
s_mov_b32 s62, 573440
v_and_b32 v192, -2097152, v45
buffer_load_dword v193, v192, s[4:7], s62 offen sc1
s_waitcnt vmcnt(16)
ds_write_b128 v58, v[164:167] offset:29136
s_waitcnt vmcnt(14)
ds_write_b128 v58, v[162:165] offset:12496
v_mov_b32 v96, v161
v_mov_b32 v97, v162
v_mov_b32 v98, v163
v_mov_b32 v99, v164
s_lshl2_add_u32 m0, s46, 98304
s_xor_b32 s38, s48, 0
buffer_load_dwordx4 v42, s[84:87], s38 offen offset:0 lds
v_mov_b32 v100, v165
v_mov_b32 v101, v166
ds_write_b128 v58, v[96:99] offset:4176
ds_write_b128 v58, v[98:101] offset:20816
v_alignbit_b32 v102, v161, v160, 16
v_alignbit_b32 v103, v162, v161, 16
v_alignbit_b32 v104, v163, v162, 16
buffer_load_dwordx4 v11, s[84:87], s38 offen offset:1024 lds
v_alignbit_b32 v105, v164, v163, 16
v_alignbit_b32 v106, v165, v164, 16
v_alignbit_b32 v107, v166, v165, 16
ds_write_b128 v58, v[102:105] offset:16
ds_write_b128 v58, v[104:107] offset:16656
v_alignbit_b32 v108, v162, v161, 16
s_add_u32 s38, s38, 14336
buffer_load_dwordx4 v42, s[84:87], s38 offen offset:2048 lds
v_alignbit_b32 v109, v163, v162, 16
v_alignbit_b32 v110, v164, v163, 16
v_alignbit_b32 v111, v165, v164, 16
v_alignbit_b32 v112, v166, v165, 16
v_alignbit_b32 v113, v167, v166, 16
ds_write_b128 v58, v[108:111] offset:8336
ds_write_b128 v58, v[110:113] offset:24976
buffer_load_dwordx4 v11, s[84:87], s38 offen offset:3072 lds
ds_write_b128 v58, v[172:175] offset:30160
s_waitcnt vmcnt(17)
ds_write_b128 v58, v[170:173] offset:13520
v_mov_b32 v114, v169
v_mov_b32 v115, v170
v_mov_b32 v116, v171
v_mov_b32 v117, v172
v_mov_b32 v118, v173
s_lshl2_add_u32 m0, s46, 114688
s_xor_b32 s38, s48, 131072
buffer_load_dwordx4 v42, s[84:87], s38 offen offset:0 lds
v_mov_b32 v119, v174
ds_write_b128 v58, v[114:117] offset:5200
ds_write_b128 v58, v[116:119] offset:21840
v_alignbit_b32 v120, v169, v168, 16
v_alignbit_b32 v121, v170, v169, 16
v_alignbit_b32 v122, v171, v170, 16
buffer_load_dwordx4 v11, s[84:87], s38 offen offset:1024 lds
v_alignbit_b32 v123, v172, v171, 16
v_alignbit_b32 v124, v173, v172, 16
v_alignbit_b32 v125, v174, v173, 16
ds_write_b128 v58, v[120:123] offset:1040
ds_write_b128 v58, v[122:125] offset:17680
v_alignbit_b32 v126, v170, v169, 16
v_alignbit_b32 v127, v171, v170, 16
s_add_u32 s38, s38, 14336
buffer_load_dwordx4 v42, s[84:87], s38 offen offset:2048 lds
v_alignbit_b32 v128, v172, v171, 16
v_alignbit_b32 v129, v173, v172, 16
v_alignbit_b32 v130, v174, v173, 16
v_alignbit_b32 v131, v175, v174, 16
ds_write_b128 v58, v[126:129] offset:9360
ds_write_b128 v58, v[128:131] offset:26000
buffer_load_dwordx4 v11, s[84:87], s38 offen offset:3072 lds
s_waitcnt vmcnt(9)
v_readfirstlane_b32 s60, v148
s_nop 0
s_cmp_lg_u32 s60, s98
s_cbranch_scc1 ann_8
annx_9:
s_mov_b64 exec, 1
buffer_store_dword v195, v194, s[4:7], s69 offen
s_mov_b64 exec, -1
annx_9b:
s_lshl2_add_u32 m0, s46, 131072
s_xor_b32 s38, s48, 262144
buffer_load_dwordx4 v42, s[84:87], s38 offen offset:0 lds
buffer_load_dwordx4 v11, s[84:87], s38 offen offset:1024 lds
s_add_u32 s38, s38, 14336
buffer_load_dwordx4 v42, s[84:87], s38 offen offset:2048 lds
buffer_load_dwordx4 v11, s[84:87], s38 offen offset:3072 lds
s_lshl2_add_u32 m0, s46, 147456
s_xor_b32 s38, s48, 393216
buffer_load_dwordx4 v42, s[84:87], s38 offen offset:0 lds
buffer_load_dwordx4 v11, s[84:87], s38 offen offset:1024 lds
s_add_u32 s38, s38, 14336
buffer_load_dwordx4 v42, s[84:87], s38 offen offset:2048 lds
buffer_load_dwordx4 v11, s[84:87], s38 offen offset:3072 lds
s_cmp_lg_u32 s77, 0
s_cbranch_scc1 skip_13
v_and_b32 v149, 28, v194
global_load_dword v149, v149, s[92:93] offset:128 sc1
skip_13:
buffer_load_dwordx2 v[150:151], v85, s[4:7], s3 offen sc1
s_mov_b32 m0, s99
s_lshl_b32 s60, s70, 4
v_bfe_u32 v186, v186, s60, 16
v_lshlrev_b32 v186, v189, v186
v_readfirstlane_b32 s8, v190
v_readfirstlane_b32 s9, v191
v_cmp_eq_u32 vcc, 0, v188
s_nop 1
v_cndmask_b32 v144, 0, v186, vcc
v_cmp_eq_u32 vcc, 1, v188
s_nop 1
v_cndmask_b32 v145, 0, v186, vcc
v_cmp_eq_u32 vcc, 2, v188
s_nop 1
v_cndmask_b32 v146, 0, v186, vcc
v_cmp_eq_u32 vcc, 3, v188
s_nop 1
v_cndmask_b32 v147, 0, v186, vcc
s_mov_b64 exec, 0
s_cmp_eq_u32 s12, 0
s_cbranch_scc1 pg_0
s_cmp_eq_u32 s12, 1
s_cbranch_scc1 pg_1
s_cmp_eq_u32 s12, 2
s_cbranch_scc1 pg_2
s_branch pg_3
pg_back:
s_mov_b64 exec, -1
s_mov_b32 s61, 0
s_waitcnt vmcnt(0)
upoll_10:
v_min_u32 v150, v150, v151
v_cmp_eq_u32 vcc, 0, v150
s_add_u32 s61, s61, 1
s_cbranch_vccz upollx_11
s_and_b32 s63, s61, 15
s_cselect_b32 s60, 0, s17
s_cmp_lg_u32 s60, 0
s_cbranch_scc1 uslow_12
upoll_10b:
s_cmp_gt_u32 s61, 200000
s_cbranch_scc1 upollx_11
buffer_load_dwordx2 v[150:151], v85, s[4:7], s3 offen sc1
s_waitcnt vmcnt(0)
s_branch upoll_10
upollx_11:
buffer_load_dwordx4 v1, s[4:7], s67 offen sc1 lds
buffer_load_dwordx4 v1, s[4:7], s67 offen offset:1024 sc1 lds
s_cmp_lg_u32 s77, 0
s_cbranch_scc1 skip_15
s_mov_b32 s61, 0
gt_14:
v_cmp_eq_u32 vcc, 0, v149
s_add_u32 s61, s61, 1
s_cbranch_vccz gt_14_ok
v_and_b32 v149, 28, v194
global_load_dword v149, v149, s[92:93] offset:128 sc1
s_waitcnt vmcnt(0)
s_cmp_gt_u32 s61, 200000
s_cbranch_scc0 gt_14
gt_14_ok:
v_lshlrev_b32 v149, 18, v1
s_lshl_b32 s60, s18, 7
s_add_u32 s60, s60, 591872
s_mov_b64 exec, 0xff
buffer_store_dword v195, v149, s[4:7], s60 offen sc1
s_mov_b64 exec, -1
skip_15:
s_cmp_eq_u32 s17, 0
s_cbranch_scc1 slow_3
v_mov_b32 v152, -1
v_mov_b32 v153, -1
v_mov_b32 v154, -1
v_mov_b32 v155, -1
v_lshlrev_b32 v46, 3, v1
s_mov_b64 exec, 0x3f
buffer_load_dword v47, v46, s[4:7], s75 offen sc1
s_mov_b64 exec, -1
v_lshlrev_b32 v24, 16, v28
v_and_b32 v25, s36, v28
v_pk_mul_f32 v[150:151], v[24:25], v[24:25]
v_lshlrev_b32 v26, 16, v29
v_and_b32 v27, s36, v29
v_pk_add_f32 v[148:149], v[24:25], v[26:27]
v_pk_fma_f32 v[150:151], v[26:27], v[26:27], v[150:151] op_sel:[0,0,0] op_sel_hi:[1,1,1]
v_lshlrev_b32 v28, 16, v30
v_and_b32 v29, s36, v30
v_pk_add_f32 v[148:149], v[148:149], v[28:29]
v_pk_fma_f32 v[150:151], v[28:29], v[28:29], v[150:151] op_sel:[0,0,0] op_sel_hi:[1,1,1]
v_lshlrev_b32 v30, 16, v31
v_and_b32 v31, s36, v31
v_pk_add_f32 v[148:149], v[148:149], v[30:31]
v_pk_fma_f32 v[150:151], v[30:31], v[30:31], v[150:151] op_sel:[0,0,0] op_sel_hi:[1,1,1]
v_add_f32 v148, v148, v149
v_add_f32 v150, v150, v151
v_lshlrev_b32 v32, 16, v36
v_and_b32 v33, s36, v36
v_permlane32_swap_b32 v148, v150
v_add_f32 v148, v148, v150
v_mov_b32 v150, v148
v_lshlrev_b32 v34, 16, v37
v_and_b32 v35, s36, v37
v_permlane16_swap_b32 v148, v150
v_add_f32 v148, v148, v150
v_lshlrev_b32 v36, 16, v38
v_and_b32 v37, s36, v38
v_add_f32_dpp v148, v148, v148 row_ror:8 row_mask:0xf bank_mask:0xf
v_lshlrev_b32 v38, 16, v39
v_and_b32 v39, s36, v39
s_lshl_b32 s60, s12, 12
s_add_u32 s60, s60, 131072
v_add_u32 v20, s60, v1
s_add_u32 s60, s46, 131072
v_add_u32 v21, s60, v1
v_pk_add_f32 v[156:157], v[32:33], v[34:35]
v_pk_mul_f32 v[158:159], v[32:33], v[32:33]
v_pk_fma_f32 v[158:159], v[34:35], v[34:35], v[158:159] op_sel:[0,0,0] op_sel_hi:[1,1,1]
v_pk_add_f32 v[156:157], v[156:157], v[36:37]
v_pk_fma_f32 v[158:159], v[36:37], v[36:37], v[158:159] op_sel:[0,0,0] op_sel_hi:[1,1,1]
v_pk_add_f32 v[156:157], v[156:157], v[38:39]
v_pk_fma_f32 v[158:159], v[38:39], v[38:39], v[158:159] op_sel:[0,0,0] op_sel_hi:[1,1,1]
v_add_f32 v156, v156, v157
v_add_f32 v158, v158, v159
s_and_b32 s76, s77, 63
s_mul_i32 s76, s76, 7168
s_add_u32 s76, s76, s15
v_permlane32_swap_b32 v156, v158
v_add_f32 v156, v156, v158
v_mov_b32 v158, v156
s_barrier
s_nop 0
v_permlane16_swap_b32 v156, v158
v_add_f32 v156, v156, v158
ds_read_b64_tr_b16 v[160:161], v41 offset:0
ds_read_b64_tr_b16 v[162:163], v41 offset:256
v_add_f32_dpp v156, v156, v156 row_ror:8 row_mask:0xf bank_mask:0xf
ds_read_b64_tr_b16 v[164:165], v41 offset:4096
ds_read_b64_tr_b16 v[166:167], v41 offset:4352
ds_read_b64_tr_b16 v[168:169], v41 offset:8192
ds_read_b64_tr_b16 v[170:171], v41 offset:8448
ds_read_b64_tr_b16 v[172:173], v41 offset:12288
ds_read_b64_tr_b16 v[174:175], v41 offset:12544
ds_read_b64_tr_b16 v[176:177], v41 offset:16384
ds_read_b64_tr_b16 v[178:179], v41 offset:16640
ds_read_b64_tr_b16 v[180:181], v41 offset:20480
ds_read_b64_tr_b16 v[182:183], v41 offset:20736
s_waitcnt vmcnt(1)
s_waitcnt lgkmcnt(0)
s_barrier
ds_read_b128 v[96:99], v40 offset:128
ds_read_b128 v[128:131], v44 offset:3712
ds_read_b128 v[100:103], v40 offset:640
ds_read_b128 v[132:135], v44 offset:3200
ds_read_b128 v[104:107], v40 offset:1152
ds_read_b128 v[136:139], v44 offset:2688
ds_read_b128 v[108:111], v40 offset:1664
ds_read_b128 v[140:143], v44 offset:2176
ds_read_b128 v[240:243], v40 offset:192
ds_read_b128 a[240:243], v44 offset:3776
ds_read_b128 v[244:247], v40 offset:704
s_add_u32 s62, s34, 393216
buffer_store_dwordx4 v[152:155], v1, s[4:7], s62 offen
ds_read_b128 a[244:247], v44 offset:3264
ds_read_b128 v[248:251], v40 offset:1216
ds_read_b128 a[248:251], v44 offset:2752
s_add_u32 s62, s34, 425984
buffer_store_dwordx4 v[152:155], v1, s[4:7], s62 offen
ds_read_b128 v[252:255], v40 offset:1728
ds_read_b128 a[252:255], v44 offset:2240
s_add_u32 s62, s41, 0
buffer_store_dwordx4 v[152:155], v4, s[4:7], s62 offen sc1
ds_read_b128 v[80:83], v40 offset:0
ds_read_b128 v[112:115], v44 offset:3584
s_add_u32 s62, s41, 32768
buffer_store_dwordx4 v[152:155], v4, s[4:7], s62 offen sc1
ds_read_b128 v[84:87], v40 offset:512
ds_read_b128 v[116:119], v44 offset:3072
ds_read_b128 v[88:91], v40 offset:1024
ds_read_b128 v[120:123], v44 offset:2560
ds_read_b128 v[92:95], v40 offset:1536
ds_read_b128 v[124:127], v44 offset:2048
s_waitcnt lgkmcnt(15)
v_mfma_f32_16x16x32_bf16 v[48:51], v[96:99], v[128:131], 0
ds_read_b128 v[224:227], v40 offset:64
s_mul_i32 s50, s70, 81920
s_mul_i32 s65, s70, -114688
s_waitcnt lgkmcnt(15)
v_mfma_f32_16x16x32_bf16 v[52:55], v[96:99], v[132:135], 0
ds_read_b128 a[224:227], v44 offset:3648
s_add_u32 s65, s65, 57344
ds_read_b128 v[228:231], v40 offset:576
v_mfma_f32_16x16x32_bf16 v[52:55], v[100:103], v[128:131], v[52:55]
s_add_u32 s50, s50, s15
ds_read_b128 a[228:231], v44 offset:3136
s_lshl_b32 s60, s71, 8
s_add_u32 s50, s50, s60
ds_read_b128 v[232:235], v40 offset:1088
v_mfma_f32_16x16x32_bf16 v[56:59], v[100:103], v[132:135], 0
s_add_u32 s17, s49, 32768
s_and_b32 s92, s30, 0x80000001
ds_read_b128 a[232:235], v44 offset:2624
s_waitcnt lgkmcnt(15)
v_mfma_f32_16x16x32_bf16 v[56:59], v[96:99], v[136:139], v[56:59]
ds_read_b128 v[236:239], v40 offset:1600
s_mov_b32 s93, s92
s_cmp_eq_u32 s81, 15
s_cselect_b32 s66, s20, 0
ds_read_b128 a[236:239], v44 offset:2112
v_mfma_f32_16x16x32_bf16 v[60:63], v[100:103], v[136:139], 0
ds_read_b128 v[100:103], v40 offset:2560
s_lshl_b32 s51, s70, 12
s_add_u32 s51, s51, s15
v_mfma_f32_16x16x32_bf16 v[56:59], v[104:107], v[128:131], v[56:59]
ds_read_b128 v[136:139], v44 offset:512
s_mul_i32 s72, s70, 229376
s_mul_i32 s60, s13, 7168
s_add_u32 s72, s72, s60
v_mfma_f32_16x16x32_bf16 v[60:63], v[104:107], v[132:135], v[60:63]
ds_read_b128 v[132:135], v44 offset:1024
ds_read_b128 v[104:107], v40 offset:3072
s_waitcnt lgkmcnt(15)
v_mfma_f32_16x16x32_bf16 v[60:63], v[96:99], v[140:143], v[60:63]
ds_read_b128 v[96:99], v40 offset:2048
s_add_u32 s72, s72, s15
s_add_u32 s72, s72, 1310720
v_mfma_f32_16x16x32_bf16 v[60:63], v[108:111], v[128:131], v[60:63]
s_waitcnt vmcnt(2)
s_add_u32 s62, s42, 540672
buffer_store_dword v148, v8, s[4:7], s62 offen offset:0
s_add_u32 s62, s42, 540672
buffer_store_dword v156, v8, s[4:7], s62 offen offset:2048
ds_read_b128 v[128:131], v44 offset:1536
ds_read_b128 v[108:111], v40 offset:3584
v_lshlrev_b32 v46, 3, v1
s_lshl_b32 s38, s2, 2
s_add_u32 s38, s38, s12
s_mul_i32 s38, s38, 512
s_mov_b64 exec, 0xf
buffer_load_dword v47, v46, s[88:91], s38 offen
s_mov_b64 exec, -1
v_lshlrev_b32 v46, 3, v1
s_lshl_b32 s38, s2, 2
s_add_u32 s38, s38, s12
s_mul_i32 s38, s38, 1792
s_mov_b64 exec, 0x3fff
buffer_load_dword v47, v46, s[56:59], s38 offen
s_mov_b64 exec, -1
v_lshlrev_b32 v46, 3, v1
s_lshl_b32 s38, s2, 2
s_add_u32 s38, s38, s12
s_mul_i32 s38, s38, 1792
s_mov_b64 exec, 0x3fff
buffer_load_dword v47, v46, s[52:55], s38 offen
s_mov_b64 exec, -1
ds_read_b128 v[140:143], v44 offset:0
s_waitcnt lgkmcnt(15)
v_mfma_f32_16x16x32_bf16 v[48:51], v[240:243], a[240:243], v[48:51]
ds_read_b64_tr_b16 v[184:185], v41 offset:24576
ds_read_b64_tr_b16 v[186:187], v41 offset:24832
ds_read_b64_tr_b16 v[188:189], v41 offset:28672
s_waitcnt lgkmcnt(15)
v_mfma_f32_16x16x32_bf16 v[52:55], v[240:243], a[244:247], v[52:55]
ds_read_b64_tr_b16 v[190:191], v41 offset:28928
ds_read_b64_tr_b16 v[192:193], v41 offset:32768
ds_read_b64_tr_b16 v[194:195], v41 offset:33024
v_mfma_f32_16x16x32_bf16 v[52:55], v[244:247], a[240:243], v[52:55]
ds_read_b64_tr_b16 v[196:197], v41 offset:36864
ds_read_b64_tr_b16 v[198:199], v41 offset:37120
ds_read_b64_tr_b16 v[200:201], v41 offset:40960
v_mfma_f32_16x16x32_bf16 v[56:59], v[244:247], a[244:247], v[56:59]
ds_read_b64_tr_b16 v[202:203], v41 offset:41216
ds_read_b64_tr_b16 v[204:205], v41 offset:45056
ds_read_b64_tr_b16 v[206:207], v41 offset:45312
s_waitcnt lgkmcnt(15)
v_mfma_f32_16x16x32_bf16 v[56:59], v[240:243], a[248:251], v[56:59]
ds_read_b64_tr_b16 v[208:209], v41 offset:49152
ds_read_b64_tr_b16 v[210:211], v41 offset:49408
ds_read_b64_tr_b16 v[212:213], v41 offset:53248
v_mfma_f32_16x16x32_bf16 v[60:63], v[244:247], a[248:251], v[60:63]
ds_read_b128 v[244:247], v40 offset:2624
ds_read_b128 a[248:251], v44 offset:576
v_mfma_f32_16x16x32_bf16 v[56:59], v[248:251], a[240:243], v[56:59]
ds_read_b64_tr_b16 v[214:215], v41 offset:53504
ds_read_b64_tr_b16 v[216:217], v41 offset:57344
ds_read_b64_tr_b16 v[218:219], v41 offset:57600
v_mfma_f32_16x16x32_bf16 v[60:63], v[248:251], a[244:247], v[60:63]
ds_read_b128 a[244:247], v44 offset:1088
ds_read_b128 v[248:251], v40 offset:3136
s_waitcnt lgkmcnt(15)
v_mfma_f32_16x16x32_bf16 v[60:63], v[240:243], a[252:255], v[60:63]
ds_read_b128 v[240:243], v40 offset:2112
ds_read_b128 a[252:255], v44 offset:64
v_mfma_f32_16x16x32_bf16 v[60:63], v[252:255], a[240:243], v[60:63]
ds_read_b128 a[240:243], v44 offset:1600
ds_read_b128 v[252:255], v40 offset:3648
s_waitcnt lgkmcnt(15)
v_mfma_f32_16x16x32_bf16 v[48:51], v[80:83], v[112:115], v[48:51]
ds_read_b64_tr_b16 v[220:221], v41 offset:61440
ds_read_b64_tr_b16 v[222:223], v41 offset:61696
v_subrev_u32 v41, 36864, v41
s_waitcnt lgkmcnt(15)
v_mfma_f32_16x16x32_bf16 v[52:55], v[80:83], v[116:119], v[52:55]
s_add_u32 s73, s72, 3072
s_lshl_b32 s60, s71, 12
s_add_u32 s72, s72, s60
v_mfma_f32_16x16x32_bf16 v[52:55], v[84:87], v[112:115], v[52:55]
v_mfma_f32_16x16x32_bf16 v[56:59], v[84:87], v[116:119], v[56:59]
s_waitcnt lgkmcnt(15)
v_mfma_f32_16x16x32_bf16 v[56:59], v[80:83], v[120:123], v[56:59]
v_mfma_f32_16x16x32_bf16 v[60:63], v[84:87], v[120:123], v[60:63]
v_mfma_f32_16x16x32_bf16 v[56:59], v[88:91], v[112:115], v[56:59]
v_mfma_f32_16x16x32_bf16 v[60:63], v[88:91], v[116:119], v[60:63]
s_waitcnt lgkmcnt(15)
v_mfma_f32_16x16x32_bf16 v[60:63], v[80:83], v[124:127], v[60:63]
s_waitcnt lgkmcnt(0)
s_barrier
v_mfma_f32_16x16x32_bf16 v[60:63], v[92:95], v[112:115], v[60:63]
v_mfma_f32_16x16x32_bf16 v[48:51], v[144:147], v[112:115], v[48:51]
v_mfma_f32_16x16x32_bf16 v[52:55], v[144:147], v[116:119], v[52:55]
v_mfma_f32_16x16x32_bf16 v[56:59], v[144:147], v[120:123], v[56:59]
v_mfma_f32_16x16x32_bf16 v[60:63], v[144:147], v[124:127], v[60:63]
v_mfma_f32_16x16x32_bf16 v[48:51], v[224:227], a[224:227], v[48:51]
v_mfma_f32_16x16x32_bf16 v[52:55], v[224:227], a[228:231], v[52:55]
v_bfe_u32 v18, v1, 4, 3
v_lshlrev_b32 v18, 7, v18
buffer_load_dword v18, v18, s[4:7], s101 offen offset:2048 sc1
v_mfma_f32_16x16x32_bf16 v[52:55], v[228:231], a[224:227], v[52:55]
s_nop 0
ds_write_b128 v20, v[48:51] offset:16384
v_mfma_f32_16x16x32_bf16 v[56:59], v[228:231], a[228:231], v[56:59]
s_nop 4
ds_write_b128 v20, v[52:55] offset:17408
v_mfma_f32_16x16x32_bf16 v[56:59], v[224:227], a[232:235], v[56:59]
v_mfma_f32_16x16x32_bf16 v[60:63], v[228:231], a[232:235], v[60:63]
v_mfma_f32_16x16x32_bf16 v[56:59], v[232:235], a[224:227], v[56:59]
v_mfma_f32_16x16x32_bf16 v[60:63], v[232:235], a[228:231], v[60:63]
v_mfma_f32_16x16x32_bf16 v[60:63], v[224:227], a[236:239], v[60:63]
s_nop 1
ds_write_b128 v20, v[56:59] offset:18432
v_mfma_f32_16x16x32_bf16 v[60:63], v[236:239], a[224:227], v[60:63]
v_mfma_f32_16x16x32_bf16 v[64:67], v[88:91], v[120:123], 0
v_mfma_f32_16x16x32_bf16 v[64:67], v[84:87], v[124:127], v[64:67]
s_nop 1
ds_write_b128 v20, v[60:63] offset:19456
v_mfma_f32_16x16x32_bf16 v[68:71], v[88:91], v[124:127], 0
v_mfma_f32_16x16x32_bf16 v[64:67], v[92:95], v[116:119], v[64:67]
v_mfma_f32_16x16x32_bf16 v[68:71], v[92:95], v[120:123], v[68:71]
v_mfma_f32_16x16x32_bf16 v[72:75], v[92:95], v[124:127], 0
s_waitcnt lgkmcnt(0)
s_barrier
v_mfma_f32_16x16x32_bf16 v[64:67], v[80:83], v[128:131], v[64:67]
ds_read_b128 v[48:51], v21 offset:16384
ds_read_b128 v[52:55], v21 offset:20480
v_mfma_f32_16x16x32_bf16 v[68:71], v[84:87], v[128:131], v[68:71]
ds_read_b128 v[56:59], v21 offset:24576
ds_read_b128 v[60:63], v21 offset:28672
v_mfma_f32_16x16x32_bf16 v[72:75], v[88:91], v[128:131], v[72:75]
v_mfma_f32_16x16x32_bf16 v[76:79], v[92:95], v[128:131], 0
ds_read_b128 v[92:95], v40 offset:1664
v_mfma_f32_16x16x32_bf16 v[64:67], v[96:99], v[112:115], v[64:67]
v_mfma_f32_16x16x32_bf16 v[68:71], v[96:99], v[116:119], v[68:71]
s_waitcnt lgkmcnt(3)
v_add_f32 v48, v48, v52
v_add_f32 v49, v49, v53
v_mfma_f32_16x16x32_bf16 v[72:75], v[96:99], v[120:123], v[72:75]
v_add_f32 v50, v50, v54
v_add_f32 v51, v51, v55
v_mfma_f32_16x16x32_bf16 v[76:79], v[96:99], v[124:127], v[76:79]
ds_read_b128 v[124:127], v44 offset:2176
ds_read_b128 v[96:99], v40 offset:2176
v_mfma_f32_16x16x32_bf16 v[68:71], v[80:83], v[132:135], v[68:71]
s_waitcnt lgkmcnt(3)
v_add_f32 v56, v56, v60
v_add_f32 v57, v57, v61
v_mfma_f32_16x16x32_bf16 v[72:75], v[84:87], v[132:135], v[72:75]
v_add_f32 v58, v58, v62
v_add_f32 v59, v59, v63
v_mfma_f32_16x16x32_bf16 v[76:79], v[88:91], v[132:135], v[76:79]
ds_read_b128 v[88:91], v40 offset:1152
v_cvt_pk_bf16_f32 v52, v48, v56
v_cvt_pk_bf16_f32 v53, v49, v57
v_mfma_f32_16x16x32_bf16 v[68:71], v[100:103], v[112:115], v[68:71]
v_cvt_pk_bf16_f32 v54, v50, v58
v_cvt_pk_bf16_f32 v55, v51, v59
v_mfma_f32_16x16x32_bf16 v[72:75], v[100:103], v[116:119], v[72:75]
v_min_u32 v52, -2, v52
v_mfma_f32_16x16x32_bf16 v[76:79], v[100:103], v[120:123], v[76:79]
ds_read_b128 v[120:123], v44 offset:2688
ds_read_b128 v[100:103], v40 offset:2688
v_mfma_f32_16x16x32_bf16 v[72:75], v[80:83], v[136:139], v[72:75]
v_mfma_f32_16x16x32_bf16 v[76:79], v[84:87], v[136:139], v[76:79]
ds_read_b128 v[84:87], v40 offset:640
v_mfma_f32_16x16x32_bf16 v[72:75], v[104:107], v[112:115], v[72:75]
v_mfma_f32_16x16x32_bf16 v[76:79], v[104:107], v[116:119], v[76:79]
ds_read_b128 v[116:119], v44 offset:3200
ds_read_b128 v[104:107], v40 offset:3200
v_mfma_f32_16x16x32_bf16 v[76:79], v[80:83], v[140:143], v[76:79]
ds_read_b128 v[80:83], v40 offset:128
v_mfma_f32_16x16x32_bf16 v[76:79], v[108:111], v[112:115], v[76:79]
ds_read_b128 v[112:115], v44 offset:3712
ds_read_b128 v[108:111], v40 offset:3712
v_mfma_f32_16x16x32_bf16 v[64:67], v[144:147], v[128:131], v[64:67]
ds_read_b128 v[128:131], v44 offset:1664
v_mfma_f32_16x16x32_bf16 v[68:71], v[144:147], v[132:135], v[68:71]
ds_read_b128 v[132:135], v44 offset:1152
v_mfma_f32_16x16x32_bf16 v[72:75], v[144:147], v[136:139], v[72:75]
ds_read_b128 v[136:139], v44 offset:640
v_mfma_f32_16x16x32_bf16 v[76:79], v[144:147], v[140:143], v[76:79]
ds_read_b128 v[140:143], v44 offset:128
v_mfma_f32_16x16x32_bf16 v[64:67], v[232:235], a[232:235], v[64:67]
v_mfma_f32_16x16x32_bf16 v[64:67], v[228:231], a[236:239], v[64:67]
v_mfma_f32_16x16x32_bf16 v[68:71], v[232:235], a[236:239], v[68:71]
v_mfma_f32_16x16x32_bf16 v[64:67], v[236:239], a[228:231], v[64:67]
v_mfma_f32_16x16x32_bf16 v[68:71], v[236:239], a[232:235], v[68:71]
v_mfma_f32_16x16x32_bf16 v[72:75], v[236:239], a[236:239], v[72:75]
v_mfma_f32_16x16x32_bf16 v[64:67], v[224:227], a[240:243], v[64:67]
v_mfma_f32_16x16x32_bf16 v[68:71], v[228:231], a[240:243], v[68:71]
v_mfma_f32_16x16x32_bf16 v[72:75], v[232:235], a[240:243], v[72:75]
v_mfma_f32_16x16x32_bf16 v[76:79], v[236:239], a[240:243], v[76:79]
ds_read_b128 v[236:239], v40 offset:1728
ds_read_b128 a[240:243], v44 offset:1728
v_mfma_f32_16x16x32_bf16 v[64:67], v[240:243], a[224:227], v[64:67]
v_mfma_f32_16x16x32_bf16 v[68:71], v[240:243], a[228:231], v[68:71]
v_mfma_f32_16x16x32_bf16 v[72:75], v[240:243], a[232:235], v[72:75]
v_mfma_f32_16x16x32_bf16 v[76:79], v[240:243], a[236:239], v[76:79]
ds_read_b128 a[236:239], v44 offset:2240
ds_read_b128 v[240:243], v40 offset:2240
v_mfma_f32_16x16x32_bf16 v[68:71], v[224:227], a[244:247], v[68:71]
v_mfma_f32_16x16x32_bf16 v[72:75], v[228:231], a[244:247], v[72:75]
v_mfma_f32_16x16x32_bf16 v[76:79], v[232:235], a[244:247], v[76:79]
ds_read_b128 v[232:235], v40 offset:1216
ds_read_b128 a[244:247], v44 offset:1216
v_mfma_f32_16x16x32_bf16 v[68:71], v[244:247], a[224:227], v[68:71]
v_mfma_f32_16x16x32_bf16 v[72:75], v[244:247], a[228:231], v[72:75]
v_mfma_f32_16x16x32_bf16 v[76:79], v[244:247], a[232:235], v[76:79]
ds_read_b128 a[232:235], v44 offset:2752
ds_read_b128 v[244:247], v40 offset:2752
v_mfma_f32_16x16x32_bf16 v[72:75], v[224:227], a[248:251], v[72:75]
v_mfma_f32_16x16x32_bf16 v[76:79], v[228:231], a[248:251], v[76:79]
ds_read_b128 v[228:231], v40 offset:704
ds_read_b128 a[248:251], v44 offset:704
v_mfma_f32_16x16x32_bf16 v[72:75], v[248:251], a[224:227], v[72:75]
v_mfma_f32_16x16x32_bf16 v[76:79], v[248:251], a[228:231], v[76:79]
ds_read_b128 a[228:231], v44 offset:3264
ds_read_b128 v[248:251], v40 offset:3264
v_mfma_f32_16x16x32_bf16 v[76:79], v[224:227], a[252:255], v[76:79]
ds_read_b128 v[224:227], v40 offset:192
ds_read_b128 a[252:255], v44 offset:192
v_mfma_f32_16x16x32_bf16 v[76:79], v[252:255], a[224:227], v[76:79]
ds_read_b128 a[224:227], v44 offset:3776
ds_read_b128 v[252:255], v40 offset:3776
s_waitcnt lgkmcnt(15)
v_mfma_f32_16x16x32_bf16 v[64:67], v[88:91], v[120:123], v[64:67]
s_add_u32 s60, s46, 151552
v_add_u32 v40, s60, v1
s_waitcnt lgkmcnt(15)
v_mfma_f32_16x16x32_bf16 v[64:67], v[84:87], v[124:127], v[64:67]
v_mfma_f32_16x16x32_bf16 v[68:71], v[88:91], v[124:127], v[68:71]
s_waitcnt lgkmcnt(15)
v_mfma_f32_16x16x32_bf16 v[64:67], v[92:95], v[116:119], v[64:67]
v_mfma_f32_16x16x32_bf16 v[68:71], v[92:95], v[120:123], v[68:71]
s_lshl2_add_u32 m0, s46, 77824
s_xor_b32 s3, s80, 131072
buffer_load_dwordx4 v42, s[88:91], s3 offen offset:0 lds
v_mfma_f32_16x16x32_bf16 v[72:75], v[92:95], v[124:127], v[72:75]
s_waitcnt lgkmcnt(15)
v_mfma_f32_16x16x32_bf16 v[64:67], v[80:83], v[128:131], v[64:67]
buffer_load_dwordx4 v11, s[88:91], s3 offen offset:1024 lds
s_waitcnt vmcnt(2)
v_cmp_eq_u32 vcc, 0, v18
s_cbranch_vccnz re_16
re_16b:
v_mfma_f32_16x16x32_bf16 v[68:71], v[84:87], v[128:131], v[68:71]
buffer_store_dwordx4 v[52:55], v45, s[4:7], s78 offen sc1
v_mfma_f32_16x16x32_bf16 v[72:75], v[88:91], v[128:131], v[72:75]
s_add_u32 s3, s3, 14336
buffer_load_dwordx4 v42, s[88:91], s3 offen offset:2048 lds
v_mfma_f32_16x16x32_bf16 v[76:79], v[92:95], v[128:131], v[76:79]
buffer_load_dwordx4 v11, s[88:91], s3 offen offset:3072 lds
v_mfma_f32_16x16x32_bf16 v[64:67], v[96:99], v[112:115], v[64:67]
v_mfma_f32_16x16x32_bf16 v[68:71], v[96:99], v[116:119], v[68:71]
v_mfma_f32_16x16x32_bf16 v[72:75], v[96:99], v[120:123], v[72:75]
v_mfma_f32_16x16x32_bf16 v[76:79], v[96:99], v[124:127], v[76:79]
v_mov_b32 v96, 0x3f803f80
v_mov_b32 v97, 0x3f803f80
s_waitcnt lgkmcnt(15)
v_mfma_f32_16x16x32_bf16 v[68:71], v[80:83], v[132:135], v[68:71]
v_mov_b32 v98, 0x3f803f80
v_mov_b32 v99, 0x3f803f80
pg_0:
s_cbranch_execz pg_4
v_mfma_f32_16x16x32_bf16 v[72:75], v[84:87], v[132:135], v[72:75]
v_mfma_f32_16x16x32_bf16 v[76:79], v[88:91], v[132:135], v[76:79]
v_mfma_f32_16x16x32_bf16 v[68:71], v[100:103], v[112:115], v[68:71]
v_mfma_f32_16x16x32_bf16 v[72:75], v[100:103], v[116:119], v[72:75]
s_add_u32 s62, s43, 540672
buffer_load_dwordx2 v[56:57], v7, s[4:7], s62 offen offset:0 sc1
v_mfma_f32_16x16x32_bf16 v[76:79], v[100:103], v[120:123], v[76:79]
s_add_u32 s62, s43, 540672
buffer_load_dwordx2 v[48:49], v7, s[4:7], s62 offen offset:2048 sc1
s_waitcnt lgkmcnt(15)
v_mfma_f32_16x16x32_bf16 v[72:75], v[80:83], v[136:139], v[72:75]
s_lshl2_add_u32 m0, s46, 94208
s_xor_b32 s3, s80, 393216
buffer_load_dwordx4 v42, s[88:91], s3 offen offset:0 lds
v_mfma_f32_16x16x32_bf16 v[76:79], v[84:87], v[136:139], v[76:79]
buffer_load_dwordx4 v11, s[88:91], s3 offen offset:1024 lds
v_mfma_f32_16x16x32_bf16 v[72:75], v[104:107], v[112:115], v[72:75]
v_mfma_f32_16x16x32_bf16 v[76:79], v[104:107], v[116:119], v[76:79]
s_add_u32 s3, s3, 14336
buffer_load_dwordx4 v42, s[88:91], s3 offen offset:2048 lds
s_waitcnt lgkmcnt(15)
v_mfma_f32_16x16x32_bf16 v[76:79], v[80:83], v[140:143], v[76:79]
v_lshrrev_b32 v104, 8, v1
v_lshl_add_u32 v104, v104, 4, s26
v_mfma_f32_16x16x32_bf16 v[76:79], v[108:111], v[112:115], v[76:79]
s_waitcnt lgkmcnt(9)
v_mfma_f32_16x16x32_bf16 v[64:67], v[232:235], a[232:235], v[64:67]
buffer_load_dwordx4 v11, s[88:91], s3 offen offset:3072 lds
s_waitcnt lgkmcnt(7)
v_mfma_f32_16x16x32_bf16 v[64:67], v[228:231], a[236:239], v[64:67]
v_mfma_f32_16x16x32_bf16 v[68:71], v[232:235], a[236:239], v[68:71]
s_waitcnt lgkmcnt(5)
v_mfma_f32_16x16x32_bf16 v[64:67], v[236:239], a[228:231], v[64:67]
v_mfma_f32_16x16x32_bf16 v[68:71], v[236:239], a[232:235], v[68:71]
v_mfma_f32_16x16x32_bf16 v[72:75], v[236:239], a[236:239], v[72:75]
s_waitcnt lgkmcnt(3)
v_mfma_f32_16x16x32_bf16 v[64:67], v[224:227], a[240:243], v[64:67]
v_mfma_f32_16x16x32_bf16 v[68:71], v[228:231], a[240:243], v[68:71]
v_mfma_f32_16x16x32_bf16 v[72:75], v[232:235], a[240:243], v[72:75]
v_mfma_f32_16x16x32_bf16 v[76:79], v[236:239], a[240:243], v[76:79]
s_waitcnt lgkmcnt(1)
v_mfma_f32_16x16x32_bf16 v[64:67], v[240:243], a[224:227], v[64:67]
v_mfma_f32_16x16x32_bf16 v[68:71], v[240:243], a[228:231], v[68:71]
v_mfma_f32_16x16x32_bf16 v[72:75], v[240:243], a[232:235], v[72:75]
s_nop 1
ds_write_b128 v20, v[64:67] offset:0
v_mfma_f32_16x16x32_bf16 v[76:79], v[240:243], a[236:239], v[76:79]
s_lshl2_add_u32 m0, s46, 110592
s_xor_b32 s3, s80, 0
buffer_load_dwordx4 v42, s[88:91], s3 offen offset:0 lds
v_mfma_f32_16x16x32_bf16 v[68:71], v[224:227], a[244:247], v[68:71]
v_mfma_f32_16x16x32_bf16 v[72:75], v[228:231], a[244:247], v[72:75]
v_mfma_f32_16x16x32_bf16 v[76:79], v[232:235], a[244:247], v[76:79]
v_mfma_f32_16x16x32_bf16 v[68:71], v[244:247], a[224:227], v[68:71]
buffer_load_dwordx4 v11, s[88:91], s3 offen offset:1024 lds
v_mfma_f32_16x16x32_bf16 v[72:75], v[244:247], a[228:231], v[72:75]
s_add_u32 s3, s3, 14336
buffer_load_dwordx4 v42, s[88:91], s3 offen offset:2048 lds
s_nop 2
ds_write_b128 v20, v[68:71] offset:1024
v_mfma_f32_16x16x32_bf16 v[76:79], v[244:247], a[232:235], v[76:79]
v_mfma_f32_16x16x32_bf16 v[72:75], v[224:227], a[248:251], v[72:75]
v_mfma_f32_16x16x32_bf16 v[76:79], v[228:231], a[248:251], v[76:79]
v_mfma_f32_16x16x32_bf16 v[72:75], v[248:251], a[224:227], v[72:75]
v_mfma_f32_16x16x32_bf16 v[76:79], v[248:251], a[228:231], v[76:79]
buffer_load_dwordx4 v11, s[88:91], s3 offen offset:3072 lds
v_mfma_f32_16x16x32_bf16 v[76:79], v[224:227], a[252:255], v[76:79]
s_nop 1
ds_write_b128 v20, v[72:75] offset:2048
s_waitcnt lgkmcnt(3)
v_mfma_f32_16x16x32_bf16 v[76:79], v[252:255], a[224:227], v[76:79]
v_mfma_f32_16x16x32_bf16 v[100:103], v[160:163], v[96:99], 0
v_mfma_f32_16x16x32_bf16 v[100:103], v[164:167], v[96:99], v[100:103]
s_nop 1
ds_write_b128 v20, v[76:79] offset:3072
v_mfma_f32_16x16x32_bf16 v[100:103], v[168:171], v[96:99], v[100:103]
v_mfma_f32_16x16x32_bf16 v[100:103], v[172:175], v[96:99], v[100:103]
v_mfma_f32_16x16x32_bf16 v[100:103], v[176:179], v[96:99], v[100:103]
v_mfma_f32_16x16x32_bf16 v[100:103], v[180:183], v[96:99], v[100:103]
s_waitcnt lgkmcnt(0)
s_barrier
ds_read_b128 v[64:67], v21 offset:0
ds_read_b128 v[68:71], v21 offset:4096
ds_read_b128 v[72:75], v21 offset:8192
ds_read_b128 v[76:79], v21 offset:12288
s_lshl2_add_u32 m0, s46, 61440
s_xor_b32 s3, s80, 262144
buffer_load_dwordx4 v42, s[88:91], s3 offen offset:0 lds
v_mfma_f32_16x16x32_bf16 v[100:103], v[184:187], v[96:99], v[100:103]
s_waitcnt lgkmcnt(2)
v_add_f32 v64, v64, v68
v_add_f32 v65, v65, v69
v_pk_add_f32 v[66:67], v[66:67], v[70:71]
s_waitcnt lgkmcnt(0)
v_pk_add_f32 v[72:73], v[72:73], v[76:77]
v_pk_add_f32 v[74:75], v[74:75], v[78:79]
v_cvt_pk_bf16_f32 v68, v64, v72
v_cvt_pk_bf16_f32 v69, v65, v73
v_cvt_pk_bf16_f32 v70, v66, v74
v_cvt_pk_bf16_f32 v71, v67, v75
v_min_u32 v68, -2, v68
buffer_store_dwordx4 v[68:71], v45, s[4:7], s79 offen sc1
s_waitcnt vmcnt(10)
v_max3_u32 v58, v56, v57, v48
v_max_u32 v58, v58, v49
v_cmp_eq_u32 vcc, -1, v58
s_cbranch_vccnz re_17
re_17b:
v_permlane32_swap_b32 v56, v57
v_add_f32 v56, v56, v57
v_mov_b32 v57, v56
buffer_load_dwordx4 v11, s[88:91], s3 offen offset:1024 lds
s_nop 0
v_permlane16_swap_b32 v56, v57
v_add_f32 v56, v56, v57
s_add_u32 s3, s3, 14336
buffer_load_dwordx4 v42, s[88:91], s3 offen offset:2048 lds
v_add_f32_dpp v56, v56, v56 row_ror:8 row_mask:0xf bank_mask:0xf
v_mul_f32 v56, 0x3b000000, v56
v_mov_b32 v57, v56
buffer_load_dwordx4 v11, s[88:91], s3 offen offset:3072 lds
s_nop 0
v_permlane32_swap_b32 v56, v57
v_fma_f32 v57, -v56, v56, v57
v_max_f32 v57, 0, v57
v_add_f32 v58, 0x3727c5ac, v57
v_rsq_f32 v58, v58
v_permlane32_swap_b32 v48, v49
v_mul_f32 v59, -v56, v58
v_pk_fma_f32 v[144:145], v[24:25], v[58:59], v[58:59] op_sel:[0,0,1] op_sel_hi:[1,0,1]
v_pk_fma_f32 v[146:147], v[26:27], v[58:59], v[58:59] op_sel:[0,0,1] op_sel_hi:[1,0,1]
v_pk_fma_f32 v[148:149], v[28:29], v[58:59], v[58:59] op_sel:[0,0,1] op_sel_hi:[1,0,1]
v_pk_fma_f32 v[150:151], v[30:31], v[58:59], v[58:59] op_sel:[0,0,1] op_sel_hi:[1,0,1]
v_add_f32 v48, v48, v49
v_mov_b32 v49, v48
v_lshrrev_b32 v68, 9, v1
v_lshl_add_u32 v68, v68, 5, s26
v_permlane16_swap_b32 v48, v49
v_add_f32 v48, v48, v49
v_add_u32 v76, s25, v1
v_mfma_f32_16x16x32_bf16 v[100:103], v[188:191], v[96:99], v[100:103]
v_add_f32_dpp v48, v48, v48 row_ror:8 row_mask:0xf bank_mask:0xf
v_mul_f32 v48, 0x3b000000, v48
v_mov_b32 v49, v48
v_mfma_f32_16x16x32_bf16 v[100:103], v[192:195], v[96:99], v[100:103]
s_nop 0
v_permlane32_swap_b32 v48, v49
v_fma_f32 v49, -v48, v48, v49
v_max_f32 v49, 0, v49
v_add_f32 v50, 0x3727c5ac, v49
v_rsq_f32 v50, v50
v_mfma_f32_16x16x32_bf16 v[100:103], v[196:199], v[96:99], v[100:103]
v_mul_f32 v51, -v48, v50
v_fma_f32 v152, v32, v50, v51
v_fma_f32 v153, v33, v50, v51
v_pk_fma_f32 v[154:155], v[34:35], v[50:51], v[50:51] op_sel:[0,0,1] op_sel_hi:[1,0,1]
v_pk_fma_f32 v[156:157], v[36:37], v[50:51], v[50:51] op_sel:[0,0,1] op_sel_hi:[1,0,1]
v_pk_fma_f32 v[158:159], v[38:39], v[50:51], v[50:51] op_sel:[0,0,1] op_sel_hi:[1,0,1]
s_nop 0
v_mfma_f32_16x16x32_bf16 v[100:103], v[200:203], v[96:99], v[100:103]
s_add_u32 s60, s34, 1835008
buffer_load_dwordx4 v[60:63], v1, s[4:7], s60 offen sc1
s_mov_b32 exec_hi, 0x00ffffff
s_xor_b32 s38, s18, 0
s_mul_i32 s38, s38, 7168
s_add_u32 m0, s39, s38
s_lshl4_add_u32 s38, s38, s16
buffer_load_dwordx4 v16, s[56:59], s38 offen lds
s_add_u32 m0, m0, 896
s_add_u32 s38, s38, 28672
buffer_load_dwordx4 v16, s[56:59], s38 offen lds
s_mov_b32 exec_hi, -1
s_mov_b32 exec_hi, 0x00ffffff
s_xor_b32 s38, s18, 1
s_mul_i32 s38, s38, 7168
s_add_u32 m0, s39, s38
s_lshl4_add_u32 s38, s38, s16
buffer_load_dwordx4 v16, s[56:59], s38 offen lds
s_add_u32 m0, m0, 896
s_add_u32 s38, s38, 28672
buffer_load_dwordx4 v16, s[56:59], s38 offen lds
s_mov_b32 exec_hi, -1
v_mfma_f32_16x16x32_bf16 v[100:103], v[204:207], v[96:99], v[100:103]
v_mov_b32 v45, 0x3f803f80
v_mfma_f32_16x16x32_bf16 v[100:103], v[208:211], v[96:99], v[100:103]
v_mfma_f32_16x16x32_bf16 v[100:103], v[212:215], v[96:99], v[100:103]
v_mfma_f32_16x16x32_bf16 v[100:103], v[216:219], v[96:99], v[100:103]
v_mfma_f32_16x16x32_bf16 v[100:103], v[220:223], v[96:99], v[100:103]
s_nop 7
ds_write_b128 v104, v[100:103]
ds_read_b128 v[64:67], v68 offset:0
ds_read_b128 v[68:71], v68 offset:16
s_mov_b32 exec_hi, 0x00ffffff
s_xor_b32 s38, s18, 2
s_mul_i32 s38, s38, 7168
s_add_u32 m0, s39, s38
s_lshl4_add_u32 s38, s38, s16
buffer_load_dwordx4 v16, s[56:59], s38 offen lds
s_add_u32 m0, m0, 896
s_add_u32 s38, s38, 28672
buffer_load_dwordx4 v16, s[56:59], s38 offen lds
s_mov_b32 exec_hi, -1
v_lshrrev_b32 v100, 9, v1
v_lshl_add_u32 v100, v100, 5, s26
ds_read_b128 v[96:99], v100 offset:0
ds_read_b128 v[100:103], v100 offset:16
s_mov_b32 exec_hi, 0x00ffffff
s_xor_b32 s38, s18, 3
s_mul_i32 s38, s38, 7168
s_add_u32 m0, s39, s38
s_lshl4_add_u32 s38, s38, s16
buffer_load_dwordx4 v16, s[56:59], s38 offen lds
s_add_u32 m0, m0, 896
s_add_u32 s38, s38, 28672
buffer_load_dwordx4 v16, s[56:59], s38 offen lds
s_mov_b32 exec_hi, -1
s_waitcnt vmcnt(9)
s_barrier
ds_read_b64_tr_b16 v[224:225], v41 offset:16384
ds_read_b64_tr_b16 v[226:227], v41 offset:16640
ds_read_b64_tr_b16 v[228:229], v41 offset:20480
ds_read_b64_tr_b16 v[230:231], v41 offset:20736
s_waitcnt vmcnt(8)
v_cmp_eq_u32 vcc, -1, v60
s_cbranch_vccnz re_18
re_18b:
ds_write_b128 v40, v[60:63] offset:0
ds_read_b64_tr_b16 v[232:233], v41 offset:24576
ds_read_b64_tr_b16 v[234:235], v41 offset:24832
ds_read_b64_tr_b16 v[236:237], v41 offset:28672
ds_read_b64_tr_b16 v[238:239], v41 offset:28928
ds_read_b64_tr_b16 v[240:241], v41 offset:32768
ds_read_b64_tr_b16 v[242:243], v41 offset:33024
ds_read_b64_tr_b16 v[244:245], v41 offset:36864
ds_read_b64_tr_b16 v[246:247], v41 offset:37120
ds_read_b64_tr_b16 v[248:249], v41 offset:40960
ds_read_b64_tr_b16 v[250:251], v41 offset:41216
ds_read_b64_tr_b16 v[252:253], v41 offset:45056
ds_read_b64_tr_b16 v[254:255], v41 offset:45312
s_waitcnt lgkmcnt(12)
s_barrier
ds_read_b32 v48, v2 offset:0
ds_read_b32 v49, v2 offset:128
ds_read_b32 v50, v2 offset:256
ds_read_b32 v51, v2 offset:384
ds_read_b64_tr_b16 a[224:225], v41 offset:49152
ds_read_b64_tr_b16 a[226:227], v41 offset:49408
ds_read_b64_tr_b16 a[228:229], v41 offset:53248
ds_read_b64_tr_b16 a[230:231], v41 offset:53504
ds_read_b64_tr_b16 a[232:233], v41 offset:57344
ds_read_b64_tr_b16 a[234:235], v41 offset:57600
ds_read_b64_tr_b16 a[236:237], v41 offset:61440
ds_read_b64_tr_b16 a[238:239], v41 offset:61696
ds_read_b64_tr_b16 a[240:241], v41 offset:0
ds_read_b64_tr_b16 a[242:243], v41 offset:256
ds_read_b64_tr_b16 a[244:245], v41 offset:4096
s_waitcnt lgkmcnt(14)
v_lshlrev_b32 v52, 16, v48
v_and_b32 v53, s36, v48
s_waitcnt lgkmcnt(13)
v_lshlrev_b32 v54, 16, v49
v_and_b32 v55, s36, v49
s_waitcnt lgkmcnt(12)
v_lshlrev_b32 v56, 16, v50
v_and_b32 v57, s36, v50
s_waitcnt lgkmcnt(11)
v_lshlrev_b32 v58, 16, v51
v_and_b32 v59, s36, v51
v_pk_fma_f32 v[24:25], v[144:145], v[52:53], v[24:25] op_sel:[0,0,0] op_sel_hi:[1,1,1]
v_pk_fma_f32 v[26:27], v[146:147], v[54:55], v[26:27] op_sel:[0,0,0] op_sel_hi:[1,1,1]
v_pk_fma_f32 v[28:29], v[148:149], v[56:57], v[28:29] op_sel:[0,0,0] op_sel_hi:[1,1,1]
v_pk_fma_f32 v[30:31], v[150:151], v[58:59], v[30:31] op_sel:[0,0,0] op_sel_hi:[1,1,1]
v_cvt_pk_bf16_f32 v60, v24, v25
v_cvt_pk_bf16_f32 v61, v26, v27
v_cvt_pk_bf16_f32 v62, v28, v29
v_cvt_pk_bf16_f32 v63, v30, v31
s_add_u32 s62, s40, 393216
buffer_store_dwordx4 v[60:63], v3, s[4:7], s62 offen
v_pk_add_f32 v[52:53], v[24:25], v[26:27]
v_pk_mul_f32 v[54:55], v[24:25], v[24:25]
v_pk_fma_f32 v[54:55], v[26:27], v[26:27], v[54:55] op_sel:[0,0,0] op_sel_hi:[1,1,1]
v_pk_add_f32 v[52:53], v[52:53], v[28:29]
s_add_u32 s60, s34, 1867776
buffer_load_dwordx4 v[108:111], v1, s[4:7], s60 offen sc1
v_pk_fma_f32 v[54:55], v[28:29], v[28:29], v[54:55] op_sel:[0,0,0] op_sel_hi:[1,1,1]
v_pk_add_f32 v[52:53], v[52:53], v[30:31]
v_pk_fma_f32 v[54:55], v[30:31], v[30:31], v[54:55] op_sel:[0,0,0] op_sel_hi:[1,1,1]
v_add_f32 v52, v52, v53
v_add_f32 v54, v54, v55
ds_read_b64_tr_b16 a[246:247], v41 offset:4352
ds_read_b64_tr_b16 a[248:249], v41 offset:8192
v_permlane32_swap_b32 v52, v54
v_add_f32 v52, v52, v54
v_mov_b32 v54, v52
ds_read_b64_tr_b16 a[250:251], v41 offset:8448
ds_read_b64_tr_b16 a[252:253], v41 offset:12288
v_permlane16_swap_b32 v52, v54
v_add_f32 v52, v52, v54
ds_read_b64_tr_b16 a[254:255], v41 offset:12544
s_add_u32 s62, s34, 1835008
buffer_store_dwordx4 v[48:51], v1, s[4:7], s62 offen
v_add_f32_dpp v52, v52, v52 row_ror:8 row_mask:0xf bank_mask:0xf
s_add_u32 s62, s42, 524288
buffer_store_dword v52, v8, s[4:7], s62 offen offset:0
s_waitcnt lgkmcnt(0)
s_barrier
s_lshl2_add_u32 m0, s46, 77824
s_lshl4_add_u32 s3, s74, s49
buffer_load_dwordx4 v42, s[52:55], s3 offen offset:0 lds
buffer_load_dwordx4 v11, s[52:55], s3 offen offset:1024 lds
s_add_u32 s3, s3, 14336
buffer_load_dwordx4 v42, s[52:55], s3 offen offset:2048 lds
buffer_load_dwordx4 v11, s[52:55], s3 offen offset:3072 lds
s_lshl2_add_u32 m0, s46, 94208
s_lshl4_add_u32 s3, s74, s17
buffer_load_dwordx4 v42, s[52:55], s3 offen offset:0 lds
buffer_load_dwordx4 v11, s[52:55], s3 offen offset:1024 lds
s_add_u32 s3, s3, 14336
buffer_load_dwordx4 v42, s[52:55], s3 offen offset:2048 lds
buffer_load_dwordx4 v11, s[52:55], s3 offen offset:3072 lds
s_waitcnt vmcnt(10)
v_cmp_eq_u32 vcc, -1, v108
s_cbranch_vccnz re_19
re_19b:
ds_write_b128 v40, v[108:111] offset:4096
v_add_u32 v108, s25, v1
s_waitcnt lgkmcnt(0)
s_barrier
ds_read_b32 v80, v2 offset:4096
ds_read_b32 v81, v2 offset:4224
ds_read_b32 v82, v2 offset:4352
ds_read_b32 v83, v2 offset:4480
s_waitcnt lgkmcnt(3)
v_lshlrev_b32 v84, 16, v80
v_and_b32 v85, s36, v80
s_waitcnt lgkmcnt(2)
v_lshlrev_b32 v86, 16, v81
v_and_b32 v87, s36, v81
s_waitcnt lgkmcnt(1)
v_lshlrev_b32 v88, 16, v82
v_and_b32 v89, s36, v82
s_add_u32 m0, s23, 16384
s_xor_b32 s38, s47, 393216
buffer_load_dwordx4 v1, s[4:7], s38 offen offset:0 sc1 lds
buffer_load_dwordx4 v1, s[4:7], s38 offen offset:1024 sc1 lds
s_waitcnt lgkmcnt(0)
v_lshlrev_b32 v90, 16, v83
v_and_b32 v91, s36, v83
v_pk_fma_f32 v[32:33], v[152:153], v[84:85], v[32:33] op_sel:[0,0,0] op_sel_hi:[1,1,1]
s_add_u32 m0, s23, 24576
s_xor_b32 s38, s47, 401408
buffer_load_dwordx4 v1, s[4:7], s38 offen offset:0 sc1 lds
buffer_load_dwordx4 v1, s[4:7], s38 offen offset:1024 sc1 lds
v_pk_fma_f32 v[34:35], v[154:155], v[86:87], v[34:35] op_sel:[0,0,0] op_sel_hi:[1,1,1]
v_pk_fma_f32 v[36:37], v[156:157], v[88:89], v[36:37] op_sel:[0,0,0] op_sel_hi:[1,1,1]
v_pk_fma_f32 v[38:39], v[158:159], v[90:91], v[38:39] op_sel:[0,0,0] op_sel_hi:[1,1,1]
s_add_u32 m0, s23, 0
s_xor_b32 s38, s47, 409600
buffer_load_dwordx4 v1, s[4:7], s38 offen offset:0 sc1 lds
buffer_load_dwordx4 v1, s[4:7], s38 offen offset:1024 sc1 lds
v_cvt_pk_bf16_f32 v92, v32, v33
v_cvt_pk_bf16_f32 v93, v34, v35
v_cvt_pk_bf16_f32 v94, v36, v37
v_cvt_pk_bf16_f32 v95, v38, v39
v_pk_add_f32 v[84:85], v[32:33], v[34:35]
v_pk_mul_f32 v[86:87], v[32:33], v[32:33]
v_pk_fma_f32 v[86:87], v[34:35], v[34:35], v[86:87] op_sel:[0,0,0] op_sel_hi:[1,1,1]
v_pk_add_f32 v[84:85], v[84:85], v[36:37]
v_pk_fma_f32 v[86:87], v[36:37], v[36:37], v[86:87] op_sel:[0,0,0] op_sel_hi:[1,1,1]
v_pk_add_f32 v[84:85], v[84:85], v[38:39]
s_add_u32 s62, s40, 425984
buffer_store_dwordx4 v[92:95], v3, s[4:7], s62 offen
v_pk_fma_f32 v[86:87], v[38:39], v[38:39], v[86:87] op_sel:[0,0,0] op_sel_hi:[1,1,1]
v_add_f32 v84, v84, v85
v_add_f32 v86, v86, v87
s_waitcnt vmcnt(13)
ds_read_b64_tr_b16 a[0:1], v43 offset:0
v_permlane32_swap_b32 v84, v86
v_add_f32 v84, v84, v86
v_mov_b32 v86, v84
ds_read_b64_tr_b16 a[4:5], v43 offset:8
ds_read_b64_tr_b16 a[2:3], v43 offset:256
v_permlane16_swap_b32 v84, v86
v_add_f32 v84, v84, v86
ds_read_b64_tr_b16 a[6:7], v43 offset:264
s_waitcnt vmcnt(11)
ds_read_b64_tr_b16 a[8:9], v43 offset:2048
v_add_f32_dpp v84, v84, v84 row_ror:8 row_mask:0xf bank_mask:0xf
s_add_u32 s62, s42, 524288
buffer_store_dword v84, v8, s[4:7], s62 offen offset:2048
ds_read_b64_tr_b16 a[12:13], v43 offset:2056
ds_read_b64_tr_b16 a[10:11], v43 offset:2304
ds_read_b64_tr_b16 a[14:15], v43 offset:2312
s_waitcnt vmcnt(10)
ds_read_b64_tr_b16 a[16:17], v43 offset:16384
ds_read_b64_tr_b16 a[20:21], v43 offset:16392
ds_read_b64_tr_b16 a[18:19], v43 offset:16640
ds_read_b64_tr_b16 a[22:23], v43 offset:16648
s_add_u32 s62, s34, 1867776
buffer_store_dwordx4 v[80:83], v1, s[4:7], s62 offen
s_add_u32 m0, s23, 8192
s_xor_b32 s38, s47, 417792
buffer_load_dwordx4 v1, s[4:7], s38 offen offset:0 sc1 lds
buffer_load_dwordx4 v1, s[4:7], s38 offen offset:1024 sc1 lds
s_waitcnt vmcnt(11)
ds_read_b64_tr_b16 a[24:25], v43 offset:18432
ds_read_b64_tr_b16 a[28:29], v43 offset:18440
ds_read_b64_tr_b16 a[26:27], v43 offset:18688
ds_read_b64_tr_b16 a[30:31], v43 offset:18696
s_waitcnt vmcnt(9)
ds_read2st64_b32 v[72:73], v0 offset0:64 offset1:68
s_waitcnt lgkmcnt(0)
v_max_u32 v72, v72, v73
v_cmp_eq_u32 vcc, -1, v72
s_cbranch_vccnz re_20
re_20b:
s_add_u32 s62, s43, 524288
buffer_load_dwordx4 v[56:59], v1, s[4:7], s62 offen offset:0 sc1
buffer_load_dwordx4 v[60:63], v1, s[4:7], s62 offen offset:1024 sc1
s_lshl2_add_u32 m0, s46, 77824
s_lshl4_add_u32 s3, s0, s49
buffer_load_dwordx4 v42, s[52:55], s3 offen offset:0 lds
s_barrier
ds_read_b128 v[112:115], v23 offset:16384
ds_read_b128 v[116:119], v23 offset:16640
ds_read_b128 v[120:123], v23 offset:18432
ds_read_b128 v[124:127], v23 offset:18688
ds_read_b128 v[128:131], v23 offset:20480
ds_read_b128 v[132:135], v23 offset:20736
ds_read_b128 v[136:139], v23 offset:22528
ds_read_b128 v[140:143], v23 offset:22784
buffer_load_dwordx4 v11, s[52:55], s3 offen offset:1024 lds
s_waitcnt lgkmcnt(6)
v_mfma_f32_16x16x32_bf16 v[48:51], v[160:163], v[112:115], 0
ds_read_b128 v[76:79], v76 offset:16384
s_waitcnt vmcnt(11)
ds_read2st64_b32 v[72:73], v0 offset0:96 offset1:100
s_add_u32 s3, s3, 14336
buffer_load_dwordx4 v42, s[52:55], s3 offen offset:2048 lds
v_mfma_f32_16x16x32_bf16 v[52:55], v[160:163], v[116:119], 0
s_waitcnt vmcnt(10)
ds_read2st64_b32 v[74:75], v0 offset0:0 offset1:4
buffer_load_dwordx4 v11, s[52:55], s3 offen offset:3072 lds
s_waitcnt lgkmcnt(7)
v_mfma_f32_16x16x32_bf16 v[48:51], v[164:167], v[120:123], v[48:51]
v_mfma_f32_16x16x32_bf16 v[52:55], v[164:167], v[124:127], v[52:55]
s_waitcnt lgkmcnt(5)
v_mfma_f32_16x16x32_bf16 v[48:51], v[168:171], v[128:131], v[48:51]
v_mfma_f32_16x16x32_bf16 v[52:55], v[168:171], v[132:135], v[52:55]
s_waitcnt lgkmcnt(0)
v_max3_u32 v72, v72, v73, v74
v_max_u32 v72, v72, v75
v_cmp_eq_u32 vcc, -1, v72
s_cbranch_vccnz re_21
re_21b:
v_mfma_f32_16x16x32_bf16 v[48:51], v[172:175], v[136:139], v[48:51]
s_barrier
ds_read_b128 v[112:115], v23 offset:24576
ds_read_b128 v[116:119], v23 offset:24832
ds_read_b128 v[120:123], v23 offset:26624
ds_read_b128 v[124:127], v23 offset:26880
ds_read_b128 v[128:131], v23 offset:28672
ds_read_b128 v[132:135], v23 offset:28928
ds_read_b128 v[136:139], v23 offset:30720
v_mfma_f32_16x16x32_bf16 v[52:55], v[172:175], v[140:143], v[52:55]
ds_read_b128 v[140:143], v23 offset:30976
s_waitcnt vmcnt(4)
v_add_f32 v56, v56, v60
v_add_f32 v57, v57, v61
v_pk_add_f32 v[58:59], v[58:59], v[62:63]
v_pk_add_f32 v[56:57], v[56:57], v[58:59]
v_lshlrev_b32 v74, 16, v77
s_waitcnt lgkmcnt(6)
v_mfma_f32_16x16x32_bf16 v[48:51], v[176:179], v[112:115], v[48:51]
ds_read_b128 v[112:115], v23 offset:0
v_permlane32_swap_b32 v56, v57
s_add_u32 m0, s23, 32768
s_xor_b32 s38, s47, 425984
buffer_load_dwordx4 v1, s[4:7], s38 offen offset:0 sc1 lds
buffer_load_dwordx4 v1, s[4:7], s38 offen offset:1024 sc1 lds
v_mfma_f32_16x16x32_bf16 v[52:55], v[176:179], v[116:119], v[52:55]
ds_read_b128 v[116:119], v23 offset:256
v_add_f32 v56, v56, v57
s_waitcnt lgkmcnt(6)
v_mfma_f32_16x16x32_bf16 v[48:51], v[180:183], v[120:123], v[48:51]
ds_read_b128 v[120:123], v23 offset:2048
s_add_u32 m0, s23, 16384
s_xor_b32 s38, s47, 434176
buffer_load_dwordx4 v1, s[4:7], s38 offen offset:0 sc1 lds
buffer_load_dwordx4 v1, s[4:7], s38 offen offset:1024 sc1 lds
v_mfma_f32_16x16x32_bf16 v[52:55], v[180:183], v[124:127], v[52:55]
ds_read_b128 v[124:127], v23 offset:2304
s_lshl2_add_u32 m0, s46, 94208
s_lshl4_add_u32 s3, s0, s17
buffer_load_dwordx4 v42, s[52:55], s3 offen offset:0 lds
s_waitcnt lgkmcnt(6)
v_mfma_f32_16x16x32_bf16 v[48:51], v[184:187], v[128:131], v[48:51]
ds_read_b128 v[128:131], v23 offset:4096
v_cmp_u_f32 vcc, v56, v56
s_cbranch_vccnz re_23
re_23b:
buffer_load_dwordx4 v11, s[52:55], s3 offen offset:1024 lds
v_mfma_f32_16x16x32_bf16 v[52:55], v[184:187], v[132:135], v[52:55]
ds_read_b128 v[132:135], v23 offset:4352
v_mul_f32 v56, 0x3b000000, v56
s_add_u32 s3, s3, 14336
buffer_load_dwordx4 v42, s[52:55], s3 offen offset:2048 lds
s_waitcnt lgkmcnt(6)
v_mfma_f32_16x16x32_bf16 v[48:51], v[188:191], v[136:139], v[48:51]
ds_read_b128 v[136:139], v23 offset:6144
v_mov_b32 v57, v56
v_and_b32 v75, s36, v77
v_mfma_f32_16x16x32_bf16 v[52:55], v[188:191], v[140:143], v[52:55]
ds_read_b128 v[140:143], v23 offset:6400
v_permlane32_swap_b32 v56, v57
s_waitcnt lgkmcnt(6)
v_mfma_f32_16x16x32_bf16 v[48:51], v[192:195], v[112:115], v[48:51]
ds_read2st64_b32 v[72:73], v0 offset0:32 offset1:36
v_fma_f32 v57, -v56, v56, v57
v_max_f32 v57, 0, v57
v_mfma_f32_16x16x32_bf16 v[52:55], v[192:195], v[116:119], v[52:55]
v_add_f32 v58, 0x3727c5ac, v57
v_rsq_f32 v58, v58
s_waitcnt lgkmcnt(5)
v_mfma_f32_16x16x32_bf16 v[48:51], v[196:199], v[120:123], v[48:51]
v_mul_f32 v59, v58, v58
v_sub_f32 v46, 0, v56
v_mfma_f32_16x16x32_bf16 v[52:55], v[196:199], v[124:127], v[52:55]
v_mul_f32 v59, v59, v57
v_mov_b32 v20, v58
s_waitcnt lgkmcnt(3)
v_mfma_f32_16x16x32_bf16 v[48:51], v[200:203], v[128:131], v[48:51]
v_add_f32 v59, 0x3727c5ac, v59
buffer_load_dwordx4 v11, s[52:55], s3 offen offset:3072 lds
v_mfma_f32_16x16x32_bf16 v[52:55], v[200:203], v[132:135], v[52:55]
v_rsq_f32 v59, v59
s_waitcnt lgkmcnt(1)
v_mfma_f32_16x16x32_bf16 v[48:51], v[204:207], v[136:139], v[48:51]
v_mul_f32 v21, v46, v58
v_mul_f32 v59, v59, v58
v_mfma_f32_16x16x32_bf16 v[52:55], v[204:207], v[140:143], v[52:55]
v_mul_f32 v19, 0xc0135761, v59
v_mul_f32 v18, v59, v59
v_rcp_f32 v47, v59
v_mul_f32 v18, v18, v19
v_mul_f32 v18, 0x3d372713, v18
s_waitcnt vmcnt(10)
ds_read_b64_tr_b16 a[32:33], v43 offset:0
ds_read_b64_tr_b16 a[36:37], v43 offset:8
ds_read_b64_tr_b16 a[34:35], v43 offset:256
ds_read_b64_tr_b16 a[38:39], v43 offset:264
v_and_b32 v77, s36, v78
v_pk_fma_f32 v[74:75], v[74:75], v[20:21], v[20:21] op_sel:[0,0,1] op_sel_hi:[1,0,1]
s_waitcnt lgkmcnt(4)
v_max_u32 v72, v72, v73
v_cmp_eq_u32 vcc, -1, v72
s_cbranch_vccnz re_22
re_22b:
v_lshlrev_b32 v72, 16, v76
v_and_b32 v73, s36, v76
v_lshlrev_b32 v76, 16, v78
v_lshlrev_b32 v78, 16, v79
v_and_b32 v79, s36, v79
v_pk_fma_f32 v[72:73], v[72:73], v[20:21], v[20:21] op_sel:[0,0,1] op_sel_hi:[1,0,1]
v_pk_fma_f32 v[76:77], v[76:77], v[20:21], v[20:21] op_sel:[0,0,1] op_sel_hi:[1,0,1]
v_pk_fma_f32 v[78:79], v[78:79], v[20:21], v[20:21] op_sel:[0,0,1] op_sel_hi:[1,0,1]
s_barrier
s_add_u32 m0, s23, 24576
s_xor_b32 s38, s47, 442368
buffer_load_dwordx4 v1, s[4:7], s38 offen offset:0 sc1 lds
buffer_load_dwordx4 v1, s[4:7], s38 offen offset:1024 sc1 lds
ds_read_b128 v[112:115], v23 offset:8192
ds_read_b128 v[116:119], v23 offset:8448
ds_read_b128 v[120:123], v23 offset:10240
ds_read_b128 v[124:127], v23 offset:10496
ds_read_b128 v[128:131], v23 offset:12288
s_add_u32 m0, s23, 0
s_xor_b32 s38, s47, 450560
buffer_load_dwordx4 v1, s[4:7], s38 offen offset:0 sc1 lds
buffer_load_dwordx4 v1, s[4:7], s38 offen offset:1024 sc1 lds
ds_read_b128 v[132:135], v23 offset:12544
ds_read_b128 v[136:139], v23 offset:14336
ds_read_b128 v[140:143], v23 offset:14592
s_waitcnt vmcnt(12)
ds_read_b64_tr_b16 a[40:41], v43 offset:2048
ds_read_b64_tr_b16 a[44:45], v43 offset:2056
ds_read_b64_tr_b16 a[42:43], v43 offset:2304
s_add_u32 s62, s43, 524288
buffer_load_dwordx4 v[88:91], v1, s[4:7], s62 offen offset:2048 sc1
buffer_load_dwordx4 v[92:95], v1, s[4:7], s62 offen offset:3072 sc1
ds_read_b64_tr_b16 a[46:47], v43 offset:2312
s_waitcnt vmcnt(12)
ds_read2st64_b32 v[104:105], v0 offset0:128 offset1:132
s_waitcnt lgkmcnt(11)
v_mfma_f32_16x16x32_bf16 v[48:51], v[208:211], v[112:115], v[48:51]
v_permlane16_swap_b32 v72, v76
s_lshl2_add_u32 m0, s46, 77824
s_lshl4_add_u32 s3, s1, s49
buffer_load_dwordx4 v42, s[52:55], s3 offen offset:0 lds
s_waitcnt lgkmcnt(5)
s_barrier
v_mfma_f32_16x16x32_bf16 v[52:55], v[208:211], v[116:119], v[52:55]
v_permlane16_swap_b32 v73, v77
v_mfma_f32_16x16x32_bf16 v[48:51], v[212:215], v[120:123], v[48:51]
v_permlane16_swap_b32 v74, v78
v_mfma_f32_16x16x32_bf16 v[52:55], v[212:215], v[124:127], v[52:55]
v_permlane16_swap_b32 v75, v79
v_mfma_f32_16x16x32_bf16 v[48:51], v[216:219], v[128:131], v[48:51]
buffer_load_dwordx4 v11, s[52:55], s3 offen offset:1024 lds
v_mfma_f32_16x16x32_bf16 v[52:55], v[216:219], v[132:135], v[52:55]
v_mfma_f32_16x16x32_bf16 v[48:51], v[220:223], v[136:139], v[48:51]
v_mfma_f32_16x16x32_bf16 v[52:55], v[220:223], v[140:143], v[52:55]
s_add_u32 s3, s3, 14336
s_waitcnt lgkmcnt(1)
buffer_load_dwordx4 v42, s[52:55], s3 offen offset:2048 lds
s_waitcnt vmcnt(11)
ds_read_b64_tr_b16 a[48:49], v43 offset:16384
ds_read_b64_tr_b16 a[52:53], v43 offset:16392
ds_read_b64_tr_b16 a[50:51], v43 offset:16640
pg_1:
s_cbranch_execz pg_5
ds_read_b64_tr_b16 a[54:55], v43 offset:16648
v_permlane16_swap_b32 v48, v52
v_permlane16_swap_b32 v49, v53
v_permlane16_swap_b32 v50, v54
v_permlane16_swap_b32 v51, v55
v_pk_fma_f32 v[48:49], v[64:65], v[46:47], v[48:49] op_sel:[0,0,0] op_sel_hi:[1,0,1]
v_pk_fma_f32 v[50:51], v[66:67], v[46:47], v[50:51] op_sel:[0,0,0] op_sel_hi:[1,0,1]
buffer_load_dwordx4 v11, s[52:55], s3 offen offset:3072 lds
v_pk_fma_f32 v[52:53], v[68:69], v[46:47], v[52:53] op_sel:[0,0,0] op_sel_hi:[1,0,1]
v_pk_fma_f32 v[54:55], v[70:71], v[46:47], v[54:55] op_sel:[0,0,0] op_sel_hi:[1,0,1]
v_pk_mul_f32 v[56:57], v[48:49], v[48:49]
v_pk_mul_f32 v[58:59], v[50:51], v[50:51]
v_pk_mul_f32 v[60:61], v[52:53], v[52:53]
v_pk_mul_f32 v[62:63], v[54:55], v[54:55]
v_pk_fma_f32 v[56:57], v[56:57], v[18:19], v[18:19] op_sel:[0,0,1] op_sel_hi:[1,0,1]
v_pk_fma_f32 v[58:59], v[58:59], v[18:19], v[18:19] op_sel:[0,0,1] op_sel_hi:[1,0,1]
v_pk_fma_f32 v[60:61], v[60:61], v[18:19], v[18:19] op_sel:[0,0,1] op_sel_hi:[1,0,1]
v_pk_fma_f32 v[62:63], v[62:63], v[18:19], v[18:19] op_sel:[0,0,1] op_sel_hi:[1,0,1]
v_pk_mul_f32 v[56:57], v[56:57], v[48:49]
v_pk_mul_f32 v[58:59], v[58:59], v[50:51]
v_pk_mul_f32 v[60:61], v[60:61], v[52:53]
v_pk_mul_f32 v[62:63], v[62:63], v[54:55]
v_exp_f32 v56, v56
v_exp_f32 v57, v57
s_lshl2_add_u32 m0, s46, 94208
s_lshl4_add_u32 s3, s1, s17
s_waitcnt lgkmcnt(0)
buffer_load_dwordx4 v42, s[52:55], s3 offen offset:0 lds
buffer_load_dwordx4 v11, s[52:55], s3 offen offset:1024 lds
s_waitcnt vmcnt(12)
ds_read_b64_tr_b16 a[56:57], v43 offset:18432
ds_read_b64_tr_b16 a[60:61], v43 offset:18440
ds_read_b64_tr_b16 a[58:59], v43 offset:18688
ds_read_b64_tr_b16 a[62:63], v43 offset:18696
v_exp_f32 v58, v58
v_exp_f32 v59, v59
v_exp_f32 v60, v60
v_exp_f32 v61, v61
v_exp_f32 v62, v62
v_exp_f32 v63, v63
v_pk_fma_f32 v[56:57], v[56:57], v[46:47], v[46:47] op_sel:[0,1,1] op_sel_hi:[1,1,1]
v_pk_fma_f32 v[58:59], v[58:59], v[46:47], v[46:47] op_sel:[0,1,1] op_sel_hi:[1,1,1]
v_pk_fma_f32 v[60:61], v[60:61], v[46:47], v[46:47] op_sel:[0,1,1] op_sel_hi:[1,1,1]
s_add_u32 s3, s3, 14336
s_waitcnt lgkmcnt(0)
buffer_load_dwordx4 v42, s[52:55], s3 offen offset:2048 lds
buffer_load_dwordx4 v11, s[52:55], s3 offen offset:3072 lds
v_pk_fma_f32 v[62:63], v[62:63], v[46:47], v[46:47] op_sel:[0,1,1] op_sel_hi:[1,1,1]
v_rcp_f32 v56, v56
v_rcp_f32 v57, v57
v_rcp_f32 v58, v58
v_rcp_f32 v59, v59
v_rcp_f32 v60, v60
v_rcp_f32 v61, v61
v_rcp_f32 v62, v62
v_rcp_f32 v63, v63
v_pk_mul_f32 v[56:57], v[56:57], v[48:49]
v_pk_mul_f32 v[58:59], v[58:59], v[50:51]
v_pk_mul_f32 v[60:61], v[60:61], v[52:53]
v_pk_mul_f32 v[62:63], v[62:63], v[54:55]
v_cvt_pk_bf16_f32 v64, v56, v57
v_cvt_pk_bf16_f32 v65, v58, v59
v_cvt_pk_bf16_f32 v66, v60, v61
v_cvt_pk_bf16_f32 v67, v62, v63
s_cmp_lg_u32 s27, 0
s_cbranch_scc1 sh_24
buffer_store_dwordx4 v[64:67], v5, s[4:7], s32 offen offset:0
sh_24b:
s_add_u32 s62, s41, 0
buffer_store_dwordx4 v[64:67], v4, s[4:7], s62 offen
v_max_u32 v104, v104, v105
v_cmp_eq_u32 vcc, -1, v104
s_cbranch_vccnz re_25
re_25b:
s_barrier
ds_read_b128 v[112:115], v23 offset:32768
ds_read_b128 v[116:119], v23 offset:33024
ds_read_b128 v[120:123], v23 offset:34816
ds_read_b128 v[124:127], v23 offset:35072
ds_read_b128 v[128:131], v23 offset:36864
ds_read_b128 v[132:135], v23 offset:37120
ds_read_b128 v[136:139], v23 offset:38912
ds_read_b128 v[140:143], v23 offset:39168
ds_read2st64_b32 v[104:105], v0 offset0:64 offset1:68
s_waitcnt vmcnt(14)
ds_read2st64_b32 v[106:107], v0 offset0:96 offset1:100
s_mov_b32 exec_hi, 0x00ffffff
s_xor_b32 s38, s18, 4
s_mul_i32 s38, s38, 7168
s_add_u32 m0, s39, s38
s_lshl4_add_u32 s38, s38, s16
buffer_load_dwordx4 v16, s[56:59], s38 offen lds
s_add_u32 m0, m0, 896
s_add_u32 s38, s38, 28672
buffer_load_dwordx4 v16, s[56:59], s38 offen lds
s_mov_b32 exec_hi, -1
s_waitcnt lgkmcnt(8)
v_mfma_f32_16x16x32_bf16 v[80:83], v[160:163], v[112:115], 0
s_mov_b32 exec_hi, 0x00ffffff
s_xor_b32 s38, s18, 5
s_mul_i32 s38, s38, 7168
s_add_u32 m0, s39, s38
s_lshl4_add_u32 s38, s38, s16
buffer_load_dwordx4 v16, s[56:59], s38 offen lds
s_add_u32 m0, m0, 896
s_add_u32 s38, s38, 28672
buffer_load_dwordx4 v16, s[56:59], s38 offen lds
s_mov_b32 exec_hi, -1
s_waitcnt vmcnt(12)
ds_read_b64_tr_b16 a[64:65], v43 offset:0
ds_read_b64_tr_b16 a[68:69], v43 offset:8
ds_read_b64_tr_b16 a[66:67], v43 offset:256
ds_read_b64_tr_b16 a[70:71], v43 offset:264
v_mfma_f32_16x16x32_bf16 v[84:87], v[160:163], v[116:119], 0
s_mov_b32 exec_hi, 0x00ffffff
s_xor_b32 s38, s18, 6
s_mul_i32 s38, s38, 7168
s_add_u32 m0, s39, s38
s_lshl4_add_u32 s38, s38, s16
buffer_load_dwordx4 v16, s[56:59], s38 offen lds
s_add_u32 m0, m0, 896
s_add_u32 s38, s38, 28672
buffer_load_dwordx4 v16, s[56:59], s38 offen lds
s_mov_b32 exec_hi, -1
s_waitcnt lgkmcnt(10)
v_mfma_f32_16x16x32_bf16 v[80:83], v[164:167], v[120:123], v[80:83]
ds_read_b128 v[108:111], v108 offset:32768
s_waitcnt lgkmcnt(5)
v_max3_u32 v104, v104, v105, v106
v_max_u32 v104, v104, v107
v_cmp_eq_u32 vcc, -1, v104
s_cbranch_vccnz re_26
re_26b:
s_waitcnt vmcnt(12)
ds_read_b64_tr_b16 a[72:73], v43 offset:2048
ds_read_b64_tr_b16 a[76:77], v43 offset:2056
ds_read_b64_tr_b16 a[74:75], v43 offset:2304
ds_read_b64_tr_b16 a[78:79], v43 offset:2312
v_mfma_f32_16x16x32_bf16 v[84:87], v[164:167], v[124:127], v[84:87]
s_waitcnt lgkmcnt(4)
s_barrier
ds_read_b128 v[144:147], v23 offset:16384
ds_read_b128 v[148:151], v23 offset:16640
ds_read_b128 v[152:155], v23 offset:18432
ds_read_b128 v[156:159], v23 offset:18688
ds_read_b128 v[112:115], v23 offset:20480
ds_read_b128 v[116:119], v23 offset:20736
ds_read_b128 v[120:123], v23 offset:22528
ds_read_b128 v[124:127], v23 offset:22784
v_mfma_f32_16x16x32_bf16 v[80:83], v[168:171], v[128:131], v[80:83]
ds_read_b128 v[128:131], v23 offset:24576
ds_read2st64_b32 v[104:105], v0 offset0:0 offset1:4
s_waitcnt vmcnt(10)
ds_read_b64_tr_b16 a[80:81], v43 offset:16384
ds_read_b64_tr_b16 a[84:85], v43 offset:16392
ds_read_b64_tr_b16 a[82:83], v43 offset:16640
v_mfma_f32_16x16x32_bf16 v[84:87], v[168:171], v[132:135], v[84:87]
ds_read_b64_tr_b16 a[86:87], v43 offset:16648
s_mov_b32 exec_hi, 0x00ffffff
s_xor_b32 s38, s18, 7
s_mul_i32 s38, s38, 7168
s_add_u32 m0, s39, s38
s_lshl4_add_u32 s38, s38, s16
buffer_load_dwordx4 v16, s[56:59], s38 offen lds
s_add_u32 m0, m0, 896
s_add_u32 s38, s38, 28672
buffer_load_dwordx4 v16, s[56:59], s38 offen lds
s_mov_b32 exec_hi, -1
ds_read_b128 v[132:135], v23 offset:24832
v_mfma_f32_16x16x32_bf16 v[80:83], v[172:175], v[136:139], v[80:83]
ds_read_b128 v[136:139], v23 offset:26624
v_add_f32 v88, v88, v92
v_add_f32 v89, v89, v93
s_waitcnt vmcnt(10)
ds_read_b64_tr_b16 a[88:89], v43 offset:18432
ds_read_b64_tr_b16 a[92:93], v43 offset:18440
ds_read_b64_tr_b16 a[90:91], v43 offset:18688
ds_read_b64_tr_b16 a[94:95], v43 offset:18696
v_mfma_f32_16x16x32_bf16 v[84:87], v[172:175], v[140:143], v[84:87]
ds_read_b128 v[140:143], v23 offset:26880
s_waitcnt lgkmcnt(11)
v_max_u32 v104, v104, v105
v_cmp_eq_u32 vcc, -1, v104
s_cbranch_vccnz re_27
re_27b:
v_mfma_f32_16x16x32_bf16 v[80:83], v[176:179], v[144:147], v[80:83]
ds_read_b128 v[144:147], v23 offset:28672
v_add_f32 v90, v90, v94
v_add_f32 v91, v91, v95
v_mfma_f32_16x16x32_bf16 v[84:87], v[176:179], v[148:151], v[84:87]
ds_read_b128 v[148:151], v23 offset:28928
v_add_f32 v88, v88, v90
v_add_f32 v89, v89, v91
v_mfma_f32_16x16x32_bf16 v[80:83], v[180:183], v[152:155], v[80:83]
ds_read_b128 v[152:155], v23 offset:30720
v_permlane32_swap_b32 v88, v89
v_mfma_f32_16x16x32_bf16 v[84:87], v[180:183], v[156:159], v[84:87]
ds_read_b128 v[156:159], v23 offset:30976
v_add_f32 v88, v88, v89
v_cmp_u_f32 vcc, v88, v88
s_cbranch_vccnz re_28
re_28b:
s_waitcnt lgkmcnt(5)
s_barrier
v_mfma_f32_16x16x32_bf16 v[80:83], v[184:187], v[112:115], v[80:83]
s_mov_b32 exec_hi, 0x00ffffff
s_xor_b32 s38, s18, 8
s_mul_i32 s38, s38, 7168
s_add_u32 m0, s39, s38
s_lshl4_add_u32 s38, s38, s16
buffer_load_dwordx4 v16, s[56:59], s38 offen lds
s_add_u32 m0, m0, 896
s_add_u32 s38, s38, 28672
buffer_load_dwordx4 v16, s[56:59], s38 offen lds
s_mov_b32 exec_hi, -1
v_mfma_f32_16x16x32_bf16 v[84:87], v[184:187], v[116:119], v[84:87]
s_waitcnt lgkmcnt(0)
s_barrier
ds_read_b128 v[112:115], v23 offset:0
ds_read_b128 v[116:119], v23 offset:256
v_mfma_f32_16x16x32_bf16 v[80:83], v[188:191], v[120:123], v[80:83]
ds_read_b128 v[120:123], v23 offset:2048
v_mul_f32 v88, 0x3b000000, v88
v_mov_b32 v89, v88
v_mfma_f32_16x16x32_bf16 v[84:87], v[188:191], v[124:127], v[84:87]
ds_read_b128 v[124:127], v23 offset:2304
v_permlane32_swap_b32 v88, v89
v_mfma_f32_16x16x32_bf16 v[80:83], v[192:195], v[128:131], v[80:83]
ds_read_b128 v[128:131], v23 offset:4096
v_fma_f32 v89, -v88, v88, v89
v_max_f32 v89, 0, v89
v_mfma_f32_16x16x32_bf16 v[84:87], v[192:195], v[132:135], v[84:87]
ds_read_b128 v[132:135], v23 offset:4352
v_add_f32 v90, 0x3727c5ac, v89
v_rsq_f32 v90, v90
v_mfma_f32_16x16x32_bf16 v[80:83], v[196:199], v[136:139], v[80:83]
ds_read_b128 v[136:139], v23 offset:6144
v_mul_f32 v91, v90, v90
v_sub_f32 v46, 0, v88
v_mfma_f32_16x16x32_bf16 v[84:87], v[196:199], v[140:143], v[84:87]
ds_read_b128 v[140:143], v23 offset:6400
v_mul_f32 v91, v91, v89
v_mov_b32 v20, v90
v_mfma_f32_16x16x32_bf16 v[80:83], v[200:203], v[144:147], v[80:83]
v_add_f32 v91, 0x3727c5ac, v91
v_rsq_f32 v91, v91
v_mfma_f32_16x16x32_bf16 v[84:87], v[200:203], v[148:151], v[84:87]
v_mul_f32 v21, v46, v90
v_mul_f32 v91, v91, v90
s_add_u32 m0, s23, 8192
s_xor_b32 s38, s22, 139264
buffer_load_dwordx4 v1, s[4:7], s38 offen offset:0 sc1 lds
buffer_load_dwordx4 v1, s[4:7], s38 offen offset:1024 sc1 lds
s_waitcnt lgkmcnt(0)
s_barrier
v_mfma_f32_16x16x32_bf16 v[80:83], v[204:207], v[152:155], v[80:83]
s_add_u32 m0, s23, 32768
s_xor_b32 s38, s22, 155648
buffer_load_dwordx4 v1, s[4:7], s38 offen offset:0 sc1 lds
buffer_load_dwordx4 v1, s[4:7], s38 offen offset:1024 sc1 lds
v_mfma_f32_16x16x32_bf16 v[84:87], v[204:207], v[156:159], v[84:87]
v_mul_f32 v19, 0xc0135761, v91
v_mul_f32 v18, v91, v91
v_mfma_f32_16x16x32_bf16 v[80:83], v[208:211], v[112:115], v[80:83]
v_rcp_f32 v47, v91
v_cndmask_b32 v44, v1, v6, s[92:93]
s_add_u32 m0, s23, 16384
s_xor_b32 s38, s22, 131072
buffer_load_dwordx4 v44, s[4:7], s38 offen offset:0 sc1 lds
buffer_load_dwordx4 v44, s[4:7], s38 offen offset:1024 sc1 lds
v_mfma_f32_16x16x32_bf16 v[84:87], v[208:211], v[116:119], v[84:87]
v_mul_f32 v18, v18, v19
v_mul_f32 v18, 0x3d372713, v18
v_mfma_f32_16x16x32_bf16 v[80:83], v[212:215], v[120:123], v[80:83]
v_lshlrev_b32 v104, 16, v108
v_and_b32 v105, s36, v108
v_mfma_f32_16x16x32_bf16 v[84:87], v[212:215], v[124:127], v[84:87]
v_lshlrev_b32 v106, 16, v109
v_and_b32 v107, s36, v109
v_mfma_f32_16x16x32_bf16 v[80:83], v[216:219], v[128:131], v[80:83]
s_add_u32 m0, s23, 24576
s_xor_b32 s38, s22, 147456
buffer_load_dwordx4 v6, s[4:7], s38 offen offset:0 sc1 lds
buffer_load_dwordx4 v6, s[4:7], s38 offen offset:1024 sc1 lds
v_mfma_f32_16x16x32_bf16 v[84:87], v[216:219], v[132:135], v[84:87]
v_lshlrev_b32 v108, 16, v110
v_and_b32 v109, s36, v110
v_mfma_f32_16x16x32_bf16 v[80:83], v[220:223], v[136:139], v[80:83]
v_lshlrev_b32 v110, 16, v111
v_and_b32 v111, s36, v111
v_mfma_f32_16x16x32_bf16 v[84:87], v[220:223], v[140:143], v[84:87]
v_fma_f32 v104, v104, v20, v21
v_fma_f32 v105, v105, v20, v21
v_fma_f32 v106, v106, v20, v21
v_fma_f32 v107, v107, v20, v21
v_pk_fma_f32 v[108:109], v[108:109], v[20:21], v[20:21] op_sel:[0,0,1] op_sel_hi:[1,0,1]
v_pk_fma_f32 v[110:111], v[110:111], v[20:21], v[20:21] op_sel:[0,0,1] op_sel_hi:[1,0,1]
s_nop 0
v_permlane16_swap_b32 v104, v108
v_permlane16_swap_b32 v80, v84
v_permlane16_swap_b32 v81, v85
v_permlane16_swap_b32 v82, v86
v_permlane16_swap_b32 v83, v87
v_pk_fma_f32 v[80:81], v[96:97], v[46:47], v[80:81] op_sel:[0,0,0] op_sel_hi:[1,0,1]
v_pk_fma_f32 v[82:83], v[98:99], v[46:47], v[82:83] op_sel:[0,0,0] op_sel_hi:[1,0,1]
v_pk_fma_f32 v[84:85], v[100:101], v[46:47], v[84:85] op_sel:[0,0,0] op_sel_hi:[1,0,1]
v_pk_fma_f32 v[86:87], v[102:103], v[46:47], v[86:87] op_sel:[0,0,0] op_sel_hi:[1,0,1]
v_pk_mul_f32 v[88:89], v[80:81], v[80:81]
v_pk_mul_f32 v[90:91], v[82:83], v[82:83]
v_pk_mul_f32 v[92:93], v[84:85], v[84:85]
v_pk_mul_f32 v[94:95], v[86:87], v[86:87]
v_pk_fma_f32 v[88:89], v[88:89], v[18:19], v[18:19] op_sel:[0,0,1] op_sel_hi:[1,0,1]
v_pk_fma_f32 v[90:91], v[90:91], v[18:19], v[18:19] op_sel:[0,0,1] op_sel_hi:[1,0,1]
v_pk_fma_f32 v[92:93], v[92:93], v[18:19], v[18:19] op_sel:[0,0,1] op_sel_hi:[1,0,1]
v_pk_fma_f32 v[94:95], v[94:95], v[18:19], v[18:19] op_sel:[0,0,1] op_sel_hi:[1,0,1]
v_pk_mul_f32 v[88:89], v[88:89], v[80:81]
v_pk_mul_f32 v[90:91], v[90:91], v[82:83]
v_pk_mul_f32 v[92:93], v[92:93], v[84:85]
v_pk_mul_f32 v[94:95], v[94:95], v[86:87]
v_exp_f32 v88, v88
v_exp_f32 v89, v89
v_exp_f32 v90, v90
v_exp_f32 v91, v91
v_exp_f32 v92, v92
v_exp_f32 v93, v93
v_exp_f32 v94, v94
v_exp_f32 v95, v95
v_pk_fma_f32 v[88:89], v[88:89], v[46:47], v[46:47] op_sel:[0,1,1] op_sel_hi:[1,1,1]
v_pk_fma_f32 v[90:91], v[90:91], v[46:47], v[46:47] op_sel:[0,1,1] op_sel_hi:[1,1,1]
v_pk_fma_f32 v[92:93], v[92:93], v[46:47], v[46:47] op_sel:[0,1,1] op_sel_hi:[1,1,1]
v_pk_fma_f32 v[94:95], v[94:95], v[46:47], v[46:47] op_sel:[0,1,1] op_sel_hi:[1,1,1]
v_rcp_f32 v88, v88
v_rcp_f32 v89, v89
v_rcp_f32 v90, v90
s_waitcnt vmcnt(6)
ds_read2st64_b32 v[56:57], v0 offset0:32 offset1:36
s_waitcnt vmcnt(4)
ds_read2st64_b32 v[58:59], v0 offset0:128 offset1:132
v_rcp_f32 v91, v91
v_rcp_f32 v92, v92
v_rcp_f32 v93, v93
v_rcp_f32 v94, v94
v_rcp_f32 v95, v95
v_pk_mul_f32 v[88:89], v[88:89], v[80:81]
v_pk_mul_f32 v[90:91], v[90:91], v[82:83]
v_pk_mul_f32 v[92:93], v[92:93], v[84:85]
v_pk_mul_f32 v[94:95], v[94:95], v[86:87]
v_cvt_pk_bf16_f32 v96, v88, v89
v_cvt_pk_bf16_f32 v97, v90, v91
v_cvt_pk_bf16_f32 v98, v92, v93
v_cvt_pk_bf16_f32 v99, v94, v95
s_cmp_lg_u32 s27, 0
s_cbranch_scc1 sh_29
buffer_store_dwordx4 v[96:99], v5, s[4:7], s33 offen offset:0
sh_29b:
s_add_u32 s62, s41, 32768
buffer_store_dwordx4 v[96:99], v4, s[4:7], s62 offen
s_waitcnt lgkmcnt(0)
v_max3_u32 v56, v56, v57, v58
v_max_u32 v56, v56, v59
v_cmp_eq_u32 vcc, -1, v56
s_cbranch_vccnz re_30
re_30b:
s_barrier
s_mov_b32 exec_hi, 0x00ffffff
s_xor_b32 s38, s18, 9
s_mul_i32 s38, s38, 7168
s_add_u32 m0, s39, s38
s_lshl4_add_u32 s38, s38, s16
buffer_load_dwordx4 v16, s[56:59], s38 offen lds
s_add_u32 m0, m0, 896
s_add_u32 s38, s38, 28672
buffer_load_dwordx4 v16, s[56:59], s38 offen lds
s_mov_b32 exec_hi, -1
ds_read_b128 v[112:115], v23 offset:8192
ds_read_b128 v[116:119], v23 offset:8448
s_mov_b32 exec_hi, 0x00ffffff
s_xor_b32 s38, s18, 10
s_mul_i32 s38, s38, 7168
s_add_u32 m0, s39, s38
s_lshl4_add_u32 s38, s38, s16
buffer_load_dwordx4 v16, s[56:59], s38 offen lds
s_add_u32 m0, m0, 896
s_add_u32 s38, s38, 28672
buffer_load_dwordx4 v16, s[56:59], s38 offen lds
s_mov_b32 exec_hi, -1
ds_read_b128 v[120:123], v23 offset:10240
s_cmp_eq_u32 s66, 0
s_cbranch_scc1 skip_31
v_cndmask_b32 v44, v1, v6, s[92:93]
s_add_u32 m0, s23, 16384
s_xor_b32 s38, s22, 131072
buffer_load_dwordx4 v44, s[4:7], s38 offen offset:0 sc1 lds
buffer_load_dwordx4 v44, s[4:7], s38 offen offset:1024 sc1 lds
s_add_u32 m0, s23, 24576
s_xor_b32 s38, s22, 147456
buffer_load_dwordx4 v6, s[4:7], s38 offen offset:0 sc1 lds
buffer_load_dwordx4 v6, s[4:7], s38 offen offset:1024 sc1 lds
skip_31:
s_waitcnt lgkmcnt(1)
v_mfma_f32_16x16x32_bf16 v[48:51], v[224:227], v[112:115], v[72:75]
s_mov_b32 exec_hi, 0x00ffffff
s_xor_b32 s38, s18, 11
s_mul_i32 s38, s38, 7168
s_add_u32 m0, s39, s38
s_lshl4_add_u32 s38, s38, s16
buffer_load_dwordx4 v16, s[56:59], s38 offen lds
s_add_u32 m0, m0, 896
s_add_u32 s38, s38, 28672
buffer_load_dwordx4 v16, s[56:59], s38 offen lds
s_mov_b32 exec_hi, -1
v_mfma_f32_16x16x32_bf16 v[52:55], v[224:227], v[116:119], v[76:79]
s_mov_b32 exec_hi, 0x00ffffff
s_xor_b32 s38, s18, 12
s_mul_i32 s38, s38, 7168
s_add_u32 m0, s39, s38
s_lshl4_add_u32 s38, s38, s16
buffer_load_dwordx4 v16, s[56:59], s38 offen lds
s_add_u32 m0, m0, 896
s_add_u32 s38, s38, 28672
buffer_load_dwordx4 v16, s[56:59], s38 offen lds
s_mov_b32 exec_hi, -1
v_mov_b32 v78, 0
v_mov_b32 v79, 0
ds_read_b128 v[124:127], v23 offset:10496
ds_read_b128 v[128:131], v23 offset:12288
ds_read_b128 v[132:135], v23 offset:12544
ds_read_b128 v[136:139], v23 offset:14336
ds_read_b128 v[140:143], v23 offset:14592
s_mov_b32 exec_hi, 0x00ffffff
s_xor_b32 s38, s18, 13
s_mul_i32 s38, s38, 7168
s_add_u32 m0, s39, s38
s_lshl4_add_u32 s38, s38, s16
buffer_load_dwordx4 v16, s[56:59], s38 offen lds
s_add_u32 m0, m0, 896
s_add_u32 s38, s38, 28672
buffer_load_dwordx4 v16, s[56:59], s38 offen lds
s_mov_b32 exec_hi, -1
s_waitcnt lgkmcnt(4)
v_mfma_f32_16x16x32_bf16 v[48:51], v[228:231], v[120:123], v[48:51]
ds_read_b128 v[112:115], v23 offset:32768
ds_read_b128 v[116:119], v23 offset:33024
v_mfma_f32_16x16x32_bf16 v[52:55], v[228:231], v[124:127], v[52:55]
ds_read_b128 v[120:123], v23 offset:34816
ds_read_b128 v[124:127], v23 offset:35072
s_waitcnt lgkmcnt(6)
v_mfma_f32_16x16x32_bf16 v[48:51], v[232:235], v[128:131], v[48:51]
ds_read_b128 v[128:131], v23 offset:36864
v_permlane16_swap_b32 v105, v109
v_mfma_f32_16x16x32_bf16 v[52:55], v[232:235], v[132:135], v[52:55]
ds_read_b128 v[132:135], v23 offset:37120
v_permlane16_swap_b32 v106, v110
s_waitcnt lgkmcnt(6)
v_mfma_f32_16x16x32_bf16 v[48:51], v[236:239], v[136:139], v[48:51]
ds_read_b128 v[136:139], v23 offset:38912
s_waitcnt vmcnt(6)
ds_read2st64_b32 v[56:57], v0 offset0:64 offset1:68
s_waitcnt vmcnt(6)
ds_read2st64_b32 v[58:59], v0 offset0:96 offset1:100
v_mfma_f32_16x16x32_bf16 v[52:55], v[236:239], v[140:143], v[52:55]
ds_read_b128 v[140:143], v23 offset:39168
v_permlane16_swap_b32 v107, v111
s_waitcnt lgkmcnt(8)
v_mfma_f32_16x16x32_bf16 v[48:51], v[240:243], v[112:115], v[48:51]
v_mfma_f32_16x16x32_bf16 v[52:55], v[240:243], v[116:119], v[52:55]
s_waitcnt lgkmcnt(6)
v_mfma_f32_16x16x32_bf16 v[48:51], v[244:247], v[120:123], v[48:51]
v_mfma_f32_16x16x32_bf16 v[52:55], v[244:247], v[124:127], v[52:55]
s_waitcnt lgkmcnt(1)
v_max3_u32 v56, v56, v57, v58
v_max_u32 v56, v56, v59
v_cmp_eq_u32 vcc, -1, v56
s_cbranch_vccnz re_32
re_32b:
s_waitcnt lgkmcnt(0)
s_barrier
v_mfma_f32_16x16x32_bf16 v[48:51], v[248:251], v[128:131], v[48:51]
ds_read_b128 v[112:115], v23 offset:16384
ds_read_b128 v[116:119], v23 offset:16640
v_mfma_f32_16x16x32_bf16 v[52:55], v[248:251], v[132:135], v[52:55]
ds_read_b128 v[120:123], v23 offset:18432
ds_read_b128 v[124:127], v23 offset:18688
v_mfma_f32_16x16x32_bf16 v[48:51], v[252:255], v[136:139], v[48:51]
ds_read_b128 v[128:131], v23 offset:20480
ds_read_b128 v[132:135], v23 offset:20736
v_mfma_f32_16x16x32_bf16 v[52:55], v[252:255], v[140:143], v[52:55]
ds_read_b128 v[136:139], v23 offset:22528
ds_read_b128 v[140:143], v23 offset:22784
s_waitcnt lgkmcnt(6)
v_mfma_f32_16x16x32_bf16 v[48:51], a[224:227], v[112:115], v[48:51]
ds_read_b128 v[112:115], v23 offset:24576
v_mfma_f32_16x16x32_bf16 v[52:55], a[224:227], v[116:119], v[52:55]
ds_read_b128 v[116:119], v23 offset:24832
s_add_u32 m0, s23, 0
s_xor_b32 s38, s22, 172032
buffer_load_dwordx4 v1, s[4:7], s38 offen offset:0 sc1 lds
buffer_load_dwordx4 v1, s[4:7], s38 offen offset:1024 sc1 lds
s_waitcnt lgkmcnt(6)
v_mfma_f32_16x16x32_bf16 v[48:51], a[228:231], v[120:123], v[48:51]
ds_read_b128 v[120:123], v23 offset:26624
s_mov_b64 exec, 0x3f
buffer_load_dword a223, v15, s[4:7], s75 offen sc1
s_mov_b64 exec, -1
v_mfma_f32_16x16x32_bf16 v[52:55], a[228:231], v[124:127], v[52:55]
ds_read_b128 v[124:127], v23 offset:26880
s_waitcnt lgkmcnt(6)
v_mfma_f32_16x16x32_bf16 v[48:51], a[232:235], v[128:131], v[48:51]
ds_read_b128 v[128:131], v23 offset:28672
s_add_u32 m0, s23, 8192
s_xor_b32 s38, s22, 188416
buffer_load_dwordx4 v1, s[4:7], s38 offen offset:0 sc1 lds
buffer_load_dwordx4 v1, s[4:7], s38 offen offset:1024 sc1 lds
v_mfma_f32_16x16x32_bf16 v[52:55], a[232:235], v[132:135], v[52:55]
ds_read_b128 v[132:135], v23 offset:28928
s_waitcnt lgkmcnt(6)
v_mfma_f32_16x16x32_bf16 v[48:51], a[236:239], v[136:139], v[48:51]
ds_read_b128 v[136:139], v23 offset:30720
v_cndmask_b32 v44, v1, v6, s[92:93]
s_add_u32 m0, s23, 32768
s_xor_b32 s38, s22, 163840
buffer_load_dwordx4 v44, s[4:7], s38 offen offset:0 sc1 lds
buffer_load_dwordx4 v44, s[4:7], s38 offen offset:1024 sc1 lds
v_mfma_f32_16x16x32_bf16 v[52:55], a[236:239], v[140:143], v[52:55]
ds_read_b128 v[140:143], v23 offset:30976
s_waitcnt lgkmcnt(6)
v_mfma_f32_16x16x32_bf16 v[48:51], a[240:243], v[112:115], v[48:51]
v_mfma_f32_16x16x32_bf16 v[52:55], a[240:243], v[116:119], v[52:55]
s_waitcnt lgkmcnt(4)
v_mfma_f32_16x16x32_bf16 v[48:51], a[244:247], v[120:123], v[48:51]
v_mfma_f32_16x16x32_bf16 v[52:55], a[244:247], v[124:127], v[52:55]
s_waitcnt lgkmcnt(2)
v_mfma_f32_16x16x32_bf16 v[48:51], a[248:251], v[128:131], v[48:51]
v_mfma_f32_16x16x32_bf16 v[52:55], a[248:251], v[132:135], v[52:55]
s_waitcnt lgkmcnt(0)
v_mfma_f32_16x16x32_bf16 v[48:51], a[252:255], v[136:139], v[48:51]
v_mfma_f32_16x16x32_bf16 v[52:55], a[252:255], v[140:143], v[52:55]
s_nop 4
v_cvt_pk_bf16_f32 v56, v48, v49
v_xor_b32 v48, s24, v1
v_cvt_pk_bf16_f32 v57, v50, v51
v_cvt_pk_bf16_f32 v58, v52, v53
v_cvt_pk_bf16_f32 v59, v54, v55
s_nop 0
v_permlane16_swap_b32 v56, v58
v_permlane16_swap_b32 v57, v59
ds_write_b128 v48, v[56:59]
s_add_u32 s62, s34, 393216
buffer_store_dwordx4 v[56:59], v1, s[4:7], s62 offen
s_waitcnt lgkmcnt(0)
s_barrier
ds_read_b128 v[52:55], v12 offset:40960
s_add_u32 m0, s23, 16384
s_xor_b32 s38, s22, 180224
buffer_load_dwordx4 v6, s[4:7], s38 offen offset:0 sc1 lds
buffer_load_dwordx4 v6, s[4:7], s38 offen offset:1024 sc1 lds
s_waitcnt lgkmcnt(0)
v_lshlrev_b32 v48, 16, v52
v_and_b32 v49, s36, v52
v_lshlrev_b32 v50, 16, v53
v_and_b32 v51, s36, v53
v_lshlrev_b32 v52, 16, v54
v_and_b32 v53, s36, v54
v_lshlrev_b32 v54, 16, v55
v_and_b32 v55, s36, v55
v_pk_add_f32 v[60:61], v[48:49], v[50:51]
v_pk_mul_f32 v[62:63], v[48:49], v[48:49]
v_pk_fma_f32 v[62:63], v[50:51], v[50:51], v[62:63] op_sel:[0,0,0] op_sel_hi:[1,1,1]
v_pk_add_f32 v[60:61], v[60:61], v[52:53]
v_pk_fma_f32 v[62:63], v[52:53], v[52:53], v[62:63] op_sel:[0,0,0] op_sel_hi:[1,1,1]
v_pk_add_f32 v[60:61], v[60:61], v[54:55]
v_pk_fma_f32 v[62:63], v[54:55], v[54:55], v[62:63] op_sel:[0,0,0] op_sel_hi:[1,1,1]
v_add_f32 v60, v60, v61
v_add_f32 v62, v62, v63
v_pk_add_f32 v[24:25], v[24:25], v[48:49]
v_pk_add_f32 v[26:27], v[26:27], v[50:51]
v_permlane32_swap_b32 v60, v62
v_add_f32 v60, v60, v62
v_mov_b32 v62, v60
v_pk_add_f32 v[28:29], v[28:29], v[52:53]
v_pk_add_f32 v[30:31], v[30:31], v[54:55]
v_permlane16_swap_b32 v60, v62
v_add_f32 v60, v60, v62
s_nop 1
v_add_f32_dpp v60, v60, v60 row_ror:8 row_mask:0xf bank_mask:0xf
s_waitcnt vmcnt(8)
ds_read2st64_b32 v[20:21], v0 offset0:0 offset1:4
s_waitcnt vmcnt(2)
s_barrier
s_add_u32 s62, s42, 532480
buffer_store_dword v60, v8, s[4:7], s62 offen offset:0
s_waitcnt lgkmcnt(0)
v_max_u32 v20, v20, v21
v_cmp_eq_u32 vcc, -1, v20
s_cbranch_vccnz re_33
re_33b:
s_barrier
ds_read_b128 v[88:91], v23 offset:0
ds_read_b128 v[92:95], v23 offset:256
ds_read_b128 v[96:99], v23 offset:2048
ds_read_b128 v[100:103], v23 offset:2304
ds_read2st64_b32 v[20:21], v0 offset0:32 offset1:36
s_mov_b32 exec_hi, 0x00ffffff
s_xor_b32 s38, s18, 14
s_mul_i32 s38, s38, 7168
s_add_u32 m0, s39, s38
s_lshl4_add_u32 s38, s38, s16
buffer_load_dwordx4 v16, s[56:59], s38 offen lds
s_add_u32 m0, m0, 896
s_add_u32 s38, s38, 28672
buffer_load_dwordx4 v16, s[56:59], s38 offen lds
s_mov_b32 exec_hi, -1
s_waitcnt vmcnt(3)
ds_read2st64_b32 v[46:47], v0 offset0:64 offset1:68
s_waitcnt lgkmcnt(1)
v_max_u32 v20, v20, v21
v_cmp_eq_u32 vcc, -1, v20
s_cbranch_vccnz re_34
re_34b:
ds_read2st64_b32 v[20:21], v0 offset0:128 offset1:132
v_mfma_f32_16x16x32_bf16 v[80:83], v[224:227], v[88:91], v[104:107]
ds_read_b128 v[88:91], v23 offset:4096
s_mov_b32 exec_hi, 0x00ffffff
s_xor_b32 s38, s18, 15
s_mul_i32 s38, s38, 7168
s_add_u32 m0, s39, s38
s_lshl4_add_u32 s38, s38, s16
buffer_load_dwordx4 v16, s[56:59], s38 offen lds
s_add_u32 m0, m0, 896
s_add_u32 s38, s38, 28672
buffer_load_dwordx4 v16, s[56:59], s38 offen lds
s_mov_b32 exec_hi, -1
s_waitcnt lgkmcnt(1)
v_max3_u32 v20, v20, v21, v46
v_max_u32 v20, v20, v47
v_cmp_eq_u32 vcc, -1, v20
s_cbranch_vccnz re_35
re_35b:
v_cndmask_b32 v44, 0, 64, s[30:31]
v_add_u32 v6, v6, v44
v_mfma_f32_16x16x32_bf16 v[84:87], v[224:227], v[92:95], v[108:111]
ds_read_b128 v[92:95], v23 offset:4352
v_mov_b32 v44, 0x3f803f80
pg_2:
s_cbranch_execz pg_6
v_mov_b32 v46, 0x3f803f80
v_mfma_f32_16x16x32_bf16 v[80:83], v[228:231], v[96:99], v[80:83]
ds_read_b128 v[96:99], v23 offset:6144
v_mov_b32 v47, 0x3f803f80
v_mfma_f32_16x16x32_bf16 v[84:87], v[228:231], v[100:103], v[84:87]
ds_read_b128 v[100:103], v23 offset:6400
s_waitcnt lgkmcnt(2)
v_mfma_f32_16x16x32_bf16 v[80:83], v[232:235], v[88:91], v[80:83]
v_mfma_f32_16x16x32_bf16 v[84:87], v[232:235], v[92:95], v[84:87]
s_waitcnt lgkmcnt(0)
s_barrier
ds_read_b128 v[88:91], v23 offset:8192
ds_read_b128 v[92:95], v23 offset:8448
v_mfma_f32_16x16x32_bf16 v[80:83], v[236:239], v[96:99], v[80:83]
ds_read_b128 v[96:99], v23 offset:10240
v_mfma_f32_16x16x32_bf16 v[84:87], v[236:239], v[100:103], v[84:87]
ds_read_b128 v[100:103], v23 offset:10496
s_waitcnt lgkmcnt(2)
v_mfma_f32_16x16x32_bf16 v[80:83], v[240:243], v[88:91], v[80:83]
ds_read_b128 v[88:91], v23 offset:12288
v_mfma_f32_16x16x32_bf16 v[84:87], v[240:243], v[92:95], v[84:87]
ds_read_b128 v[92:95], v23 offset:12544
s_waitcnt lgkmcnt(2)
v_mfma_f32_16x16x32_bf16 v[80:83], v[244:247], v[96:99], v[80:83]
ds_read_b128 v[96:99], v23 offset:14336
v_mfma_f32_16x16x32_bf16 v[84:87], v[244:247], v[100:103], v[84:87]
ds_read_b128 v[100:103], v23 offset:14592
s_waitcnt lgkmcnt(2)
v_mfma_f32_16x16x32_bf16 v[80:83], v[248:251], v[88:91], v[80:83]
v_mfma_f32_16x16x32_bf16 v[84:87], v[248:251], v[92:95], v[84:87]
s_waitcnt lgkmcnt(0)
s_barrier
ds_read_b128 v[88:91], v23 offset:32768
ds_read_b128 v[92:95], v23 offset:33024
v_mfma_f32_16x16x32_bf16 v[80:83], v[252:255], v[96:99], v[80:83]
ds_read_b128 v[96:99], v23 offset:34816
v_mfma_f32_16x16x32_bf16 v[84:87], v[252:255], v[100:103], v[84:87]
ds_read_b128 v[100:103], v23 offset:35072
s_waitcnt lgkmcnt(2)
v_mfma_f32_16x16x32_bf16 v[80:83], a[224:227], v[88:91], v[80:83]
ds_read_b128 v[88:91], v23 offset:36864
v_mfma_f32_16x16x32_bf16 v[84:87], a[224:227], v[92:95], v[84:87]
ds_read_b128 v[92:95], v23 offset:37120
s_waitcnt lgkmcnt(2)
v_mfma_f32_16x16x32_bf16 v[80:83], a[228:231], v[96:99], v[80:83]
ds_read_b128 v[96:99], v23 offset:38912
v_mfma_f32_16x16x32_bf16 v[84:87], a[228:231], v[100:103], v[84:87]
ds_read_b128 v[100:103], v23 offset:39168
s_lshl_b32 s60, s71, 8
v_xor_b32 v112, s60, v1
s_add_u32 s62, s51, 532480
buffer_load_dwordx4 v[116:119], v112, s[4:7], s62 offen offset:1024 sc1
buffer_load_dwordx4 v[112:115], v112, s[4:7], s62 offen offset:0 sc1
s_waitcnt lgkmcnt(2)
v_mfma_f32_16x16x32_bf16 v[80:83], a[232:235], v[88:91], v[80:83]
ds_read_b128 v[88:91], v23 offset:16384
s_lshl2_add_u32 m0, s46, 114688
s_lshl4_add_u32 s3, s82, s49
buffer_load_dwordx4 v42, s[52:55], s3 offen offset:0 lds
v_mfma_f32_16x16x32_bf16 v[84:87], a[232:235], v[92:95], v[84:87]
ds_read_b128 v[92:95], v23 offset:16640
s_waitcnt lgkmcnt(2)
v_mfma_f32_16x16x32_bf16 v[80:83], a[236:239], v[96:99], v[80:83]
ds_read_b128 v[96:99], v23 offset:18432
buffer_load_dwordx4 v11, s[52:55], s3 offen offset:1024 lds
v_mfma_f32_16x16x32_bf16 v[84:87], a[236:239], v[100:103], v[84:87]
ds_read_b128 v[100:103], v23 offset:18688
s_add_u32 s3, s3, 14336
buffer_load_dwordx4 v42, s[52:55], s3 offen offset:2048 lds
s_waitcnt lgkmcnt(2)
v_mfma_f32_16x16x32_bf16 v[80:83], a[240:243], v[88:91], v[80:83]
ds_read_b128 v[88:91], v23 offset:20480
buffer_load_dwordx4 v11, s[52:55], s3 offen offset:3072 lds
v_mfma_f32_16x16x32_bf16 v[84:87], a[240:243], v[92:95], v[84:87]
ds_read_b128 v[92:95], v23 offset:20736
s_waitcnt lgkmcnt(2)
v_mfma_f32_16x16x32_bf16 v[80:83], a[244:247], v[96:99], v[80:83]
ds_read_b128 v[96:99], v23 offset:22528
s_waitcnt vmcnt(6)
s_barrier
v_mfma_f32_16x16x32_bf16 v[84:87], a[244:247], v[100:103], v[84:87]
ds_read_b128 v[100:103], v23 offset:22784
ds_read_b64_tr_b16 v[144:145], v13 offset:0
ds_read_b64_tr_b16 v[146:147], v13 offset:1792
s_waitcnt lgkmcnt(4)
v_mfma_f32_16x16x32_bf16 v[80:83], a[248:251], v[88:91], v[80:83]
ds_read_b64_tr_b16 v[148:149], v13 offset:32
ds_read_b64_tr_b16 v[150:151], v13 offset:1824
ds_read_b64_tr_b16 v[152:153], v13 offset:64
v_mfma_f32_16x16x32_bf16 v[84:87], a[248:251], v[92:95], v[84:87]
ds_read_b64_tr_b16 v[154:155], v13 offset:1856
ds_read_b64_tr_b16 v[156:157], v14 offset:0
ds_read_b64_tr_b16 v[158:159], v14 offset:1792
s_waitcnt lgkmcnt(8)
v_mfma_f32_16x16x32_bf16 v[80:83], a[252:255], v[96:99], v[80:83]
v_mfma_f32_16x16x32_bf16 v[84:87], a[252:255], v[100:103], v[84:87]
s_waitcnt vmcnt(4)
v_add_f32 v112, v112, v116
v_add_f32 v113, v113, v117
v_pk_add_f32 v[114:115], v[114:115], v[118:119]
v_pk_add_f32 v[112:113], v[112:113], v[114:115]
v_cvt_pk_bf16_f32 v88, v80, v81
v_xor_b32 v80, s24, v1
v_permlane32_swap_b32 v112, v113
v_add_f32 v112, v112, v113
v_cmp_u_f32 vcc, v112, v112
s_cbranch_vccnz re_36
re_36b:
s_xor_b32 s64, s50, 393216
s_sub_u32 s64, s64, 114688
buffer_load_dwordx4 v[120:123], v23, s[4:7], s64 offen offset:0 sc1
v_mul_f32 v112, 0x3b000000, v112
v_mov_b32 v113, v112
s_xor_b32 s67, s64, 256
buffer_load_dwordx4 v[124:127], v23, s[4:7], s67 offen offset:0 sc1
v_permlane32_swap_b32 v112, v113
buffer_load_dwordx4 v[128:131], v23, s[4:7], s64 offen offset:2048 sc1
v_fma_f32 v113, -v112, v112, v113
s_xor_b32 s64, s50, 397312
s_sub_u32 s64, s64, 114688
buffer_load_dwordx4 v[136:139], v23, s[4:7], s64 offen offset:0 sc1
v_max_f32 v113, 0, v113
v_add_f32 v114, 0x3727c5ac, v113
v_rsq_f32 v114, v114
v_cvt_pk_bf16_f32 v113, -v112, -v112
buffer_load_dwordx4 v[132:135], v23, s[4:7], s67 offen offset:2048 sc1
v_lshlrev_b32 v113, 16, v113
v_sub_f32 v113, -v112, v113
v_mul_f32 v19, 0xc0135761, v114
v_mul_f32 v18, v114, v114
s_xor_b32 s67, s64, 256
buffer_load_dwordx4 v[140:143], v23, s[4:7], s67 offen offset:0 sc1
v_rcp_f32 v40, v114
v_mul_f32 v18, v18, v19
v_mul_f32 v18, 0x3d372713, v18
v_cvt_pk_bf16_f32 v22, -v112, v113
v_cvt_pk_bf16_f32 v89, v82, v83
v_cvt_pk_bf16_f32 v90, v84, v85
v_cvt_pk_bf16_f32 v91, v86, v87
s_nop 0
v_permlane16_swap_b32 v88, v90
v_permlane16_swap_b32 v89, v91
buffer_load_dwordx4 v[112:115], v23, s[4:7], s64 offen offset:2048 sc1
ds_write_b128 v80, v[88:91]
s_add_u32 s62, s34, 425984
buffer_store_dwordx4 v[88:91], v1, s[4:7], s62 offen
s_waitcnt lgkmcnt(0)
s_barrier
ds_read_b128 v[84:87], v12 offset:40960
buffer_load_dwordx4 v[116:119], v23, s[4:7], s67 offen offset:2048 sc1
s_waitcnt lgkmcnt(0)
v_lshlrev_b32 v80, 16, v84
v_and_b32 v81, s36, v84
v_lshlrev_b32 v82, 16, v85
s_lshl2_add_u32 m0, s46, 131072
s_lshl4_add_u32 s3, s82, s17
buffer_load_dwordx4 v42, s[52:55], s3 offen offset:0 lds
s_waitcnt vmcnt(12)
ds_read_b64_tr_b16 a[96:97], v43 offset:36864
ds_read_b64_tr_b16 a[100:101], v43 offset:36872
ds_read_b64_tr_b16 a[98:99], v43 offset:37120
ds_read_b64_tr_b16 a[102:103], v43 offset:37128
v_and_b32 v83, s36, v85
v_lshlrev_b32 v84, 16, v86
v_and_b32 v85, s36, v86
v_lshlrev_b32 v86, 16, v87
v_and_b32 v87, s36, v87
v_pk_add_f32 v[92:93], v[80:81], v[82:83]
buffer_load_dwordx4 v11, s[52:55], s3 offen offset:1024 lds
v_pk_mul_f32 v[94:95], v[80:81], v[80:81]
v_pk_fma_f32 v[94:95], v[82:83], v[82:83], v[94:95] op_sel:[0,0,0] op_sel_hi:[1,1,1]
v_pk_add_f32 v[92:93], v[92:93], v[84:85]
v_pk_fma_f32 v[94:95], v[84:85], v[84:85], v[94:95] op_sel:[0,0,0] op_sel_hi:[1,1,1]
v_pk_add_f32 v[92:93], v[92:93], v[86:87]
v_pk_fma_f32 v[94:95], v[86:87], v[86:87], v[94:95] op_sel:[0,0,0] op_sel_hi:[1,1,1]
v_add_f32 v92, v92, v93
v_add_f32 v94, v94, v95
v_pk_add_f32 v[32:33], v[32:33], v[80:81]
v_pk_add_f32 v[34:35], v[34:35], v[82:83]
s_xor_b32 s64, s50, 401408
s_sub_u32 s64, s64, 114688
buffer_load_dwordx4 v[80:83], v23, s[4:7], s64 offen offset:0 sc1
v_permlane32_swap_b32 v92, v94
s_waitcnt vmcnt(11)
v_mfma_f32_16x16x32_bf16 v[48:51], v[144:147], v[120:123], 0
ds_read_b64_tr_b16 a[104:105], v43 offset:38912
ds_read_b64_tr_b16 a[108:109], v43 offset:38920
ds_read_b64_tr_b16 a[106:107], v43 offset:39168
s_waitcnt vmcnt(10)
v_mfma_f32_16x16x32_bf16 v[52:55], v[144:147], v[124:127], 0
ds_read_b64_tr_b16 v[144:145], v13 offset:7168
s_add_u32 s3, s3, 14336
buffer_load_dwordx4 v42, s[52:55], s3 offen offset:2048 lds
v_mfma_f32_16x16x32_bf16 v[56:59], v[148:151], v[120:123], 0
ds_read_b64_tr_b16 v[146:147], v13 offset:8960
ds_read_b64_tr_b16 a[110:111], v43 offset:39176
v_add_f32 v92, v92, v94
v_mfma_f32_16x16x32_bf16 v[60:63], v[148:151], v[124:127], 0
ds_read_b64_tr_b16 v[148:149], v13 offset:7200
v_mov_b32 v94, v92
v_add_f32 v36, v36, v84
v_add_f32 v37, v37, v85
v_mfma_f32_16x16x32_bf16 v[64:67], v[152:155], v[120:123], 0
ds_read_b64_tr_b16 v[150:151], v13 offset:8992
v_permlane16_swap_b32 v92, v94
v_mfma_f32_16x16x32_bf16 v[68:71], v[152:155], v[124:127], 0
ds_read_b64_tr_b16 v[152:153], v13 offset:7232
buffer_load_dwordx4 v[124:127], v23, s[4:7], s64 offen offset:2048 sc1
v_mfma_f32_16x16x32_bf16 v[72:75], v[156:159], v[120:123], 0
ds_read_b64_tr_b16 v[154:155], v13 offset:9024
ds_read_b64_tr_b16 v[156:157], v14 offset:7168
v_add_f32 v92, v92, v94
s_waitcnt vmcnt(11) lgkmcnt(6)
v_mfma_f32_16x16x32_bf16 v[48:51], v[144:147], v[128:131], v[48:51]
ds_read_b64_tr_b16 v[158:159], v14 offset:8960
v_add_f32_dpp v92, v92, v92 row_ror:8 row_mask:0xf bank_mask:0xf
v_add_f32 v38, v38, v86
v_add_f32 v39, v39, v87
s_waitcnt vmcnt(9)
v_mfma_f32_16x16x32_bf16 v[52:55], v[144:147], v[132:135], v[52:55]
ds_read_b64_tr_b16 v[144:145], v13 offset:14336
s_xor_b32 s67, s64, 256
buffer_load_dwordx4 v[120:123], v23, s[4:7], s67 offen offset:0 sc1
s_waitcnt lgkmcnt(5)
v_mfma_f32_16x16x32_bf16 v[56:59], v[148:151], v[128:131], v[56:59]
ds_read_b64_tr_b16 v[146:147], v13 offset:16128
s_waitcnt vmcnt(7)
s_barrier
v_mfma_f32_16x16x32_bf16 v[60:63], v[148:151], v[132:135], v[60:63]
ds_read_b64_tr_b16 v[148:149], v13 offset:14368
s_add_u32 s62, s42, 532480
buffer_store_dword v92, v8, s[4:7], s62 offen offset:2048
s_waitcnt lgkmcnt(5)
v_mfma_f32_16x16x32_bf16 v[64:67], v[152:155], v[128:131], v[64:67]
ds_read_b64_tr_b16 v[150:151], v13 offset:16160
buffer_load_dwordx4 v[84:87], v23, s[4:7], s67 offen offset:2048 sc1
v_mfma_f32_16x16x32_bf16 v[68:71], v[152:155], v[132:135], v[68:71]
ds_read_b64_tr_b16 v[152:153], v13 offset:14400
s_waitcnt lgkmcnt(5)
v_mfma_f32_16x16x32_bf16 v[72:75], v[156:159], v[128:131], v[72:75]
ds_read_b64_tr_b16 v[154:155], v13 offset:16192
ds_read_b64_tr_b16 v[156:157], v14 offset:14336
s_xor_b32 s64, s50, 405504
s_sub_u32 s64, s64, 114688
buffer_load_dwordx4 v[128:131], v23, s[4:7], s64 offen offset:0 sc1
s_waitcnt lgkmcnt(5)
v_mfma_f32_16x16x32_bf16 v[48:51], v[144:147], v[136:139], v[48:51]
ds_read_b64_tr_b16 v[158:159], v14 offset:16128
v_mfma_f32_16x16x32_bf16 v[52:55], v[144:147], v[140:143], v[52:55]
v_mfma_f32_16x16x32_bf16 v[96:99], v[44:47], v[144:147], 0
ds_read_b64_tr_b16 v[144:145], v13 offset:21504
s_xor_b32 s67, s64, 256
buffer_load_dwordx4 v[132:135], v23, s[4:7], s67 offen offset:0 sc1
s_waitcnt lgkmcnt(5)
v_mfma_f32_16x16x32_bf16 v[56:59], v[148:151], v[136:139], v[56:59]
ds_read_b64_tr_b16 v[146:147], v13 offset:23296
v_mfma_f32_16x16x32_bf16 v[60:63], v[148:151], v[140:143], v[60:63]
v_mfma_f32_16x16x32_bf16 v[100:103], v[44:47], v[148:151], 0
ds_read_b64_tr_b16 v[148:149], v13 offset:21536
s_waitcnt lgkmcnt(5)
v_mfma_f32_16x16x32_bf16 v[64:67], v[152:155], v[136:139], v[64:67]
ds_read_b64_tr_b16 v[150:151], v13 offset:23328
buffer_load_dwordx4 v[88:91], v23, s[4:7], s64 offen offset:2048 sc1
v_mfma_f32_16x16x32_bf16 v[68:71], v[152:155], v[140:143], v[68:71]
v_mfma_f32_16x16x32_bf16 v[104:107], v[44:47], v[152:155], 0
ds_read_b64_tr_b16 v[152:153], v13 offset:21568
s_waitcnt lgkmcnt(5)
v_mfma_f32_16x16x32_bf16 v[72:75], v[156:159], v[136:139], v[72:75]
ds_read_b64_tr_b16 v[154:155], v13 offset:23360
s_xor_b32 s64, s50, 409600
s_sub_u32 s64, s64, 114688
buffer_load_dwordx4 v[140:143], v23, s[4:7], s64 offen offset:0 sc1
v_mfma_f32_16x16x32_bf16 v[108:111], v[44:47], v[156:159], 0
ds_read_b64_tr_b16 v[156:157], v14 offset:21504
s_waitcnt lgkmcnt(5)
v_mfma_f32_16x16x32_bf16 v[48:51], v[144:147], v[112:115], v[48:51]
ds_read_b64_tr_b16 v[158:159], v14 offset:23296
s_waitcnt vmcnt(12)
v_mfma_f32_16x16x32_bf16 v[52:55], v[144:147], v[116:119], v[52:55]
v_mfma_f32_16x16x32_bf16 v[96:99], v[44:47], v[144:147], v[96:99]
ds_read_b64_tr_b16 v[144:145], v13 offset:28672
buffer_load_dwordx4 v[136:139], v23, s[4:7], s67 offen offset:2048 sc1
s_waitcnt lgkmcnt(5)
v_mfma_f32_16x16x32_bf16 v[56:59], v[148:151], v[112:115], v[56:59]
ds_read_b64_tr_b16 v[146:147], v13 offset:30464
v_mfma_f32_16x16x32_bf16 v[60:63], v[148:151], v[116:119], v[60:63]
v_mfma_f32_16x16x32_bf16 v[100:103], v[44:47], v[148:151], v[100:103]
ds_read_b64_tr_b16 v[148:149], v13 offset:28704
s_waitcnt lgkmcnt(5)
v_mfma_f32_16x16x32_bf16 v[64:67], v[152:155], v[112:115], v[64:67]
ds_read_b64_tr_b16 v[150:151], v13 offset:30496
s_xor_b32 s67, s64, 256
buffer_load_dwordx4 v[92:95], v23, s[4:7], s67 offen offset:0 sc1
v_mfma_f32_16x16x32_bf16 v[68:71], v[152:155], v[116:119], v[68:71]
v_mfma_f32_16x16x32_bf16 v[104:107], v[44:47], v[152:155], v[104:107]
ds_read_b64_tr_b16 v[152:153], v13 offset:28736
s_waitcnt lgkmcnt(5)
v_mfma_f32_16x16x32_bf16 v[72:75], v[156:159], v[112:115], v[72:75]
ds_read_b64_tr_b16 v[154:155], v13 offset:30528
v_mfma_f32_16x16x32_bf16 v[108:111], v[44:47], v[156:159], v[108:111]
ds_read_b64_tr_b16 v[156:157], v14 offset:28672
buffer_load_dwordx4 v[112:115], v23, s[4:7], s64 offen offset:2048 sc1
s_waitcnt vmcnt(12) lgkmcnt(5)
v_mfma_f32_16x16x32_bf16 v[48:51], v[144:147], v[80:83], v[48:51]
ds_read_b64_tr_b16 v[158:159], v14 offset:30464
ds_read_b64_tr_b16 a[112:113], v43 offset:53248
ds_read_b64_tr_b16 a[116:117], v43 offset:53256
ds_read_b64_tr_b16 a[114:115], v43 offset:53504
ds_read_b64_tr_b16 a[118:119], v43 offset:53512
buffer_load_dwordx4 v[116:119], v23, s[4:7], s67 offen offset:2048 sc1
s_waitcnt vmcnt(10)
v_mfma_f32_16x16x32_bf16 v[52:55], v[144:147], v[120:123], v[52:55]
buffer_load_dwordx4 v11, s[52:55], s3 offen offset:3072 lds
v_mfma_f32_16x16x32_bf16 v[96:99], v[44:47], v[144:147], v[96:99]
ds_read_b64_tr_b16 v[144:145], v13 offset:35840
s_waitcnt lgkmcnt(9)
v_mfma_f32_16x16x32_bf16 v[56:59], v[148:151], v[80:83], v[56:59]
ds_read_b64_tr_b16 v[146:147], v13 offset:37632
v_mfma_f32_16x16x32_bf16 v[60:63], v[148:151], v[120:123], v[60:63]
s_lshl2_add_u32 m0, s46, 114688
s_lshl4_add_u32 s3, s83, s49
buffer_load_dwordx4 v42, s[52:55], s3 offen offset:0 lds
v_mfma_f32_16x16x32_bf16 v[100:103], v[44:47], v[148:151], v[100:103]
ds_read_b64_tr_b16 v[148:149], v13 offset:35872
s_waitcnt lgkmcnt(9)
v_mfma_f32_16x16x32_bf16 v[64:67], v[152:155], v[80:83], v[64:67]
ds_read_b64_tr_b16 v[150:151], v13 offset:37664
v_mfma_f32_16x16x32_bf16 v[68:71], v[152:155], v[120:123], v[68:71]
v_mfma_f32_16x16x32_bf16 v[104:107], v[44:47], v[152:155], v[104:107]
ds_read_b64_tr_b16 v[152:153], v13 offset:35904
s_xor_b32 s64, s50, 413696
s_sub_u32 s64, s64, 114688
buffer_load_dwordx4 v[120:123], v23, s[4:7], s64 offen offset:0 sc1
s_waitcnt lgkmcnt(9)
v_mfma_f32_16x16x32_bf16 v[72:75], v[156:159], v[80:83], v[72:75]
ds_read_b64_tr_b16 v[154:155], v13 offset:37696
v_mfma_f32_16x16x32_bf16 v[108:111], v[44:47], v[156:159], v[108:111]
ds_read_b64_tr_b16 v[156:157], v14 offset:35840
s_waitcnt lgkmcnt(5)
v_mfma_f32_16x16x32_bf16 v[48:51], v[144:147], v[124:127], v[48:51]
ds_read_b64_tr_b16 v[158:159], v14 offset:37632
buffer_load_dwordx4 v[80:83], v23, s[4:7], s64 offen offset:2048 sc1
s_waitcnt vmcnt(12)
v_mfma_f32_16x16x32_bf16 v[52:55], v[144:147], v[84:87], v[52:55]
v_mfma_f32_16x16x32_bf16 v[96:99], v[44:47], v[144:147], v[96:99]
ds_read_b64_tr_b16 v[144:145], v13 offset:43008
s_waitcnt lgkmcnt(5)
v_mfma_f32_16x16x32_bf16 v[56:59], v[148:151], v[124:127], v[56:59]
ds_read_b64_tr_b16 v[146:147], v13 offset:44800
v_mfma_f32_16x16x32_bf16 v[60:63], v[148:151], v[84:87], v[60:63]
buffer_load_dwordx4 v11, s[52:55], s3 offen offset:1024 lds
v_mfma_f32_16x16x32_bf16 v[100:103], v[44:47], v[148:151], v[100:103]
ds_read_b64_tr_b16 v[148:149], v13 offset:43040
s_waitcnt lgkmcnt(5)
v_mfma_f32_16x16x32_bf16 v[64:67], v[152:155], v[124:127], v[64:67]
ds_read_b64_tr_b16 v[150:151], v13 offset:44832
v_mfma_f32_16x16x32_bf16 v[68:71], v[152:155], v[84:87], v[68:71]
v_mfma_f32_16x16x32_bf16 v[104:107], v[44:47], v[152:155], v[104:107]
ds_read_b64_tr_b16 v[152:153], v13 offset:43072
s_add_u32 s3, s3, 14336
buffer_load_dwordx4 v42, s[52:55], s3 offen offset:2048 lds
s_waitcnt lgkmcnt(5)
v_mfma_f32_16x16x32_bf16 v[72:75], v[156:159], v[124:127], v[72:75]
ds_read_b64_tr_b16 v[154:155], v13 offset:44864
v_mfma_f32_16x16x32_bf16 v[108:111], v[44:47], v[156:159], v[108:111]
ds_read_b64_tr_b16 v[156:157], v14 offset:43008
s_waitcnt vmcnt(13) lgkmcnt(5)
v_mfma_f32_16x16x32_bf16 v[48:51], v[144:147], v[128:131], v[48:51]
ds_read_b64_tr_b16 v[158:159], v14 offset:44800
s_xor_b32 s67, s64, 256
buffer_load_dwordx4 v[124:127], v23, s[4:7], s67 offen offset:0 sc1
s_waitcnt vmcnt(13)
v_mfma_f32_16x16x32_bf16 v[52:55], v[144:147], v[132:135], v[52:55]
v_mfma_f32_16x16x32_bf16 v[96:99], v[44:47], v[144:147], v[96:99]
ds_read_b64_tr_b16 v[144:145], v13 offset:50176
s_waitcnt lgkmcnt(5)
v_mfma_f32_16x16x32_bf16 v[56:59], v[148:151], v[128:131], v[56:59]
ds_read_b64_tr_b16 v[146:147], v13 offset:51968
v_mfma_f32_16x16x32_bf16 v[60:63], v[148:151], v[132:135], v[60:63]
s_xor_b32 s64, s50, 417792
s_sub_u32 s64, s64, 114688
buffer_load_dwordx4 v[84:87], v23, s[4:7], s64 offen offset:0 sc1
v_mfma_f32_16x16x32_bf16 v[100:103], v[44:47], v[148:151], v[100:103]
ds_read_b64_tr_b16 v[148:149], v13 offset:50208
s_waitcnt lgkmcnt(5)
v_mfma_f32_16x16x32_bf16 v[64:67], v[152:155], v[128:131], v[64:67]
ds_read_b64_tr_b16 v[150:151], v13 offset:52000
v_mfma_f32_16x16x32_bf16 v[68:71], v[152:155], v[132:135], v[68:71]
v_mfma_f32_16x16x32_bf16 v[104:107], v[44:47], v[152:155], v[104:107]
ds_read_b64_tr_b16 v[152:153], v13 offset:50240
buffer_load_dwordx4 v11, s[52:55], s3 offen offset:3072 lds
s_waitcnt lgkmcnt(5)
v_mfma_f32_16x16x32_bf16 v[72:75], v[156:159], v[128:131], v[72:75]
ds_read_b64_tr_b16 v[154:155], v13 offset:52032
v_mfma_f32_16x16x32_bf16 v[108:111], v[44:47], v[156:159], v[108:111]
ds_read_b64_tr_b16 v[156:157], v14 offset:50176
s_waitcnt vmcnt(14) lgkmcnt(5)
v_mfma_f32_16x16x32_bf16 v[48:51], v[144:147], v[88:91], v[48:51]
ds_read_b64_tr_b16 v[158:159], v14 offset:51968
s_waitcnt vmcnt(12)
v_mfma_f32_16x16x32_bf16 v[52:55], v[144:147], v[136:139], v[52:55]
v_mfma_f32_16x16x32_bf16 v[96:99], v[44:47], v[144:147], v[96:99]
v_add_u32 v13, s65, v13
ds_read_b64_tr_b16 v[144:145], v13 offset:0
s_waitcnt lgkmcnt(5)
v_mfma_f32_16x16x32_bf16 v[56:59], v[148:151], v[88:91], v[56:59]
ds_read_b64_tr_b16 v[146:147], v13 offset:1792
v_mfma_f32_16x16x32_bf16 v[60:63], v[148:151], v[136:139], v[60:63]
s_lshl_b32 s60, s71, 8
v_xor_b32 v128, s60, v1
s_add_u32 s62, s51, 532480
buffer_load_dwordx4 v[132:135], v128, s[4:7], s62 offen offset:3072 sc1
buffer_load_dwordx4 v[128:131], v128, s[4:7], s62 offen offset:2048 sc1
v_mfma_f32_16x16x32_bf16 v[100:103], v[44:47], v[148:151], v[100:103]
ds_read_b64_tr_b16 v[148:149], v13 offset:32
s_waitcnt lgkmcnt(5)
v_mfma_f32_16x16x32_bf16 v[64:67], v[152:155], v[88:91], v[64:67]
ds_read_b64_tr_b16 v[150:151], v13 offset:1824
v_mfma_f32_16x16x32_bf16 v[68:71], v[152:155], v[136:139], v[68:71]
v_mfma_f32_16x16x32_bf16 v[104:107], v[44:47], v[152:155], v[104:107]
ds_read_b64_tr_b16 v[152:153], v13 offset:64
buffer_load_dwordx4 v[136:139], v23, s[4:7], s67 offen offset:2048 sc1
s_waitcnt lgkmcnt(5)
v_mfma_f32_16x16x32_bf16 v[72:75], v[156:159], v[88:91], v[72:75]
ds_read_b64_tr_b16 v[154:155], v13 offset:1856
v_mfma_f32_16x16x32_bf16 v[108:111], v[44:47], v[156:159], v[108:111]
v_add_u32 v14, s65, v14
ds_read_b64_tr_b16 v[156:157], v14 offset:0
s_waitcnt lgkmcnt(5)
v_mfma_f32_16x16x32_bf16 v[48:51], v[144:147], v[140:143], v[48:51]
ds_read_b64_tr_b16 v[158:159], v14 offset:1792
s_waitcnt vmcnt(14)
v_mfma_f32_16x16x32_bf16 v[52:55], v[144:147], v[92:95], v[52:55]
v_mfma_f32_16x16x32_bf16 v[96:99], v[44:47], v[144:147], v[96:99]
ds_read_b64_tr_b16 v[144:145], v13 offset:7168
s_waitcnt vmcnt(11)
ds_read_b64_tr_b16 a[120:121], v43 offset:55296
s_waitcnt lgkmcnt(6)
v_mfma_f32_16x16x32_bf16 v[56:59], v[148:151], v[140:143], v[56:59]
ds_read_b64_tr_b16 v[146:147], v13 offset:8960
ds_read_b64_tr_b16 a[124:125], v43 offset:55304
ds_read_b64_tr_b16 a[122:123], v43 offset:55552
v_mfma_f32_16x16x32_bf16 v[60:63], v[148:151], v[92:95], v[60:63]
ds_read_b64_tr_b16 a[126:127], v43 offset:55560
v_mfma_f32_16x16x32_bf16 v[100:103], v[44:47], v[148:151], v[100:103]
ds_read_b64_tr_b16 v[148:149], v13 offset:7200
s_waitcnt lgkmcnt(9)
v_mfma_f32_16x16x32_bf16 v[64:67], v[152:155], v[140:143], v[64:67]
ds_read_b64_tr_b16 v[150:151], v13 offset:8992
v_mfma_f32_16x16x32_bf16 v[68:71], v[152:155], v[92:95], v[68:71]
s_lshl2_add_u32 m0, s46, 131072
s_lshl4_add_u32 s3, s83, s17
buffer_load_dwordx4 v42, s[52:55], s3 offen offset:0 lds
v_mfma_f32_16x16x32_bf16 v[104:107], v[44:47], v[152:155], v[104:107]
ds_read_b64_tr_b16 v[152:153], v13 offset:7232
buffer_load_dwordx4 v11, s[52:55], s3 offen offset:1024 lds
s_waitcnt lgkmcnt(9)
v_mfma_f32_16x16x32_bf16 v[72:75], v[156:159], v[140:143], v[72:75]
ds_read_b64_tr_b16 v[154:155], v13 offset:9024
s_xor_b32 s67, s64, 256
buffer_load_dwordx4 v[140:143], v23, s[4:7], s67 offen offset:0 sc1
v_mfma_f32_16x16x32_bf16 v[108:111], v[44:47], v[156:159], v[108:111]
ds_read_b64_tr_b16 v[156:157], v14 offset:7168
s_waitcnt lgkmcnt(8)
v_mfma_f32_16x16x32_bf16 v[48:51], v[144:147], v[112:115], v[48:51]
ds_read_b64_tr_b16 v[158:159], v14 offset:8960
v_mfma_f32_16x16x32_bf16 v[52:55], v[144:147], v[116:119], v[52:55]
v_mfma_f32_16x16x32_bf16 v[96:99], v[44:47], v[144:147], v[96:99]
ds_read_b64_tr_b16 v[144:145], v13 offset:14336
s_waitcnt lgkmcnt(5)
v_mfma_f32_16x16x32_bf16 v[56:59], v[148:151], v[112:115], v[56:59]
ds_read_b64_tr_b16 v[146:147], v13 offset:16128
v_mfma_f32_16x16x32_bf16 v[60:63], v[148:151], v[116:119], v[60:63]
s_lshl_b32 s60, s12, 8
s_add_u32 s60, s60, 159744
v_lshrrev_b32 v98, 2, v1
v_add_u32 v98, s60, v98
v_mfma_f32_16x16x32_bf16 v[100:103], v[44:47], v[148:151], v[100:103]
ds_read_b64_tr_b16 v[148:149], v13 offset:14368
s_waitcnt lgkmcnt(5)
v_mfma_f32_16x16x32_bf16 v[64:67], v[152:155], v[112:115], v[64:67]
ds_read_b64_tr_b16 v[150:151], v13 offset:16160
s_add_u32 s3, s3, 14336
buffer_load_dwordx4 v42, s[52:55], s3 offen offset:2048 lds
v_mfma_f32_16x16x32_bf16 v[68:71], v[152:155], v[116:119], v[68:71]
buffer_load_dwordx4 v[116:119], v23, s[4:7], s67 offen offset:2048 sc1
v_mfma_f32_16x16x32_bf16 v[104:107], v[44:47], v[152:155], v[104:107]
ds_read_b64_tr_b16 v[152:153], v13 offset:14400
s_waitcnt vmcnt(12)
ds_read_b64_tr_b16 a[128:129], v43 offset:36864
s_waitcnt lgkmcnt(6)
v_mfma_f32_16x16x32_bf16 v[72:75], v[156:159], v[112:115], v[72:75]
ds_read_b64_tr_b16 v[154:155], v13 offset:16192
buffer_load_dwordx4 v[112:115], v23, s[4:7], s64 offen offset:2048 sc1
v_mfma_f32_16x16x32_bf16 v[108:111], v[44:47], v[156:159], v[108:111]
ds_read_b64_tr_b16 v[156:157], v14 offset:14336
ds_read_b64_tr_b16 a[132:133], v43 offset:36872
ds_read_b64_tr_b16 a[130:131], v43 offset:37120
s_waitcnt lgkmcnt(8)
v_mfma_f32_16x16x32_bf16 v[48:51], v[144:147], v[120:123], v[48:51]
ds_read_b64_tr_b16 v[158:159], v14 offset:16128
buffer_load_dwordx4 v11, s[52:55], s3 offen offset:3072 lds
s_waitcnt vmcnt(12)
v_mfma_f32_16x16x32_bf16 v[52:55], v[144:147], v[124:127], v[52:55]
ds_read_b64_tr_b16 v[144:145], v13 offset:21504
ds_read_b64_tr_b16 a[134:135], v43 offset:37128
v_mov_b32 v110, 0
s_waitcnt lgkmcnt(9)
v_mfma_f32_16x16x32_bf16 v[56:59], v[148:151], v[120:123], v[56:59]
ds_read_b64_tr_b16 v[146:147], v13 offset:23296
v_mov_b32 v111, 0
s_mov_b64 vcc, 0xffff
s_lshl_b64 vcc, vcc, 16
v_cndmask_b32 v96, v96, v100, vcc
v_mfma_f32_16x16x32_bf16 v[60:63], v[148:151], v[124:127], v[60:63]
ds_read_b64_tr_b16 v[148:149], v13 offset:21536
s_mov_b64 vcc, 0xffff
s_lshl_b64 vcc, vcc, 32
v_cndmask_b32 v96, v96, v104, vcc
s_waitcnt lgkmcnt(8)
v_mfma_f32_16x16x32_bf16 v[64:67], v[152:155], v[120:123], v[64:67]
ds_read_b64_tr_b16 v[150:151], v13 offset:23328
s_mov_b64 vcc, 0xffff
s_lshl_b64 vcc, vcc, 48
v_cndmask_b32 v96, v96, v108, vcc
v_mfma_f32_16x16x32_bf16 v[68:71], v[152:155], v[124:127], v[68:71]
ds_read_b64_tr_b16 v[152:153], v13 offset:21568
v_mov_b32 v124, v22
v_mov_b32 v126, 0
s_waitcnt lgkmcnt(6)
v_mfma_f32_16x16x32_bf16 v[72:75], v[156:159], v[120:123], v[72:75]
ds_read_b64_tr_b16 v[154:155], v13 offset:23360
ds_read_b64_tr_b16 v[156:157], v14 offset:21504
v_mov_b32 v120, v22
s_waitcnt lgkmcnt(5)
v_mfma_f32_16x16x32_bf16 v[48:51], v[144:147], v[80:83], v[48:51]
ds_read_b64_tr_b16 v[158:159], v14 offset:23296
v_permlane16_swap_b32 v120, v124
v_mov_b32 v122, 0
s_waitcnt vmcnt(7)
v_mfma_f32_16x16x32_bf16 v[52:55], v[144:147], v[136:139], v[52:55]
ds_read_b64_tr_b16 v[144:145], v13 offset:28672
v_mov_b32 v123, 0
v_mov_b32 v127, 0
s_waitcnt lgkmcnt(5)
v_mfma_f32_16x16x32_bf16 v[56:59], v[148:151], v[80:83], v[56:59]
ds_read_b64_tr_b16 v[146:147], v13 offset:30464
v_mov_b32 v121, v120
v_mov_b32 v125, v124
v_mfma_f32_16x16x32_bf16 v[60:63], v[148:151], v[136:139], v[60:63]
ds_read_b64_tr_b16 v[148:149], v13 offset:28704
v_add_f32 v128, v128, v132
v_add_f32 v129, v129, v133
s_waitcnt lgkmcnt(5)
v_mfma_f32_16x16x32_bf16 v[64:67], v[152:155], v[80:83], v[64:67]
ds_read_b64_tr_b16 v[150:151], v13 offset:30496
v_add_f32 v130, v130, v134
v_add_f32 v131, v131, v135
v_mfma_f32_16x16x32_bf16 v[68:71], v[152:155], v[136:139], v[68:71]
ds_read_b64_tr_b16 v[152:153], v13 offset:28736
v_add_f32 v128, v128, v130
v_add_f32 v129, v129, v131
s_waitcnt lgkmcnt(5)
v_mfma_f32_16x16x32_bf16 v[72:75], v[156:159], v[80:83], v[72:75]
ds_read_b64_tr_b16 v[154:155], v13 offset:30528
ds_read_b64_tr_b16 v[156:157], v14 offset:28672
v_permlane32_swap_b32 v128, v129
s_waitcnt lgkmcnt(5)
v_mfma_f32_16x16x32_bf16 v[48:51], v[144:147], v[84:87], v[48:51]
ds_read_b64_tr_b16 v[158:159], v14 offset:30464
v_add_f32 v128, v128, v129
v_cmp_u_f32 vcc, v128, v128
s_cbranch_vccnz re_37
re_37b:
v_mul_f32 v128, 0x3b000000, v128
v_mov_b32 v129, v128
ds_read_b64_tr_b16 a[136:137], v43 offset:38912
ds_read_b64_tr_b16 a[140:141], v43 offset:38920
v_permlane32_swap_b32 v128, v129
v_fma_f32 v129, -v128, v128, v129
v_max_f32 v129, 0, v129
v_add_f32 v130, 0x3727c5ac, v129
v_rsq_f32 v130, v130
v_cvt_pk_bf16_f32 v129, -v128, -v128
v_lshlrev_b32 v129, 16, v129
v_sub_f32 v129, -v128, v129
v_mul_f32 v21, 0xc0135761, v130
v_mul_f32 v20, v130, v130
v_rcp_f32 v41, v130
v_mul_f32 v20, v20, v21
v_mul_f32 v20, 0x3d372713, v20
v_cvt_pk_bf16_f32 v2, -v128, v129
s_xor_b32 s64, s50, 421888
s_sub_u32 s64, s64, 114688
buffer_load_dwordx4 v[128:131], v23, s[4:7], s64 offen offset:0 sc1
s_xor_b32 s67, s64, 256
buffer_load_dwordx4 v[132:135], v23, s[4:7], s67 offen offset:0 sc1
ds_read_b64_tr_b16 a[138:139], v43 offset:39168
pg_3:
s_cbranch_execz pg_7
buffer_load_dwordx4 v[136:139], v23, s[4:7], s64 offen offset:2048 sc1
ds_read_b64_tr_b16 a[142:143], v43 offset:39176
ds_write_b32 v98, v96
v_xor_b32 v98, 512, v98
s_barrier
s_waitcnt vmcnt(7)
v_mfma_f32_16x16x32_bf16 v[52:55], v[144:147], v[140:143], v[52:55]
ds_read_b64_tr_b16 v[144:145], v13 offset:35840
ds_read_b64_tr_b16 a[144:145], v43 offset:53248
ds_read_b64_tr_b16 a[148:149], v43 offset:53256
s_waitcnt lgkmcnt(12)
v_mfma_f32_16x16x32_bf16 v[56:59], v[148:151], v[84:87], v[56:59]
ds_read_b64_tr_b16 v[146:147], v13 offset:37632
ds_read_b64_tr_b16 a[146:147], v43 offset:53504
ds_read_b64_tr_b16 a[150:151], v43 offset:53512
v_mfma_f32_16x16x32_bf16 v[60:63], v[148:151], v[140:143], v[60:63]
ds_read_b64_tr_b16 v[148:149], v13 offset:35872
s_waitcnt lgkmcnt(7)
s_barrier
v_mfma_f32_16x16x32_bf16 v[64:67], v[152:155], v[84:87], v[64:67]
ds_read_b64_tr_b16 v[150:151], v13 offset:37664
ds_read_b32 v97, v98
v_mfma_f32_16x16x32_bf16 v[68:71], v[152:155], v[140:143], v[68:71]
ds_read_b64_tr_b16 v[152:153], v13 offset:35904
buffer_load_dwordx4 v[140:143], v23, s[4:7], s67 offen offset:2048 sc1
v_mfma_f32_16x16x32_bf16 v[72:75], v[156:159], v[84:87], v[72:75]
ds_read_b64_tr_b16 v[154:155], v13 offset:37696
ds_read_b64_tr_b16 v[156:157], v14 offset:35840
s_waitcnt vmcnt(5) lgkmcnt(8)
v_mfma_f32_16x16x32_bf16 v[48:51], v[144:147], v[112:115], v[48:51]
ds_read_b64_tr_b16 v[158:159], v14 offset:37632
s_waitcnt lgkmcnt(4)
v_add_f32 v96, v96, v97
v_mfma_f32_16x16x32_bf16 v[52:55], v[144:147], v[116:119], v[52:55]
ds_read_b64_tr_b16 v[144:145], v13 offset:43008
v_cvt_pk_bf16_f32 v16, v96, v96
v_lshlrev_b32 v97, 16, v16
v_mfma_f32_16x16x32_bf16 v[56:59], v[148:151], v[112:115], v[56:59]
ds_read_b64_tr_b16 v[146:147], v13 offset:44800
v_sub_f32 v96, v96, v97
v_cvt_pk_bf16_f32 v17, v96, v96
v_mfma_f32_16x16x32_bf16 v[60:63], v[148:151], v[116:119], v[60:63]
ds_read_b64_tr_b16 v[148:149], v13 offset:43040
s_mov_b64 vcc, 0xffff
s_lshl_b64 vcc, vcc, 0
v_cndmask_b32 v76, 0, v16, vcc
v_cndmask_b32 v77, 0, v17, vcc
s_waitcnt lgkmcnt(5)
v_mfma_f32_16x16x32_bf16 v[64:67], v[152:155], v[112:115], v[64:67]
ds_read_b64_tr_b16 v[150:151], v13 offset:44832
s_mov_b64 vcc, 0xffff
s_lshl_b64 vcc, vcc, 0
v_cndmask_b32 v108, 0, v16, vcc
v_cndmask_b32 v109, 0, v17, vcc
v_mfma_f32_16x16x32_bf16 v[68:71], v[152:155], v[116:119], v[68:71]
ds_read_b64_tr_b16 v[152:153], v13 offset:43072
s_waitcnt lgkmcnt(5)
v_mfma_f32_16x16x32_bf16 v[72:75], v[156:159], v[112:115], v[72:75]
ds_read_b64_tr_b16 v[154:155], v13 offset:44864
ds_read_b64_tr_b16 v[156:157], v14 offset:43008
s_xor_b32 s64, s50, 425984
s_sub_u32 s64, s64, 114688
buffer_load_dwordx4 v[112:115], v23, s[4:7], s64 offen offset:0 sc1
v_mfma_f32_16x16x32_bf16 v[48:51], v[76:79], v[120:123], v[48:51]
s_xor_b32 s67, s64, 256
buffer_load_dwordx4 v[116:119], v23, s[4:7], s67 offen offset:0 sc1
v_mfma_f32_16x16x32_bf16 v[52:55], v[76:79], v[124:127], v[52:55]
s_mov_b64 vcc, 0xffff
s_lshl_b64 vcc, vcc, 16
v_cndmask_b32 v76, 0, v16, vcc
v_cndmask_b32 v77, 0, v17, vcc
s_waitcnt vmcnt(5) lgkmcnt(5)
v_mfma_f32_16x16x32_bf16 v[48:51], v[144:147], v[128:131], v[48:51]
ds_read_b64_tr_b16 v[158:159], v14 offset:44800
ds_read_b64_tr_b16 a[152:153], v43 offset:55296
ds_read_b64_tr_b16 a[156:157], v43 offset:55304
v_mfma_f32_16x16x32_bf16 v[56:59], v[76:79], v[120:123], v[56:59]
ds_read_b64_tr_b16 a[154:155], v43 offset:55552
ds_read_b64_tr_b16 a[158:159], v43 offset:55560
v_mfma_f32_16x16x32_bf16 v[60:63], v[76:79], v[124:127], v[60:63]
s_mov_b64 vcc, 0xffff
s_lshl_b64 vcc, vcc, 32
v_cndmask_b32 v76, 0, v16, vcc
v_cndmask_b32 v77, 0, v17, vcc
s_waitcnt vmcnt(4)
v_mfma_f32_16x16x32_bf16 v[52:55], v[144:147], v[132:135], v[52:55]
ds_read_b64_tr_b16 v[144:145], v13 offset:50176
v_mfma_f32_16x16x32_bf16 v[64:67], v[76:79], v[120:123], v[64:67]
v_mfma_f32_16x16x32_bf16 v[68:71], v[76:79], v[124:127], v[68:71]
s_mov_b64 vcc, 0xffff
s_lshl_b64 vcc, vcc, 48
v_cndmask_b32 v76, 0, v16, vcc
v_cndmask_b32 v77, 0, v17, vcc
s_waitcnt lgkmcnt(9)
v_mfma_f32_16x16x32_bf16 v[56:59], v[148:151], v[128:131], v[56:59]
ds_read_b64_tr_b16 v[146:147], v13 offset:51968
buffer_load_dwordx4 v[124:127], v23, s[4:7], s67 offen offset:2048 sc1
v_mfma_f32_16x16x32_bf16 v[72:75], v[76:79], v[120:123], v[72:75]
buffer_load_dwordx4 v[120:123], v23, s[4:7], s64 offen offset:2048 sc1
v_mfma_f32_16x16x32_bf16 v[60:63], v[148:151], v[132:135], v[60:63]
ds_read_b64_tr_b16 v[148:149], v13 offset:50208
s_waitcnt lgkmcnt(9)
v_mfma_f32_16x16x32_bf16 v[64:67], v[152:155], v[128:131], v[64:67]
ds_read_b64_tr_b16 v[150:151], v13 offset:52000
v_mfma_f32_16x16x32_bf16 v[68:71], v[152:155], v[132:135], v[68:71]
ds_read_b64_tr_b16 v[152:153], v13 offset:50240
v_mov_b32 v132, v2
v_mov_b32 v134, 0
s_waitcnt lgkmcnt(9)
v_mfma_f32_16x16x32_bf16 v[72:75], v[156:159], v[128:131], v[72:75]
ds_read_b64_tr_b16 v[154:155], v13 offset:52032
ds_read_b64_tr_b16 v[156:157], v14 offset:50176
v_subrev_u32 v13, s65, v13
s_waitcnt vmcnt(5) lgkmcnt(5)
v_mfma_f32_16x16x32_bf16 v[48:51], v[144:147], v[136:139], v[48:51]
ds_read_b64_tr_b16 v[158:159], v14 offset:51968
v_subrev_u32 v14, s65, v14
v_mov_b32 v128, v2
s_waitcnt vmcnt(4)
v_mfma_f32_16x16x32_bf16 v[52:55], v[144:147], v[140:143], v[52:55]
ds_read_b64_tr_b16 v[144:145], v13 offset:0
v_permlane16_swap_b32 v128, v132
s_waitcnt lgkmcnt(5)
v_mfma_f32_16x16x32_bf16 v[56:59], v[148:151], v[136:139], v[56:59]
ds_read_b64_tr_b16 v[146:147], v13 offset:1792
v_mov_b32 v130, 0
v_mov_b32 v131, 0
v_mfma_f32_16x16x32_bf16 v[60:63], v[148:151], v[140:143], v[60:63]
ds_read_b64_tr_b16 v[148:149], v13 offset:32
v_mov_b32 v135, 0
v_mov_b32 v129, v128
s_waitcnt lgkmcnt(5)
v_mfma_f32_16x16x32_bf16 v[64:67], v[152:155], v[136:139], v[64:67]
ds_read_b64_tr_b16 v[150:151], v13 offset:1824
v_mov_b32 v133, v132
v_permlane16_swap_b32 v48, v52
v_mfma_f32_16x16x32_bf16 v[68:71], v[152:155], v[140:143], v[68:71]
ds_read_b64_tr_b16 v[152:153], v13 offset:64
ds_read_b64_tr_b16 v[154:155], v13 offset:1856
v_permlane16_swap_b32 v49, v53
s_waitcnt lgkmcnt(6)
v_mfma_f32_16x16x32_bf16 v[72:75], v[156:159], v[136:139], v[72:75]
s_xor_b32 s64, s50, 430080
s_sub_u32 s64, s64, 114688
buffer_load_dwordx4 v[136:139], v23, s[4:7], s64 offen offset:0 sc1
s_waitcnt vmcnt(4) lgkmcnt(4)
v_mfma_f32_16x16x32_bf16 v[80:83], v[144:147], v[112:115], 0
s_xor_b32 s67, s64, 256
buffer_load_dwordx4 v[140:143], v23, s[4:7], s67 offen offset:0 sc1
s_waitcnt vmcnt(4)
v_mfma_f32_16x16x32_bf16 v[84:87], v[144:147], v[116:119], 0
ds_read_b64_tr_b16 v[144:145], v13 offset:7168
ds_read_b64_tr_b16 v[156:157], v14 offset:0
ds_read_b64_tr_b16 v[158:159], v14 offset:1792
s_waitcnt lgkmcnt(5)
v_mfma_f32_16x16x32_bf16 v[88:91], v[148:151], v[112:115], 0
ds_read_b64_tr_b16 v[146:147], v13 offset:8960
v_permlane16_swap_b32 v50, v54
v_mfma_f32_16x16x32_bf16 v[92:95], v[148:151], v[116:119], 0
ds_read_b64_tr_b16 v[148:149], v13 offset:7200
v_permlane16_swap_b32 v51, v55
s_waitcnt lgkmcnt(5)
v_mfma_f32_16x16x32_bf16 v[96:99], v[152:155], v[112:115], 0
ds_read_b64_tr_b16 v[150:151], v13 offset:8992
v_mul_f32 v44, v48, v48
v_mul_f32 v45, v49, v49
v_mfma_f32_16x16x32_bf16 v[100:103], v[152:155], v[116:119], 0
ds_read_b64_tr_b16 v[152:153], v13 offset:7232
buffer_load_dwordx4 v[116:119], v23, s[4:7], s67 offen offset:2048 sc1
s_waitcnt lgkmcnt(4)
v_mfma_f32_16x16x32_bf16 v[104:107], v[156:159], v[112:115], 0
ds_read_b64_tr_b16 v[154:155], v13 offset:9024
ds_read_b64_tr_b16 v[156:157], v14 offset:7168
buffer_load_dwordx4 v[112:115], v23, s[4:7], s64 offen offset:2048 sc1
s_waitcnt vmcnt(4) lgkmcnt(5)
v_mfma_f32_16x16x32_bf16 v[80:83], v[144:147], v[120:123], v[80:83]
ds_read_b64_tr_b16 v[158:159], v14 offset:8960
v_mul_f32 v46, v50, v50
v_mul_f32 v47, v51, v51
v_mfma_f32_16x16x32_bf16 v[84:87], v[144:147], v[124:127], v[84:87]
ds_read_b64_tr_b16 v[144:145], v13 offset:14336
v_fma_f32 v44, v44, v18, v19
v_fma_f32 v45, v45, v18, v19
s_waitcnt lgkmcnt(5)
v_mfma_f32_16x16x32_bf16 v[88:91], v[148:151], v[120:123], v[88:91]
ds_read_b64_tr_b16 v[146:147], v13 offset:16128
v_fma_f32 v46, v46, v18, v19
v_fma_f32 v47, v47, v18, v19
v_mfma_f32_16x16x32_bf16 v[92:95], v[148:151], v[124:127], v[92:95]
ds_read_b64_tr_b16 v[148:149], v13 offset:14368
v_mul_f32 v44, v44, v48
v_mul_f32 v45, v45, v49
s_waitcnt lgkmcnt(5)
v_mfma_f32_16x16x32_bf16 v[96:99], v[152:155], v[120:123], v[96:99]
ds_read_b64_tr_b16 v[150:151], v13 offset:16160
v_mul_f32 v46, v46, v50
v_mul_f32 v47, v47, v51
v_mfma_f32_16x16x32_bf16 v[100:103], v[152:155], v[124:127], v[100:103]
ds_read_b64_tr_b16 v[152:153], v13 offset:14400
v_exp_f32 v44, v44
s_waitcnt lgkmcnt(5)
v_mfma_f32_16x16x32_bf16 v[104:107], v[156:159], v[120:123], v[104:107]
ds_read_b64_tr_b16 v[154:155], v13 offset:16192
ds_read_b64_tr_b16 v[156:157], v14 offset:14336
s_xor_b32 s64, s50, 434176
s_sub_u32 s64, s64, 114688
buffer_load_dwordx4 v[120:123], v23, s[4:7], s64 offen offset:0 sc1
v_mfma_f32_16x16x32_bf16 v[80:83], v[108:111], v[128:131], v[80:83]
v_exp_f32 v45, v45
v_mfma_f32_16x16x32_bf16 v[84:87], v[108:111], v[132:135], v[84:87]
s_mov_b64 vcc, 0xffff
s_lshl_b64 vcc, vcc, 16
v_cndmask_b32 v108, 0, v16, vcc
v_cndmask_b32 v109, 0, v17, vcc
s_waitcnt vmcnt(4) lgkmcnt(5)
v_mfma_f32_16x16x32_bf16 v[80:83], v[144:147], v[136:139], v[80:83]
ds_read_b64_tr_b16 v[158:159], v14 offset:16128
v_exp_f32 v46, v46
s_lshl2_add_u32 m0, s46, 114688
s_lshl4_add_u32 s3, s44, s49
buffer_load_dwordx4 v42, s[52:55], s3 offen offset:0 lds
buffer_load_dwordx4 v11, s[52:55], s3 offen offset:1024 lds
v_mfma_f32_16x16x32_bf16 v[88:91], v[108:111], v[128:131], v[88:91]
s_add_u32 s3, s3, 14336
buffer_load_dwordx4 v42, s[52:55], s3 offen offset:2048 lds
v_mfma_f32_16x16x32_bf16 v[92:95], v[108:111], v[132:135], v[92:95]
s_mov_b64 vcc, 0xffff
s_lshl_b64 vcc, vcc, 32
v_cndmask_b32 v108, 0, v16, vcc
v_cndmask_b32 v109, 0, v17, vcc
buffer_load_dwordx4 v11, s[52:55], s3 offen offset:3072 lds
s_nop 0
v_mfma_f32_16x16x32_bf16 v[96:99], v[108:111], v[128:131], v[96:99]
v_exp_f32 v47, v47
v_mfma_f32_16x16x32_bf16 v[100:103], v[108:111], v[132:135], v[100:103]
s_mov_b64 vcc, 0xffff
s_lshl_b64 vcc, vcc, 48
v_cndmask_b32 v108, 0, v16, vcc
v_cndmask_b32 v109, 0, v17, vcc
s_xor_b32 s67, s64, 256
buffer_load_dwordx4 v[132:135], v23, s[4:7], s67 offen offset:0 sc1
v_mfma_f32_16x16x32_bf16 v[104:107], v[108:111], v[128:131], v[104:107]
v_fma_f32 v44, v44, v40, v40
v_fma_f32 v45, v45, v40, v40
s_waitcnt vmcnt(8)
v_mfma_f32_16x16x32_bf16 v[84:87], v[144:147], v[140:143], v[84:87]
ds_read_b64_tr_b16 v[144:145], v13 offset:21504
v_fma_f32 v46, v46, v40, v40
v_fma_f32 v47, v47, v40, v40
s_waitcnt lgkmcnt(5)
v_mfma_f32_16x16x32_bf16 v[88:91], v[148:151], v[136:139], v[88:91]
ds_read_b64_tr_b16 v[146:147], v13 offset:23296
v_rcp_f32 v44, v44
v_mfma_f32_16x16x32_bf16 v[92:95], v[148:151], v[140:143], v[92:95]
ds_read_b64_tr_b16 v[148:149], v13 offset:21536
v_rcp_f32 v45, v45
s_waitcnt lgkmcnt(5)
v_mfma_f32_16x16x32_bf16 v[96:99], v[152:155], v[136:139], v[96:99]
ds_read_b64_tr_b16 v[150:151], v13 offset:23328
v_rcp_f32 v46, v46
v_mfma_f32_16x16x32_bf16 v[100:103], v[152:155], v[140:143], v[100:103]
ds_read_b64_tr_b16 v[152:153], v13 offset:21568
buffer_load_dwordx4 v[140:143], v23, s[4:7], s67 offen offset:2048 sc1
s_waitcnt lgkmcnt(5)
v_mfma_f32_16x16x32_bf16 v[104:107], v[156:159], v[136:139], v[104:107]
ds_read_b64_tr_b16 v[154:155], v13 offset:23360
ds_read_b64_tr_b16 v[156:157], v14 offset:21504
buffer_load_dwordx4 v[136:139], v23, s[4:7], s64 offen offset:2048 sc1
s_waitcnt vmcnt(8) lgkmcnt(5)
v_mfma_f32_16x16x32_bf16 v[80:83], v[144:147], v[112:115], v[80:83]
ds_read_b64_tr_b16 v[158:159], v14 offset:23296
v_rcp_f32 v47, v47
v_mfma_f32_16x16x32_bf16 v[84:87], v[144:147], v[116:119], v[84:87]
ds_read_b64_tr_b16 v[144:145], v13 offset:28672
v_mul_f32 v44, v44, v48
v_mul_f32 v45, v45, v49
s_waitcnt lgkmcnt(5)
v_mfma_f32_16x16x32_bf16 v[88:91], v[148:151], v[112:115], v[88:91]
ds_read_b64_tr_b16 v[146:147], v13 offset:30464
v_mul_f32 v46, v46, v50
v_mul_f32 v47, v47, v51
v_mfma_f32_16x16x32_bf16 v[92:95], v[148:151], v[116:119], v[92:95]
ds_read_b64_tr_b16 v[148:149], v13 offset:28704
v_cvt_pk_bf16_f32 v48, v44, v45
v_cvt_pk_bf16_f32 v49, v46, v47
s_waitcnt lgkmcnt(5)
v_mfma_f32_16x16x32_bf16 v[96:99], v[152:155], v[112:115], v[96:99]
ds_read_b64_tr_b16 v[150:151], v13 offset:30496
v_mul_f32 v76, v52, v52
v_mul_f32 v77, v53, v53
v_mfma_f32_16x16x32_bf16 v[100:103], v[152:155], v[116:119], v[100:103]
ds_read_b64_tr_b16 v[152:153], v13 offset:28736
v_mul_f32 v78, v54, v54
v_mul_f32 v79, v55, v55
s_waitcnt lgkmcnt(5)
v_mfma_f32_16x16x32_bf16 v[104:107], v[156:159], v[112:115], v[104:107]
ds_read_b64_tr_b16 v[154:155], v13 offset:30528
ds_read_b64_tr_b16 v[156:157], v14 offset:28672
s_xor_b32 s64, s50, 438272
s_sub_u32 s64, s64, 114688
buffer_load_dwordx4 v[112:115], v23, s[4:7], s64 offen offset:0 sc1
s_xor_b32 s67, s64, 256
buffer_load_dwordx4 v[116:119], v23, s[4:7], s67 offen offset:0 sc1
s_waitcnt vmcnt(9) lgkmcnt(5)
v_mfma_f32_16x16x32_bf16 v[80:83], v[144:147], v[120:123], v[80:83]
ds_read_b64_tr_b16 v[158:159], v14 offset:30464
v_fma_f32 v76, v76, v18, v19
v_fma_f32 v77, v77, v18, v19
v_fma_f32 v78, v78, v18, v19
v_fma_f32 v79, v79, v18, v19
v_pk_mul_f32 v[76:77], v[76:77], v[52:53]
v_pk_mul_f32 v[78:79], v[78:79], v[54:55]
v_exp_f32 v76, v76
v_exp_f32 v77, v77
v_exp_f32 v78, v78
v_exp_f32 v79, v79
v_pk_fma_f32 v[76:77], v[76:77], v[40:41], v[40:41] op_sel:[0,0,0] op_sel_hi:[1,0,0]
v_pk_fma_f32 v[78:79], v[78:79], v[40:41], v[40:41] op_sel:[0,0,0] op_sel_hi:[1,0,0]
v_rcp_f32 v76, v76
v_rcp_f32 v77, v77
v_rcp_f32 v78, v78
v_rcp_f32 v79, v79
v_mov_b32 v124, -1
v_mov_b32 v125, -1
v_pk_mul_f32 v[76:77], v[76:77], v[52:53]
v_mov_b32 v126, -1
v_pk_mul_f32 v[78:79], v[78:79], v[54:55]
v_mov_b32 v127, -1
s_add_u32 s62, s34, 131072
buffer_store_dwordx4 v[124:127], v1, s[4:7], s62 offen
s_add_u32 s62, s34, 163840
buffer_store_dwordx4 v[124:127], v1, s[4:7], s62 offen
v_cvt_pk_bf16_f32 v50, v76, v77
v_cvt_pk_bf16_f32 v51, v78, v79
s_lshl_b32 s60, s71, 8
v_xor_b32 v52, s60, v1
s_add_u32 s62, s72, 0
buffer_store_dwordx4 v[48:51], v52, s[4:7], s62 offen offset:0 sc1
v_permlane16_swap_b32 v56, v60
s_nop 0
buffer_load_dwordx4 v[48:51], v23, s[4:7], s64 offen offset:2048 sc1
v_permlane16_swap_b32 v57, v61
v_permlane16_swap_b32 v58, v62
v_permlane16_swap_b32 v59, v63
v_pk_mul_f32 v[44:45], v[56:57], v[56:57]
v_pk_mul_f32 v[46:47], v[58:59], v[58:59]
v_pk_fma_f32 v[44:45], v[44:45], v[18:19], v[18:19] op_sel:[0,0,1] op_sel_hi:[1,0,1]
v_pk_fma_f32 v[46:47], v[46:47], v[18:19], v[18:19] op_sel:[0,0,1] op_sel_hi:[1,0,1]
v_pk_mul_f32 v[44:45], v[44:45], v[56:57]
v_pk_mul_f32 v[46:47], v[46:47], v[58:59]
v_exp_f32 v44, v44
buffer_load_dwordx4 v[52:55], v23, s[4:7], s67 offen offset:2048 sc1
v_exp_f32 v45, v45
v_exp_f32 v46, v46
v_exp_f32 v47, v47
s_waitcnt vmcnt(12)
ds_read_b64_tr_b16 a[160:161], v43 offset:36864
ds_read_b64_tr_b16 a[164:165], v43 offset:36872
ds_read_b64_tr_b16 a[162:163], v43 offset:37120
ds_read_b64_tr_b16 a[166:167], v43 offset:37128
v_pk_fma_f32 v[44:45], v[44:45], v[40:41], v[40:41] op_sel:[0,0,0] op_sel_hi:[1,0,0]
v_pk_fma_f32 v[46:47], v[46:47], v[40:41], v[40:41] op_sel:[0,0,0] op_sel_hi:[1,0,0]
v_rcp_f32 v44, v44
v_rcp_f32 v45, v45
v_rcp_f32 v46, v46
v_rcp_f32 v47, v47
v_pk_mul_f32 v[44:45], v[44:45], v[56:57]
v_pk_mul_f32 v[46:47], v[46:47], v[58:59]
v_cvt_pk_bf16_f32 v56, v44, v45
v_cvt_pk_bf16_f32 v57, v46, v47
v_pk_mul_f32 v[76:77], v[60:61], v[60:61]
v_pk_mul_f32 v[78:79], v[62:63], v[62:63]
v_pk_fma_f32 v[76:77], v[76:77], v[18:19], v[18:19] op_sel:[0,0,1] op_sel_hi:[1,0,1]
v_pk_fma_f32 v[78:79], v[78:79], v[18:19], v[18:19] op_sel:[0,0,1] op_sel_hi:[1,0,1]
v_pk_mul_f32 v[76:77], v[76:77], v[60:61]
v_pk_mul_f32 v[78:79], v[78:79], v[62:63]
v_exp_f32 v76, v76
v_exp_f32 v77, v77
v_exp_f32 v78, v78
v_exp_f32 v79, v79
v_pk_fma_f32 v[76:77], v[76:77], v[40:41], v[40:41] op_sel:[0,0,0] op_sel_hi:[1,0,0]
v_pk_fma_f32 v[78:79], v[78:79], v[40:41], v[40:41] op_sel:[0,0,0] op_sel_hi:[1,0,0]
v_rcp_f32 v76, v76
v_rcp_f32 v77, v77
s_waitcnt vmcnt(10)
ds_read_b64_tr_b16 a[168:169], v43 offset:38912
ds_read_b64_tr_b16 a[172:173], v43 offset:38920
ds_read_b64_tr_b16 a[170:171], v43 offset:39168
ds_read_b64_tr_b16 a[174:175], v43 offset:39176
s_waitcnt vmcnt(9)
v_mfma_f32_16x16x32_bf16 v[84:87], v[144:147], v[132:135], v[84:87]
ds_read_b64_tr_b16 v[144:145], v13 offset:35840
v_rcp_f32 v78, v78
s_waitcnt lgkmcnt(13)
v_mfma_f32_16x16x32_bf16 v[88:91], v[148:151], v[120:123], v[88:91]
ds_read_b64_tr_b16 v[146:147], v13 offset:37632
v_rcp_f32 v79, v79
v_mfma_f32_16x16x32_bf16 v[92:95], v[148:151], v[132:135], v[92:95]
ds_read_b64_tr_b16 v[148:149], v13 offset:35872
v_mul_f32 v76, v76, v60
v_mul_f32 v77, v77, v61
s_waitcnt lgkmcnt(13)
v_mfma_f32_16x16x32_bf16 v[96:99], v[152:155], v[120:123], v[96:99]
ds_read_b64_tr_b16 v[150:151], v13 offset:37664
v_mul_f32 v78, v78, v62
v_mul_f32 v79, v79, v63
v_mfma_f32_16x16x32_bf16 v[100:103], v[152:155], v[132:135], v[100:103]
ds_read_b64_tr_b16 v[152:153], v13 offset:35904
v_cvt_pk_bf16_f32 v58, v76, v77
v_cvt_pk_bf16_f32 v59, v78, v79
s_waitcnt lgkmcnt(13)
v_mfma_f32_16x16x32_bf16 v[104:107], v[156:159], v[120:123], v[104:107]
ds_read_b64_tr_b16 v[154:155], v13 offset:37696
ds_read_b64_tr_b16 v[156:157], v14 offset:35840
s_xor_b32 s64, s50, 442368
s_sub_u32 s64, s64, 114688
buffer_load_dwordx4 v[120:123], v23, s[4:7], s64 offen offset:0 sc1
s_xor_b32 s67, s64, 256
buffer_load_dwordx4 v[124:127], v23, s[4:7], s67 offen offset:0 sc1
s_waitcnt vmcnt(9) lgkmcnt(5)
v_mfma_f32_16x16x32_bf16 v[80:83], v[144:147], v[136:139], v[80:83]
ds_read_b64_tr_b16 v[158:159], v14 offset:37632
buffer_load_dwordx4 v[128:131], v23, s[4:7], s64 offen offset:2048 sc1
v_mfma_f32_16x16x32_bf16 v[84:87], v[144:147], v[140:143], v[84:87]
ds_read_b64_tr_b16 v[144:145], v13 offset:43008
s_lshl_b32 s60, s71, 8
v_xor_b32 v60, s60, v1
s_add_u32 s62, s72, 0
buffer_store_dwordx4 v[56:59], v60, s[4:7], s62 offen offset:1024 sc1
s_waitcnt lgkmcnt(5)
v_mfma_f32_16x16x32_bf16 v[88:91], v[148:151], v[136:139], v[88:91]
ds_read_b64_tr_b16 v[146:147], v13 offset:44800
buffer_load_dwordx4 v[132:135], v23, s[4:7], s67 offen offset:2048 sc1
v_mfma_f32_16x16x32_bf16 v[92:95], v[148:151], v[140:143], v[92:95]
ds_read_b64_tr_b16 v[148:149], v13 offset:43040
v_permlane16_swap_b32 v64, v68
s_waitcnt lgkmcnt(5)
v_mfma_f32_16x16x32_bf16 v[96:99], v[152:155], v[136:139], v[96:99]
ds_read_b64_tr_b16 v[150:151], v13 offset:44832
v_permlane16_swap_b32 v65, v69
v_mfma_f32_16x16x32_bf16 v[100:103], v[152:155], v[140:143], v[100:103]
ds_read_b64_tr_b16 v[152:153], v13 offset:43072
s_xor_b32 s64, s50, 446464
s_sub_u32 s64, s64, 114688
buffer_load_dwordx4 v[56:59], v23, s[4:7], s64 offen offset:0 sc1
s_waitcnt lgkmcnt(5)
v_mfma_f32_16x16x32_bf16 v[104:107], v[156:159], v[136:139], v[104:107]
ds_read_b64_tr_b16 v[154:155], v13 offset:44864
ds_read_b64_tr_b16 v[156:157], v14 offset:43008
v_permlane16_swap_b32 v66, v70
s_waitcnt vmcnt(12) lgkmcnt(5)
v_mfma_f32_16x16x32_bf16 v[80:83], v[144:147], v[112:115], v[80:83]
ds_read_b64_tr_b16 v[158:159], v14 offset:44800
s_xor_b32 s67, s64, 256
buffer_load_dwordx4 v[60:63], v23, s[4:7], s67 offen offset:0 sc1
s_waitcnt vmcnt(12)
v_mfma_f32_16x16x32_bf16 v[84:87], v[144:147], v[116:119], v[84:87]
ds_read_b64_tr_b16 v[144:145], v13 offset:50176
v_permlane16_swap_b32 v67, v71
s_waitcnt lgkmcnt(5)
v_mfma_f32_16x16x32_bf16 v[88:91], v[148:151], v[112:115], v[88:91]
ds_read_b64_tr_b16 v[146:147], v13 offset:51968
v_mul_f32 v44, v64, v64
v_mul_f32 v45, v65, v65
v_mfma_f32_16x16x32_bf16 v[92:95], v[148:151], v[116:119], v[92:95]
ds_read_b64_tr_b16 v[148:149], v13 offset:50208
v_mul_f32 v46, v66, v66
v_mul_f32 v47, v67, v67
s_waitcnt lgkmcnt(5)
v_mfma_f32_16x16x32_bf16 v[96:99], v[152:155], v[112:115], v[96:99]
ds_read_b64_tr_b16 v[150:151], v13 offset:52000
buffer_load_dwordx4 v[136:139], v23, s[4:7], s64 offen offset:2048 sc1
v_mfma_f32_16x16x32_bf16 v[100:103], v[152:155], v[116:119], v[100:103]
ds_read_b64_tr_b16 v[152:153], v13 offset:50240
v_fma_f32 v44, v44, v18, v19
v_fma_f32 v45, v45, v18, v19
s_waitcnt lgkmcnt(5)
v_mfma_f32_16x16x32_bf16 v[104:107], v[156:159], v[112:115], v[104:107]
ds_read_b64_tr_b16 v[154:155], v13 offset:52032
ds_read_b64_tr_b16 v[156:157], v14 offset:50176
v_fma_f32 v46, v46, v18, v19
v_fma_f32 v47, v47, v18, v19
s_xor_b32 s64, s50, 450560
s_sub_u32 s64, s64, 114688
buffer_load_dwordx4 v[112:115], v23, s[4:7], s64 offen offset:0 sc1
v_pk_mul_f32 v[44:45], v[44:45], v[64:65]
v_pk_mul_f32 v[46:47], v[46:47], v[66:67]
v_exp_f32 v44, v44
v_exp_f32 v45, v45
v_exp_f32 v46, v46
v_exp_f32 v47, v47
v_pk_fma_f32 v[44:45], v[44:45], v[40:41], v[40:41] op_sel:[0,0,0] op_sel_hi:[1,0,0]
v_pk_fma_f32 v[46:47], v[46:47], v[40:41], v[40:41] op_sel:[0,0,0] op_sel_hi:[1,0,0]
v_rcp_f32 v44, v44
buffer_load_dwordx4 v[140:143], v23, s[4:7], s67 offen offset:2048 sc1
v_rcp_f32 v45, v45
v_rcp_f32 v46, v46
v_rcp_f32 v47, v47
v_pk_mul_f32 v[44:45], v[44:45], v[64:65]
v_pk_mul_f32 v[46:47], v[46:47], v[66:67]
v_cvt_pk_bf16_f32 v64, v44, v45
v_cvt_pk_bf16_f32 v65, v46, v47
v_pk_mul_f32 v[76:77], v[68:69], v[68:69]
v_pk_mul_f32 v[78:79], v[70:71], v[70:71]
v_pk_fma_f32 v[76:77], v[76:77], v[18:19], v[18:19] op_sel:[0,0,1] op_sel_hi:[1,0,1]
v_pk_fma_f32 v[78:79], v[78:79], v[18:19], v[18:19] op_sel:[0,0,1] op_sel_hi:[1,0,1]
v_pk_mul_f32 v[76:77], v[76:77], v[68:69]
v_pk_mul_f32 v[78:79], v[78:79], v[70:71]
v_exp_f32 v76, v76
v_exp_f32 v77, v77
v_exp_f32 v78, v78
v_exp_f32 v79, v79
v_pk_fma_f32 v[76:77], v[76:77], v[40:41], v[40:41] op_sel:[0,0,0] op_sel_hi:[1,0,0]
v_pk_fma_f32 v[78:79], v[78:79], v[40:41], v[40:41] op_sel:[0,0,0] op_sel_hi:[1,0,0]
v_rcp_f32 v76, v76
v_rcp_f32 v77, v77
v_rcp_f32 v78, v78
v_rcp_f32 v79, v79
v_pk_mul_f32 v[76:77], v[76:77], v[68:69]
s_xor_b32 s67, s64, 256
buffer_load_dwordx4 v[116:119], v23, s[4:7], s67 offen offset:0 sc1
s_waitcnt vmcnt(12) lgkmcnt(5)
v_mfma_f32_16x16x32_bf16 v[80:83], v[144:147], v[48:51], v[80:83]
ds_read_b64_tr_b16 v[158:159], v14 offset:51968
v_mul_f32 v78, v78, v70
v_mul_f32 v79, v79, v71
s_waitcnt vmcnt(11)
v_mfma_f32_16x16x32_bf16 v[84:87], v[144:147], v[52:55], v[84:87]
v_add_u32 v13, s65, v13
ds_read_b64_tr_b16 v[144:145], v13 offset:0
s_waitcnt lgkmcnt(5)
v_mfma_f32_16x16x32_bf16 v[88:91], v[148:151], v[48:51], v[88:91]
ds_read_b64_tr_b16 v[146:147], v13 offset:1792
v_cvt_pk_bf16_f32 v66, v76, v77
v_cvt_pk_bf16_f32 v67, v78, v79
v_mfma_f32_16x16x32_bf16 v[92:95], v[148:151], v[52:55], v[92:95]
ds_read_b64_tr_b16 v[148:149], v13 offset:32
s_lshl_b32 s60, s71, 8
v_xor_b32 v68, s60, v1
s_add_u32 s62, s72, 0
buffer_store_dwordx4 v[64:67], v68, s[4:7], s62 offen offset:2048 sc1
s_waitcnt lgkmcnt(5)
v_mfma_f32_16x16x32_bf16 v[96:99], v[152:155], v[48:51], v[96:99]
ds_read_b64_tr_b16 v[150:151], v13 offset:1824
buffer_load_dwordx4 v[64:67], v23, s[4:7], s64 offen offset:2048 sc1
v_mfma_f32_16x16x32_bf16 v[100:103], v[152:155], v[52:55], v[100:103]
ds_read_b64_tr_b16 v[152:153], v13 offset:64
buffer_load_dwordx4 v[68:71], v23, s[4:7], s67 offen offset:2048 sc1
s_waitcnt lgkmcnt(5)
v_mfma_f32_16x16x32_bf16 v[104:107], v[156:159], v[48:51], v[104:107]
ds_read_b64_tr_b16 v[154:155], v13 offset:1856
v_add_u32 v14, s65, v14
ds_read_b64_tr_b16 v[156:157], v14 offset:0
s_waitcnt vmcnt(13) lgkmcnt(5)
v_mfma_f32_16x16x32_bf16 v[80:83], v[144:147], v[120:123], v[80:83]
ds_read_b64_tr_b16 v[158:159], v14 offset:1792
v_mov_b32 v76, v18
v_mul_f32 v44, v72, v72
v_mul_f32 v45, v73, v73
s_waitcnt vmcnt(12)
v_mfma_f32_16x16x32_bf16 v[84:87], v[144:147], v[124:127], v[84:87]
ds_read_b64_tr_b16 v[144:145], v13 offset:7168
v_permlane16_swap_b32 v18, v76
s_waitcnt lgkmcnt(5)
v_mfma_f32_16x16x32_bf16 v[88:91], v[148:151], v[120:123], v[88:91]
ds_read_b64_tr_b16 v[146:147], v13 offset:8960
v_mov_b32 v76, v19
v_mul_f32 v46, v74, v74
v_mul_f32 v47, v75, v75
v_mfma_f32_16x16x32_bf16 v[92:95], v[148:151], v[124:127], v[92:95]
ds_read_b64_tr_b16 v[148:149], v13 offset:7200
v_permlane16_swap_b32 v19, v76
s_waitcnt lgkmcnt(5)
v_mfma_f32_16x16x32_bf16 v[96:99], v[152:155], v[120:123], v[96:99]
ds_read_b64_tr_b16 v[150:151], v13 offset:8992
v_mov_b32 v76, v40
v_fma_f32 v44, v44, v18, v19
v_fma_f32 v45, v45, v18, v19
v_mfma_f32_16x16x32_bf16 v[100:103], v[152:155], v[124:127], v[100:103]
ds_read_b64_tr_b16 v[152:153], v13 offset:7232
v_permlane16_swap_b32 v40, v76
s_waitcnt lgkmcnt(5)
v_mfma_f32_16x16x32_bf16 v[104:107], v[156:159], v[120:123], v[104:107]
ds_read_b64_tr_b16 v[154:155], v13 offset:9024
ds_read_b64_tr_b16 v[156:157], v14 offset:7168
s_xor_b32 s64, s50, 454656
s_sub_u32 s64, s64, 114688
buffer_load_dwordx4 v[120:123], v23, s[4:7], s64 offen offset:0 sc1
s_waitcnt vmcnt(12) lgkmcnt(5)
v_mfma_f32_16x16x32_bf16 v[80:83], v[144:147], v[128:131], v[80:83]
ds_read_b64_tr_b16 v[158:159], v14 offset:8960
s_xor_b32 s67, s64, 256
buffer_load_dwordx4 v[124:127], v23, s[4:7], s67 offen offset:0 sc1
v_pk_fma_f32 v[46:47], v[46:47], v[18:19], v[18:19] op_sel:[0,0,1] op_sel_hi:[1,0,1]
v_pk_mul_f32 v[44:45], v[44:45], v[72:73]
v_pk_mul_f32 v[46:47], v[46:47], v[74:75]
v_exp_f32 v44, v44
v_exp_f32 v45, v45
v_exp_f32 v46, v46
v_exp_f32 v47, v47
v_pk_fma_f32 v[44:45], v[44:45], v[40:41], v[40:41] op_sel:[0,0,0] op_sel_hi:[1,0,0]
v_pk_fma_f32 v[46:47], v[46:47], v[40:41], v[40:41] op_sel:[0,0,0] op_sel_hi:[1,0,0]
v_rcp_f32 v44, v44
v_rcp_f32 v45, v45
v_rcp_f32 v46, v46
v_rcp_f32 v47, v47
v_pk_mul_f32 v[44:45], v[44:45], v[72:73]
v_pk_mul_f32 v[46:47], v[46:47], v[74:75]
v_cvt_pk_bf16_f32 v72, v44, v45
v_cvt_pk_bf16_f32 v73, v46, v47
v_mov_b32 v74, v72
v_mov_b32 v75, v73
s_nop 0
v_permlane16_swap_b32 v72, v74
v_permlane16_swap_b32 v73, v75
s_waitcnt vmcnt(11)
v_mfma_f32_16x16x32_bf16 v[84:87], v[144:147], v[132:135], v[84:87]
ds_read_b64_tr_b16 v[144:145], v13 offset:14336
s_lshl_b32 s60, s71, 8
v_xor_b32 v77, s60, v1
s_add_u32 s62, s73, 0
s_mov_b32 exec_lo, 0xffff
s_mov_b32 exec_hi, 0xffff
buffer_store_dwordx4 v[72:75], v77, s[4:7], s62 offen sc1
s_mov_b64 exec, -1
s_waitcnt lgkmcnt(5)
v_mfma_f32_16x16x32_bf16 v[88:91], v[148:151], v[128:131], v[88:91]
ds_read_b64_tr_b16 v[146:147], v13 offset:16128
v_mfma_f32_16x16x32_bf16 v[92:95], v[148:151], v[132:135], v[92:95]
pg_4:
s_cbranch_execz pg_8
ds_read_b64_tr_b16 v[148:149], v13 offset:14368
s_waitcnt lgkmcnt(5)
v_mfma_f32_16x16x32_bf16 v[96:99], v[152:155], v[128:131], v[96:99]
ds_read_b64_tr_b16 v[150:151], v13 offset:16160
v_mfma_f32_16x16x32_bf16 v[100:103], v[152:155], v[132:135], v[100:103]
ds_read_b64_tr_b16 v[152:153], v13 offset:14400
buffer_load_dwordx4 v[132:135], v23, s[4:7], s67 offen offset:2048 sc1
s_waitcnt lgkmcnt(5)
v_mfma_f32_16x16x32_bf16 v[104:107], v[156:159], v[128:131], v[104:107]
ds_read_b64_tr_b16 v[154:155], v13 offset:16192
ds_read_b64_tr_b16 v[156:157], v14 offset:14336
buffer_load_dwordx4 v[128:131], v23, s[4:7], s64 offen offset:2048 sc1
s_waitcnt vmcnt(13) lgkmcnt(5)
v_mfma_f32_16x16x32_bf16 v[80:83], v[144:147], v[56:59], v[80:83]
ds_read_b64_tr_b16 v[158:159], v14 offset:16128
s_waitcnt vmcnt(12)
v_mfma_f32_16x16x32_bf16 v[84:87], v[144:147], v[60:63], v[84:87]
ds_read_b64_tr_b16 v[144:145], v13 offset:21504
s_waitcnt lgkmcnt(5)
v_mfma_f32_16x16x32_bf16 v[88:91], v[148:151], v[56:59], v[88:91]
ds_read_b64_tr_b16 v[146:147], v13 offset:23296
v_mfma_f32_16x16x32_bf16 v[92:95], v[148:151], v[60:63], v[92:95]
ds_read_b64_tr_b16 v[148:149], v13 offset:21536
s_waitcnt lgkmcnt(5)
v_mfma_f32_16x16x32_bf16 v[96:99], v[152:155], v[56:59], v[96:99]
ds_read_b64_tr_b16 v[150:151], v13 offset:23328
v_mfma_f32_16x16x32_bf16 v[100:103], v[152:155], v[60:63], v[100:103]
ds_read_b64_tr_b16 v[152:153], v13 offset:21568
s_waitcnt lgkmcnt(5)
v_mfma_f32_16x16x32_bf16 v[104:107], v[156:159], v[56:59], v[104:107]
ds_read_b64_tr_b16 v[154:155], v13 offset:23360
ds_read_b64_tr_b16 v[156:157], v14 offset:21504
s_waitcnt vmcnt(11) lgkmcnt(5)
v_mfma_f32_16x16x32_bf16 v[80:83], v[144:147], v[136:139], v[80:83]
ds_read_b64_tr_b16 v[158:159], v14 offset:23296
s_waitcnt vmcnt(9)
v_mfma_f32_16x16x32_bf16 v[84:87], v[144:147], v[140:143], v[84:87]
ds_read_b64_tr_b16 v[144:145], v13 offset:28672
s_waitcnt lgkmcnt(5)
v_mfma_f32_16x16x32_bf16 v[88:91], v[148:151], v[136:139], v[88:91]
ds_read_b64_tr_b16 v[146:147], v13 offset:30464
v_mfma_f32_16x16x32_bf16 v[92:95], v[148:151], v[140:143], v[92:95]
ds_read_b64_tr_b16 v[148:149], v13 offset:28704
s_waitcnt lgkmcnt(5)
v_mfma_f32_16x16x32_bf16 v[96:99], v[152:155], v[136:139], v[96:99]
ds_read_b64_tr_b16 v[150:151], v13 offset:30496
v_mfma_f32_16x16x32_bf16 v[100:103], v[152:155], v[140:143], v[100:103]
ds_read_b64_tr_b16 v[152:153], v13 offset:28736
s_waitcnt lgkmcnt(5)
v_mfma_f32_16x16x32_bf16 v[104:107], v[156:159], v[136:139], v[104:107]
ds_read_b64_tr_b16 v[154:155], v13 offset:30528
ds_read_b64_tr_b16 v[156:157], v14 offset:28672
s_waitcnt lgkmcnt(5)
v_mfma_f32_16x16x32_bf16 v[80:83], v[144:147], v[112:115], v[80:83]
ds_read_b64_tr_b16 v[158:159], v14 offset:30464
s_waitcnt vmcnt(8)
v_mfma_f32_16x16x32_bf16 v[84:87], v[144:147], v[116:119], v[84:87]
ds_read_b64_tr_b16 v[144:145], v13 offset:35840
s_waitcnt lgkmcnt(5)
v_mfma_f32_16x16x32_bf16 v[88:91], v[148:151], v[112:115], v[88:91]
ds_read_b64_tr_b16 v[146:147], v13 offset:37632
v_mfma_f32_16x16x32_bf16 v[92:95], v[148:151], v[116:119], v[92:95]
ds_read_b64_tr_b16 v[148:149], v13 offset:35872
s_waitcnt lgkmcnt(5)
v_mfma_f32_16x16x32_bf16 v[96:99], v[152:155], v[112:115], v[96:99]
ds_read_b64_tr_b16 v[150:151], v13 offset:37664
s_lshl2_add_u32 m0, s46, 131072
s_lshl4_add_u32 s3, s44, s17
buffer_load_dwordx4 v42, s[52:55], s3 offen offset:0 lds
buffer_load_dwordx4 v11, s[52:55], s3 offen offset:1024 lds
v_mfma_f32_16x16x32_bf16 v[100:103], v[152:155], v[116:119], v[100:103]
ds_read_b64_tr_b16 v[152:153], v13 offset:35904
s_add_u32 s3, s3, 14336
buffer_load_dwordx4 v42, s[52:55], s3 offen offset:2048 lds
s_waitcnt lgkmcnt(5)
v_mfma_f32_16x16x32_bf16 v[104:107], v[156:159], v[112:115], v[104:107]
ds_read_b64_tr_b16 v[154:155], v13 offset:37696
ds_read_b64_tr_b16 v[156:157], v14 offset:35840
buffer_load_dwordx4 v11, s[52:55], s3 offen offset:3072 lds
s_lshl2_add_u32 m0, s46, 114688
s_lshl4_add_u32 s3, s100, s49
buffer_load_dwordx4 v42, s[52:55], s3 offen offset:0 lds
s_waitcnt vmcnt(11) lgkmcnt(5)
v_mfma_f32_16x16x32_bf16 v[80:83], v[144:147], v[64:67], v[80:83]
ds_read_b64_tr_b16 v[158:159], v14 offset:37632
s_waitcnt vmcnt(10)
v_mfma_f32_16x16x32_bf16 v[84:87], v[144:147], v[68:71], v[84:87]
ds_read_b64_tr_b16 v[144:145], v13 offset:43008
buffer_load_dwordx4 v11, s[52:55], s3 offen offset:1024 lds
s_waitcnt lgkmcnt(5)
v_mfma_f32_16x16x32_bf16 v[88:91], v[148:151], v[64:67], v[88:91]
ds_read_b64_tr_b16 v[146:147], v13 offset:44800
v_mfma_f32_16x16x32_bf16 v[92:95], v[148:151], v[68:71], v[92:95]
ds_read_b64_tr_b16 v[148:149], v13 offset:43040
s_waitcnt lgkmcnt(5)
v_mfma_f32_16x16x32_bf16 v[96:99], v[152:155], v[64:67], v[96:99]
ds_read_b64_tr_b16 v[150:151], v13 offset:44832
s_add_u32 s3, s3, 14336
buffer_load_dwordx4 v42, s[52:55], s3 offen offset:2048 lds
v_mfma_f32_16x16x32_bf16 v[100:103], v[152:155], v[68:71], v[100:103]
ds_read_b64_tr_b16 v[152:153], v13 offset:43072
s_waitcnt lgkmcnt(5)
v_mfma_f32_16x16x32_bf16 v[104:107], v[156:159], v[64:67], v[104:107]
ds_read_b64_tr_b16 v[154:155], v13 offset:44864
ds_read_b64_tr_b16 v[156:157], v14 offset:43008
s_waitcnt vmcnt(11) lgkmcnt(5)
v_mfma_f32_16x16x32_bf16 v[80:83], v[144:147], v[120:123], v[80:83]
ds_read_b64_tr_b16 v[158:159], v14 offset:44800
s_waitcnt vmcnt(10)
v_mfma_f32_16x16x32_bf16 v[84:87], v[144:147], v[124:127], v[84:87]
ds_read_b64_tr_b16 v[144:145], v13 offset:50176
buffer_load_dwordx4 v11, s[52:55], s3 offen offset:3072 lds
s_waitcnt lgkmcnt(5)
v_mfma_f32_16x16x32_bf16 v[88:91], v[148:151], v[120:123], v[88:91]
ds_read_b64_tr_b16 v[146:147], v13 offset:51968
v_mfma_f32_16x16x32_bf16 v[92:95], v[148:151], v[124:127], v[92:95]
ds_read_b64_tr_b16 v[148:149], v13 offset:50208
s_waitcnt lgkmcnt(5)
v_mfma_f32_16x16x32_bf16 v[96:99], v[152:155], v[120:123], v[96:99]
ds_read_b64_tr_b16 v[150:151], v13 offset:52000
v_mfma_f32_16x16x32_bf16 v[100:103], v[152:155], v[124:127], v[100:103]
ds_read_b64_tr_b16 v[152:153], v13 offset:50240
s_waitcnt lgkmcnt(5)
v_mfma_f32_16x16x32_bf16 v[104:107], v[156:159], v[120:123], v[104:107]
ds_read_b64_tr_b16 v[154:155], v13 offset:52032
ds_read_b64_tr_b16 v[156:157], v14 offset:50176
v_subrev_u32 v13, s65, v13
s_waitcnt vmcnt(8) lgkmcnt(5)
v_mfma_f32_16x16x32_bf16 v[80:83], v[144:147], v[128:131], v[80:83]
ds_read_b64_tr_b16 v[158:159], v14 offset:51968
v_mov_b32 v76, 1
s_mov_b64 exec, 1
buffer_store_dword v76, v1, s[4:7], s45 offen
s_mov_b64 exec, -1
v_mfma_f32_16x16x32_bf16 v[84:87], v[144:147], v[132:135], v[84:87]
v_subrev_u32 v14, s65, v14
s_waitcnt lgkmcnt(4)
v_mfma_f32_16x16x32_bf16 v[88:91], v[148:151], v[128:131], v[88:91]
v_mfma_f32_16x16x32_bf16 v[92:95], v[148:151], v[132:135], v[92:95]
s_nop 1
v_permlane16_swap_b32 v80, v84
v_permlane16_swap_b32 v81, v85
v_permlane16_swap_b32 v82, v86
v_permlane16_swap_b32 v83, v87
v_pk_mul_f32 v[44:45], v[80:81], v[80:81]
v_pk_mul_f32 v[46:47], v[82:83], v[82:83]
v_pk_fma_f32 v[44:45], v[44:45], v[20:21], v[20:21] op_sel:[0,0,1] op_sel_hi:[1,0,1]
v_pk_fma_f32 v[46:47], v[46:47], v[20:21], v[20:21] op_sel:[0,0,1] op_sel_hi:[1,0,1]
v_pk_mul_f32 v[44:45], v[44:45], v[80:81]
v_pk_mul_f32 v[46:47], v[46:47], v[82:83]
v_exp_f32 v44, v44
v_exp_f32 v45, v45
v_exp_f32 v46, v46
v_exp_f32 v47, v47
v_pk_fma_f32 v[44:45], v[44:45], v[40:41], v[40:41] op_sel:[0,1,1] op_sel_hi:[1,1,1]
v_pk_fma_f32 v[46:47], v[46:47], v[40:41], v[40:41] op_sel:[0,1,1] op_sel_hi:[1,1,1]
v_rcp_f32 v44, v44
v_rcp_f32 v45, v45
v_rcp_f32 v46, v46
v_rcp_f32 v47, v47
v_pk_mul_f32 v[44:45], v[44:45], v[80:81]
v_pk_mul_f32 v[46:47], v[46:47], v[82:83]
v_cvt_pk_bf16_f32 v80, v44, v45
v_cvt_pk_bf16_f32 v81, v46, v47
v_pk_mul_f32 v[108:109], v[84:85], v[84:85]
v_pk_mul_f32 v[110:111], v[86:87], v[86:87]
v_pk_fma_f32 v[108:109], v[108:109], v[20:21], v[20:21] op_sel:[0,0,1] op_sel_hi:[1,0,1]
v_pk_fma_f32 v[110:111], v[110:111], v[20:21], v[20:21] op_sel:[0,0,1] op_sel_hi:[1,0,1]
v_pk_mul_f32 v[108:109], v[108:109], v[84:85]
v_pk_mul_f32 v[110:111], v[110:111], v[86:87]
v_exp_f32 v108, v108
v_exp_f32 v109, v109
v_exp_f32 v110, v110
v_exp_f32 v111, v111
v_pk_fma_f32 v[108:109], v[108:109], v[40:41], v[40:41] op_sel:[0,1,1] op_sel_hi:[1,1,1]
v_pk_fma_f32 v[110:111], v[110:111], v[40:41], v[40:41] op_sel:[0,1,1] op_sel_hi:[1,1,1]
v_rcp_f32 v108, v108
v_rcp_f32 v109, v109
v_rcp_f32 v110, v110
v_rcp_f32 v111, v111
v_pk_mul_f32 v[108:109], v[108:109], v[84:85]
v_pk_mul_f32 v[110:111], v[110:111], v[86:87]
v_cvt_pk_bf16_f32 v82, v108, v109
v_cvt_pk_bf16_f32 v83, v110, v111
s_lshl_b32 s60, s71, 8
v_xor_b32 v84, s60, v1
s_add_u32 s62, s72, 114688
buffer_store_dwordx4 v[80:83], v84, s[4:7], s62 offen offset:0 sc1
v_permlane16_swap_b32 v88, v92
v_permlane16_swap_b32 v89, v93
v_permlane16_swap_b32 v90, v94
v_permlane16_swap_b32 v91, v95
v_pk_mul_f32 v[44:45], v[88:89], v[88:89]
v_pk_mul_f32 v[46:47], v[90:91], v[90:91]
v_pk_fma_f32 v[44:45], v[44:45], v[20:21], v[20:21] op_sel:[0,0,1] op_sel_hi:[1,0,1]
v_pk_fma_f32 v[46:47], v[46:47], v[20:21], v[20:21] op_sel:[0,0,1] op_sel_hi:[1,0,1]
v_pk_mul_f32 v[44:45], v[44:45], v[88:89]
v_pk_mul_f32 v[46:47], v[46:47], v[90:91]
v_exp_f32 v44, v44
v_exp_f32 v45, v45
v_exp_f32 v46, v46
v_exp_f32 v47, v47
v_pk_fma_f32 v[44:45], v[44:45], v[40:41], v[40:41] op_sel:[0,1,1] op_sel_hi:[1,1,1]
v_pk_fma_f32 v[46:47], v[46:47], v[40:41], v[40:41] op_sel:[0,1,1] op_sel_hi:[1,1,1]
v_rcp_f32 v44, v44
v_rcp_f32 v45, v45
v_rcp_f32 v46, v46
v_rcp_f32 v47, v47
v_pk_mul_f32 v[44:45], v[44:45], v[88:89]
v_pk_mul_f32 v[46:47], v[46:47], v[90:91]
v_cvt_pk_bf16_f32 v88, v44, v45
v_cvt_pk_bf16_f32 v89, v46, v47
v_pk_mul_f32 v[108:109], v[92:93], v[92:93]
v_pk_mul_f32 v[110:111], v[94:95], v[94:95]
v_pk_fma_f32 v[108:109], v[108:109], v[20:21], v[20:21] op_sel:[0,0,1] op_sel_hi:[1,0,1]
v_pk_fma_f32 v[110:111], v[110:111], v[20:21], v[20:21] op_sel:[0,0,1] op_sel_hi:[1,0,1]
v_pk_mul_f32 v[108:109], v[108:109], v[92:93]
v_pk_mul_f32 v[110:111], v[110:111], v[94:95]
v_exp_f32 v108, v108
v_exp_f32 v109, v109
v_exp_f32 v110, v110
v_exp_f32 v111, v111
v_pk_fma_f32 v[108:109], v[108:109], v[40:41], v[40:41] op_sel:[0,1,1] op_sel_hi:[1,1,1]
v_pk_fma_f32 v[110:111], v[110:111], v[40:41], v[40:41] op_sel:[0,1,1] op_sel_hi:[1,1,1]
v_rcp_f32 v108, v108
v_rcp_f32 v109, v109
v_rcp_f32 v110, v110
v_rcp_f32 v111, v111
v_pk_mul_f32 v[108:109], v[108:109], v[92:93]
v_pk_mul_f32 v[110:111], v[110:111], v[94:95]
v_cvt_pk_bf16_f32 v90, v108, v109
v_cvt_pk_bf16_f32 v91, v110, v111
s_lshl_b32 s60, s71, 8
v_xor_b32 v92, s60, v1
s_add_u32 s62, s72, 114688
buffer_store_dwordx4 v[88:91], v92, s[4:7], s62 offen offset:1024 sc1
s_waitcnt vmcnt(9)
ds_read_b64_tr_b16 a[176:177], v43 offset:53248
ds_read_b64_tr_b16 a[180:181], v43 offset:53256
ds_read_b64_tr_b16 a[178:179], v43 offset:53504
ds_read_b64_tr_b16 a[182:183], v43 offset:53512
s_waitcnt vmcnt(7)
ds_read_b64_tr_b16 a[184:185], v43 offset:55296
ds_read_b64_tr_b16 a[188:189], v43 offset:55304
ds_read_b64_tr_b16 a[186:187], v43 offset:55552
ds_read_b64_tr_b16 a[190:191], v43 offset:55560
s_waitcnt lgkmcnt(10)
v_mfma_f32_16x16x32_bf16 v[96:99], v[152:155], v[128:131], v[96:99]
s_waitcnt vmcnt(5)
ds_read_b64_tr_b16 a[192:193], v43 offset:36864
ds_read_b64_tr_b16 a[196:197], v43 offset:36872
v_mfma_f32_16x16x32_bf16 v[100:103], v[152:155], v[132:135], v[100:103]
ds_read_b64_tr_b16 a[194:195], v43 offset:37120
ds_read_b64_tr_b16 a[198:199], v43 offset:37128
s_waitcnt lgkmcnt(12)
v_mfma_f32_16x16x32_bf16 v[104:107], v[156:159], v[128:131], v[104:107]
s_nop 3
v_permlane16_swap_b32 v96, v100
v_permlane16_swap_b32 v97, v101
v_permlane16_swap_b32 v98, v102
v_permlane16_swap_b32 v99, v103
v_pk_mul_f32 v[44:45], v[96:97], v[96:97]
v_pk_mul_f32 v[46:47], v[98:99], v[98:99]
v_pk_fma_f32 v[44:45], v[44:45], v[20:21], v[20:21] op_sel:[0,0,1] op_sel_hi:[1,0,1]
v_pk_fma_f32 v[46:47], v[46:47], v[20:21], v[20:21] op_sel:[0,0,1] op_sel_hi:[1,0,1]
v_pk_mul_f32 v[44:45], v[44:45], v[96:97]
v_pk_mul_f32 v[46:47], v[46:47], v[98:99]
v_exp_f32 v44, v44
v_exp_f32 v45, v45
v_exp_f32 v46, v46
v_exp_f32 v47, v47
v_pk_fma_f32 v[44:45], v[44:45], v[40:41], v[40:41] op_sel:[0,1,1] op_sel_hi:[1,1,1]
v_pk_fma_f32 v[46:47], v[46:47], v[40:41], v[40:41] op_sel:[0,1,1] op_sel_hi:[1,1,1]
v_rcp_f32 v44, v44
v_rcp_f32 v45, v45
v_rcp_f32 v46, v46
v_rcp_f32 v47, v47
v_pk_mul_f32 v[44:45], v[44:45], v[96:97]
v_pk_mul_f32 v[46:47], v[46:47], v[98:99]
v_cvt_pk_bf16_f32 v96, v44, v45
v_cvt_pk_bf16_f32 v97, v46, v47
v_pk_mul_f32 v[108:109], v[100:101], v[100:101]
v_pk_mul_f32 v[110:111], v[102:103], v[102:103]
v_pk_fma_f32 v[108:109], v[108:109], v[20:21], v[20:21] op_sel:[0,0,1] op_sel_hi:[1,0,1]
v_pk_fma_f32 v[110:111], v[110:111], v[20:21], v[20:21] op_sel:[0,0,1] op_sel_hi:[1,0,1]
v_pk_mul_f32 v[108:109], v[108:109], v[100:101]
v_pk_mul_f32 v[110:111], v[110:111], v[102:103]
v_exp_f32 v108, v108
v_exp_f32 v109, v109
v_exp_f32 v110, v110
v_exp_f32 v111, v111
v_pk_fma_f32 v[108:109], v[108:109], v[40:41], v[40:41] op_sel:[0,1,1] op_sel_hi:[1,1,1]
v_pk_fma_f32 v[110:111], v[110:111], v[40:41], v[40:41] op_sel:[0,1,1] op_sel_hi:[1,1,1]
v_rcp_f32 v108, v108
v_rcp_f32 v109, v109
v_rcp_f32 v110, v110
v_rcp_f32 v111, v111
v_pk_mul_f32 v[108:109], v[108:109], v[100:101]
v_pk_mul_f32 v[110:111], v[110:111], v[102:103]
v_cvt_pk_bf16_f32 v98, v108, v109
v_cvt_pk_bf16_f32 v99, v110, v111
s_lshl_b32 s60, s71, 8
v_xor_b32 v100, s60, v1
s_add_u32 s62, s72, 114688
buffer_store_dwordx4 v[96:99], v100, s[4:7], s62 offen offset:2048 sc1
v_mov_b32 v108, v20
v_pk_mul_f32 v[44:45], v[104:105], v[104:105]
v_pk_mul_f32 v[46:47], v[106:107], v[106:107]
v_permlane16_swap_b32 v20, v108
v_mov_b32 v108, v21
s_waitcnt vmcnt(4)
ds_read_b64_tr_b16 a[200:201], v43 offset:38912
v_permlane16_swap_b32 v21, v108
v_mov_b32 v108, v41
v_pk_fma_f32 v[44:45], v[44:45], v[20:21], v[20:21] op_sel:[0,0,1] op_sel_hi:[1,0,1]
v_pk_fma_f32 v[46:47], v[46:47], v[20:21], v[20:21] op_sel:[0,0,1] op_sel_hi:[1,0,1]
v_permlane16_swap_b32 v41, v108
v_pk_mul_f32 v[44:45], v[44:45], v[104:105]
v_pk_mul_f32 v[46:47], v[46:47], v[106:107]
v_exp_f32 v44, v44
v_exp_f32 v45, v45
v_exp_f32 v46, v46
v_exp_f32 v47, v47
v_pk_fma_f32 v[44:45], v[44:45], v[40:41], v[40:41] op_sel:[0,1,1] op_sel_hi:[1,1,1]
v_pk_fma_f32 v[46:47], v[46:47], v[40:41], v[40:41] op_sel:[0,1,1] op_sel_hi:[1,1,1]
v_rcp_f32 v44, v44
v_rcp_f32 v45, v45
v_rcp_f32 v46, v46
v_rcp_f32 v47, v47
v_pk_mul_f32 v[44:45], v[44:45], v[104:105]
v_pk_mul_f32 v[46:47], v[46:47], v[106:107]
v_cvt_pk_bf16_f32 v104, v44, v45
v_cvt_pk_bf16_f32 v105, v46, v47
v_mov_b32 v106, v104
v_mov_b32 v107, v105
v_lshrrev_b32 v15, 2, v1
buffer_load_dword v15, v15, s[4:7], s37 offen sc1
v_permlane16_swap_b32 v104, v106
v_permlane16_swap_b32 v105, v107
s_lshl_b32 s60, s71, 8
v_xor_b32 v109, s60, v1
s_add_u32 s62, s73, 114688
s_mov_b32 exec_lo, 0xffff
s_mov_b32 exec_hi, 0xffff
buffer_store_dwordx4 v[104:107], v109, s[4:7], s62 offen sc1
s_mov_b64 exec, -1
s_lshl2_add_u32 m0, s46, 131072
s_lshl4_add_u32 s3, s100, s17
s_waitcnt lgkmcnt(9)
buffer_load_dwordx4 v42, s[52:55], s3 offen offset:0 lds
buffer_load_dwordx4 v11, s[52:55], s3 offen offset:1024 lds
ds_read_b64_tr_b16 a[204:205], v43 offset:38920
ds_read_b64_tr_b16 a[202:203], v43 offset:39168
s_add_u32 s3, s3, 14336
s_waitcnt lgkmcnt(7)
buffer_load_dwordx4 v42, s[52:55], s3 offen offset:2048 lds
ds_read_b64_tr_b16 a[206:207], v43 offset:39176
v_mov_b32 v44, -1
buffer_load_dwordx4 v11, s[52:55], s3 offen offset:3072 lds
s_lshl2_add_u32 s60, s46, 114688
v_add_u32 v10, s60, v1
v_xor_b32 v11, 0x80, v10
v_mov_b32 v45, -1
v_mov_b32 v46, -1
v_mov_b32 v47, -1
s_waitcnt vmcnt(5)
v_cmp_gt_u32 vcc, 1, v15
s_nop 0
s_and_b64 vcc, vcc, s[28:29]
s_cbranch_scc1 re_38
re_38b:
s_add_u32 s67, s74, 0
buffer_load_dwordx4 v[112:115], v1, s[4:7], s67 offen offset:0 sc1
buffer_load_dwordx4 v[116:119], v1, s[4:7], s67 offen offset:1024 sc1
buffer_load_dwordx4 v[120:123], v1, s[4:7], s67 offen offset:2048 sc1
buffer_load_dwordx4 v[124:127], v1, s[4:7], s67 offen offset:3072 sc1
s_add_u32 s67, s0, 0
buffer_load_dwordx4 v[128:131], v1, s[4:7], s67 offen offset:0 sc1
buffer_load_dwordx4 v[132:135], v1, s[4:7], s67 offen offset:1024 sc1
s_waitcnt vmcnt(8)
ds_read_b64_tr_b16 a[208:209], v43 offset:53248
ds_read_b64_tr_b16 a[212:213], v43 offset:53256
ds_read_b64_tr_b16 a[210:211], v43 offset:53504
ds_read_b64_tr_b16 a[214:215], v43 offset:53512
v_mov_b32 v108, 2
s_mov_b64 exec, 1
buffer_store_dword v108, v1, s[4:7], s45 offen
s_mov_b64 exec, -1
buffer_load_dwordx4 v[136:139], v1, s[4:7], s67 offen offset:2048 sc1
s_waitcnt vmcnt(8)
ds_read_b64_tr_b16 a[216:217], v43 offset:55296
ds_read_b64_tr_b16 a[220:221], v43 offset:55304
ds_read_b64_tr_b16 a[218:219], v43 offset:55552
ds_read_b64_tr_b16 a[222:223], v43 offset:55560
buffer_load_dwordx4 v[140:143], v1, s[4:7], s67 offen offset:3072 sc1
s_add_u32 s67, s1, 0
buffer_load_dwordx4 v[144:147], v1, s[4:7], s67 offen offset:0 sc1
s_waitcnt lgkmcnt(0)
s_barrier
buffer_load_dwordx4 v[148:151], v1, s[4:7], s67 offen offset:1024 sc1
buffer_load_dwordx4 v[152:155], v1, s[4:7], s67 offen offset:2048 sc1
s_waitcnt vmcnt(11)
v_mfma_f32_32x32x16_bf16 v[48:63], a[0:3], v[112:115], 0
buffer_load_dwordx4 v[156:159], v1, s[4:7], s67 offen offset:3072 sc1
v_mfma_f32_32x32x16_bf16 v[64:79], a[4:7], v[112:115], 0
s_waitcnt vmcnt(11)
v_mfma_f32_32x32x16_bf16 v[48:63], a[8:11], v[116:119], v[48:63]
s_add_u32 s67, s82, 0
buffer_load_dwordx4 v[112:115], v1, s[4:7], s67 offen offset:0 sc1
v_mfma_f32_32x32x16_bf16 v[64:79], a[12:15], v[116:119], v[64:79]
s_waitcnt vmcnt(11)
v_mfma_f32_32x32x16_bf16 v[48:63], a[16:19], v[120:123], v[48:63]
buffer_load_dwordx4 v[116:119], v1, s[4:7], s67 offen offset:1024 sc1
v_mfma_f32_32x32x16_bf16 v[64:79], a[20:23], v[120:123], v[64:79]
s_waitcnt vmcnt(11)
v_mfma_f32_32x32x16_bf16 v[48:63], a[24:27], v[124:127], v[48:63]
buffer_load_dwordx4 v[120:123], v1, s[4:7], s67 offen offset:2048 sc1
v_mfma_f32_32x32x16_bf16 v[64:79], a[28:31], v[124:127], v[64:79]
s_waitcnt vmcnt(11)
v_mfma_f32_32x32x16_bf16 v[48:63], a[32:35], v[128:131], v[48:63]
buffer_load_dwordx4 v[124:127], v1, s[4:7], s67 offen offset:3072 sc1
v_mfma_f32_32x32x16_bf16 v[64:79], a[36:39], v[128:131], v[64:79]
s_waitcnt vmcnt(11)
v_mfma_f32_32x32x16_bf16 v[48:63], a[40:43], v[132:135], v[48:63]
s_add_u32 s67, s83, 0
buffer_load_dwordx4 v[128:131], v1, s[4:7], s67 offen offset:0 sc1
v_mfma_f32_32x32x16_bf16 v[64:79], a[44:47], v[132:135], v[64:79]
buffer_load_dwordx4 v[132:135], v1, s[4:7], s67 offen offset:1024 sc1
s_waitcnt vmcnt(11)
v_mfma_f32_32x32x16_bf16 v[48:63], a[48:51], v[136:139], v[48:63]
v_mfma_f32_32x32x16_bf16 v[64:79], a[52:55], v[136:139], v[64:79]
buffer_load_dwordx4 v[136:139], v1, s[4:7], s67 offen offset:2048 sc1
s_waitcnt vmcnt(11)
v_mfma_f32_32x32x16_bf16 v[48:63], a[56:59], v[140:143], v[48:63]
v_mfma_f32_32x32x16_bf16 v[64:79], a[60:63], v[140:143], v[64:79]
buffer_load_dwordx4 v[140:143], v1, s[4:7], s67 offen offset:3072 sc1
s_waitcnt vmcnt(11)
v_mfma_f32_32x32x16_bf16 v[48:63], a[64:67], v[144:147], v[48:63]
v_mfma_f32_32x32x16_bf16 v[64:79], a[68:71], v[144:147], v[64:79]
s_add_u32 s67, s44, 0
buffer_load_dwordx4 v[144:147], v1, s[4:7], s67 offen offset:0 sc1
s_waitcnt vmcnt(11)
v_mfma_f32_32x32x16_bf16 v[48:63], a[72:75], v[148:151], v[48:63]
v_mfma_f32_32x32x16_bf16 v[64:79], a[76:79], v[148:151], v[64:79]
v_lshrrev_b32 v15, 2, v1
buffer_load_dword v15, v15, s[4:7], s37 offen sc1
s_waitcnt vmcnt(11)
v_mfma_f32_32x32x16_bf16 v[48:63], a[80:83], v[152:155], v[48:63]
buffer_load_dwordx4 v[148:151], v1, s[4:7], s67 offen offset:1024 sc1
v_mfma_f32_32x32x16_bf16 v[64:79], a[84:87], v[152:155], v[64:79]
s_waitcnt vmcnt(11)
v_mfma_f32_32x32x16_bf16 v[48:63], a[88:91], v[156:159], v[48:63]
buffer_load_dwordx4 v[152:155], v1, s[4:7], s67 offen offset:2048 sc1
v_mfma_f32_32x32x16_bf16 v[64:79], a[92:95], v[156:159], v[64:79]
s_waitcnt vmcnt(11)
v_mfma_f32_32x32x16_bf16 v[48:63], a[96:99], v[112:115], v[48:63]
buffer_load_dwordx4 v[156:159], v1, s[4:7], s67 offen offset:3072 sc1
v_mfma_f32_32x32x16_bf16 v[64:79], a[100:103], v[112:115], v[64:79]
s_waitcnt vmcnt(11)
v_mfma_f32_32x32x16_bf16 v[48:63], a[104:107], v[116:119], v[48:63]
s_add_u32 s67, s100, 0
buffer_load_dwordx4 v[112:115], v1, s[4:7], s67 offen offset:0 sc1
v_mfma_f32_32x32x16_bf16 v[64:79], a[108:111], v[116:119], v[64:79]
s_waitcnt vmcnt(11)
v_mfma_f32_32x32x16_bf16 v[48:63], a[112:115], v[120:123], v[48:63]
buffer_load_dwordx4 v[116:119], v1, s[4:7], s67 offen offset:1024 sc1
v_mfma_f32_32x32x16_bf16 v[64:79], a[116:119], v[120:123], v[64:79]
s_waitcnt vmcnt(11)
v_mfma_f32_32x32x16_bf16 v[48:63], a[120:123], v[124:127], v[48:63]
buffer_load_dwordx4 v[120:123], v1, s[4:7], s67 offen offset:2048 sc1
v_mfma_f32_32x32x16_bf16 v[64:79], a[124:127], v[124:127], v[64:79]
s_waitcnt vmcnt(11)
v_mfma_f32_32x32x16_bf16 v[48:63], a[128:131], v[128:131], v[48:63]
buffer_load_dwordx4 v[124:127], v1, s[4:7], s67 offen offset:3072 sc1
v_mfma_f32_32x32x16_bf16 v[64:79], a[132:135], v[128:131], v[64:79]
s_waitcnt vmcnt(11)
v_mfma_f32_32x32x16_bf16 v[48:63], a[136:139], v[132:135], v[48:63]
v_mfma_f32_32x32x16_bf16 v[64:79], a[140:143], v[132:135], v[64:79]
s_waitcnt vmcnt(10)
v_mfma_f32_32x32x16_bf16 v[48:63], a[144:147], v[136:139], v[48:63]
v_mfma_f32_32x32x16_bf16 v[64:79], a[148:151], v[136:139], v[64:79]
s_waitcnt vmcnt(9)
v_mfma_f32_32x32x16_bf16 v[48:63], a[152:155], v[140:143], v[48:63]
v_mfma_f32_32x32x16_bf16 v[64:79], a[156:159], v[140:143], v[64:79]
s_waitcnt vmcnt(7)
v_cmp_gt_u32 vcc, 2, v15
s_nop 0
s_and_b64 vcc, vcc, -1
s_cbranch_scc1 re_39
re_39b:
s_add_u32 s67, s74, 114688
buffer_load_dwordx4 v[128:131], v1, s[4:7], s67 offen offset:0 sc1
buffer_load_dwordx4 v[132:135], v1, s[4:7], s67 offen offset:1024 sc1
v_mfma_f32_32x32x16_bf16 v[48:63], a[160:163], v[144:147], v[48:63]
buffer_load_dwordx4 v[136:139], v1, s[4:7], s67 offen offset:2048 sc1
v_mfma_f32_32x32x16_bf16 v[64:79], a[164:167], v[144:147], v[64:79]
buffer_load_dwordx4 v[140:143], v1, s[4:7], s67 offen offset:3072 sc1
s_waitcnt vmcnt(10)
v_mfma_f32_32x32x16_bf16 v[48:63], a[168:171], v[148:151], v[48:63]
s_add_u32 s67, s0, 114688
buffer_load_dwordx4 v[144:147], v1, s[4:7], s67 offen offset:0 sc1
v_mfma_f32_32x32x16_bf16 v[64:79], a[172:175], v[148:151], v[64:79]
s_add_u32 s62, s34, 393216
buffer_store_dwordx4 v[44:47], v1, s[4:7], s62 offen
s_waitcnt vmcnt(11)
v_mfma_f32_32x32x16_bf16 v[48:63], a[176:179], v[152:155], v[48:63]
v_mfma_f32_32x32x16_bf16 v[64:79], a[180:183], v[152:155], v[64:79]
s_add_u32 s62, s34, 425984
buffer_store_dwordx4 v[44:47], v1, s[4:7], s62 offen
s_waitcnt vmcnt(11)
v_mfma_f32_32x32x16_bf16 v[48:63], a[184:187], v[156:159], v[48:63]
v_mfma_f32_32x32x16_bf16 v[64:79], a[188:191], v[156:159], v[64:79]
buffer_load_dwordx4 v[148:151], v1, s[4:7], s67 offen offset:1024 sc1
s_waitcnt vmcnt(11)
v_mfma_f32_32x32x16_bf16 v[48:63], a[192:195], v[112:115], v[48:63]
v_mfma_f32_32x32x16_bf16 v[64:79], a[196:199], v[112:115], v[64:79]
buffer_load_dwordx4 v[152:155], v1, s[4:7], s67 offen offset:2048 sc1
s_waitcnt vmcnt(11)
v_mfma_f32_32x32x16_bf16 v[48:63], a[200:203], v[116:119], v[48:63]
v_mfma_f32_32x32x16_bf16 v[64:79], a[204:207], v[116:119], v[64:79]
buffer_load_dwordx4 v[156:159], v1, s[4:7], s67 offen offset:3072 sc1
s_waitcnt vmcnt(11)
v_mfma_f32_32x32x16_bf16 v[48:63], a[208:211], v[120:123], v[48:63]
v_mfma_f32_32x32x16_bf16 v[64:79], a[212:215], v[120:123], v[64:79]
s_add_u32 s67, s1, 114688
buffer_load_dwordx4 v[112:115], v1, s[4:7], s67 offen offset:0 sc1
s_waitcnt vmcnt(11)
v_mfma_f32_32x32x16_bf16 v[48:63], a[216:219], v[124:127], v[48:63]
v_mfma_f32_32x32x16_bf16 v[64:79], a[220:223], v[124:127], v[64:79]
buffer_load_dwordx4 v[116:119], v1, s[4:7], s67 offen offset:1024 sc1
s_nop 3
ds_write_b128 v10, v[48:51] offset:0
ds_write_b128 v11, v[52:55] offset:1024
s_waitcnt vmcnt(11)
v_mfma_f32_32x32x16_bf16 v[80:95], a[0:3], v[128:131], 0
buffer_load_dwordx4 v[120:123], v1, s[4:7], s67 offen offset:2048 sc1
ds_write_b128 v10, v[56:59] offset:2048
v_mfma_f32_32x32x16_bf16 v[96:111], a[4:7], v[128:131], 0
ds_write_b128 v11, v[60:63] offset:3072
buffer_load_dwordx4 v[124:127], v1, s[4:7], s67 offen offset:3072 sc1
s_waitcnt vmcnt(12)
v_mfma_f32_32x32x16_bf16 v[80:95], a[8:11], v[132:135], v[80:95]
ds_write_b128 v10, v[64:67] offset:16384
s_add_u32 s67, s82, 114688
buffer_load_dwordx4 v[128:131], v1, s[4:7], s67 offen offset:0 sc1
v_mfma_f32_32x32x16_bf16 v[96:111], a[12:15], v[132:135], v[96:111]
ds_write_b128 v11, v[68:71] offset:17408
s_waitcnt lgkmcnt(2)
s_barrier
buffer_load_dwordx4 v[132:135], v1, s[4:7], s67 offen offset:1024 sc1
ds_write_b128 v10, v[72:75] offset:18432
ds_write_b128 v11, v[76:79] offset:19456
s_waitcnt vmcnt(13)
v_mfma_f32_32x32x16_bf16 v[80:95], a[16:19], v[136:139], v[80:95]
ds_read_b128 v[48:51], v12 offset:0
ds_read_b128 v[52:55], v12 offset:4096
ds_read_b128 v[56:59], v12 offset:8192
ds_read_b128 v[60:63], v12 offset:12288
v_mfma_f32_32x32x16_bf16 v[96:111], a[20:23], v[136:139], v[96:111]
buffer_load_dwordx4 v[136:139], v1, s[4:7], s67 offen offset:2048 sc1
s_waitcnt vmcnt(13)
v_mfma_f32_32x32x16_bf16 v[80:95], a[24:27], v[140:143], v[80:95]
s_waitcnt lgkmcnt(2)
v_add_f32 v48, v48, v52
v_add_f32 v49, v49, v53
v_mfma_f32_32x32x16_bf16 v[96:111], a[28:31], v[140:143], v[96:111]
buffer_load_dwordx4 v[140:143], v1, s[4:7], s67 offen offset:3072 sc1
s_waitcnt vmcnt(11) lgkmcnt(0)
s_barrier
v_mfma_f32_32x32x16_bf16 v[80:95], a[32:35], v[144:147], v[80:95]
v_add_f32 v50, v50, v54
v_add_f32 v51, v51, v55
v_add_f32 v56, v56, v60
v_add_f32 v57, v57, v61
v_add_f32 v58, v58, v62
v_add_f32 v59, v59, v63
v_mfma_f32_32x32x16_bf16 v[96:111], a[36:39], v[144:147], v[96:111]
s_add_u32 s67, s83, 114688
buffer_load_dwordx4 v[144:147], v1, s[4:7], s67 offen offset:0 sc1
s_waitcnt vmcnt(11)
v_mfma_f32_32x32x16_bf16 v[80:95], a[40:43], v[148:151], v[80:95]
v_add_f32 v24, v24, v48
v_add_f32 v25, v25, v49
v_add_f32 v26, v26, v50
v_add_f32 v27, v27, v51
v_add_f32 v24, v24, v56
v_add_f32 v25, v25, v57
v_mfma_f32_32x32x16_bf16 v[96:111], a[44:47], v[148:151], v[96:111]
buffer_load_dwordx4 v[148:151], v1, s[4:7], s67 offen offset:1024 sc1
v_add_f32 v26, v26, v58
v_add_f32 v27, v27, v59
ds_read_b128 v[64:67], v12 offset:16384
s_waitcnt vmcnt(11)
v_mfma_f32_32x32x16_bf16 v[80:95], a[48:51], v[152:155], v[80:95]
ds_read_b128 v[68:71], v12 offset:20480
ds_read_b128 v[72:75], v12 offset:24576
ds_read_b128 v[76:79], v12 offset:28672
v_add_f32 v48, v24, v26
v_add_f32 v49, v25, v27
v_mfma_f32_32x32x16_bf16 v[96:111], a[52:55], v[152:155], v[96:111]
buffer_load_dwordx4 v[152:155], v1, s[4:7], s67 offen offset:2048 sc1
v_mul_f32 v50, v24, v24
v_mul_f32 v51, v25, v25
v_fmac_f32 v50, v26, v26
v_fmac_f32 v51, v27, v27
s_waitcnt vmcnt(11)
v_mfma_f32_32x32x16_bf16 v[80:95], a[56:59], v[156:159], v[80:95]
s_waitcnt lgkmcnt(2)
v_add_f32 v64, v64, v68
v_add_f32 v65, v65, v69
v_add_f32 v66, v66, v70
v_add_f32 v67, v67, v71
v_add_f32 v28, v28, v64
v_add_f32 v29, v29, v65
v_mfma_f32_32x32x16_bf16 v[96:111], a[60:63], v[156:159], v[96:111]
buffer_load_dwordx4 v[156:159], v1, s[4:7], s67 offen offset:3072 sc1
s_waitcnt lgkmcnt(0)
v_add_f32 v72, v72, v76
v_add_f32 v73, v73, v77
s_waitcnt vmcnt(11)
v_mfma_f32_32x32x16_bf16 v[80:95], a[64:67], v[112:115], v[80:95]
v_add_f32 v74, v74, v78
v_add_f32 v75, v75, v79
v_add_f32 v30, v30, v66
v_add_f32 v31, v31, v67
s_add_u32 s62, s34, 1835008
buffer_load_dwordx4 v[64:67], v1, s[4:7], s62 offen sc1
v_mfma_f32_32x32x16_bf16 v[96:111], a[68:71], v[112:115], v[96:111]
s_add_u32 s67, s44, 114688
buffer_load_dwordx4 v[112:115], v1, s[4:7], s67 offen offset:0 sc1
v_add_f32 v28, v28, v72
v_add_f32 v29, v29, v73
s_waitcnt vmcnt(12)
v_mfma_f32_32x32x16_bf16 v[80:95], a[72:75], v[116:119], v[80:95]
v_add_f32 v30, v30, v74
v_add_f32 v31, v31, v75
v_add_f32 v48, v48, v28
pg_5:
s_cbranch_execz pg_9
v_add_f32 v49, v49, v29
v_fmac_f32 v50, v28, v28
v_fmac_f32 v51, v29, v29
v_mfma_f32_32x32x16_bf16 v[96:111], a[76:79], v[116:119], v[96:111]
buffer_load_dwordx4 v[116:119], v1, s[4:7], s67 offen offset:1024 sc1
v_add_f32 v48, v48, v30
v_add_f32 v49, v49, v31
v_fmac_f32 v50, v30, v30
v_fmac_f32 v51, v31, v31
s_waitcnt vmcnt(12)
v_mfma_f32_32x32x16_bf16 v[80:95], a[80:83], v[120:123], v[80:95]
v_add_f32 v48, v48, v49
v_add_f32 v50, v50, v51
s_nop 1
v_permlane32_swap_b32 v48, v50
v_mfma_f32_32x32x16_bf16 v[96:111], a[84:87], v[120:123], v[96:111]
buffer_load_dwordx4 v[120:123], v1, s[4:7], s67 offen offset:2048 sc1
v_add_f32 v48, v48, v50
v_mov_b32 v50, v48
s_waitcnt vmcnt(12)
v_mfma_f32_32x32x16_bf16 v[80:95], a[88:91], v[124:127], v[80:95]
v_permlane16_swap_b32 v48, v50
v_add_f32 v48, v48, v50
s_nop 1
v_add_f32_dpp v48, v48, v48 row_ror:8 row_mask:0xf bank_mask:0xf
v_mfma_f32_32x32x16_bf16 v[96:111], a[92:95], v[124:127], v[96:111]
buffer_load_dwordx4 v[124:127], v1, s[4:7], s67 offen offset:3072 sc1
s_waitcnt vmcnt(12)
v_mfma_f32_32x32x16_bf16 v[80:95], a[96:99], v[128:131], v[80:95]
s_add_u32 s62, s42, 565248
buffer_store_dword v48, v8, s[4:7], s62 offen offset:0
v_mfma_f32_32x32x16_bf16 v[96:111], a[100:103], v[128:131], v[96:111]
s_add_u32 s67, s100, 114688
buffer_load_dwordx4 v[128:131], v1, s[4:7], s67 offen offset:0 sc1
s_waitcnt vmcnt(13)
v_mfma_f32_32x32x16_bf16 v[80:95], a[104:107], v[132:135], v[80:95]
v_mfma_f32_32x32x16_bf16 v[96:111], a[108:111], v[132:135], v[96:111]
buffer_load_dwordx4 v[132:135], v1, s[4:7], s67 offen offset:1024 sc1
s_waitcnt vmcnt(13)
v_mfma_f32_32x32x16_bf16 v[80:95], a[112:115], v[136:139], v[80:95]
v_mfma_f32_32x32x16_bf16 v[96:111], a[116:119], v[136:139], v[96:111]
buffer_load_dwordx4 v[136:139], v1, s[4:7], s67 offen offset:2048 sc1
s_waitcnt vmcnt(13)
v_mfma_f32_32x32x16_bf16 v[80:95], a[120:123], v[140:143], v[80:95]
v_mfma_f32_32x32x16_bf16 v[96:111], a[124:127], v[140:143], v[96:111]
buffer_load_dwordx4 v[140:143], v1, s[4:7], s67 offen offset:3072 sc1
s_waitcnt vmcnt(13)
v_mfma_f32_32x32x16_bf16 v[80:95], a[128:131], v[144:147], v[80:95]
v_mfma_f32_32x32x16_bf16 v[96:111], a[132:135], v[144:147], v[96:111]
s_waitcnt vmcnt(12)
v_mfma_f32_32x32x16_bf16 v[80:95], a[136:139], v[148:151], v[80:95]
s_waitcnt vmcnt(9)
v_lshlrev_b32 v68, 16, v64
v_mfma_f32_32x32x16_bf16 v[96:111], a[140:143], v[148:151], v[96:111]
v_and_b32 v69, s36, v64
v_lshlrev_b32 v70, 16, v65
v_and_b32 v71, s36, v65
v_lshlrev_b32 v72, 16, v66
v_and_b32 v73, s36, v66
v_lshlrev_b32 v74, 16, v67
v_mfma_f32_32x32x16_bf16 v[80:95], a[144:147], v[152:155], v[80:95]
v_and_b32 v75, s36, v67
v_mfma_f32_32x32x16_bf16 v[96:111], a[148:151], v[152:155], v[96:111]
v_mfma_f32_32x32x16_bf16 v[80:95], a[152:155], v[156:159], v[80:95]
v_mfma_f32_32x32x16_bf16 v[96:111], a[156:159], v[156:159], v[96:111]
s_waitcnt vmcnt(8)
v_mfma_f32_32x32x16_bf16 v[80:95], a[160:163], v[112:115], v[80:95]
v_mfma_f32_32x32x16_bf16 v[96:111], a[164:167], v[112:115], v[96:111]
s_waitcnt vmcnt(7)
v_mfma_f32_32x32x16_bf16 v[80:95], a[168:171], v[116:119], v[80:95]
v_mfma_f32_32x32x16_bf16 v[96:111], a[172:175], v[116:119], v[96:111]
s_waitcnt vmcnt(6)
v_mfma_f32_32x32x16_bf16 v[80:95], a[176:179], v[120:123], v[80:95]
s_add_u32 s62, s43, 565248
buffer_load_dwordx2 v[52:53], v7, s[4:7], s62 offen offset:0 sc1
v_mfma_f32_32x32x16_bf16 v[96:111], a[180:183], v[120:123], v[96:111]
s_waitcnt vmcnt(6)
v_mfma_f32_32x32x16_bf16 v[80:95], a[184:187], v[124:127], v[80:95]
v_mfma_f32_32x32x16_bf16 v[96:111], a[188:191], v[124:127], v[96:111]
s_waitcnt vmcnt(4)
v_mfma_f32_32x32x16_bf16 v[80:95], a[192:195], v[128:131], v[80:95]
v_mfma_f32_32x32x16_bf16 v[96:111], a[196:199], v[128:131], v[96:111]
s_waitcnt vmcnt(3)
v_mfma_f32_32x32x16_bf16 v[80:95], a[200:203], v[132:135], v[80:95]
v_mfma_f32_32x32x16_bf16 v[96:111], a[204:207], v[132:135], v[96:111]
s_waitcnt vmcnt(2)
v_mfma_f32_32x32x16_bf16 v[80:95], a[208:211], v[136:139], v[80:95]
v_mfma_f32_32x32x16_bf16 v[96:111], a[212:215], v[136:139], v[96:111]
s_waitcnt vmcnt(1)
v_mfma_f32_32x32x16_bf16 v[80:95], a[216:219], v[140:143], v[80:95]
s_waitcnt vmcnt(0)
v_max_u32 v54, v52, v53
v_cmp_eq_u32 vcc, -1, v54
s_cbranch_vccnz re_40
re_40b:
v_mfma_f32_32x32x16_bf16 v[96:111], a[220:223], v[140:143], v[96:111]
v_permlane32_swap_b32 v52, v53
s_nop 3
ds_write_b128 v10, v[80:83] offset:0
ds_write_b128 v11, v[84:87] offset:1024
v_add_f32 v52, v52, v53
v_mov_b32 v53, v52
s_nop 1
v_permlane16_swap_b32 v52, v53
v_add_f32 v52, v52, v53
ds_write_b128 v10, v[88:91] offset:2048
s_nop 0
v_add_f32_dpp v52, v52, v52 row_ror:8 row_mask:0xf bank_mask:0xf
v_mul_f32 v52, 0x3b000000, v52
v_mov_b32 v53, v52
s_nop 1
v_permlane32_swap_b32 v52, v53
ds_write_b128 v11, v[92:95] offset:3072
v_fma_f32 v53, -v52, v52, v53
v_max_f32 v53, 0, v53
v_add_f32 v54, 0x3727c5ac, v53
v_rsq_f32 v54, v54
s_nop 0
v_mul_f32 v55, -v52, v54
v_pk_fma_f32 v[56:57], v[24:25], v[54:55], v[54:55] op_sel:[0,0,1] op_sel_hi:[1,0,1]
v_pk_fma_f32 v[58:59], v[26:27], v[54:55], v[54:55] op_sel:[0,0,1] op_sel_hi:[1,0,1]
v_pk_fma_f32 v[60:61], v[28:29], v[54:55], v[54:55] op_sel:[0,0,1] op_sel_hi:[1,0,1]
v_pk_fma_f32 v[62:63], v[30:31], v[54:55], v[54:55] op_sel:[0,0,1] op_sel_hi:[1,0,1]
v_pk_fma_f32 v[24:25], v[56:57], v[68:69], v[24:25] op_sel:[0,0,0] op_sel_hi:[1,1,1]
v_pk_fma_f32 v[26:27], v[58:59], v[70:71], v[26:27] op_sel:[0,0,0] op_sel_hi:[1,1,1]
v_pk_fma_f32 v[28:29], v[60:61], v[72:73], v[28:29] op_sel:[0,0,0] op_sel_hi:[1,1,1]
v_pk_fma_f32 v[30:31], v[62:63], v[74:75], v[30:31] op_sel:[0,0,0] op_sel_hi:[1,1,1]
v_cvt_pk_bf16_f32 v76, v24, v25
v_cvt_pk_bf16_f32 v77, v26, v27
v_cvt_pk_bf16_f32 v78, v28, v29
v_cvt_pk_bf16_f32 v79, v30, v31
s_add_u32 s62, s40, 393216
buffer_store_dwordx4 v[76:79], v3, s[4:7], s62 offen
s_waitcnt lgkmcnt(0)
s_barrier
ds_write_b128 v10, v[96:99] offset:16384
ds_write_b128 v11, v[100:103] offset:17408
ds_read_b128 v[80:83], v12 offset:0
ds_read_b128 v[84:87], v12 offset:4096
ds_read_b128 v[88:91], v12 offset:8192
ds_read_b128 v[92:95], v12 offset:12288
ds_write_b128 v10, v[104:107] offset:18432
v_add_u32 v76, s25, v1
v_pk_add_f32 v[68:69], v[24:25], v[26:27]
v_pk_mul_f32 v[70:71], v[24:25], v[24:25]
ds_write_b128 v11, v[108:111] offset:19456
s_waitcnt lgkmcnt(4)
v_pk_add_f32 v[80:81], v[80:81], v[84:85]
v_pk_add_f32 v[82:83], v[82:83], v[86:87]
s_waitcnt lgkmcnt(2)
v_pk_add_f32 v[88:89], v[88:89], v[92:93]
v_pk_add_f32 v[90:91], v[90:91], v[94:95]
v_pk_add_f32 v[32:33], v[32:33], v[80:81]
v_pk_add_f32 v[34:35], v[34:35], v[82:83]
v_pk_add_f32 v[32:33], v[32:33], v[88:89]
v_pk_add_f32 v[34:35], v[34:35], v[90:91]
s_waitcnt lgkmcnt(0)
s_barrier
ds_read_b128 v[96:99], v12 offset:16384
ds_read_b128 v[100:103], v12 offset:20480
ds_read_b128 v[104:107], v12 offset:24576
ds_read_b128 v[108:111], v12 offset:28672
v_pk_add_f32 v[80:81], v[32:33], v[34:35]
v_pk_mul_f32 v[82:83], v[32:33], v[32:33]
v_pk_fma_f32 v[82:83], v[34:35], v[34:35], v[82:83] op_sel:[0,0,0] op_sel_hi:[1,1,1]
v_pk_fma_f32 v[70:71], v[26:27], v[26:27], v[70:71] op_sel:[0,0,0] op_sel_hi:[1,1,1]
v_pk_add_f32 v[68:69], v[68:69], v[28:29]
v_pk_fma_f32 v[70:71], v[28:29], v[28:29], v[70:71] op_sel:[0,0,0] op_sel_hi:[1,1,1]
v_pk_add_f32 v[68:69], v[68:69], v[30:31]
s_waitcnt lgkmcnt(2)
v_pk_add_f32 v[96:97], v[96:97], v[100:101]
v_pk_add_f32 v[98:99], v[98:99], v[102:103]
v_pk_add_f32 v[36:37], v[36:37], v[96:97]
v_pk_add_f32 v[38:39], v[38:39], v[98:99]
s_add_u32 s62, s34, 1867776
buffer_load_dwordx4 v[96:99], v1, s[4:7], s62 offen sc1
s_waitcnt lgkmcnt(0)
v_pk_add_f32 v[104:105], v[104:105], v[108:109]
v_pk_add_f32 v[106:107], v[106:107], v[110:111]
v_pk_add_f32 v[36:37], v[36:37], v[104:105]
v_pk_add_f32 v[38:39], v[38:39], v[106:107]
v_pk_add_f32 v[80:81], v[80:81], v[36:37]
v_pk_fma_f32 v[82:83], v[36:37], v[36:37], v[82:83] op_sel:[0,0,0] op_sel_hi:[1,1,1]
v_pk_add_f32 v[80:81], v[80:81], v[38:39]
s_add_u32 m0, s23, 32768
s_xor_b32 s38, s47, 393216
buffer_load_dwordx4 v1, s[4:7], s38 offen offset:0 sc1 lds
buffer_load_dwordx4 v1, s[4:7], s38 offen offset:1024 sc1 lds
v_pk_fma_f32 v[82:83], v[38:39], v[38:39], v[82:83] op_sel:[0,0,0] op_sel_hi:[1,1,1]
v_add_f32 v80, v80, v81
v_add_f32 v82, v82, v83
v_pk_fma_f32 v[70:71], v[30:31], v[30:31], v[70:71] op_sel:[0,0,0] op_sel_hi:[1,1,1]
v_add_f32 v68, v68, v69
v_permlane32_swap_b32 v80, v82
v_add_f32 v80, v80, v82
s_add_u32 m0, s23, 0
s_xor_b32 s38, s47, 401408
buffer_load_dwordx4 v1, s[4:7], s38 offen offset:0 sc1 lds
buffer_load_dwordx4 v1, s[4:7], s38 offen offset:1024 sc1 lds
v_mov_b32 v82, v80
v_add_f32 v70, v70, v71
s_nop 0
v_permlane16_swap_b32 v80, v82
v_add_f32 v80, v80, v82
v_permlane32_swap_b32 v68, v70
s_nop 0
v_add_f32_dpp v80, v80, v80 row_ror:8 row_mask:0xf bank_mask:0xf
s_add_u32 s62, s42, 565248
buffer_store_dword v80, v8, s[4:7], s62 offen offset:2048
v_add_f32 v68, v68, v70
v_mov_b32 v70, v68
s_nop 1
v_permlane16_swap_b32 v68, v70
v_add_f32 v68, v68, v70
s_nop 1
v_add_f32_dpp v68, v68, v68 row_ror:8 row_mask:0xf bank_mask:0xf
s_add_u32 m0, s23, 8192
s_xor_b32 s38, s47, 409600
buffer_load_dwordx4 v1, s[4:7], s38 offen offset:0 sc1 lds
buffer_load_dwordx4 v1, s[4:7], s38 offen offset:1024 sc1 lds
s_waitcnt vmcnt(7)
v_lshlrev_b32 v100, 16, v96
v_and_b32 v101, s36, v96
v_lshlrev_b32 v102, 16, v97
v_and_b32 v103, s36, v97
v_lshlrev_b32 v104, 16, v98
v_and_b32 v105, s36, v98
v_lshlrev_b32 v106, 16, v99
v_and_b32 v107, s36, v99
s_add_u32 s62, s42, 548864
buffer_store_dword v68, v8, s[4:7], s62 offen offset:0
v_lshrrev_b32 v68, 9, v1
v_lshl_add_u32 v68, v68, 5, s26
ds_read_b128 v[64:67], v68 offset:0
ds_read_b128 v[68:71], v68 offset:16
s_waitcnt vmcnt(6)
ds_read2st64_b32 v[72:73], v0 offset0:128 offset1:132
s_waitcnt lgkmcnt(0)
v_max_u32 v72, v72, v73
v_cmp_eq_u32 vcc, -1, v72
s_cbranch_vccnz re_42
re_42b:
s_barrier
ds_read_b128 v[112:115], v23 offset:32768
ds_read_b128 v[116:119], v23 offset:33024
ds_read_b128 v[120:123], v23 offset:34816
ds_read_b128 v[124:127], v23 offset:35072
ds_read_b128 v[128:131], v23 offset:36864
ds_read_b128 v[132:135], v23 offset:37120
ds_read_b128 v[136:139], v23 offset:38912
ds_read_b128 v[140:143], v23 offset:39168
s_add_u32 m0, s23, 16384
s_xor_b32 s38, s47, 417792
buffer_load_dwordx4 v1, s[4:7], s38 offen offset:0 sc1 lds
buffer_load_dwordx4 v1, s[4:7], s38 offen offset:1024 sc1 lds
s_waitcnt vmcnt(6)
ds_read2st64_b32 v[72:73], v0 offset0:0 offset1:4
ds_read_b128 v[76:79], v76 offset:32768
s_waitcnt lgkmcnt(8)
v_mfma_f32_16x16x32_bf16 v[48:51], v[160:163], v[112:115], 0
s_waitcnt vmcnt(3)
ds_read2st64_b32 v[74:75], v0 offset0:32 offset1:36
v_mfma_f32_16x16x32_bf16 v[52:55], v[160:163], v[116:119], 0
s_waitcnt lgkmcnt(7)
v_mfma_f32_16x16x32_bf16 v[48:51], v[164:167], v[120:123], v[48:51]
v_mfma_f32_16x16x32_bf16 v[52:55], v[164:167], v[124:127], v[52:55]
s_waitcnt lgkmcnt(5)
v_mfma_f32_16x16x32_bf16 v[48:51], v[168:171], v[128:131], v[48:51]
s_add_u32 s62, s43, 565248
buffer_load_dwordx2 v[84:85], v7, s[4:7], s62 offen offset:2048 sc1
s_waitcnt lgkmcnt(0)
v_max3_u32 v72, v72, v73, v74
v_max_u32 v72, v72, v75
v_cmp_eq_u32 vcc, -1, v72
s_cbranch_vccnz re_43
re_43b:
s_barrier
ds_read_b128 v[144:147], v23 offset:0
ds_read_b128 v[148:151], v23 offset:256
ds_read_b128 v[152:155], v23 offset:2048
ds_read_b128 v[156:159], v23 offset:2304
ds_read_b128 v[112:115], v23 offset:4096
ds_read_b128 v[116:119], v23 offset:4352
ds_read_b128 v[120:123], v23 offset:6144
ds_read_b128 v[124:127], v23 offset:6400
ds_read_b128 v[128:131], v23 offset:8192
v_mfma_f32_16x16x32_bf16 v[52:55], v[168:171], v[132:135], v[52:55]
ds_read_b128 v[132:135], v23 offset:8448
s_add_u32 s62, s43, 548864
buffer_load_dwordx4 v[56:59], v1, s[4:7], s62 offen offset:0 sc1
buffer_load_dwordx4 v[60:63], v1, s[4:7], s62 offen offset:1024 sc1
v_mfma_f32_16x16x32_bf16 v[48:51], v[172:175], v[136:139], v[48:51]
ds_read_b128 v[136:139], v23 offset:10240
s_waitcnt vmcnt(3)
ds_read2st64_b32 v[72:73], v0 offset0:64 offset1:68
s_waitcnt vmcnt(2)
v_max_u32 v86, v84, v85
v_cmp_eq_u32 vcc, -1, v86
s_cbranch_vccnz re_41
re_41b:
v_permlane32_swap_b32 v84, v85
v_add_f32 v84, v84, v85
v_mov_b32 v85, v84
v_mfma_f32_16x16x32_bf16 v[52:55], v[172:175], v[140:143], v[52:55]
ds_read_b128 v[140:143], v23 offset:10496
v_permlane16_swap_b32 v84, v85
v_add_f32 v84, v84, v85
s_waitcnt lgkmcnt(11)
v_mfma_f32_16x16x32_bf16 v[48:51], v[176:179], v[144:147], v[48:51]
ds_read_b128 v[144:147], v23 offset:12288
v_add_f32_dpp v84, v84, v84 row_ror:8 row_mask:0xf bank_mask:0xf
v_mul_f32 v84, 0x3b000000, v84
v_mov_b32 v85, v84
v_mfma_f32_16x16x32_bf16 v[52:55], v[176:179], v[148:151], v[52:55]
ds_read_b128 v[148:151], v23 offset:12544
v_permlane32_swap_b32 v84, v85
v_fma_f32 v85, -v84, v84, v85
v_max_f32 v85, 0, v85
v_add_f32 v86, 0x3727c5ac, v85
v_rsq_f32 v86, v86
s_waitcnt lgkmcnt(11)
v_mfma_f32_16x16x32_bf16 v[48:51], v[180:183], v[152:155], v[48:51]
ds_read_b128 v[152:155], v23 offset:14336
v_mul_f32 v87, -v84, v86
v_fma_f32 v88, v32, v86, v87
v_fma_f32 v89, v33, v86, v87
v_pk_fma_f32 v[90:91], v[34:35], v[86:87], v[86:87] op_sel:[0,0,1] op_sel_hi:[1,0,1]
v_pk_fma_f32 v[92:93], v[36:37], v[86:87], v[86:87] op_sel:[0,0,1] op_sel_hi:[1,0,1]
v_pk_fma_f32 v[94:95], v[38:39], v[86:87], v[86:87] op_sel:[0,0,1] op_sel_hi:[1,0,1]
v_pk_fma_f32 v[32:33], v[88:89], v[100:101], v[32:33] op_sel:[0,0,0] op_sel_hi:[1,1,1]
v_pk_fma_f32 v[34:35], v[90:91], v[102:103], v[34:35] op_sel:[0,0,0] op_sel_hi:[1,1,1]
v_pk_fma_f32 v[36:37], v[92:93], v[104:105], v[36:37] op_sel:[0,0,0] op_sel_hi:[1,1,1]
v_pk_fma_f32 v[38:39], v[94:95], v[106:107], v[38:39] op_sel:[0,0,0] op_sel_hi:[1,1,1]
v_cvt_pk_bf16_f32 v108, v32, v33
v_cvt_pk_bf16_f32 v109, v34, v35
v_cvt_pk_bf16_f32 v110, v36, v37
v_cvt_pk_bf16_f32 v111, v38, v39
s_add_u32 s62, s40, 425984
buffer_store_dwordx4 v[108:111], v3, s[4:7], s62 offen
s_nop 1
v_add_u32 v108, s25, v1
v_pk_add_f32 v[100:101], v[32:33], v[34:35]
v_pk_mul_f32 v[102:103], v[32:33], v[32:33]
v_pk_fma_f32 v[102:103], v[34:35], v[34:35], v[102:103] op_sel:[0,0,0] op_sel_hi:[1,1,1]
v_pk_add_f32 v[100:101], v[100:101], v[36:37]
v_pk_fma_f32 v[102:103], v[36:37], v[36:37], v[102:103] op_sel:[0,0,0] op_sel_hi:[1,1,1]
v_pk_add_f32 v[100:101], v[100:101], v[38:39]
v_pk_fma_f32 v[102:103], v[38:39], v[38:39], v[102:103] op_sel:[0,0,0] op_sel_hi:[1,1,1]
v_add_f32 v100, v100, v101
v_add_f32 v102, v102, v103
v_mfma_f32_16x16x32_bf16 v[52:55], v[180:183], v[156:159], v[52:55]
ds_read_b128 v[156:159], v23 offset:14592
v_permlane32_swap_b32 v100, v102
v_add_f32 v100, v100, v102
v_mov_b32 v102, v100
s_waitcnt lgkmcnt(11)
v_mfma_f32_16x16x32_bf16 v[48:51], v[184:187], v[112:115], v[48:51]
v_permlane16_swap_b32 v100, v102
v_add_f32 v100, v100, v102
s_waitcnt lgkmcnt(5)
v_max_u32 v72, v72, v73
v_cmp_eq_u32 vcc, -1, v72
s_cbranch_vccnz re_44
re_44b:
v_add_f32_dpp v100, v100, v100 row_ror:8 row_mask:0xf bank_mask:0xf
s_add_u32 s62, s42, 548864
buffer_store_dword v100, v8, s[4:7], s62 offen offset:2048
v_mfma_f32_16x16x32_bf16 v[52:55], v[184:187], v[116:119], v[52:55]
s_waitcnt lgkmcnt(0)
s_barrier
ds_read_b128 v[112:115], v23 offset:16384
ds_read_b128 v[116:119], v23 offset:16640
v_mfma_f32_16x16x32_bf16 v[48:51], v[188:191], v[120:123], v[48:51]
ds_read_b128 v[120:123], v23 offset:18432
v_lshrrev_b32 v100, 9, v1
v_lshl_add_u32 v100, v100, 5, s26
v_mfma_f32_16x16x32_bf16 v[52:55], v[188:191], v[124:127], v[52:55]
ds_read_b128 v[124:127], v23 offset:18688
ds_read_b128 v[96:99], v100 offset:0
v_mfma_f32_16x16x32_bf16 v[48:51], v[192:195], v[128:131], v[48:51]
ds_read_b128 v[128:131], v23 offset:20480
ds_read_b128 v[100:103], v100 offset:16
v_mfma_f32_16x16x32_bf16 v[52:55], v[192:195], v[132:135], v[52:55]
ds_read_b128 v[132:135], v23 offset:20736
s_waitcnt vmcnt(2)
v_add_f32 v56, v56, v60
v_add_f32 v57, v57, v61
v_mfma_f32_16x16x32_bf16 v[48:51], v[196:199], v[136:139], v[48:51]
ds_read_b128 v[136:139], v23 offset:22528
v_add_f32 v58, v58, v62
v_add_f32 v59, v59, v63
v_mfma_f32_16x16x32_bf16 v[52:55], v[196:199], v[140:143], v[52:55]
ds_read_b128 v[140:143], v23 offset:22784
v_add_f32 v56, v56, v58
v_add_f32 v57, v57, v59
v_mfma_f32_16x16x32_bf16 v[48:51], v[200:203], v[144:147], v[48:51]
s_nop 0
v_permlane32_swap_b32 v56, v57
v_mfma_f32_16x16x32_bf16 v[52:55], v[200:203], v[148:151], v[52:55]
v_add_f32 v56, v56, v57
v_cmp_u_f32 vcc, v56, v56
s_cbranch_vccnz re_45
re_45b:
v_mfma_f32_16x16x32_bf16 v[48:51], v[204:207], v[152:155], v[48:51]
v_mul_f32 v56, 0x3b000000, v56
v_mov_b32 v57, v56
v_mfma_f32_16x16x32_bf16 v[52:55], v[204:207], v[156:159], v[52:55]
s_waitcnt lgkmcnt(0)
s_barrier
v_mfma_f32_16x16x32_bf16 v[48:51], v[208:211], v[112:115], v[48:51]
v_permlane32_swap_b32 v56, v57
v_mfma_f32_16x16x32_bf16 v[52:55], v[208:211], v[116:119], v[52:55]
v_fma_f32 v57, -v56, v56, v57
v_max_f32 v57, 0, v57
v_mfma_f32_16x16x32_bf16 v[48:51], v[212:215], v[120:123], v[48:51]
v_add_f32 v58, 0x3727c5ac, v57
v_rsq_f32 v58, v58
v_mfma_f32_16x16x32_bf16 v[52:55], v[212:215], v[124:127], v[52:55]
v_mul_f32 v59, v58, v58
v_sub_f32 v46, 0, v56
v_mfma_f32_16x16x32_bf16 v[48:51], v[216:219], v[128:131], v[48:51]
v_mul_f32 v59, v59, v57
v_mov_b32 v20, v58
v_mfma_f32_16x16x32_bf16 v[52:55], v[216:219], v[132:135], v[52:55]
v_add_f32 v59, 0x3727c5ac, v59
v_rsq_f32 v59, v59
v_mfma_f32_16x16x32_bf16 v[48:51], v[220:223], v[136:139], v[48:51]
v_mul_f32 v21, v46, v58
v_mul_f32 v59, v59, v58
v_mfma_f32_16x16x32_bf16 v[52:55], v[220:223], v[140:143], v[52:55]
v_mul_f32 v19, 0xc0135761, v59
v_mul_f32 v18, v59, v59
v_rcp_f32 v47, v59
v_mul_f32 v18, v18, v19
v_mul_f32 v18, 0x3d372713, v18
v_lshlrev_b32 v72, 16, v76
v_and_b32 v73, s36, v76
s_nop 0
v_permlane16_swap_b32 v48, v52
v_permlane16_swap_b32 v49, v53
v_permlane16_swap_b32 v50, v54
s_add_u32 m0, s23, 24576
s_xor_b32 s38, s47, 425984
buffer_load_dwordx4 v1, s[4:7], s38 offen offset:0 sc1 lds
buffer_load_dwordx4 v1, s[4:7], s38 offen offset:1024 sc1 lds
v_permlane16_swap_b32 v51, v55
v_pk_fma_f32 v[48:49], v[64:65], v[46:47], v[48:49] op_sel:[0,0,0] op_sel_hi:[1,0,1]
v_pk_fma_f32 v[50:51], v[66:67], v[46:47], v[50:51] op_sel:[0,0,0] op_sel_hi:[1,0,1]
s_add_u32 m0, s23, 32768
s_xor_b32 s38, s47, 434176
buffer_load_dwordx4 v1, s[4:7], s38 offen offset:0 sc1 lds
buffer_load_dwordx4 v1, s[4:7], s38 offen offset:1024 sc1 lds
v_pk_fma_f32 v[52:53], v[68:69], v[46:47], v[52:53] op_sel:[0,0,0] op_sel_hi:[1,0,1]
v_pk_fma_f32 v[54:55], v[70:71], v[46:47], v[54:55] op_sel:[0,0,0] op_sel_hi:[1,0,1]
v_pk_mul_f32 v[56:57], v[48:49], v[48:49]
s_add_u32 m0, s23, 0
s_xor_b32 s38, s47, 442368
buffer_load_dwordx4 v1, s[4:7], s38 offen offset:0 sc1 lds
buffer_load_dwordx4 v1, s[4:7], s38 offen offset:1024 sc1 lds
v_pk_mul_f32 v[58:59], v[50:51], v[50:51]
v_pk_mul_f32 v[60:61], v[52:53], v[52:53]
v_pk_mul_f32 v[62:63], v[54:55], v[54:55]
v_pk_fma_f32 v[56:57], v[56:57], v[18:19], v[18:19] op_sel:[0,0,1] op_sel_hi:[1,0,1]
v_pk_fma_f32 v[58:59], v[58:59], v[18:19], v[18:19] op_sel:[0,0,1] op_sel_hi:[1,0,1]
v_pk_fma_f32 v[60:61], v[60:61], v[18:19], v[18:19] op_sel:[0,0,1] op_sel_hi:[1,0,1]
v_pk_fma_f32 v[62:63], v[62:63], v[18:19], v[18:19] op_sel:[0,0,1] op_sel_hi:[1,0,1]
v_pk_mul_f32 v[56:57], v[56:57], v[48:49]
v_pk_mul_f32 v[58:59], v[58:59], v[50:51]
v_pk_mul_f32 v[60:61], v[60:61], v[52:53]
v_pk_mul_f32 v[62:63], v[62:63], v[54:55]
v_exp_f32 v56, v56
v_exp_f32 v57, v57
v_exp_f32 v58, v58
v_exp_f32 v59, v59
v_exp_f32 v60, v60
v_exp_f32 v61, v61
s_add_u32 m0, s23, 8192
s_xor_b32 s38, s47, 450560
buffer_load_dwordx4 v1, s[4:7], s38 offen offset:0 sc1 lds
buffer_load_dwordx4 v1, s[4:7], s38 offen offset:1024 sc1 lds
v_exp_f32 v62, v62
v_exp_f32 v63, v63
v_pk_fma_f32 v[56:57], v[56:57], v[46:47], v[46:47] op_sel:[0,1,1] op_sel_hi:[1,1,1]
v_pk_fma_f32 v[58:59], v[58:59], v[46:47], v[46:47] op_sel:[0,1,1] op_sel_hi:[1,1,1]
v_pk_fma_f32 v[60:61], v[60:61], v[46:47], v[46:47] op_sel:[0,1,1] op_sel_hi:[1,1,1]
v_pk_fma_f32 v[62:63], v[62:63], v[46:47], v[46:47] op_sel:[0,1,1] op_sel_hi:[1,1,1]
v_rcp_f32 v56, v56
s_waitcnt vmcnt(6)
ds_read2st64_b32 v[104:105], v0 offset0:96 offset1:100
v_rcp_f32 v57, v57
v_rcp_f32 v58, v58
v_rcp_f32 v59, v59
v_rcp_f32 v60, v60
v_rcp_f32 v61, v61
v_rcp_f32 v62, v62
v_rcp_f32 v63, v63
v_pk_mul_f32 v[56:57], v[56:57], v[48:49]
v_pk_mul_f32 v[58:59], v[58:59], v[50:51]
s_add_u32 s62, s43, 548864
buffer_load_dwordx4 v[88:91], v1, s[4:7], s62 offen offset:2048 sc1
buffer_load_dwordx4 v[92:95], v1, s[4:7], s62 offen offset:3072 sc1
v_pk_mul_f32 v[60:61], v[60:61], v[52:53]
v_pk_mul_f32 v[62:63], v[62:63], v[54:55]
v_cvt_pk_bf16_f32 v64, v56, v57
v_cvt_pk_bf16_f32 v65, v58, v59
v_cvt_pk_bf16_f32 v66, v60, v61
v_cvt_pk_bf16_f32 v67, v62, v63
v_lshlrev_b32 v74, 16, v77
v_and_b32 v75, s36, v77
v_lshlrev_b32 v76, 16, v78
s_waitcnt vmcnt(6)
ds_read2st64_b32 v[106:107], v0 offset0:128 offset1:132
s_cmp_lg_u32 s27, 0
s_cbranch_scc1 sh_46
buffer_store_dwordx4 v[64:67], v5, s[4:7], s32 offen offset:64
sh_46b:
s_add_u32 s62, s41, 0
buffer_store_dwordx4 v[64:67], v4, s[4:7], s62 offen
v_and_b32 v77, s36, v78
s_waitcnt lgkmcnt(0)
v_max3_u32 v104, v104, v105, v106
v_max_u32 v104, v104, v107
v_cmp_eq_u32 vcc, -1, v104
s_cbranch_vccnz re_47
re_47b:
s_barrier
s_waitcnt vmcnt(6)
ds_read2st64_b32 v[104:105], v0 offset0:0 offset1:4
ds_read_b128 v[108:111], v108 offset:24576
ds_read_b128 v[112:115], v23 offset:24576
ds_read_b128 v[116:119], v23 offset:24832
ds_read_b128 v[120:123], v23 offset:26624
ds_read_b128 v[124:127], v23 offset:26880
ds_read_b128 v[128:131], v23 offset:28672
ds_read_b128 v[132:135], v23 offset:28928
ds_read_b128 v[136:139], v23 offset:30720
ds_read_b128 v[140:143], v23 offset:30976
ds_read_b128 v[144:147], v23 offset:32768
ds_read_b128 v[148:151], v23 offset:33024
ds_read_b128 v[152:155], v23 offset:34816
ds_read_b128 v[156:159], v23 offset:35072
v_lshlrev_b32 v78, 16, v79
v_and_b32 v79, s36, v79
s_waitcnt vmcnt(4)
ds_read2st64_b32 v[106:107], v0 offset0:32 offset1:36
s_waitcnt lgkmcnt(11)
v_mfma_f32_16x16x32_bf16 v[80:83], v[160:163], v[112:115], 0
ds_read_b128 v[112:115], v23 offset:36864
v_fma_f32 v72, v72, v20, v21
v_fma_f32 v73, v73, v20, v21
v_mfma_f32_16x16x32_bf16 v[84:87], v[160:163], v[116:119], 0
ds_read_b128 v[116:119], v23 offset:37120
v_fma_f32 v74, v74, v20, v21
v_fma_f32 v75, v75, v20, v21
s_waitcnt lgkmcnt(11)
v_mfma_f32_16x16x32_bf16 v[80:83], v[164:167], v[120:123], v[80:83]
ds_read_b128 v[120:123], v23 offset:38912
v_fma_f32 v76, v76, v20, v21
v_fma_f32 v77, v77, v20, v21
v_mfma_f32_16x16x32_bf16 v[84:87], v[164:167], v[124:127], v[84:87]
ds_read_b128 v[124:127], v23 offset:39168
v_fma_f32 v78, v78, v20, v21
v_fma_f32 v79, v79, v20, v21
s_waitcnt lgkmcnt(11)
v_mfma_f32_16x16x32_bf16 v[80:83], v[168:171], v[128:131], v[80:83]
v_permlane16_swap_b32 v72, v76
v_mfma_f32_16x16x32_bf16 v[84:87], v[168:171], v[132:135], v[84:87]
s_waitcnt vmcnt(2)
v_add_f32 v88, v88, v92
v_add_f32 v89, v89, v93
s_waitcnt lgkmcnt(9)
v_mfma_f32_16x16x32_bf16 v[80:83], v[172:175], v[136:139], v[80:83]
v_add_f32 v90, v90, v94
v_add_f32 v91, v91, v95
s_waitcnt lgkmcnt(4)
v_max3_u32 v104, v104, v105, v106
v_max_u32 v104, v104, v107
v_cmp_eq_u32 vcc, -1, v104
s_cbranch_vccnz re_48
re_48b:
v_mfma_f32_16x16x32_bf16 v[84:87], v[172:175], v[140:143], v[84:87]
v_add_f32 v88, v88, v90
v_add_f32 v89, v89, v91
v_mfma_f32_16x16x32_bf16 v[80:83], v[176:179], v[144:147], v[80:83]
s_waitcnt lgkmcnt(0)
s_barrier
v_mfma_f32_16x16x32_bf16 v[84:87], v[176:179], v[148:151], v[84:87]
ds_read_b128 v[128:131], v23 offset:0
ds_read_b128 v[132:135], v23 offset:256
v_mfma_f32_16x16x32_bf16 v[80:83], v[180:183], v[152:155], v[80:83]
ds_read_b128 v[136:139], v23 offset:2048
ds_read_b128 v[140:143], v23 offset:2304
v_mfma_f32_16x16x32_bf16 v[84:87], v[180:183], v[156:159], v[84:87]
ds_read_b128 v[144:147], v23 offset:4096
ds_read_b128 v[148:151], v23 offset:4352
v_mfma_f32_16x16x32_bf16 v[80:83], v[184:187], v[112:115], v[80:83]
ds_read_b128 v[152:155], v23 offset:6144
ds_read_b128 v[156:159], v23 offset:6400
v_mfma_f32_16x16x32_bf16 v[84:87], v[184:187], v[116:119], v[84:87]
ds_read_b128 v[112:115], v23 offset:8192
ds_read_b128 v[116:119], v23 offset:8448
v_mfma_f32_16x16x32_bf16 v[80:83], v[188:191], v[120:123], v[80:83]
ds_read_b128 v[120:123], v23 offset:10240
v_permlane32_swap_b32 v88, v89
v_mfma_f32_16x16x32_bf16 v[84:87], v[188:191], v[124:127], v[84:87]
ds_read_b128 v[124:127], v23 offset:10496
s_add_u32 m0, s23, 16384
s_xor_b32 s38, s22, 139264
buffer_load_dwordx4 v1, s[4:7], s38 offen offset:0 sc1 lds
buffer_load_dwordx4 v1, s[4:7], s38 offen offset:1024 sc1 lds
s_waitcnt lgkmcnt(10)
v_mfma_f32_16x16x32_bf16 v[80:83], v[192:195], v[128:131], v[80:83]
ds_read_b128 v[128:131], v23 offset:12288
v_add_f32 v88, v88, v89
v_cmp_u_f32 vcc, v88, v88
s_cbranch_vccnz re_49
re_49b:
s_add_u32 m0, s23, 24576
s_xor_b32 s38, s22, 155648
buffer_load_dwordx4 v1, s[4:7], s38 offen offset:0 sc1 lds
buffer_load_dwordx4 v1, s[4:7], s38 offen offset:1024 sc1 lds
v_mfma_f32_16x16x32_bf16 v[84:87], v[192:195], v[132:135], v[84:87]
ds_read_b128 v[132:135], v23 offset:12544
v_mul_f32 v88, 0x3b000000, v88
v_mov_b32 v89, v88
v_cndmask_b32 v44, v1, v6, s[92:93]
s_add_u32 m0, s23, 32768
s_xor_b32 s38, s22, 131072
buffer_load_dwordx4 v44, s[4:7], s38 offen offset:0 sc1 lds
buffer_load_dwordx4 v44, s[4:7], s38 offen offset:1024 sc1 lds
s_waitcnt lgkmcnt(10)
v_mfma_f32_16x16x32_bf16 v[80:83], v[196:199], v[136:139], v[80:83]
ds_read_b128 v[136:139], v23 offset:14336
v_permlane32_swap_b32 v88, v89
v_mfma_f32_16x16x32_bf16 v[84:87], v[196:199], v[140:143], v[84:87]
ds_read_b128 v[140:143], v23 offset:14592
v_fma_f32 v89, -v88, v88, v89
v_max_f32 v89, 0, v89
s_waitcnt lgkmcnt(10)
v_mfma_f32_16x16x32_bf16 v[80:83], v[200:203], v[144:147], v[80:83]
ds_read_b64_tr_b16 v[144:145], v13 offset:0
v_add_f32 v90, 0x3727c5ac, v89
v_rsq_f32 v90, v90
v_mfma_f32_16x16x32_bf16 v[84:87], v[200:203], v[148:151], v[84:87]
pg_6:
s_cbranch_execz pg_back
ds_read_b64_tr_b16 v[146:147], v13 offset:1792
v_mul_f32 v91, v90, v90
v_sub_f32 v46, 0, v88
s_waitcnt lgkmcnt(10)
v_mfma_f32_16x16x32_bf16 v[80:83], v[204:207], v[152:155], v[80:83]
ds_read_b64_tr_b16 v[148:149], v13 offset:32
v_mul_f32 v91, v91, v89
v_mov_b32 v20, v90
v_mfma_f32_16x16x32_bf16 v[84:87], v[204:207], v[156:159], v[84:87]
s_waitcnt lgkmcnt(3)
s_barrier
s_add_u32 m0, s23, 0
s_xor_b32 s38, s22, 147456
buffer_load_dwordx4 v6, s[4:7], s38 offen offset:0 sc1 lds
buffer_load_dwordx4 v6, s[4:7], s38 offen offset:1024 sc1 lds
v_mfma_f32_16x16x32_bf16 v[80:83], v[208:211], v[112:115], v[80:83]
s_waitcnt vmcnt(6)
ds_read2st64_b32 v[56:57], v0 offset0:64 offset1:68
v_add_f32 v91, 0x3727c5ac, v91
v_mfma_f32_16x16x32_bf16 v[84:87], v[208:211], v[116:119], v[84:87]
ds_read_b64_tr_b16 v[150:151], v13 offset:1824
v_rsq_f32 v91, v91
v_mfma_f32_16x16x32_bf16 v[80:83], v[212:215], v[120:123], v[80:83]
ds_read_b64_tr_b16 v[152:153], v13 offset:64
v_mul_f32 v21, v46, v90
v_mul_f32 v91, v91, v90
v_mfma_f32_16x16x32_bf16 v[84:87], v[212:215], v[124:127], v[84:87]
ds_read_b64_tr_b16 v[154:155], v13 offset:1856
v_mul_f32 v19, 0xc0135761, v91
v_mul_f32 v18, v91, v91
v_mfma_f32_16x16x32_bf16 v[80:83], v[216:219], v[128:131], v[80:83]
ds_read_b64_tr_b16 v[156:157], v14 offset:0
v_rcp_f32 v47, v91
v_mfma_f32_16x16x32_bf16 v[84:87], v[216:219], v[132:135], v[84:87]
s_waitcnt vmcnt(4)
ds_read2st64_b32 v[58:59], v0 offset0:96 offset1:100
v_mul_f32 v18, v18, v19
v_mfma_f32_16x16x32_bf16 v[80:83], v[220:223], v[136:139], v[80:83]
ds_read_b64_tr_b16 v[158:159], v14 offset:1792
v_mul_f32 v18, 0x3d372713, v18
v_lshlrev_b32 v104, 16, v108
v_mfma_f32_16x16x32_bf16 v[84:87], v[220:223], v[140:143], v[84:87]
v_and_b32 v105, s36, v108
v_lshlrev_b32 v106, 16, v109
v_and_b32 v107, s36, v109
v_lshlrev_b32 v108, 16, v110
v_and_b32 v109, s36, v110
v_lshlrev_b32 v110, 16, v111
v_and_b32 v111, s36, v111
v_pk_fma_f32 v[104:105], v[104:105], v[20:21], v[20:21] op_sel:[0,0,1] op_sel_hi:[1,0,1]
v_permlane16_swap_b32 v80, v84
v_permlane16_swap_b32 v81, v85
v_permlane16_swap_b32 v82, v86
v_permlane16_swap_b32 v83, v87
v_pk_fma_f32 v[80:81], v[96:97], v[46:47], v[80:81] op_sel:[0,0,0] op_sel_hi:[1,0,1]
v_pk_fma_f32 v[82:83], v[98:99], v[46:47], v[82:83] op_sel:[0,0,0] op_sel_hi:[1,0,1]
v_pk_fma_f32 v[84:85], v[100:101], v[46:47], v[84:85] op_sel:[0,0,0] op_sel_hi:[1,0,1]
v_pk_fma_f32 v[86:87], v[102:103], v[46:47], v[86:87] op_sel:[0,0,0] op_sel_hi:[1,0,1]
v_pk_mul_f32 v[88:89], v[80:81], v[80:81]
v_pk_mul_f32 v[90:91], v[82:83], v[82:83]
v_pk_mul_f32 v[92:93], v[84:85], v[84:85]
v_pk_mul_f32 v[94:95], v[86:87], v[86:87]
v_pk_fma_f32 v[88:89], v[88:89], v[18:19], v[18:19] op_sel:[0,0,1] op_sel_hi:[1,0,1]
v_pk_fma_f32 v[90:91], v[90:91], v[18:19], v[18:19] op_sel:[0,0,1] op_sel_hi:[1,0,1]
v_pk_fma_f32 v[92:93], v[92:93], v[18:19], v[18:19] op_sel:[0,0,1] op_sel_hi:[1,0,1]
v_pk_fma_f32 v[94:95], v[94:95], v[18:19], v[18:19] op_sel:[0,0,1] op_sel_hi:[1,0,1]
v_pk_mul_f32 v[88:89], v[88:89], v[80:81]
v_pk_mul_f32 v[90:91], v[90:91], v[82:83]
v_pk_mul_f32 v[92:93], v[92:93], v[84:85]
v_pk_mul_f32 v[94:95], v[94:95], v[86:87]
v_exp_f32 v88, v88
v_exp_f32 v89, v89
v_exp_f32 v90, v90
v_exp_f32 v91, v91
v_exp_f32 v92, v92
v_exp_f32 v93, v93
v_exp_f32 v94, v94
v_exp_f32 v95, v95
v_pk_fma_f32 v[88:89], v[88:89], v[46:47], v[46:47] op_sel:[0,1,1] op_sel_hi:[1,1,1]
v_pk_fma_f32 v[90:91], v[90:91], v[46:47], v[46:47] op_sel:[0,1,1] op_sel_hi:[1,1,1]
v_pk_fma_f32 v[92:93], v[92:93], v[46:47], v[46:47] op_sel:[0,1,1] op_sel_hi:[1,1,1]
v_pk_fma_f32 v[94:95], v[94:95], v[46:47], v[46:47] op_sel:[0,1,1] op_sel_hi:[1,1,1]
v_rcp_f32 v88, v88
v_rcp_f32 v89, v89
v_rcp_f32 v90, v90
v_rcp_f32 v91, v91
v_rcp_f32 v92, v92
v_rcp_f32 v93, v93
v_rcp_f32 v94, v94
v_rcp_f32 v95, v95
v_pk_mul_f32 v[88:89], v[88:89], v[80:81]
v_pk_mul_f32 v[90:91], v[90:91], v[82:83]
v_pk_mul_f32 v[92:93], v[92:93], v[84:85]
v_pk_mul_f32 v[94:95], v[94:95], v[86:87]
v_cvt_pk_bf16_f32 v96, v88, v89
v_cvt_pk_bf16_f32 v97, v90, v91
v_cvt_pk_bf16_f32 v98, v92, v93
v_cvt_pk_bf16_f32 v99, v94, v95
s_cmp_lg_u32 s27, 0
s_cbranch_scc1 sh_50
buffer_store_dwordx4 v[96:99], v5, s[4:7], s33 offen offset:64
sh_50b:
s_add_u32 s62, s41, 32768
buffer_store_dwordx4 v[96:99], v4, s[4:7], s62 offen
s_waitcnt lgkmcnt(1)
v_max3_u32 v56, v56, v57, v58
v_max_u32 v56, v56, v59
v_cmp_eq_u32 vcc, -1, v56
s_cbranch_vccnz re_51
re_51b:
s_barrier
ds_read_b128 v[112:115], v23 offset:16384
ds_read_b128 v[116:119], v23 offset:16640
ds_read_b128 v[120:123], v23 offset:18432
ds_read_b128 v[124:127], v23 offset:18688
ds_read_b128 v[128:131], v23 offset:20480
ds_read_b128 v[132:135], v23 offset:20736
ds_read_b128 v[136:139], v23 offset:22528
ds_read_b128 v[140:143], v23 offset:22784
v_pk_fma_f32 v[106:107], v[106:107], v[20:21], v[20:21] op_sel:[0,0,1] op_sel_hi:[1,0,1]
v_pk_fma_f32 v[108:109], v[108:109], v[20:21], v[20:21] op_sel:[0,0,1] op_sel_hi:[1,0,1]
v_pk_fma_f32 v[110:111], v[110:111], v[20:21], v[20:21] op_sel:[0,0,1] op_sel_hi:[1,0,1]
s_nop 0
v_permlane16_swap_b32 v104, v108
v_permlane16_swap_b32 v105, v109
v_permlane16_swap_b32 v106, v110
v_permlane16_swap_b32 v107, v111
s_cmp_eq_u32 s66, 0
s_cbranch_scc1 skip_52
v_cndmask_b32 v44, v1, v6, s[92:93]
s_add_u32 m0, s23, 32768
s_xor_b32 s38, s22, 131072
buffer_load_dwordx4 v44, s[4:7], s38 offen offset:0 sc1 lds
buffer_load_dwordx4 v44, s[4:7], s38 offen offset:1024 sc1 lds
s_add_u32 m0, s23, 0
s_xor_b32 s38, s22, 147456
buffer_load_dwordx4 v6, s[4:7], s38 offen offset:0 sc1 lds
buffer_load_dwordx4 v6, s[4:7], s38 offen offset:1024 sc1 lds
skip_52:
v_permlane16_swap_b32 v73, v77
v_permlane16_swap_b32 v74, v78
v_permlane16_swap_b32 v75, v79
s_waitcnt lgkmcnt(6)
s_nop 0
v_mfma_f32_16x16x32_bf16 v[48:51], v[224:227], v[112:115], v[72:75]
ds_read_b128 v[112:115], v23 offset:24576
v_mfma_f32_16x16x32_bf16 v[52:55], v[224:227], v[116:119], v[76:79]
ds_read_b128 v[116:119], v23 offset:24832
s_nop 1
v_mov_b32 v78, 0
v_mov_b32 v79, 0
s_waitcnt lgkmcnt(6)
v_mfma_f32_16x16x32_bf16 v[48:51], v[228:231], v[120:123], v[48:51]
ds_read_b128 v[120:123], v23 offset:26624
s_mov_b64 vcc, 0xffff
s_lshl_b64 vcc, vcc, 0
v_cndmask_b32 v76, 0, v16, vcc
v_cndmask_b32 v77, 0, v17, vcc
v_mfma_f32_16x16x32_bf16 v[52:55], v[228:231], v[124:127], v[52:55]
ds_read_b128 v[124:127], v23 offset:26880
s_waitcnt lgkmcnt(6)
v_mfma_f32_16x16x32_bf16 v[48:51], v[232:235], v[128:131], v[48:51]
ds_read_b128 v[128:131], v23 offset:28672
v_mfma_f32_16x16x32_bf16 v[52:55], v[232:235], v[132:135], v[52:55]
ds_read_b128 v[132:135], v23 offset:28928
s_waitcnt lgkmcnt(6)
v_mfma_f32_16x16x32_bf16 v[48:51], v[236:239], v[136:139], v[48:51]
ds_read_b128 v[136:139], v23 offset:30720
v_mfma_f32_16x16x32_bf16 v[52:55], v[236:239], v[140:143], v[52:55]
ds_read_b128 v[140:143], v23 offset:30976
s_waitcnt lgkmcnt(6)
v_mfma_f32_16x16x32_bf16 v[48:51], v[240:243], v[112:115], v[48:51]
v_mfma_f32_16x16x32_bf16 v[52:55], v[240:243], v[116:119], v[52:55]
s_waitcnt lgkmcnt(4)
v_mfma_f32_16x16x32_bf16 v[48:51], v[244:247], v[120:123], v[48:51]
v_mfma_f32_16x16x32_bf16 v[52:55], v[244:247], v[124:127], v[52:55]
s_waitcnt lgkmcnt(2)
v_mfma_f32_16x16x32_bf16 v[48:51], v[248:251], v[128:131], v[48:51]
v_mfma_f32_16x16x32_bf16 v[52:55], v[248:251], v[132:135], v[52:55]
s_waitcnt lgkmcnt(0)
v_mfma_f32_16x16x32_bf16 v[48:51], v[252:255], v[136:139], v[48:51]
v_mfma_f32_16x16x32_bf16 v[52:55], v[252:255], v[140:143], v[52:55]
s_waitcnt vmcnt(0)
ds_read2st64_b32 v[56:57], v0 offset0:128 offset1:132
s_waitcnt vmcnt(0)
ds_read2st64_b32 v[58:59], v0 offset0:0 offset1:4
s_add_u32 m0, s23, 8192
s_xor_b32 s38, s22, 172032
buffer_load_dwordx4 v1, s[4:7], s38 offen offset:0 sc1 lds
buffer_load_dwordx4 v1, s[4:7], s38 offen offset:1024 sc1 lds
s_waitcnt lgkmcnt(0)
v_max3_u32 v56, v56, v57, v58
v_max_u32 v56, v56, v59
v_cmp_eq_u32 vcc, -1, v56
s_cbranch_vccnz re_53
re_53b:
s_barrier
s_add_u32 m0, s23, 16384
s_xor_b32 s38, s22, 188416
buffer_load_dwordx4 v1, s[4:7], s38 offen offset:0 sc1 lds
buffer_load_dwordx4 v1, s[4:7], s38 offen offset:1024 sc1 lds
ds_read_b128 v[112:115], v23 offset:32768
ds_read_b128 v[116:119], v23 offset:33024
ds_read_b128 v[120:123], v23 offset:34816
ds_read_b128 v[124:127], v23 offset:35072
ds_read_b128 v[128:131], v23 offset:36864
ds_read_b128 v[132:135], v23 offset:37120
ds_read_b128 v[136:139], v23 offset:38912
v_cndmask_b32 v44, v1, v6, s[92:93]
s_add_u32 m0, s23, 24576
s_xor_b32 s38, s22, 163840
buffer_load_dwordx4 v44, s[4:7], s38 offen offset:0 sc1 lds
buffer_load_dwordx4 v44, s[4:7], s38 offen offset:1024 sc1 lds
s_waitcnt lgkmcnt(5)
v_mfma_f32_16x16x32_bf16 v[48:51], a[224:227], v[112:115], v[48:51]
ds_read_b128 v[140:143], v23 offset:39168
ds_read_b128 v[112:115], v23 offset:0
v_mfma_f32_16x16x32_bf16 v[52:55], a[224:227], v[116:119], v[52:55]
ds_read_b128 v[116:119], v23 offset:256
s_waitcnt lgkmcnt(6)
v_mfma_f32_16x16x32_bf16 v[48:51], a[228:231], v[120:123], v[48:51]
ds_read_b128 v[120:123], v23 offset:2048
s_waitcnt vmcnt(4)
ds_read2st64_b32 v[20:21], v0 offset0:32 offset1:36
v_mfma_f32_16x16x32_bf16 v[52:55], a[228:231], v[124:127], v[52:55]
ds_read_b128 v[124:127], v23 offset:2304
s_waitcnt lgkmcnt(7)
v_mfma_f32_16x16x32_bf16 v[48:51], a[232:235], v[128:131], v[48:51]
ds_read_b128 v[128:131], v23 offset:4096
v_mfma_f32_16x16x32_bf16 v[52:55], a[232:235], v[132:135], v[52:55]
ds_read_b128 v[132:135], v23 offset:4352
s_waitcnt lgkmcnt(7)
v_mfma_f32_16x16x32_bf16 v[48:51], a[236:239], v[136:139], v[48:51]
ds_read_b128 v[136:139], v23 offset:6144
v_mfma_f32_16x16x32_bf16 v[52:55], a[236:239], v[140:143], v[52:55]
ds_read_b128 v[140:143], v23 offset:6400
s_waitcnt lgkmcnt(7)
v_mfma_f32_16x16x32_bf16 v[48:51], a[240:243], v[112:115], v[48:51]
v_mfma_f32_16x16x32_bf16 v[52:55], a[240:243], v[116:119], v[52:55]
s_waitcnt lgkmcnt(4)
v_mfma_f32_16x16x32_bf16 v[48:51], a[244:247], v[120:123], v[48:51]
v_mfma_f32_16x16x32_bf16 v[52:55], a[244:247], v[124:127], v[52:55]
s_waitcnt lgkmcnt(2)
v_mfma_f32_16x16x32_bf16 v[48:51], a[248:251], v[128:131], v[48:51]
s_waitcnt vmcnt(2)
ds_read2st64_b32 v[46:47], v0 offset0:64 offset1:68
v_mfma_f32_16x16x32_bf16 v[52:55], a[248:251], v[132:135], v[52:55]
s_waitcnt lgkmcnt(1)
v_mfma_f32_16x16x32_bf16 v[48:51], a[252:255], v[136:139], v[48:51]
v_mfma_f32_16x16x32_bf16 v[52:55], a[252:255], v[140:143], v[52:55]
s_nop 4
v_cvt_pk_bf16_f32 v56, v48, v49
v_cvt_pk_bf16_f32 v57, v50, v51
v_xor_b32 v48, s24, v1
v_cvt_pk_bf16_f32 v58, v52, v53
v_cvt_pk_bf16_f32 v59, v54, v55
s_nop 0
v_permlane16_swap_b32 v56, v58
v_permlane16_swap_b32 v57, v59
s_add_u32 s62, s34, 393216
buffer_store_dwordx4 v[56:59], v1, s[4:7], s62 offen
ds_write_b128 v48, v[56:59]
s_waitcnt lgkmcnt(1)
v_max3_u32 v20, v20, v21, v46
v_max_u32 v20, v20, v47
v_cmp_eq_u32 vcc, -1, v20
s_cbranch_vccnz re_54
re_54b:
s_waitcnt lgkmcnt(0)
s_barrier
ds_read_b128 v[52:55], v12 offset:40960
s_add_u32 m0, s23, 32768
s_xor_b32 s38, s22, 180224
buffer_load_dwordx4 v6, s[4:7], s38 offen offset:0 sc1 lds
buffer_load_dwordx4 v6, s[4:7], s38 offen offset:1024 sc1 lds
s_waitcnt lgkmcnt(0)
v_lshlrev_b32 v48, 16, v52
v_and_b32 v49, s36, v52
v_lshlrev_b32 v50, 16, v53
v_and_b32 v51, s36, v53
v_lshlrev_b32 v52, 16, v54
v_and_b32 v53, s36, v54
v_lshlrev_b32 v54, 16, v55
v_and_b32 v55, s36, v55
v_pk_add_f32 v[60:61], v[48:49], v[50:51]
v_pk_mul_f32 v[62:63], v[48:49], v[48:49]
v_pk_fma_f32 v[62:63], v[50:51], v[50:51], v[62:63] op_sel:[0,0,0] op_sel_hi:[1,1,1]
v_pk_add_f32 v[60:61], v[60:61], v[52:53]
v_pk_fma_f32 v[62:63], v[52:53], v[52:53], v[62:63] op_sel:[0,0,0] op_sel_hi:[1,1,1]
v_pk_add_f32 v[60:61], v[60:61], v[54:55]
v_pk_fma_f32 v[62:63], v[54:55], v[54:55], v[62:63] op_sel:[0,0,0] op_sel_hi:[1,1,1]
v_add_f32 v60, v60, v61
v_add_f32 v62, v62, v63
s_waitcnt vmcnt(2)
s_barrier
v_permlane32_swap_b32 v60, v62
v_add_f32 v60, v60, v62
v_mov_b32 v62, v60
v_pk_add_f32 v[24:25], v[24:25], v[48:49]
v_pk_add_f32 v[26:27], v[26:27], v[50:51]
v_permlane16_swap_b32 v60, v62
v_add_f32 v60, v60, v62
v_pk_add_f32 v[28:29], v[28:29], v[52:53]
v_pk_add_f32 v[30:31], v[30:31], v[54:55]
v_add_f32_dpp v60, v60, v60 row_ror:8 row_mask:0xf bank_mask:0xf
s_add_u32 s62, s42, 557056
buffer_store_dword v60, v8, s[4:7], s62 offen offset:0
s_barrier
ds_read_b128 v[88:91], v23 offset:8192
ds_read_b128 v[92:95], v23 offset:8448
ds_read_b128 v[96:99], v23 offset:10240
ds_read_b128 v[100:103], v23 offset:10496
ds_read2st64_b32 v[20:21], v0 offset0:96 offset1:100
s_waitcnt lgkmcnt(3)
v_mfma_f32_16x16x32_bf16 v[80:83], v[224:227], v[88:91], v[104:107]
ds_read_b128 v[88:91], v23 offset:12288
v_mfma_f32_16x16x32_bf16 v[84:87], v[224:227], v[92:95], v[108:111]
ds_read_b128 v[92:95], v23 offset:12544
s_nop 1
v_mov_b32 v110, 0
s_waitcnt lgkmcnt(3)
v_mfma_f32_16x16x32_bf16 v[80:83], v[228:231], v[96:99], v[80:83]
ds_read_b128 v[96:99], v23 offset:14336
v_mov_b32 v111, 0
v_mfma_f32_16x16x32_bf16 v[84:87], v[228:231], v[100:103], v[84:87]
ds_read_b128 v[100:103], v23 offset:14592
s_mov_b64 vcc, 0xffff
s_lshl_b64 vcc, vcc, 0
v_cndmask_b32 v108, 0, v16, vcc
v_cndmask_b32 v109, 0, v17, vcc
s_waitcnt lgkmcnt(2)
v_mfma_f32_16x16x32_bf16 v[80:83], v[232:235], v[88:91], v[80:83]
ds_read_b128 v[88:91], v23 offset:16384
v_mfma_f32_16x16x32_bf16 v[84:87], v[232:235], v[92:95], v[84:87]
ds_read_b128 v[92:95], v23 offset:16640
s_waitcnt vmcnt(1)
ds_read2st64_b32 v[46:47], v0 offset0:128 offset1:132
s_waitcnt lgkmcnt(3)
v_mfma_f32_16x16x32_bf16 v[80:83], v[236:239], v[96:99], v[80:83]
ds_read_b128 v[96:99], v23 offset:18432
v_mfma_f32_16x16x32_bf16 v[84:87], v[236:239], v[100:103], v[84:87]
ds_read_b128 v[100:103], v23 offset:18688
s_waitcnt lgkmcnt(3)
v_mfma_f32_16x16x32_bf16 v[80:83], v[240:243], v[88:91], v[80:83]
ds_read_b128 v[88:91], v23 offset:20480
v_mfma_f32_16x16x32_bf16 v[84:87], v[240:243], v[92:95], v[84:87]
ds_read_b128 v[92:95], v23 offset:20736
s_waitcnt lgkmcnt(2)
v_mfma_f32_16x16x32_bf16 v[80:83], v[244:247], v[96:99], v[80:83]
ds_read_b128 v[96:99], v23 offset:22528
v_mfma_f32_16x16x32_bf16 v[84:87], v[244:247], v[100:103], v[84:87]
ds_read_b128 v[100:103], v23 offset:22784
s_waitcnt lgkmcnt(2)
v_mfma_f32_16x16x32_bf16 v[80:83], v[248:251], v[88:91], v[80:83]
v_max3_u32 v20, v20, v21, v46
v_max_u32 v20, v20, v47
v_cmp_eq_u32 vcc, -1, v20
s_cbranch_vccnz re_55
re_55b:
v_mfma_f32_16x16x32_bf16 v[84:87], v[248:251], v[92:95], v[84:87]
s_waitcnt lgkmcnt(0)
s_barrier
v_mfma_f32_16x16x32_bf16 v[80:83], v[252:255], v[96:99], v[80:83]
ds_read_b128 v[88:91], v23 offset:24576
ds_read_b128 v[92:95], v23 offset:24832
v_mfma_f32_16x16x32_bf16 v[84:87], v[252:255], v[100:103], v[84:87]
ds_read_b128 v[96:99], v23 offset:26624
ds_read_b128 v[100:103], v23 offset:26880
s_lshl_b32 s60, s71, 8
v_xor_b32 v112, s60, v1
s_add_u32 s62, s51, 557056
buffer_load_dwordx4 v[116:119], v112, s[4:7], s62 offen offset:1024 sc1
buffer_load_dwordx4 v[112:115], v112, s[4:7], s62 offen offset:0 sc1
s_waitcnt lgkmcnt(2)
v_mfma_f32_16x16x32_bf16 v[80:83], a[224:227], v[88:91], v[80:83]
ds_read_b128 v[88:91], v23 offset:28672
v_mfma_f32_16x16x32_bf16 v[84:87], a[224:227], v[92:95], v[84:87]
ds_read_b128 v[92:95], v23 offset:28928
s_waitcnt lgkmcnt(2)
v_mfma_f32_16x16x32_bf16 v[80:83], a[228:231], v[96:99], v[80:83]
ds_read_b128 v[96:99], v23 offset:30720
v_mfma_f32_16x16x32_bf16 v[84:87], a[228:231], v[100:103], v[84:87]
ds_read_b128 v[100:103], v23 offset:30976
s_waitcnt lgkmcnt(2)
v_mfma_f32_16x16x32_bf16 v[80:83], a[232:235], v[88:91], v[80:83]
ds_read_b128 v[88:91], v23 offset:32768
v_mfma_f32_16x16x32_bf16 v[84:87], a[232:235], v[92:95], v[84:87]
ds_read_b128 v[92:95], v23 offset:33024
s_waitcnt lgkmcnt(2)
v_mfma_f32_16x16x32_bf16 v[80:83], a[236:239], v[96:99], v[80:83]
ds_read_b128 v[96:99], v23 offset:34816
v_mfma_f32_16x16x32_bf16 v[84:87], a[236:239], v[100:103], v[84:87]
ds_read_b128 v[100:103], v23 offset:35072
s_waitcnt lgkmcnt(2)
v_mfma_f32_16x16x32_bf16 v[80:83], a[240:243], v[88:91], v[80:83]
ds_read_b128 v[88:91], v23 offset:36864
v_mfma_f32_16x16x32_bf16 v[84:87], a[240:243], v[92:95], v[84:87]
ds_read_b128 v[92:95], v23 offset:37120
s_waitcnt lgkmcnt(2)
v_mfma_f32_16x16x32_bf16 v[80:83], a[244:247], v[96:99], v[80:83]
ds_read_b128 v[96:99], v23 offset:38912
v_mfma_f32_16x16x32_bf16 v[84:87], a[244:247], v[100:103], v[84:87]
ds_read_b128 v[100:103], v23 offset:39168
s_waitcnt lgkmcnt(2)
v_mfma_f32_16x16x32_bf16 v[80:83], a[248:251], v[88:91], v[80:83]
s_waitcnt vmcnt(0)
v_add_f32 v112, v112, v116
v_add_f32 v113, v113, v117
v_pk_add_f32 v[114:115], v[114:115], v[118:119]
v_pk_add_f32 v[112:113], v[112:113], v[114:115]
v_mfma_f32_16x16x32_bf16 v[84:87], a[248:251], v[92:95], v[84:87]
s_nop 0
v_permlane32_swap_b32 v112, v113
v_add_f32 v112, v112, v113
v_cmp_u_f32 vcc, v112, v112
s_cbranch_vccnz re_56
re_56b:
v_mul_f32 v112, 0x3b000000, v112
v_mov_b32 v113, v112
s_waitcnt lgkmcnt(0)
v_mfma_f32_16x16x32_bf16 v[80:83], a[252:255], v[96:99], v[80:83]
s_xor_b32 s64, s50, 393216
s_sub_u32 s64, s64, 114688
buffer_load_dwordx4 v[120:123], v23, s[4:7], s64 offen offset:0 sc1
v_permlane32_swap_b32 v112, v113
v_fma_f32 v113, -v112, v112, v113
v_max_f32 v113, 0, v113
v_add_f32 v114, 0x3727c5ac, v113
v_rsq_f32 v114, v114
v_mfma_f32_16x16x32_bf16 v[84:87], a[252:255], v[100:103], v[84:87]
s_xor_b32 s67, s64, 256
buffer_load_dwordx4 v[124:127], v23, s[4:7], s67 offen offset:0 sc1
v_cvt_pk_bf16_f32 v113, -v112, -v112
v_lshlrev_b32 v113, 16, v113
v_sub_f32 v113, -v112, v113
v_mul_f32 v19, 0xc0135761, v114
v_mul_f32 v18, v114, v114
v_rcp_f32 v40, v114
v_mul_f32 v18, v18, v19
v_mul_f32 v18, 0x3d372713, v18
v_cvt_pk_bf16_f32 v22, -v112, v113
buffer_load_dwordx4 v[128:131], v23, s[4:7], s64 offen offset:2048 sc1
buffer_load_dwordx4 v[132:135], v23, s[4:7], s67 offen offset:2048 sc1
s_xor_b32 s64, s50, 397312
s_sub_u32 s64, s64, 114688
buffer_load_dwordx4 v[136:139], v23, s[4:7], s64 offen offset:0 sc1
v_cvt_pk_bf16_f32 v88, v80, v81
v_cvt_pk_bf16_f32 v89, v82, v83
v_cvt_pk_bf16_f32 v90, v84, v85
v_cvt_pk_bf16_f32 v91, v86, v87
s_xor_b32 s67, s64, 256
buffer_load_dwordx4 v[140:143], v23, s[4:7], s67 offen offset:0 sc1
v_permlane16_swap_b32 v88, v90
v_permlane16_swap_b32 v89, v91
v_xor_b32 v80, s24, v1
ds_write_b128 v80, v[88:91]
s_add_u32 s62, s34, 425984
buffer_store_dwordx4 v[88:91], v1, s[4:7], s62 offen
s_waitcnt vmcnt(6)
v_mfma_f32_16x16x32_bf16 v[48:51], v[144:147], v[120:123], 0
s_waitcnt lgkmcnt(0)
s_barrier
buffer_load_dwordx4 v[112:115], v23, s[4:7], s64 offen offset:2048 sc1
ds_read_b128 v[84:87], v12 offset:40960
s_waitcnt vmcnt(6)
v_mfma_f32_16x16x32_bf16 v[52:55], v[144:147], v[124:127], 0
ds_read_b64_tr_b16 v[144:145], v13 offset:7168
buffer_load_dwordx4 v[116:119], v23, s[4:7], s67 offen offset:2048 sc1
v_mfma_f32_16x16x32_bf16 v[56:59], v[148:151], v[120:123], 0
ds_read_b64_tr_b16 v[146:147], v13 offset:8960
v_mfma_f32_16x16x32_bf16 v[60:63], v[148:151], v[124:127], 0
ds_read_b64_tr_b16 v[148:149], v13 offset:7200
v_mfma_f32_16x16x32_bf16 v[64:67], v[152:155], v[120:123], 0
ds_read_b64_tr_b16 v[150:151], v13 offset:8992
s_waitcnt lgkmcnt(4)
v_lshlrev_b32 v80, 16, v84
v_mfma_f32_16x16x32_bf16 v[68:71], v[152:155], v[124:127], 0
ds_read_b64_tr_b16 v[152:153], v13 offset:7232
v_mov_b32 v124, v22
v_mov_b32 v126, 0
v_mfma_f32_16x16x32_bf16 v[72:75], v[156:159], v[120:123], 0
ds_read_b64_tr_b16 v[154:155], v13 offset:9024
ds_read_b64_tr_b16 v[156:157], v14 offset:7168
v_mov_b32 v120, v22
s_waitcnt vmcnt(6) lgkmcnt(5)
v_mfma_f32_16x16x32_bf16 v[48:51], v[144:147], v[128:131], v[48:51]
ds_read_b64_tr_b16 v[158:159], v14 offset:8960
v_permlane16_swap_b32 v120, v124
v_mov_b32 v122, 0
s_waitcnt vmcnt(5)
v_mfma_f32_16x16x32_bf16 v[52:55], v[144:147], v[132:135], v[52:55]
ds_read_b64_tr_b16 v[144:145], v13 offset:14336
v_mov_b32 v123, 0
v_mov_b32 v127, 0
s_waitcnt lgkmcnt(5)
v_mfma_f32_16x16x32_bf16 v[56:59], v[148:151], v[128:131], v[56:59]
ds_read_b64_tr_b16 v[146:147], v13 offset:16128
v_mov_b32 v121, v120
v_mov_b32 v125, v124
v_mfma_f32_16x16x32_bf16 v[60:63], v[148:151], v[132:135], v[60:63]
ds_read_b64_tr_b16 v[148:149], v13 offset:14368
v_and_b32 v81, s36, v84
v_lshlrev_b32 v82, 16, v85
s_waitcnt lgkmcnt(5)
v_mfma_f32_16x16x32_bf16 v[64:67], v[152:155], v[128:131], v[64:67]
ds_read_b64_tr_b16 v[150:151], v13 offset:16160
v_and_b32 v83, s36, v85
v_lshlrev_b32 v84, 16, v86
v_mfma_f32_16x16x32_bf16 v[68:71], v[152:155], v[132:135], v[68:71]
ds_read_b64_tr_b16 v[152:153], v13 offset:14400
v_and_b32 v85, s36, v86
v_lshlrev_b32 v86, 16, v87
s_waitcnt lgkmcnt(5)
v_mfma_f32_16x16x32_bf16 v[72:75], v[156:159], v[128:131], v[72:75]
ds_read_b64_tr_b16 v[154:155], v13 offset:16192
ds_read_b64_tr_b16 v[156:157], v14 offset:14336
s_xor_b32 s64, s50, 401408
s_sub_u32 s64, s64, 114688
buffer_load_dwordx4 v[128:131], v23, s[4:7], s64 offen offset:0 sc1
s_waitcnt vmcnt(5) lgkmcnt(5)
v_mfma_f32_16x16x32_bf16 v[48:51], v[144:147], v[136:139], v[48:51]
ds_read_b64_tr_b16 v[158:159], v14 offset:16128
s_xor_b32 s67, s64, 256
buffer_load_dwordx4 v[132:135], v23, s[4:7], s67 offen offset:0 sc1
s_waitcnt vmcnt(5)
v_mfma_f32_16x16x32_bf16 v[52:55], v[144:147], v[140:143], v[52:55]
ds_read_b64_tr_b16 v[144:145], v13 offset:21504
v_and_b32 v87, s36, v87
v_add_f32 v92, v80, v82
v_add_f32 v93, v81, v83
s_waitcnt lgkmcnt(5)
v_mfma_f32_16x16x32_bf16 v[56:59], v[148:151], v[136:139], v[56:59]
ds_read_b64_tr_b16 v[146:147], v13 offset:23296
v_mul_f32 v94, v80, v80
v_mul_f32 v95, v81, v81
v_mfma_f32_16x16x32_bf16 v[60:63], v[148:151], v[140:143], v[60:63]
ds_read_b64_tr_b16 v[148:149], v13 offset:21536
v_fmac_f32 v94, v82, v82
v_fmac_f32 v95, v83, v83
s_waitcnt lgkmcnt(5)
v_mfma_f32_16x16x32_bf16 v[64:67], v[152:155], v[136:139], v[64:67]
ds_read_b64_tr_b16 v[150:151], v13 offset:23328
v_add_f32 v92, v92, v84
v_add_f32 v93, v93, v85
v_mfma_f32_16x16x32_bf16 v[68:71], v[152:155], v[140:143], v[68:71]
ds_read_b64_tr_b16 v[152:153], v13 offset:21568
buffer_load_dwordx4 v[140:143], v23, s[4:7], s67 offen offset:2048 sc1
s_waitcnt lgkmcnt(5)
v_mfma_f32_16x16x32_bf16 v[72:75], v[156:159], v[136:139], v[72:75]
ds_read_b64_tr_b16 v[154:155], v13 offset:23360
ds_read_b64_tr_b16 v[156:157], v14 offset:21504
buffer_load_dwordx4 v[136:139], v23, s[4:7], s64 offen offset:2048 sc1
s_waitcnt vmcnt(5) lgkmcnt(5)
v_mfma_f32_16x16x32_bf16 v[48:51], v[144:147], v[112:115], v[48:51]
ds_read_b64_tr_b16 v[158:159], v14 offset:23296
v_fmac_f32 v94, v84, v84
v_fmac_f32 v95, v85, v85
v_mfma_f32_16x16x32_bf16 v[48:51], v[76:79], v[120:123], v[48:51]
s_barrier
v_pk_add_f32 v[92:93], v[92:93], v[86:87]
v_pk_fma_f32 v[94:95], v[86:87], v[86:87], v[94:95] op_sel:[0,0,0] op_sel_hi:[1,1,1]
s_waitcnt vmcnt(4)
v_mfma_f32_16x16x32_bf16 v[52:55], v[144:147], v[116:119], v[52:55]
ds_read_b64_tr_b16 v[144:145], v13 offset:28672
v_add_f32 v92, v92, v93
v_add_f32 v94, v94, v95
s_waitcnt lgkmcnt(5)
v_mfma_f32_16x16x32_bf16 v[56:59], v[148:151], v[112:115], v[56:59]
ds_read_b64_tr_b16 v[146:147], v13 offset:30464
v_permlane32_swap_b32 v92, v94
v_mfma_f32_16x16x32_bf16 v[60:63], v[148:151], v[116:119], v[60:63]
ds_read_b64_tr_b16 v[148:149], v13 offset:28704
v_add_f32 v92, v92, v94
v_mov_b32 v94, v92
s_waitcnt lgkmcnt(5)
v_mfma_f32_16x16x32_bf16 v[64:67], v[152:155], v[112:115], v[64:67]
ds_read_b64_tr_b16 v[150:151], v13 offset:30496
v_permlane16_swap_b32 v92, v94
v_mfma_f32_16x16x32_bf16 v[68:71], v[152:155], v[116:119], v[68:71]
ds_read_b64_tr_b16 v[152:153], v13 offset:28736
v_add_f32 v92, v92, v94
v_add_f32 v32, v32, v80
v_add_f32 v33, v33, v81
s_waitcnt lgkmcnt(5)
v_mfma_f32_16x16x32_bf16 v[72:75], v[156:159], v[112:115], v[72:75]
ds_read_b64_tr_b16 v[154:155], v13 offset:30528
ds_read_b64_tr_b16 v[156:157], v14 offset:28672
s_xor_b32 s64, s50, 405504
s_sub_u32 s64, s64, 114688
buffer_load_dwordx4 v[112:115], v23, s[4:7], s64 offen offset:0 sc1
v_mfma_f32_16x16x32_bf16 v[52:55], v[76:79], v[124:127], v[52:55]
s_mov_b64 vcc, 0xffff
s_lshl_b64 vcc, vcc, 16
v_cndmask_b32 v76, 0, v16, vcc
v_cndmask_b32 v77, 0, v17, vcc
s_waitcnt vmcnt(4) lgkmcnt(5)
v_mfma_f32_16x16x32_bf16 v[48:51], v[144:147], v[128:131], v[48:51]
ds_read_b64_tr_b16 v[158:159], v14 offset:30464
s_xor_b32 s67, s64, 256
buffer_load_dwordx4 v[116:119], v23, s[4:7], s67 offen offset:0 sc1
v_mfma_f32_16x16x32_bf16 v[56:59], v[76:79], v[120:123], v[56:59]
v_add_f32_dpp v92, v92, v92 row_ror:8 row_mask:0xf bank_mask:0xf
s_add_u32 s62, s42, 557056
buffer_store_dword v92, v8, s[4:7], s62 offen offset:2048
v_mfma_f32_16x16x32_bf16 v[60:63], v[76:79], v[124:127], v[60:63]
s_mov_b64 vcc, 0xffff
s_lshl_b64 vcc, vcc, 32
v_cndmask_b32 v76, 0, v16, vcc
v_cndmask_b32 v77, 0, v17, vcc
s_waitcnt vmcnt(5)
v_mfma_f32_16x16x32_bf16 v[52:55], v[144:147], v[132:135], v[52:55]
ds_read_b64_tr_b16 v[144:145], v13 offset:35840
v_add_f32 v34, v34, v82
v_add_f32 v35, v35, v83
v_mfma_f32_16x16x32_bf16 v[64:67], v[76:79], v[120:123], v[64:67]
v_add_f32 v36, v36, v84
v_add_f32 v37, v37, v85
v_mfma_f32_16x16x32_bf16 v[68:71], v[76:79], v[124:127], v[68:71]
s_mov_b64 vcc, 0xffff
s_lshl_b64 vcc, vcc, 48
v_cndmask_b32 v76, 0, v16, vcc
v_cndmask_b32 v77, 0, v17, vcc
s_waitcnt lgkmcnt(5)
v_mfma_f32_16x16x32_bf16 v[56:59], v[148:151], v[128:131], v[56:59]
ds_read_b64_tr_b16 v[146:147], v13 offset:37632
buffer_load_dwordx4 v[124:127], v23, s[4:7], s67 offen offset:2048 sc1
v_mfma_f32_16x16x32_bf16 v[72:75], v[76:79], v[120:123], v[72:75]
buffer_load_dwordx4 v[120:123], v23, s[4:7], s64 offen offset:2048 sc1
v_mfma_f32_16x16x32_bf16 v[60:63], v[148:151], v[132:135], v[60:63]
ds_read_b64_tr_b16 v[148:149], v13 offset:35872
v_add_f32 v38, v38, v86
v_add_f32 v39, v39, v87
s_waitcnt lgkmcnt(5)
v_mfma_f32_16x16x32_bf16 v[64:67], v[152:155], v[128:131], v[64:67]
ds_read_b64_tr_b16 v[150:151], v13 offset:37664
v_mfma_f32_16x16x32_bf16 v[68:71], v[152:155], v[132:135], v[68:71]
ds_read_b64_tr_b16 v[152:153], v13 offset:35904
s_waitcnt lgkmcnt(5)
v_mfma_f32_16x16x32_bf16 v[72:75], v[156:159], v[128:131], v[72:75]
ds_read_b64_tr_b16 v[154:155], v13 offset:37696
ds_read_b64_tr_b16 v[156:157], v14 offset:35840
s_xor_b32 s64, s50, 409600
s_sub_u32 s64, s64, 114688
pg_7:
s_cbranch_execz pg_back
buffer_load_dwordx4 v[128:131], v23, s[4:7], s64 offen offset:0 sc1
s_waitcnt vmcnt(6) lgkmcnt(5)
v_mfma_f32_16x16x32_bf16 v[48:51], v[144:147], v[136:139], v[48:51]
ds_read_b64_tr_b16 v[158:159], v14 offset:37632
s_xor_b32 s67, s64, 256
buffer_load_dwordx4 v[132:135], v23, s[4:7], s67 offen offset:0 sc1
v_mfma_f32_16x16x32_bf16 v[52:55], v[144:147], v[140:143], v[52:55]
ds_read_b64_tr_b16 v[144:145], v13 offset:43008
s_waitcnt lgkmcnt(5)
v_mfma_f32_16x16x32_bf16 v[56:59], v[148:151], v[136:139], v[56:59]
ds_read_b64_tr_b16 v[146:147], v13 offset:44800
v_mfma_f32_16x16x32_bf16 v[60:63], v[148:151], v[140:143], v[60:63]
ds_read_b64_tr_b16 v[148:149], v13 offset:43040
s_waitcnt lgkmcnt(5)
v_mfma_f32_16x16x32_bf16 v[64:67], v[152:155], v[136:139], v[64:67]
ds_read_b64_tr_b16 v[150:151], v13 offset:44832
v_mfma_f32_16x16x32_bf16 v[68:71], v[152:155], v[140:143], v[68:71]
ds_read_b64_tr_b16 v[152:153], v13 offset:43072
buffer_load_dwordx4 v[140:143], v23, s[4:7], s67 offen offset:2048 sc1
s_waitcnt lgkmcnt(5)
v_mfma_f32_16x16x32_bf16 v[72:75], v[156:159], v[136:139], v[72:75]
ds_read_b64_tr_b16 v[154:155], v13 offset:44864
ds_read_b64_tr_b16 v[156:157], v14 offset:43008
buffer_load_dwordx4 v[136:139], v23, s[4:7], s64 offen offset:2048 sc1
s_waitcnt vmcnt(8) lgkmcnt(5)
v_mfma_f32_16x16x32_bf16 v[48:51], v[144:147], v[112:115], v[48:51]
ds_read_b64_tr_b16 v[158:159], v14 offset:44800
s_waitcnt vmcnt(7)
v_mfma_f32_16x16x32_bf16 v[52:55], v[144:147], v[116:119], v[52:55]
ds_read_b64_tr_b16 v[144:145], v13 offset:50176
s_waitcnt lgkmcnt(5)
v_mfma_f32_16x16x32_bf16 v[56:59], v[148:151], v[112:115], v[56:59]
ds_read_b64_tr_b16 v[146:147], v13 offset:51968
v_mfma_f32_16x16x32_bf16 v[60:63], v[148:151], v[116:119], v[60:63]
ds_read_b64_tr_b16 v[148:149], v13 offset:50208
s_waitcnt lgkmcnt(5)
v_mfma_f32_16x16x32_bf16 v[64:67], v[152:155], v[112:115], v[64:67]
ds_read_b64_tr_b16 v[150:151], v13 offset:52000
v_mfma_f32_16x16x32_bf16 v[68:71], v[152:155], v[116:119], v[68:71]
ds_read_b64_tr_b16 v[152:153], v13 offset:50240
s_waitcnt lgkmcnt(5)
v_mfma_f32_16x16x32_bf16 v[72:75], v[156:159], v[112:115], v[72:75]
ds_read_b64_tr_b16 v[154:155], v13 offset:52032
ds_read_b64_tr_b16 v[156:157], v14 offset:50176
s_xor_b32 s64, s50, 413696
s_sub_u32 s64, s64, 114688
buffer_load_dwordx4 v[112:115], v23, s[4:7], s64 offen offset:0 sc1
s_waitcnt vmcnt(5) lgkmcnt(5)
v_mfma_f32_16x16x32_bf16 v[48:51], v[144:147], v[120:123], v[48:51]
ds_read_b64_tr_b16 v[158:159], v14 offset:51968
s_xor_b32 s67, s64, 256
buffer_load_dwordx4 v[116:119], v23, s[4:7], s67 offen offset:0 sc1
v_mfma_f32_16x16x32_bf16 v[52:55], v[144:147], v[124:127], v[52:55]
v_add_u32 v13, s65, v13
ds_read_b64_tr_b16 v[144:145], v13 offset:0
s_waitcnt lgkmcnt(5)
v_mfma_f32_16x16x32_bf16 v[56:59], v[148:151], v[120:123], v[56:59]
ds_read_b64_tr_b16 v[146:147], v13 offset:1792
v_mfma_f32_16x16x32_bf16 v[60:63], v[148:151], v[124:127], v[60:63]
ds_read_b64_tr_b16 v[148:149], v13 offset:32
s_waitcnt lgkmcnt(5)
v_mfma_f32_16x16x32_bf16 v[64:67], v[152:155], v[120:123], v[64:67]
ds_read_b64_tr_b16 v[150:151], v13 offset:1824
v_mfma_f32_16x16x32_bf16 v[68:71], v[152:155], v[124:127], v[68:71]
ds_read_b64_tr_b16 v[152:153], v13 offset:64
s_waitcnt lgkmcnt(5)
v_mfma_f32_16x16x32_bf16 v[72:75], v[156:159], v[120:123], v[72:75]
ds_read_b64_tr_b16 v[154:155], v13 offset:1856
v_add_u32 v14, s65, v14
ds_read_b64_tr_b16 v[156:157], v14 offset:0
s_waitcnt vmcnt(5) lgkmcnt(5)
v_mfma_f32_16x16x32_bf16 v[48:51], v[144:147], v[128:131], v[48:51]
ds_read_b64_tr_b16 v[158:159], v14 offset:1792
s_waitcnt vmcnt(4)
v_mfma_f32_16x16x32_bf16 v[52:55], v[144:147], v[132:135], v[52:55]
ds_read_b64_tr_b16 v[144:145], v13 offset:7168
s_lshl_b32 s60, s71, 8
v_xor_b32 v120, s60, v1
s_add_u32 s62, s51, 557056
buffer_load_dwordx4 v[124:127], v120, s[4:7], s62 offen offset:3072 sc1
buffer_load_dwordx4 v[120:123], v120, s[4:7], s62 offen offset:2048 sc1
s_waitcnt lgkmcnt(5)
v_mfma_f32_16x16x32_bf16 v[56:59], v[148:151], v[128:131], v[56:59]
ds_read_b64_tr_b16 v[146:147], v13 offset:8960
v_mfma_f32_16x16x32_bf16 v[60:63], v[148:151], v[132:135], v[60:63]
ds_read_b64_tr_b16 v[148:149], v13 offset:7200
s_waitcnt lgkmcnt(5)
v_mfma_f32_16x16x32_bf16 v[64:67], v[152:155], v[128:131], v[64:67]
ds_read_b64_tr_b16 v[150:151], v13 offset:8992
v_mfma_f32_16x16x32_bf16 v[68:71], v[152:155], v[132:135], v[68:71]
ds_read_b64_tr_b16 v[152:153], v13 offset:7232
buffer_load_dwordx4 v[132:135], v23, s[4:7], s67 offen offset:2048 sc1
s_waitcnt lgkmcnt(5)
v_mfma_f32_16x16x32_bf16 v[72:75], v[156:159], v[128:131], v[72:75]
ds_read_b64_tr_b16 v[154:155], v13 offset:9024
ds_read_b64_tr_b16 v[156:157], v14 offset:7168
buffer_load_dwordx4 v[128:131], v23, s[4:7], s64 offen offset:2048 sc1
s_waitcnt vmcnt(6) lgkmcnt(5)
v_mfma_f32_16x16x32_bf16 v[48:51], v[144:147], v[136:139], v[48:51]
ds_read_b64_tr_b16 v[158:159], v14 offset:8960
v_mfma_f32_16x16x32_bf16 v[52:55], v[144:147], v[140:143], v[52:55]
ds_read_b64_tr_b16 v[144:145], v13 offset:14336
s_waitcnt lgkmcnt(5)
v_mfma_f32_16x16x32_bf16 v[56:59], v[148:151], v[136:139], v[56:59]
ds_read_b64_tr_b16 v[146:147], v13 offset:16128
v_mfma_f32_16x16x32_bf16 v[60:63], v[148:151], v[140:143], v[60:63]
ds_read_b64_tr_b16 v[148:149], v13 offset:14368
s_waitcnt lgkmcnt(5)
v_mfma_f32_16x16x32_bf16 v[64:67], v[152:155], v[136:139], v[64:67]
ds_read_b64_tr_b16 v[150:151], v13 offset:16160
v_mfma_f32_16x16x32_bf16 v[68:71], v[152:155], v[140:143], v[68:71]
ds_read_b64_tr_b16 v[152:153], v13 offset:14400
s_waitcnt lgkmcnt(5)
v_mfma_f32_16x16x32_bf16 v[72:75], v[156:159], v[136:139], v[72:75]
ds_read_b64_tr_b16 v[154:155], v13 offset:16192
ds_read_b64_tr_b16 v[156:157], v14 offset:14336
s_xor_b32 s64, s50, 417792
s_sub_u32 s64, s64, 114688
buffer_load_dwordx4 v[136:139], v23, s[4:7], s64 offen offset:0 sc1
s_waitcnt vmcnt(6) lgkmcnt(5)
v_mfma_f32_16x16x32_bf16 v[48:51], v[144:147], v[112:115], v[48:51]
ds_read_b64_tr_b16 v[158:159], v14 offset:16128
s_xor_b32 s67, s64, 256
buffer_load_dwordx4 v[140:143], v23, s[4:7], s67 offen offset:0 sc1
s_waitcnt vmcnt(6)
v_mfma_f32_16x16x32_bf16 v[52:55], v[144:147], v[116:119], v[52:55]
ds_read_b64_tr_b16 v[144:145], v13 offset:21504
s_waitcnt lgkmcnt(5)
v_mfma_f32_16x16x32_bf16 v[56:59], v[148:151], v[112:115], v[56:59]
ds_read_b64_tr_b16 v[146:147], v13 offset:23296
v_mfma_f32_16x16x32_bf16 v[60:63], v[148:151], v[116:119], v[60:63]
ds_read_b64_tr_b16 v[148:149], v13 offset:21536
s_waitcnt vmcnt(4)
v_add_f32 v120, v120, v124
v_add_f32 v121, v121, v125
s_waitcnt lgkmcnt(5)
v_mfma_f32_16x16x32_bf16 v[64:67], v[152:155], v[112:115], v[64:67]
ds_read_b64_tr_b16 v[150:151], v13 offset:23328
v_add_f32 v122, v122, v126
v_add_f32 v123, v123, v127
v_mfma_f32_16x16x32_bf16 v[68:71], v[152:155], v[116:119], v[68:71]
ds_read_b64_tr_b16 v[152:153], v13 offset:21568
v_add_f32 v120, v120, v122
v_add_f32 v121, v121, v123
s_waitcnt lgkmcnt(5)
v_mfma_f32_16x16x32_bf16 v[72:75], v[156:159], v[112:115], v[72:75]
ds_read_b64_tr_b16 v[154:155], v13 offset:23360
ds_read_b64_tr_b16 v[156:157], v14 offset:21504
v_permlane32_swap_b32 v120, v121
v_add_f32 v120, v120, v121
v_cmp_u_f32 vcc, v120, v120
s_cbranch_vccnz re_57
re_57b:
v_mul_f32 v120, 0x3b000000, v120
v_mov_b32 v121, v120
buffer_load_dwordx4 v[112:115], v23, s[4:7], s64 offen offset:2048 sc1
s_nop 0
v_permlane32_swap_b32 v120, v121
v_fma_f32 v121, -v120, v120, v121
v_max_f32 v121, 0, v121
v_add_f32 v122, 0x3727c5ac, v121
v_rsq_f32 v122, v122
v_cvt_pk_bf16_f32 v121, -v120, -v120
v_lshlrev_b32 v121, 16, v121
v_sub_f32 v121, -v120, v121
v_mul_f32 v21, 0xc0135761, v122
v_mul_f32 v20, v122, v122
v_rcp_f32 v41, v122
v_mul_f32 v20, v20, v21
v_mul_f32 v20, 0x3d372713, v20
v_cvt_pk_bf16_f32 v2, -v120, v121
s_waitcnt vmcnt(3) lgkmcnt(5)
v_mfma_f32_16x16x32_bf16 v[48:51], v[144:147], v[128:131], v[48:51]
ds_read_b64_tr_b16 v[158:159], v14 offset:23296
buffer_load_dwordx4 v[116:119], v23, s[4:7], s67 offen offset:2048 sc1
v_mfma_f32_16x16x32_bf16 v[52:55], v[144:147], v[132:135], v[52:55]
ds_read_b64_tr_b16 v[144:145], v13 offset:28672
s_xor_b32 s64, s50, 421888
s_sub_u32 s64, s64, 114688
buffer_load_dwordx4 v[120:123], v23, s[4:7], s64 offen offset:0 sc1
s_waitcnt lgkmcnt(5)
v_mfma_f32_16x16x32_bf16 v[56:59], v[148:151], v[128:131], v[56:59]
ds_read_b64_tr_b16 v[146:147], v13 offset:30464
s_xor_b32 s67, s64, 256
buffer_load_dwordx4 v[124:127], v23, s[4:7], s67 offen offset:0 sc1
v_mfma_f32_16x16x32_bf16 v[60:63], v[148:151], v[132:135], v[60:63]
ds_read_b64_tr_b16 v[148:149], v13 offset:28704
s_waitcnt lgkmcnt(5)
v_mfma_f32_16x16x32_bf16 v[64:67], v[152:155], v[128:131], v[64:67]
ds_read_b64_tr_b16 v[150:151], v13 offset:30496
v_mfma_f32_16x16x32_bf16 v[68:71], v[152:155], v[132:135], v[68:71]
ds_read_b64_tr_b16 v[152:153], v13 offset:28736
buffer_load_dwordx4 v[132:135], v23, s[4:7], s67 offen offset:2048 sc1
s_waitcnt lgkmcnt(5)
v_mfma_f32_16x16x32_bf16 v[72:75], v[156:159], v[128:131], v[72:75]
ds_read_b64_tr_b16 v[154:155], v13 offset:30528
ds_read_b64_tr_b16 v[156:157], v14 offset:28672
buffer_load_dwordx4 v[128:131], v23, s[4:7], s64 offen offset:2048 sc1
s_waitcnt vmcnt(7) lgkmcnt(5)
v_mfma_f32_16x16x32_bf16 v[48:51], v[144:147], v[136:139], v[48:51]
ds_read_b64_tr_b16 v[158:159], v14 offset:30464
s_waitcnt vmcnt(6)
v_mfma_f32_16x16x32_bf16 v[52:55], v[144:147], v[140:143], v[52:55]
ds_read_b64_tr_b16 v[144:145], v13 offset:35840
s_waitcnt lgkmcnt(5)
v_mfma_f32_16x16x32_bf16 v[56:59], v[148:151], v[136:139], v[56:59]
ds_read_b64_tr_b16 v[146:147], v13 offset:37632
v_mfma_f32_16x16x32_bf16 v[60:63], v[148:151], v[140:143], v[60:63]
ds_read_b64_tr_b16 v[148:149], v13 offset:35872
s_waitcnt lgkmcnt(5)
v_mfma_f32_16x16x32_bf16 v[64:67], v[152:155], v[136:139], v[64:67]
ds_read_b64_tr_b16 v[150:151], v13 offset:37664
v_mfma_f32_16x16x32_bf16 v[68:71], v[152:155], v[140:143], v[68:71]
ds_read_b64_tr_b16 v[152:153], v13 offset:35904
s_waitcnt lgkmcnt(5)
v_mfma_f32_16x16x32_bf16 v[72:75], v[156:159], v[136:139], v[72:75]
ds_read_b64_tr_b16 v[154:155], v13 offset:37696
ds_read_b64_tr_b16 v[156:157], v14 offset:35840
s_xor_b32 s64, s50, 425984
s_sub_u32 s64, s64, 114688
buffer_load_dwordx4 v[136:139], v23, s[4:7], s64 offen offset:0 sc1
s_waitcnt vmcnt(6) lgkmcnt(5)
v_mfma_f32_16x16x32_bf16 v[48:51], v[144:147], v[112:115], v[48:51]
ds_read_b64_tr_b16 v[158:159], v14 offset:37632
s_xor_b32 s67, s64, 256
buffer_load_dwordx4 v[140:143], v23, s[4:7], s67 offen offset:0 sc1
s_waitcnt vmcnt(6)
v_mfma_f32_16x16x32_bf16 v[52:55], v[144:147], v[116:119], v[52:55]
ds_read_b64_tr_b16 v[144:145], v13 offset:43008
s_waitcnt lgkmcnt(5)
v_mfma_f32_16x16x32_bf16 v[56:59], v[148:151], v[112:115], v[56:59]
ds_read_b64_tr_b16 v[146:147], v13 offset:44800
v_mfma_f32_16x16x32_bf16 v[60:63], v[148:151], v[116:119], v[60:63]
ds_read_b64_tr_b16 v[148:149], v13 offset:43040
s_waitcnt lgkmcnt(5)
v_mfma_f32_16x16x32_bf16 v[64:67], v[152:155], v[112:115], v[64:67]
ds_read_b64_tr_b16 v[150:151], v13 offset:44832
v_mfma_f32_16x16x32_bf16 v[68:71], v[152:155], v[116:119], v[68:71]
ds_read_b64_tr_b16 v[152:153], v13 offset:43072
buffer_load_dwordx4 v[116:119], v23, s[4:7], s67 offen offset:2048 sc1
s_waitcnt lgkmcnt(5)
v_mfma_f32_16x16x32_bf16 v[72:75], v[156:159], v[112:115], v[72:75]
ds_read_b64_tr_b16 v[154:155], v13 offset:44864
ds_read_b64_tr_b16 v[156:157], v14 offset:43008
buffer_load_dwordx4 v[112:115], v23, s[4:7], s64 offen offset:2048 sc1
s_waitcnt vmcnt(7) lgkmcnt(5)
v_mfma_f32_16x16x32_bf16 v[48:51], v[144:147], v[120:123], v[48:51]
ds_read_b64_tr_b16 v[158:159], v14 offset:44800
s_waitcnt vmcnt(6)
v_mfma_f32_16x16x32_bf16 v[52:55], v[144:147], v[124:127], v[52:55]
ds_read_b64_tr_b16 v[144:145], v13 offset:50176
s_waitcnt lgkmcnt(5)
v_mfma_f32_16x16x32_bf16 v[56:59], v[148:151], v[120:123], v[56:59]
ds_read_b64_tr_b16 v[146:147], v13 offset:51968
v_mfma_f32_16x16x32_bf16 v[60:63], v[148:151], v[124:127], v[60:63]
ds_read_b64_tr_b16 v[148:149], v13 offset:50208
s_waitcnt lgkmcnt(5)
v_mfma_f32_16x16x32_bf16 v[64:67], v[152:155], v[120:123], v[64:67]
ds_read_b64_tr_b16 v[150:151], v13 offset:52000
v_mfma_f32_16x16x32_bf16 v[68:71], v[152:155], v[124:127], v[68:71]
ds_read_b64_tr_b16 v[152:153], v13 offset:50240
v_mov_b32 v124, v2
v_mov_b32 v126, 0
s_waitcnt lgkmcnt(5)
v_mfma_f32_16x16x32_bf16 v[72:75], v[156:159], v[120:123], v[72:75]
ds_read_b64_tr_b16 v[154:155], v13 offset:52032
ds_read_b64_tr_b16 v[156:157], v14 offset:50176
v_subrev_u32 v13, s65, v13
s_waitcnt vmcnt(4) lgkmcnt(5)
v_mfma_f32_16x16x32_bf16 v[48:51], v[144:147], v[128:131], v[48:51]
ds_read_b64_tr_b16 v[158:159], v14 offset:51968
v_subrev_u32 v14, s65, v14
v_mov_b32 v120, v2
v_mfma_f32_16x16x32_bf16 v[52:55], v[144:147], v[132:135], v[52:55]
ds_read_b64_tr_b16 v[144:145], v13 offset:0
ds_read_b64_tr_b16 v[146:147], v13 offset:1792
v_permlane16_swap_b32 v120, v124
s_waitcnt lgkmcnt(6)
v_mfma_f32_16x16x32_bf16 v[56:59], v[148:151], v[128:131], v[56:59]
v_mov_b32 v122, 0
v_mov_b32 v123, 0
v_mfma_f32_16x16x32_bf16 v[60:63], v[148:151], v[132:135], v[60:63]
ds_read_b64_tr_b16 v[148:149], v13 offset:32
ds_read_b64_tr_b16 v[150:151], v13 offset:1824
v_permlane16_swap_b32 v48, v52
s_waitcnt lgkmcnt(6)
v_mfma_f32_16x16x32_bf16 v[64:67], v[152:155], v[128:131], v[64:67]
v_permlane16_swap_b32 v49, v53
s_waitcnt vmcnt(3) lgkmcnt(2)
v_mfma_f32_16x16x32_bf16 v[80:83], v[144:147], v[136:139], 0
v_permlane16_swap_b32 v50, v54
v_mfma_f32_16x16x32_bf16 v[68:71], v[152:155], v[132:135], v[68:71]
ds_read_b64_tr_b16 v[152:153], v13 offset:64
ds_read_b64_tr_b16 v[154:155], v13 offset:1856
v_permlane16_swap_b32 v51, v55
s_waitcnt vmcnt(2)
v_mfma_f32_16x16x32_bf16 v[84:87], v[144:147], v[140:143], 0
ds_read_b64_tr_b16 v[144:145], v13 offset:7168
v_mul_f32 v44, v48, v48
v_mul_f32 v45, v49, v49
s_waitcnt lgkmcnt(3)
v_mfma_f32_16x16x32_bf16 v[88:91], v[148:151], v[136:139], 0
ds_read_b64_tr_b16 v[146:147], v13 offset:8960
v_mul_f32 v46, v50, v50
v_mul_f32 v47, v51, v51
v_mfma_f32_16x16x32_bf16 v[92:95], v[148:151], v[140:143], 0
ds_read_b64_tr_b16 v[148:149], v13 offset:7200
v_fma_f32 v44, v44, v18, v19
v_fma_f32 v45, v45, v18, v19
s_waitcnt lgkmcnt(3)
v_mfma_f32_16x16x32_bf16 v[96:99], v[152:155], v[136:139], 0
ds_read_b64_tr_b16 v[150:151], v13 offset:8992
v_fma_f32 v46, v46, v18, v19
v_fma_f32 v47, v47, v18, v19
v_mfma_f32_16x16x32_bf16 v[100:103], v[152:155], v[140:143], 0
ds_read_b64_tr_b16 v[152:153], v13 offset:7232
v_mul_f32 v44, v44, v48
v_mul_f32 v45, v45, v49
v_mfma_f32_16x16x32_bf16 v[72:75], v[156:159], v[128:131], v[72:75]
ds_read_b64_tr_b16 v[156:157], v14 offset:0
ds_read_b64_tr_b16 v[158:159], v14 offset:1792
s_xor_b32 s64, s50, 430080
s_sub_u32 s64, s64, 114688
buffer_load_dwordx4 v[128:131], v23, s[4:7], s64 offen offset:0 sc1
s_xor_b32 s67, s64, 256
buffer_load_dwordx4 v[132:135], v23, s[4:7], s67 offen offset:0 sc1
v_pk_mul_f32 v[46:47], v[46:47], v[50:51]
buffer_load_dwordx4 v[140:143], v23, s[4:7], s67 offen offset:2048 sc1
v_exp_f32 v44, v44
s_waitcnt lgkmcnt(0)
v_mfma_f32_16x16x32_bf16 v[104:107], v[156:159], v[136:139], 0
ds_read_b64_tr_b16 v[154:155], v13 offset:9024
ds_read_b64_tr_b16 v[156:157], v14 offset:7168
buffer_load_dwordx4 v[136:139], v23, s[4:7], s64 offen offset:2048 sc1
s_waitcnt vmcnt(4)
v_mfma_f32_16x16x32_bf16 v[80:83], v[144:147], v[112:115], v[80:83]
ds_read_b64_tr_b16 v[158:159], v14 offset:8960
v_exp_f32 v45, v45
v_mfma_f32_16x16x32_bf16 v[84:87], v[144:147], v[116:119], v[84:87]
ds_read_b64_tr_b16 v[144:145], v13 offset:14336
v_exp_f32 v46, v46
v_mfma_f32_16x16x32_bf16 v[88:91], v[148:151], v[112:115], v[88:91]
ds_read_b64_tr_b16 v[146:147], v13 offset:16128
v_exp_f32 v47, v47
v_mfma_f32_16x16x32_bf16 v[92:95], v[148:151], v[116:119], v[92:95]
ds_read_b64_tr_b16 v[148:149], v13 offset:14368
v_fma_f32 v44, v44, v40, v40
v_fma_f32 v45, v45, v40, v40
s_waitcnt lgkmcnt(5)
v_mfma_f32_16x16x32_bf16 v[96:99], v[152:155], v[112:115], v[96:99]
ds_read_b64_tr_b16 v[150:151], v13 offset:16160
v_fma_f32 v46, v46, v40, v40
v_fma_f32 v47, v47, v40, v40
v_mfma_f32_16x16x32_bf16 v[100:103], v[152:155], v[116:119], v[100:103]
ds_read_b64_tr_b16 v[152:153], v13 offset:14400
v_rcp_f32 v44, v44
s_waitcnt lgkmcnt(5)
v_mfma_f32_16x16x32_bf16 v[104:107], v[156:159], v[112:115], v[104:107]
ds_read_b64_tr_b16 v[154:155], v13 offset:16192
ds_read_b64_tr_b16 v[156:157], v14 offset:14336
s_xor_b32 s64, s50, 434176
s_sub_u32 s64, s64, 114688
buffer_load_dwordx4 v[112:115], v23, s[4:7], s64 offen offset:0 sc1
s_xor_b32 s67, s64, 256
buffer_load_dwordx4 v[116:119], v23, s[4:7], s67 offen offset:0 sc1
v_rcp_f32 v45, v45
v_rcp_f32 v46, v46
v_rcp_f32 v47, v47
v_pk_mul_f32 v[44:45], v[44:45], v[48:49]
v_pk_mul_f32 v[46:47], v[46:47], v[50:51]
v_cvt_pk_bf16_f32 v48, v44, v45
v_cvt_pk_bf16_f32 v49, v46, v47
v_pk_mul_f32 v[76:77], v[52:53], v[52:53]
v_pk_mul_f32 v[78:79], v[54:55], v[54:55]
v_pk_fma_f32 v[76:77], v[76:77], v[18:19], v[18:19] op_sel:[0,0,1] op_sel_hi:[1,0,1]
v_pk_fma_f32 v[78:79], v[78:79], v[18:19], v[18:19] op_sel:[0,0,1] op_sel_hi:[1,0,1]
v_pk_mul_f32 v[76:77], v[76:77], v[52:53]
v_pk_mul_f32 v[78:79], v[78:79], v[54:55]
v_exp_f32 v76, v76
v_exp_f32 v77, v77
v_exp_f32 v78, v78
v_exp_f32 v79, v79
v_pk_fma_f32 v[76:77], v[76:77], v[40:41], v[40:41] op_sel:[0,0,0] op_sel_hi:[1,0,0]
v_pk_fma_f32 v[78:79], v[78:79], v[40:41], v[40:41] op_sel:[0,0,0] op_sel_hi:[1,0,0]
v_rcp_f32 v76, v76
v_rcp_f32 v77, v77
v_rcp_f32 v78, v78
v_rcp_f32 v79, v79
v_pk_mul_f32 v[76:77], v[76:77], v[52:53]
v_pk_mul_f32 v[78:79], v[78:79], v[54:55]
v_cvt_pk_bf16_f32 v50, v76, v77
v_cvt_pk_bf16_f32 v51, v78, v79
s_lshl_b32 s60, s71, 8
v_xor_b32 v52, s60, v1
s_add_u32 s62, s72, 0
buffer_store_dwordx4 v[48:51], v52, s[4:7], s62 offen offset:0 sc1
v_permlane16_swap_b32 v56, v60
v_permlane16_swap_b32 v57, v61
v_permlane16_swap_b32 v58, v62
v_permlane16_swap_b32 v59, v63
v_pk_mul_f32 v[44:45], v[56:57], v[56:57]
v_pk_mul_f32 v[46:47], v[58:59], v[58:59]
v_pk_fma_f32 v[44:45], v[44:45], v[18:19], v[18:19] op_sel:[0,0,1] op_sel_hi:[1,0,1]
v_pk_fma_f32 v[46:47], v[46:47], v[18:19], v[18:19] op_sel:[0,0,1] op_sel_hi:[1,0,1]
v_pk_mul_f32 v[44:45], v[44:45], v[56:57]
v_pk_mul_f32 v[46:47], v[46:47], v[58:59]
v_exp_f32 v44, v44
v_exp_f32 v45, v45
v_exp_f32 v46, v46
v_exp_f32 v47, v47
v_pk_fma_f32 v[44:45], v[44:45], v[40:41], v[40:41] op_sel:[0,0,0] op_sel_hi:[1,0,0]
v_pk_fma_f32 v[46:47], v[46:47], v[40:41], v[40:41] op_sel:[0,0,0] op_sel_hi:[1,0,0]
v_rcp_f32 v44, v44
v_rcp_f32 v45, v45
v_rcp_f32 v46, v46
v_rcp_f32 v47, v47
v_pk_mul_f32 v[44:45], v[44:45], v[56:57]
v_pk_mul_f32 v[46:47], v[46:47], v[58:59]
v_cvt_pk_bf16_f32 v56, v44, v45
v_cvt_pk_bf16_f32 v57, v46, v47
v_pk_mul_f32 v[76:77], v[60:61], v[60:61]
v_pk_mul_f32 v[78:79], v[62:63], v[62:63]
v_pk_fma_f32 v[76:77], v[76:77], v[18:19], v[18:19] op_sel:[0,0,1] op_sel_hi:[1,0,1]
v_pk_fma_f32 v[78:79], v[78:79], v[18:19], v[18:19] op_sel:[0,0,1] op_sel_hi:[1,0,1]
v_pk_mul_f32 v[76:77], v[76:77], v[60:61]
v_pk_mul_f32 v[78:79], v[78:79], v[62:63]
v_exp_f32 v76, v76
v_exp_f32 v77, v77
v_exp_f32 v78, v78
v_exp_f32 v79, v79
v_pk_fma_f32 v[76:77], v[76:77], v[40:41], v[40:41] op_sel:[0,0,0] op_sel_hi:[1,0,0]
v_pk_fma_f32 v[78:79], v[78:79], v[40:41], v[40:41] op_sel:[0,0,0] op_sel_hi:[1,0,0]
v_rcp_f32 v76, v76
v_rcp_f32 v77, v77
v_rcp_f32 v78, v78
v_rcp_f32 v79, v79
v_pk_mul_f32 v[76:77], v[76:77], v[60:61]
v_pk_mul_f32 v[78:79], v[78:79], v[62:63]
v_cvt_pk_bf16_f32 v58, v76, v77
v_cvt_pk_bf16_f32 v59, v78, v79
s_lshl_b32 s60, s71, 8
v_xor_b32 v60, s60, v1
s_add_u32 s62, s72, 0
buffer_store_dwordx4 v[56:59], v60, s[4:7], s62 offen offset:1024 sc1
v_permlane16_swap_b32 v64, v68
v_permlane16_swap_b32 v65, v69
v_permlane16_swap_b32 v66, v70
v_permlane16_swap_b32 v67, v71
v_pk_mul_f32 v[44:45], v[64:65], v[64:65]
v_pk_mul_f32 v[46:47], v[66:67], v[66:67]
v_pk_fma_f32 v[44:45], v[44:45], v[18:19], v[18:19] op_sel:[0,0,1] op_sel_hi:[1,0,1]
v_pk_fma_f32 v[46:47], v[46:47], v[18:19], v[18:19] op_sel:[0,0,1] op_sel_hi:[1,0,1]
v_pk_mul_f32 v[44:45], v[44:45], v[64:65]
v_pk_mul_f32 v[46:47], v[46:47], v[66:67]
v_exp_f32 v44, v44
v_exp_f32 v45, v45
v_exp_f32 v46, v46
v_exp_f32 v47, v47
v_pk_fma_f32 v[44:45], v[44:45], v[40:41], v[40:41] op_sel:[0,0,0] op_sel_hi:[1,0,0]
v_pk_fma_f32 v[46:47], v[46:47], v[40:41], v[40:41] op_sel:[0,0,0] op_sel_hi:[1,0,0]
v_rcp_f32 v44, v44
v_rcp_f32 v45, v45
v_rcp_f32 v46, v46
v_rcp_f32 v47, v47
v_pk_mul_f32 v[44:45], v[44:45], v[64:65]
v_pk_mul_f32 v[46:47], v[46:47], v[66:67]
v_cvt_pk_bf16_f32 v64, v44, v45
v_cvt_pk_bf16_f32 v65, v46, v47
v_pk_mul_f32 v[76:77], v[68:69], v[68:69]
v_pk_mul_f32 v[78:79], v[70:71], v[70:71]
v_pk_fma_f32 v[76:77], v[76:77], v[18:19], v[18:19] op_sel:[0,0,1] op_sel_hi:[1,0,1]
v_pk_fma_f32 v[78:79], v[78:79], v[18:19], v[18:19] op_sel:[0,0,1] op_sel_hi:[1,0,1]
v_pk_mul_f32 v[76:77], v[76:77], v[68:69]
v_pk_mul_f32 v[78:79], v[78:79], v[70:71]
v_exp_f32 v76, v76
v_exp_f32 v77, v77
v_exp_f32 v78, v78
v_exp_f32 v79, v79
v_pk_fma_f32 v[76:77], v[76:77], v[40:41], v[40:41] op_sel:[0,0,0] op_sel_hi:[1,0,0]
v_pk_fma_f32 v[78:79], v[78:79], v[40:41], v[40:41] op_sel:[0,0,0] op_sel_hi:[1,0,0]
v_rcp_f32 v76, v76
v_rcp_f32 v77, v77
v_rcp_f32 v78, v78
v_rcp_f32 v79, v79
v_pk_mul_f32 v[76:77], v[76:77], v[68:69]
v_pk_mul_f32 v[78:79], v[78:79], v[70:71]
v_cvt_pk_bf16_f32 v66, v76, v77
v_cvt_pk_bf16_f32 v67, v78, v79
s_lshl_b32 s60, s71, 8
v_xor_b32 v68, s60, v1
s_add_u32 s62, s72, 0
buffer_store_dwordx4 v[64:67], v68, s[4:7], s62 offen offset:2048 sc1
v_mov_b32 v127, 0
v_mov_b32 v121, v120
v_mov_b32 v125, v124
v_mov_b32 v76, v18
v_mfma_f32_16x16x32_bf16 v[80:83], v[108:111], v[120:123], v[80:83]
s_nop 0
v_permlane16_swap_b32 v18, v76
v_mfma_f32_16x16x32_bf16 v[84:87], v[108:111], v[124:127], v[84:87]
s_mov_b64 vcc, 0xffff
s_lshl_b64 vcc, vcc, 16
v_cndmask_b32 v108, 0, v16, vcc
v_cndmask_b32 v109, 0, v17, vcc
s_waitcnt vmcnt(8) lgkmcnt(5)
v_mfma_f32_16x16x32_bf16 v[80:83], v[144:147], v[128:131], v[80:83]
ds_read_b64_tr_b16 v[158:159], v14 offset:16128
v_mov_b32 v76, v19
v_mul_f32 v44, v72, v72
v_mul_f32 v45, v73, v73
v_mfma_f32_16x16x32_bf16 v[88:91], v[108:111], v[120:123], v[88:91]
v_permlane16_swap_b32 v19, v76
v_mfma_f32_16x16x32_bf16 v[92:95], v[108:111], v[124:127], v[92:95]
s_mov_b64 vcc, 0xffff
s_lshl_b64 vcc, vcc, 32
v_cndmask_b32 v108, 0, v16, vcc
v_cndmask_b32 v109, 0, v17, vcc
s_waitcnt vmcnt(7)
v_mfma_f32_16x16x32_bf16 v[84:87], v[144:147], v[132:135], v[84:87]
ds_read_b64_tr_b16 v[144:145], v13 offset:21504
v_mov_b32 v76, v40
v_mul_f32 v46, v74, v74
v_mul_f32 v47, v75, v75
v_mfma_f32_16x16x32_bf16 v[96:99], v[108:111], v[120:123], v[96:99]
v_permlane16_swap_b32 v40, v76
v_mfma_f32_16x16x32_bf16 v[100:103], v[108:111], v[124:127], v[100:103]
buffer_load_dwordx4 v[124:127], v23, s[4:7], s67 offen offset:2048 sc1
s_waitcnt lgkmcnt(5)
v_mfma_f32_16x16x32_bf16 v[88:91], v[148:151], v[128:131], v[88:91]
ds_read_b64_tr_b16 v[146:147], v13 offset:23296
v_fma_f32 v44, v44, v18, v19
v_fma_f32 v45, v45, v18, v19
v_mfma_f32_16x16x32_bf16 v[92:95], v[148:151], v[132:135], v[92:95]
ds_read_b64_tr_b16 v[148:149], v13 offset:21536
v_fma_f32 v46, v46, v18, v19
v_fma_f32 v47, v47, v18, v19
s_waitcnt lgkmcnt(5)
v_mfma_f32_16x16x32_bf16 v[96:99], v[152:155], v[128:131], v[96:99]
ds_read_b64_tr_b16 v[150:151], v13 offset:23328
v_mul_f32 v44, v44, v72
v_mul_f32 v45, v45, v73
v_mfma_f32_16x16x32_bf16 v[100:103], v[152:155], v[132:135], v[100:103]
ds_read_b64_tr_b16 v[152:153], v13 offset:21568
v_mul_f32 v46, v46, v74
v_mul_f32 v47, v47, v75
v_exp_f32 v44, v44
v_exp_f32 v45, v45
v_exp_f32 v46, v46
v_exp_f32 v47, v47
v_pk_fma_f32 v[44:45], v[44:45], v[40:41], v[40:41] op_sel:[0,0,0] op_sel_hi:[1,0,0]
v_pk_fma_f32 v[46:47], v[46:47], v[40:41], v[40:41] op_sel:[0,0,0] op_sel_hi:[1,0,0]
v_rcp_f32 v44, v44
v_rcp_f32 v45, v45
s_mov_b64 vcc, 0xffff
s_lshl_b64 vcc, vcc, 48
v_cndmask_b32 v108, 0, v16, vcc
v_cndmask_b32 v109, 0, v17, vcc
v_rcp_f32 v46, v46
s_nop 0
v_mfma_f32_16x16x32_bf16 v[104:107], v[108:111], v[120:123], v[104:107]
buffer_load_dwordx4 v[120:123], v23, s[4:7], s64 offen offset:2048 sc1
s_waitcnt lgkmcnt(5)
v_mfma_f32_16x16x32_bf16 v[104:107], v[156:159], v[128:131], v[104:107]
ds_read_b64_tr_b16 v[154:155], v13 offset:23360
ds_read_b64_tr_b16 v[156:157], v14 offset:21504
s_xor_b32 s64, s50, 438272
s_sub_u32 s64, s64, 114688
buffer_load_dwordx4 v[128:131], v23, s[4:7], s64 offen offset:0 sc1
s_waitcnt vmcnt(8) lgkmcnt(5)
v_mfma_f32_16x16x32_bf16 v[80:83], v[144:147], v[136:139], v[80:83]
ds_read_b64_tr_b16 v[158:159], v14 offset:23296
s_xor_b32 s67, s64, 256
buffer_load_dwordx4 v[132:135], v23, s[4:7], s67 offen offset:0 sc1
v_mfma_f32_16x16x32_bf16 v[84:87], v[144:147], v[140:143], v[84:87]
ds_read_b64_tr_b16 v[144:145], v13 offset:28672
v_rcp_f32 v47, v47
s_waitcnt lgkmcnt(5)
v_mfma_f32_16x16x32_bf16 v[88:91], v[148:151], v[136:139], v[88:91]
ds_read_b64_tr_b16 v[146:147], v13 offset:30464
v_mul_f32 v44, v44, v72
v_mul_f32 v45, v45, v73
v_mfma_f32_16x16x32_bf16 v[92:95], v[148:151], v[140:143], v[92:95]
ds_read_b64_tr_b16 v[148:149], v13 offset:28704
v_mul_f32 v46, v46, v74
v_mul_f32 v47, v47, v75
s_waitcnt lgkmcnt(5)
v_mfma_f32_16x16x32_bf16 v[96:99], v[152:155], v[136:139], v[96:99]
ds_read_b64_tr_b16 v[150:151], v13 offset:30496
v_cvt_pk_bf16_f32 v72, v44, v45
v_cvt_pk_bf16_f32 v73, v46, v47
v_mfma_f32_16x16x32_bf16 v[100:103], v[152:155], v[140:143], v[100:103]
ds_read_b64_tr_b16 v[152:153], v13 offset:28736
buffer_load_dwordx4 v[140:143], v23, s[4:7], s67 offen offset:2048 sc1
s_waitcnt lgkmcnt(5)
v_mfma_f32_16x16x32_bf16 v[104:107], v[156:159], v[136:139], v[104:107]
ds_read_b64_tr_b16 v[154:155], v13 offset:30528
ds_read_b64_tr_b16 v[156:157], v14 offset:28672
buffer_load_dwordx4 v[136:139], v23, s[4:7], s64 offen offset:2048 sc1
s_waitcnt vmcnt(10) lgkmcnt(5)
v_mfma_f32_16x16x32_bf16 v[80:83], v[144:147], v[112:115], v[80:83]
ds_read_b64_tr_b16 v[158:159], v14 offset:30464
v_mov_b32 v74, v72
v_mov_b32 v75, v73
s_waitcnt vmcnt(9)
v_mfma_f32_16x16x32_bf16 v[84:87], v[144:147], v[116:119], v[84:87]
ds_read_b64_tr_b16 v[144:145], v13 offset:35840
v_permlane16_swap_b32 v72, v74
s_waitcnt lgkmcnt(5)
v_mfma_f32_16x16x32_bf16 v[88:91], v[148:151], v[112:115], v[88:91]
ds_read_b64_tr_b16 v[146:147], v13 offset:37632
v_permlane16_swap_b32 v73, v75
s_lshl_b32 s60, s71, 8
v_xor_b32 v77, s60, v1
s_add_u32 s62, s73, 0
s_mov_b32 exec_lo, 0xffff
s_mov_b32 exec_hi, 0xffff
buffer_store_dwordx4 v[72:75], v77, s[4:7], s62 offen sc1
s_mov_b64 exec, -1
v_mfma_f32_16x16x32_bf16 v[92:95], v[148:151], v[116:119], v[92:95]
ds_read_b64_tr_b16 v[148:149], v13 offset:35872
s_waitcnt lgkmcnt(5)
v_mfma_f32_16x16x32_bf16 v[96:99], v[152:155], v[112:115], v[96:99]
ds_read_b64_tr_b16 v[150:151], v13 offset:37664
v_mfma_f32_16x16x32_bf16 v[100:103], v[152:155], v[116:119], v[100:103]
ds_read_b64_tr_b16 v[152:153], v13 offset:35904
pg_8:
s_cbranch_execz pg_back
s_waitcnt lgkmcnt(5)
v_mfma_f32_16x16x32_bf16 v[104:107], v[156:159], v[112:115], v[104:107]
ds_read_b64_tr_b16 v[154:155], v13 offset:37696
ds_read_b64_tr_b16 v[156:157], v14 offset:35840
s_xor_b32 s64, s50, 442368
s_sub_u32 s64, s64, 114688
buffer_load_dwordx4 v[112:115], v23, s[4:7], s64 offen offset:0 sc1
s_xor_b32 s67, s64, 256
buffer_load_dwordx4 v[116:119], v23, s[4:7], s67 offen offset:0 sc1
s_waitcnt vmcnt(7) lgkmcnt(5)
v_mfma_f32_16x16x32_bf16 v[80:83], v[144:147], v[120:123], v[80:83]
ds_read_b64_tr_b16 v[158:159], v14 offset:37632
v_mfma_f32_16x16x32_bf16 v[84:87], v[144:147], v[124:127], v[84:87]
ds_read_b64_tr_b16 v[144:145], v13 offset:43008
s_waitcnt lgkmcnt(5)
v_mfma_f32_16x16x32_bf16 v[88:91], v[148:151], v[120:123], v[88:91]
ds_read_b64_tr_b16 v[146:147], v13 offset:44800
v_mfma_f32_16x16x32_bf16 v[92:95], v[148:151], v[124:127], v[92:95]
ds_read_b64_tr_b16 v[148:149], v13 offset:43040
s_waitcnt lgkmcnt(5)
v_mfma_f32_16x16x32_bf16 v[96:99], v[152:155], v[120:123], v[96:99]
ds_read_b64_tr_b16 v[150:151], v13 offset:44832
v_mfma_f32_16x16x32_bf16 v[100:103], v[152:155], v[124:127], v[100:103]
ds_read_b64_tr_b16 v[152:153], v13 offset:43072
buffer_load_dwordx4 v[124:127], v23, s[4:7], s67 offen offset:2048 sc1
s_waitcnt lgkmcnt(5)
v_mfma_f32_16x16x32_bf16 v[104:107], v[156:159], v[120:123], v[104:107]
ds_read_b64_tr_b16 v[154:155], v13 offset:44864
ds_read_b64_tr_b16 v[156:157], v14 offset:43008
buffer_load_dwordx4 v[120:123], v23, s[4:7], s64 offen offset:2048 sc1
s_waitcnt vmcnt(8) lgkmcnt(5)
v_mfma_f32_16x16x32_bf16 v[80:83], v[144:147], v[128:131], v[80:83]
ds_read_b64_tr_b16 v[158:159], v14 offset:44800
s_waitcnt vmcnt(7)
v_mfma_f32_16x16x32_bf16 v[84:87], v[144:147], v[132:135], v[84:87]
ds_read_b64_tr_b16 v[144:145], v13 offset:50176
s_waitcnt lgkmcnt(5)
v_mfma_f32_16x16x32_bf16 v[88:91], v[148:151], v[128:131], v[88:91]
ds_read_b64_tr_b16 v[146:147], v13 offset:51968
v_mfma_f32_16x16x32_bf16 v[92:95], v[148:151], v[132:135], v[92:95]
ds_read_b64_tr_b16 v[148:149], v13 offset:50208
s_waitcnt lgkmcnt(5)
v_mfma_f32_16x16x32_bf16 v[96:99], v[152:155], v[128:131], v[96:99]
ds_read_b64_tr_b16 v[150:151], v13 offset:52000
v_mfma_f32_16x16x32_bf16 v[100:103], v[152:155], v[132:135], v[100:103]
ds_read_b64_tr_b16 v[152:153], v13 offset:50240
s_waitcnt lgkmcnt(5)
v_mfma_f32_16x16x32_bf16 v[104:107], v[156:159], v[128:131], v[104:107]
ds_read_b64_tr_b16 v[154:155], v13 offset:52032
ds_read_b64_tr_b16 v[156:157], v14 offset:50176
s_xor_b32 s64, s50, 446464
s_sub_u32 s64, s64, 114688
buffer_load_dwordx4 v[128:131], v23, s[4:7], s64 offen offset:0 sc1
s_waitcnt vmcnt(6) lgkmcnt(5)
v_mfma_f32_16x16x32_bf16 v[80:83], v[144:147], v[136:139], v[80:83]
ds_read_b64_tr_b16 v[158:159], v14 offset:51968
s_xor_b32 s67, s64, 256
buffer_load_dwordx4 v[132:135], v23, s[4:7], s67 offen offset:0 sc1
v_mfma_f32_16x16x32_bf16 v[84:87], v[144:147], v[140:143], v[84:87]
v_add_u32 v13, s65, v13
ds_read_b64_tr_b16 v[144:145], v13 offset:0
s_waitcnt lgkmcnt(5)
v_mfma_f32_16x16x32_bf16 v[88:91], v[148:151], v[136:139], v[88:91]
ds_read_b64_tr_b16 v[146:147], v13 offset:1792
v_mfma_f32_16x16x32_bf16 v[92:95], v[148:151], v[140:143], v[92:95]
ds_read_b64_tr_b16 v[148:149], v13 offset:32
s_waitcnt lgkmcnt(5)
v_mfma_f32_16x16x32_bf16 v[96:99], v[152:155], v[136:139], v[96:99]
ds_read_b64_tr_b16 v[150:151], v13 offset:1824
v_mfma_f32_16x16x32_bf16 v[100:103], v[152:155], v[140:143], v[100:103]
ds_read_b64_tr_b16 v[152:153], v13 offset:64
buffer_load_dwordx4 v[140:143], v23, s[4:7], s67 offen offset:2048 sc1
s_waitcnt lgkmcnt(5)
v_mfma_f32_16x16x32_bf16 v[104:107], v[156:159], v[136:139], v[104:107]
ds_read_b64_tr_b16 v[154:155], v13 offset:1856
v_add_u32 v14, s65, v14
ds_read_b64_tr_b16 v[156:157], v14 offset:0
buffer_load_dwordx4 v[136:139], v23, s[4:7], s64 offen offset:2048 sc1
v_mov_b32 v76, 3
s_waitcnt vmcnt(8)
s_mov_b64 exec, 1
buffer_store_dword v76, v1, s[4:7], s45 offen
s_mov_b64 exec, -1
s_waitcnt vmcnt(8) lgkmcnt(5)
v_mfma_f32_16x16x32_bf16 v[80:83], v[144:147], v[112:115], v[80:83]
ds_read_b64_tr_b16 v[158:159], v14 offset:1792
s_waitcnt vmcnt(7)
v_mfma_f32_16x16x32_bf16 v[84:87], v[144:147], v[116:119], v[84:87]
ds_read_b64_tr_b16 v[144:145], v13 offset:7168
s_waitcnt lgkmcnt(5)
v_mfma_f32_16x16x32_bf16 v[88:91], v[148:151], v[112:115], v[88:91]
ds_read_b64_tr_b16 v[146:147], v13 offset:8960
v_mfma_f32_16x16x32_bf16 v[92:95], v[148:151], v[116:119], v[92:95]
ds_read_b64_tr_b16 v[148:149], v13 offset:7200
s_waitcnt lgkmcnt(5)
v_mfma_f32_16x16x32_bf16 v[96:99], v[152:155], v[112:115], v[96:99]
ds_read_b64_tr_b16 v[150:151], v13 offset:8992
v_mfma_f32_16x16x32_bf16 v[100:103], v[152:155], v[116:119], v[100:103]
ds_read_b64_tr_b16 v[152:153], v13 offset:7232
s_waitcnt lgkmcnt(5)
v_mfma_f32_16x16x32_bf16 v[104:107], v[156:159], v[112:115], v[104:107]
ds_read_b64_tr_b16 v[154:155], v13 offset:9024
ds_read_b64_tr_b16 v[156:157], v14 offset:7168
s_xor_b32 s64, s50, 450560
s_sub_u32 s64, s64, 114688
buffer_load_dwordx4 v[112:115], v23, s[4:7], s64 offen offset:0 sc1
s_waitcnt vmcnt(6) lgkmcnt(5)
v_mfma_f32_16x16x32_bf16 v[80:83], v[144:147], v[120:123], v[80:83]
ds_read_b64_tr_b16 v[158:159], v14 offset:8960
s_xor_b32 s67, s64, 256
buffer_load_dwordx4 v[116:119], v23, s[4:7], s67 offen offset:0 sc1
v_mfma_f32_16x16x32_bf16 v[84:87], v[144:147], v[124:127], v[84:87]
ds_read_b64_tr_b16 v[144:145], v13 offset:14336
s_waitcnt lgkmcnt(5)
v_mfma_f32_16x16x32_bf16 v[88:91], v[148:151], v[120:123], v[88:91]
ds_read_b64_tr_b16 v[146:147], v13 offset:16128
v_mfma_f32_16x16x32_bf16 v[92:95], v[148:151], v[124:127], v[92:95]
ds_read_b64_tr_b16 v[148:149], v13 offset:14368
s_waitcnt lgkmcnt(5)
v_mfma_f32_16x16x32_bf16 v[96:99], v[152:155], v[120:123], v[96:99]
ds_read_b64_tr_b16 v[150:151], v13 offset:16160
v_mfma_f32_16x16x32_bf16 v[100:103], v[152:155], v[124:127], v[100:103]
ds_read_b64_tr_b16 v[152:153], v13 offset:14400
buffer_load_dwordx4 v[124:127], v23, s[4:7], s67 offen offset:2048 sc1
s_waitcnt lgkmcnt(5)
v_mfma_f32_16x16x32_bf16 v[104:107], v[156:159], v[120:123], v[104:107]
ds_read_b64_tr_b16 v[154:155], v13 offset:16192
ds_read_b64_tr_b16 v[156:157], v14 offset:14336
buffer_load_dwordx4 v[120:123], v23, s[4:7], s64 offen offset:2048 sc1
s_waitcnt vmcnt(8) lgkmcnt(5)
v_mfma_f32_16x16x32_bf16 v[80:83], v[144:147], v[128:131], v[80:83]
ds_read_b64_tr_b16 v[158:159], v14 offset:16128
s_waitcnt vmcnt(7)
v_mfma_f32_16x16x32_bf16 v[84:87], v[144:147], v[132:135], v[84:87]
ds_read_b64_tr_b16 v[144:145], v13 offset:21504
s_waitcnt lgkmcnt(5)
v_mfma_f32_16x16x32_bf16 v[88:91], v[148:151], v[128:131], v[88:91]
ds_read_b64_tr_b16 v[146:147], v13 offset:23296
v_mfma_f32_16x16x32_bf16 v[92:95], v[148:151], v[132:135], v[92:95]
ds_read_b64_tr_b16 v[148:149], v13 offset:21536
s_waitcnt lgkmcnt(5)
v_mfma_f32_16x16x32_bf16 v[96:99], v[152:155], v[128:131], v[96:99]
ds_read_b64_tr_b16 v[150:151], v13 offset:23328
v_mfma_f32_16x16x32_bf16 v[100:103], v[152:155], v[132:135], v[100:103]
ds_read_b64_tr_b16 v[152:153], v13 offset:21568
s_waitcnt lgkmcnt(5)
v_mfma_f32_16x16x32_bf16 v[104:107], v[156:159], v[128:131], v[104:107]
ds_read_b64_tr_b16 v[154:155], v13 offset:23360
ds_read_b64_tr_b16 v[156:157], v14 offset:21504
s_xor_b32 s64, s50, 454656
s_sub_u32 s64, s64, 114688
buffer_load_dwordx4 v[128:131], v23, s[4:7], s64 offen offset:0 sc1
s_waitcnt vmcnt(6) lgkmcnt(5)
v_mfma_f32_16x16x32_bf16 v[80:83], v[144:147], v[136:139], v[80:83]
ds_read_b64_tr_b16 v[158:159], v14 offset:23296
s_xor_b32 s67, s64, 256
buffer_load_dwordx4 v[132:135], v23, s[4:7], s67 offen offset:0 sc1
v_mfma_f32_16x16x32_bf16 v[84:87], v[144:147], v[140:143], v[84:87]
ds_read_b64_tr_b16 v[144:145], v13 offset:28672
s_waitcnt lgkmcnt(5)
v_mfma_f32_16x16x32_bf16 v[88:91], v[148:151], v[136:139], v[88:91]
ds_read_b64_tr_b16 v[146:147], v13 offset:30464
v_mfma_f32_16x16x32_bf16 v[92:95], v[148:151], v[140:143], v[92:95]
ds_read_b64_tr_b16 v[148:149], v13 offset:28704
s_waitcnt lgkmcnt(5)
v_mfma_f32_16x16x32_bf16 v[96:99], v[152:155], v[136:139], v[96:99]
ds_read_b64_tr_b16 v[150:151], v13 offset:30496
v_mfma_f32_16x16x32_bf16 v[100:103], v[152:155], v[140:143], v[100:103]
ds_read_b64_tr_b16 v[152:153], v13 offset:28736
buffer_load_dwordx4 v[140:143], v23, s[4:7], s67 offen offset:2048 sc1
s_waitcnt lgkmcnt(5)
v_mfma_f32_16x16x32_bf16 v[104:107], v[156:159], v[136:139], v[104:107]
ds_read_b64_tr_b16 v[154:155], v13 offset:30528
ds_read_b64_tr_b16 v[156:157], v14 offset:28672
buffer_load_dwordx4 v[136:139], v23, s[4:7], s64 offen offset:2048 sc1
s_waitcnt vmcnt(7) lgkmcnt(5)
v_mfma_f32_16x16x32_bf16 v[80:83], v[144:147], v[112:115], v[80:83]
ds_read_b64_tr_b16 v[158:159], v14 offset:30464
s_waitcnt vmcnt(6)
v_mfma_f32_16x16x32_bf16 v[84:87], v[144:147], v[116:119], v[84:87]
ds_read_b64_tr_b16 v[144:145], v13 offset:35840
s_waitcnt lgkmcnt(5)
v_mfma_f32_16x16x32_bf16 v[88:91], v[148:151], v[112:115], v[88:91]
ds_read_b64_tr_b16 v[146:147], v13 offset:37632
v_mfma_f32_16x16x32_bf16 v[92:95], v[148:151], v[116:119], v[92:95]
ds_read_b64_tr_b16 v[148:149], v13 offset:35872
s_waitcnt lgkmcnt(5)
v_mfma_f32_16x16x32_bf16 v[96:99], v[152:155], v[112:115], v[96:99]
ds_read_b64_tr_b16 v[150:151], v13 offset:37664
v_mfma_f32_16x16x32_bf16 v[100:103], v[152:155], v[116:119], v[100:103]
ds_read_b64_tr_b16 v[152:153], v13 offset:35904
s_waitcnt lgkmcnt(5)
v_mfma_f32_16x16x32_bf16 v[104:107], v[156:159], v[112:115], v[104:107]
ds_read_b64_tr_b16 v[154:155], v13 offset:37696
ds_read_b64_tr_b16 v[156:157], v14 offset:35840
s_waitcnt vmcnt(4) lgkmcnt(5)
v_mfma_f32_16x16x32_bf16 v[80:83], v[144:147], v[120:123], v[80:83]
ds_read_b64_tr_b16 v[158:159], v14 offset:37632
v_mfma_f32_16x16x32_bf16 v[84:87], v[144:147], v[124:127], v[84:87]
ds_read_b64_tr_b16 v[144:145], v13 offset:43008
s_waitcnt lgkmcnt(5)
v_mfma_f32_16x16x32_bf16 v[88:91], v[148:151], v[120:123], v[88:91]
ds_read_b64_tr_b16 v[146:147], v13 offset:44800
v_mfma_f32_16x16x32_bf16 v[92:95], v[148:151], v[124:127], v[92:95]
ds_read_b64_tr_b16 v[148:149], v13 offset:43040
s_waitcnt lgkmcnt(5)
v_mfma_f32_16x16x32_bf16 v[96:99], v[152:155], v[120:123], v[96:99]
ds_read_b64_tr_b16 v[150:151], v13 offset:44832
v_mfma_f32_16x16x32_bf16 v[100:103], v[152:155], v[124:127], v[100:103]
ds_read_b64_tr_b16 v[152:153], v13 offset:43072
s_waitcnt lgkmcnt(5)
v_mfma_f32_16x16x32_bf16 v[104:107], v[156:159], v[120:123], v[104:107]
ds_read_b64_tr_b16 v[154:155], v13 offset:44864
ds_read_b64_tr_b16 v[156:157], v14 offset:43008
s_waitcnt vmcnt(3) lgkmcnt(5)
v_mfma_f32_16x16x32_bf16 v[80:83], v[144:147], v[128:131], v[80:83]
ds_read_b64_tr_b16 v[158:159], v14 offset:44800
v_lshrrev_b32 v15, 2, v1
buffer_load_dword v15, v15, s[4:7], s37 offen sc1
s_waitcnt vmcnt(3)
v_mfma_f32_16x16x32_bf16 v[84:87], v[144:147], v[132:135], v[84:87]
ds_read_b64_tr_b16 v[144:145], v13 offset:50176
s_waitcnt lgkmcnt(5)
v_mfma_f32_16x16x32_bf16 v[88:91], v[148:151], v[128:131], v[88:91]
ds_read_b64_tr_b16 v[146:147], v13 offset:51968
v_mfma_f32_16x16x32_bf16 v[92:95], v[148:151], v[132:135], v[92:95]
ds_read_b64_tr_b16 v[148:149], v13 offset:50208
s_waitcnt lgkmcnt(5)
v_mfma_f32_16x16x32_bf16 v[96:99], v[152:155], v[128:131], v[96:99]
ds_read_b64_tr_b16 v[150:151], v13 offset:52000
v_mfma_f32_16x16x32_bf16 v[100:103], v[152:155], v[132:135], v[100:103]
ds_read_b64_tr_b16 v[152:153], v13 offset:50240
s_waitcnt lgkmcnt(5)
v_mfma_f32_16x16x32_bf16 v[104:107], v[156:159], v[128:131], v[104:107]
ds_read_b64_tr_b16 v[154:155], v13 offset:52032
ds_read_b64_tr_b16 v[156:157], v14 offset:50176
v_subrev_u32 v13, s65, v13
s_waitcnt vmcnt(1) lgkmcnt(5)
v_mfma_f32_16x16x32_bf16 v[80:83], v[144:147], v[136:139], v[80:83]
ds_read_b64_tr_b16 v[158:159], v14 offset:51968
v_subrev_u32 v14, s65, v14
v_mfma_f32_16x16x32_bf16 v[84:87], v[144:147], v[140:143], v[84:87]
s_waitcnt lgkmcnt(4)
v_mfma_f32_16x16x32_bf16 v[88:91], v[148:151], v[136:139], v[88:91]
v_mfma_f32_16x16x32_bf16 v[92:95], v[148:151], v[140:143], v[92:95]
s_nop 1
v_permlane16_swap_b32 v80, v84
v_permlane16_swap_b32 v81, v85
v_permlane16_swap_b32 v82, v86
v_permlane16_swap_b32 v83, v87
s_waitcnt lgkmcnt(2)
v_mfma_f32_16x16x32_bf16 v[96:99], v[152:155], v[136:139], v[96:99]
v_mul_f32 v44, v80, v80
v_mul_f32 v45, v81, v81
v_mul_f32 v46, v82, v82
v_mul_f32 v47, v83, v83
s_waitcnt vmcnt(0)
v_cmp_gt_u32 vcc, 3, v15
s_nop 0
s_and_b64 vcc, vcc, s[28:29]
s_cbranch_scc1 re_58
re_58b:
v_pk_fma_f32 v[44:45], v[44:45], v[20:21], v[20:21] op_sel:[0,0,1] op_sel_hi:[1,0,1]
v_pk_fma_f32 v[46:47], v[46:47], v[20:21], v[20:21] op_sel:[0,0,1] op_sel_hi:[1,0,1]
s_nop 0
v_mfma_f32_16x16x32_bf16 v[100:103], v[152:155], v[140:143], v[100:103]
s_add_u32 s67, s74, 0
buffer_load_dwordx4 v[112:115], v1, s[4:7], s67 offen offset:0 sc1
v_pk_mul_f32 v[44:45], v[44:45], v[80:81]
v_pk_mul_f32 v[46:47], v[46:47], v[82:83]
v_exp_f32 v44, v44
v_exp_f32 v45, v45
v_exp_f32 v46, v46
v_exp_f32 v47, v47
v_pk_fma_f32 v[44:45], v[44:45], v[40:41], v[40:41] op_sel:[0,1,1] op_sel_hi:[1,1,1]
v_pk_fma_f32 v[46:47], v[46:47], v[40:41], v[40:41] op_sel:[0,1,1] op_sel_hi:[1,1,1]
v_rcp_f32 v44, v44
v_rcp_f32 v45, v45
v_rcp_f32 v46, v46
v_rcp_f32 v47, v47
v_pk_mul_f32 v[44:45], v[44:45], v[80:81]
v_pk_mul_f32 v[46:47], v[46:47], v[82:83]
v_cvt_pk_bf16_f32 v80, v44, v45
v_cvt_pk_bf16_f32 v81, v46, v47
v_pk_mul_f32 v[108:109], v[84:85], v[84:85]
v_pk_mul_f32 v[110:111], v[86:87], v[86:87]
v_pk_fma_f32 v[108:109], v[108:109], v[20:21], v[20:21] op_sel:[0,0,1] op_sel_hi:[1,0,1]
v_pk_fma_f32 v[110:111], v[110:111], v[20:21], v[20:21] op_sel:[0,0,1] op_sel_hi:[1,0,1]
v_pk_mul_f32 v[108:109], v[108:109], v[84:85]
v_pk_mul_f32 v[110:111], v[110:111], v[86:87]
v_exp_f32 v108, v108
v_exp_f32 v109, v109
v_exp_f32 v110, v110
v_exp_f32 v111, v111
v_pk_fma_f32 v[108:109], v[108:109], v[40:41], v[40:41] op_sel:[0,1,1] op_sel_hi:[1,1,1]
v_pk_fma_f32 v[110:111], v[110:111], v[40:41], v[40:41] op_sel:[0,1,1] op_sel_hi:[1,1,1]
v_rcp_f32 v108, v108
v_rcp_f32 v109, v109
v_rcp_f32 v110, v110
v_rcp_f32 v111, v111
v_pk_mul_f32 v[108:109], v[108:109], v[84:85]
v_pk_mul_f32 v[110:111], v[110:111], v[86:87]
v_cvt_pk_bf16_f32 v82, v108, v109
v_cvt_pk_bf16_f32 v83, v110, v111
s_lshl_b32 s60, s71, 8
v_xor_b32 v84, s60, v1
s_add_u32 s62, s72, 114688
buffer_store_dwordx4 v[80:83], v84, s[4:7], s62 offen offset:0 sc1
v_permlane16_swap_b32 v88, v92
v_permlane16_swap_b32 v89, v93
v_permlane16_swap_b32 v90, v94
v_permlane16_swap_b32 v91, v95
v_pk_mul_f32 v[44:45], v[88:89], v[88:89]
v_pk_mul_f32 v[46:47], v[90:91], v[90:91]
v_pk_fma_f32 v[44:45], v[44:45], v[20:21], v[20:21] op_sel:[0,0,1] op_sel_hi:[1,0,1]
v_pk_fma_f32 v[46:47], v[46:47], v[20:21], v[20:21] op_sel:[0,0,1] op_sel_hi:[1,0,1]
v_pk_mul_f32 v[44:45], v[44:45], v[88:89]
v_pk_mul_f32 v[46:47], v[46:47], v[90:91]
v_exp_f32 v44, v44
v_exp_f32 v45, v45
v_exp_f32 v46, v46
v_exp_f32 v47, v47
s_waitcnt lgkmcnt(0)
v_mfma_f32_16x16x32_bf16 v[104:107], v[156:159], v[136:139], v[104:107]
buffer_load_dwordx4 v[116:119], v1, s[4:7], s67 offen offset:1024 sc1
v_fma_f32 v44, v44, v41, v41
v_fma_f32 v45, v45, v41, v41
v_pk_fma_f32 v[46:47], v[46:47], v[40:41], v[40:41] op_sel:[0,1,1] op_sel_hi:[1,1,1]
v_rcp_f32 v44, v44
v_rcp_f32 v45, v45
v_rcp_f32 v46, v46
v_rcp_f32 v47, v47
v_pk_mul_f32 v[44:45], v[44:45], v[88:89]
v_pk_mul_f32 v[46:47], v[46:47], v[90:91]
v_cvt_pk_bf16_f32 v88, v44, v45
v_cvt_pk_bf16_f32 v89, v46, v47
v_pk_mul_f32 v[108:109], v[92:93], v[92:93]
v_pk_mul_f32 v[110:111], v[94:95], v[94:95]
v_pk_fma_f32 v[108:109], v[108:109], v[20:21], v[20:21] op_sel:[0,0,1] op_sel_hi:[1,0,1]
v_pk_fma_f32 v[110:111], v[110:111], v[20:21], v[20:21] op_sel:[0,0,1] op_sel_hi:[1,0,1]
v_pk_mul_f32 v[108:109], v[108:109], v[92:93]
v_pk_mul_f32 v[110:111], v[110:111], v[94:95]
v_exp_f32 v108, v108
v_exp_f32 v109, v109
v_exp_f32 v110, v110
v_exp_f32 v111, v111
v_pk_fma_f32 v[108:109], v[108:109], v[40:41], v[40:41] op_sel:[0,1,1] op_sel_hi:[1,1,1]
v_pk_fma_f32 v[110:111], v[110:111], v[40:41], v[40:41] op_sel:[0,1,1] op_sel_hi:[1,1,1]
v_rcp_f32 v108, v108
v_rcp_f32 v109, v109
v_rcp_f32 v110, v110
v_rcp_f32 v111, v111
v_pk_mul_f32 v[108:109], v[108:109], v[92:93]
v_pk_mul_f32 v[110:111], v[110:111], v[94:95]
v_cvt_pk_bf16_f32 v90, v108, v109
v_cvt_pk_bf16_f32 v91, v110, v111
s_lshl_b32 s60, s71, 8
v_xor_b32 v92, s60, v1
s_add_u32 s62, s72, 114688
buffer_store_dwordx4 v[88:91], v92, s[4:7], s62 offen offset:1024 sc1
v_permlane16_swap_b32 v96, v100
v_permlane16_swap_b32 v97, v101
v_permlane16_swap_b32 v98, v102
v_permlane16_swap_b32 v99, v103
v_pk_mul_f32 v[44:45], v[96:97], v[96:97]
v_pk_mul_f32 v[46:47], v[98:99], v[98:99]
v_pk_fma_f32 v[44:45], v[44:45], v[20:21], v[20:21] op_sel:[0,0,1] op_sel_hi:[1,0,1]
v_pk_fma_f32 v[46:47], v[46:47], v[20:21], v[20:21] op_sel:[0,0,1] op_sel_hi:[1,0,1]
v_pk_mul_f32 v[44:45], v[44:45], v[96:97]
v_pk_mul_f32 v[46:47], v[46:47], v[98:99]
v_exp_f32 v44, v44
v_exp_f32 v45, v45
v_exp_f32 v46, v46
v_exp_f32 v47, v47
v_pk_fma_f32 v[44:45], v[44:45], v[40:41], v[40:41] op_sel:[0,1,1] op_sel_hi:[1,1,1]
v_pk_fma_f32 v[46:47], v[46:47], v[40:41], v[40:41] op_sel:[0,1,1] op_sel_hi:[1,1,1]
v_rcp_f32 v44, v44
v_rcp_f32 v45, v45
v_rcp_f32 v46, v46
v_rcp_f32 v47, v47
v_pk_mul_f32 v[44:45], v[44:45], v[96:97]
v_pk_mul_f32 v[46:47], v[46:47], v[98:99]
v_cvt_pk_bf16_f32 v96, v44, v45
v_cvt_pk_bf16_f32 v97, v46, v47
v_pk_mul_f32 v[108:109], v[100:101], v[100:101]
v_pk_mul_f32 v[110:111], v[102:103], v[102:103]
v_pk_fma_f32 v[108:109], v[108:109], v[20:21], v[20:21] op_sel:[0,0,1] op_sel_hi:[1,0,1]
v_pk_fma_f32 v[110:111], v[110:111], v[20:21], v[20:21] op_sel:[0,0,1] op_sel_hi:[1,0,1]
v_pk_mul_f32 v[108:109], v[108:109], v[100:101]
v_pk_mul_f32 v[110:111], v[110:111], v[102:103]
v_exp_f32 v108, v108
v_exp_f32 v109, v109
v_exp_f32 v110, v110
v_exp_f32 v111, v111
v_pk_fma_f32 v[108:109], v[108:109], v[40:41], v[40:41] op_sel:[0,1,1] op_sel_hi:[1,1,1]
v_pk_fma_f32 v[110:111], v[110:111], v[40:41], v[40:41] op_sel:[0,1,1] op_sel_hi:[1,1,1]
v_rcp_f32 v108, v108
v_rcp_f32 v109, v109
v_rcp_f32 v110, v110
v_rcp_f32 v111, v111
v_pk_mul_f32 v[108:109], v[108:109], v[100:101]
v_pk_mul_f32 v[110:111], v[110:111], v[102:103]
v_cvt_pk_bf16_f32 v98, v108, v109
v_cvt_pk_bf16_f32 v99, v110, v111
s_lshl_b32 s60, s71, 8
v_xor_b32 v100, s60, v1
s_add_u32 s62, s72, 114688
buffer_store_dwordx4 v[96:99], v100, s[4:7], s62 offen offset:2048 sc1
v_mov_b32 v108, v20
v_pk_mul_f32 v[44:45], v[104:105], v[104:105]
v_pk_mul_f32 v[46:47], v[106:107], v[106:107]
v_permlane16_swap_b32 v20, v108
v_mov_b32 v108, v21
buffer_load_dwordx4 v[120:123], v1, s[4:7], s67 offen offset:2048 sc1
s_nop 0
v_permlane16_swap_b32 v21, v108
v_mov_b32 v108, v41
v_pk_fma_f32 v[44:45], v[44:45], v[20:21], v[20:21] op_sel:[0,0,1] op_sel_hi:[1,0,1]
v_pk_fma_f32 v[46:47], v[46:47], v[20:21], v[20:21] op_sel:[0,0,1] op_sel_hi:[1,0,1]
v_permlane16_swap_b32 v41, v108
v_pk_mul_f32 v[44:45], v[44:45], v[104:105]
v_pk_mul_f32 v[46:47], v[46:47], v[106:107]
v_exp_f32 v44, v44
v_exp_f32 v45, v45
v_exp_f32 v46, v46
v_exp_f32 v47, v47
v_pk_fma_f32 v[44:45], v[44:45], v[40:41], v[40:41] op_sel:[0,1,1] op_sel_hi:[1,1,1]
v_pk_fma_f32 v[46:47], v[46:47], v[40:41], v[40:41] op_sel:[0,1,1] op_sel_hi:[1,1,1]
v_rcp_f32 v44, v44
v_rcp_f32 v45, v45
v_rcp_f32 v46, v46
v_rcp_f32 v47, v47
v_pk_mul_f32 v[44:45], v[44:45], v[104:105]
v_pk_mul_f32 v[46:47], v[46:47], v[106:107]
v_cvt_pk_bf16_f32 v104, v44, v45
v_cvt_pk_bf16_f32 v105, v46, v47
v_mov_b32 v106, v104
v_mov_b32 v107, v105
buffer_load_dwordx4 v[124:127], v1, s[4:7], s67 offen offset:3072 sc1
v_permlane16_swap_b32 v104, v106
v_permlane16_swap_b32 v105, v107
s_lshl_b32 s60, s71, 8
v_xor_b32 v109, s60, v1
s_add_u32 s62, s73, 114688
s_mov_b32 exec_lo, 0xffff
s_mov_b32 exec_hi, 0xffff
buffer_store_dwordx4 v[104:107], v109, s[4:7], s62 offen sc1
s_mov_b64 exec, -1
s_add_u32 s67, s0, 0
buffer_load_dwordx4 v[128:131], v1, s[4:7], s67 offen offset:0 sc1
buffer_load_dwordx4 v[132:135], v1, s[4:7], s67 offen offset:1024 sc1
s_waitcnt vmcnt(9)
v_mfma_f32_32x32x16_bf16 v[48:63], a[0:3], v[112:115], 0
buffer_load_dwordx4 v[136:139], v1, s[4:7], s67 offen offset:2048 sc1
v_mfma_f32_32x32x16_bf16 v[64:79], a[4:7], v[112:115], 0
buffer_load_dwordx4 v[140:143], v1, s[4:7], s67 offen offset:3072 sc1
s_waitcnt vmcnt(9)
v_mfma_f32_32x32x16_bf16 v[48:63], a[8:11], v[116:119], v[48:63]
v_mfma_f32_32x32x16_bf16 v[64:79], a[12:15], v[116:119], v[64:79]
s_add_u32 s67, s1, 0
buffer_load_dwordx4 v[144:147], v1, s[4:7], s67 offen offset:0 sc1
buffer_load_dwordx4 v[148:151], v1, s[4:7], s67 offen offset:1024 sc1
buffer_load_dwordx4 v[152:155], v1, s[4:7], s67 offen offset:2048 sc1
buffer_load_dwordx4 v[156:159], v1, s[4:7], s67 offen offset:3072 sc1
s_add_u32 s67, s82, 0
buffer_load_dwordx4 v[112:115], v1, s[4:7], s67 offen offset:0 sc1
s_waitcnt vmcnt(11)
v_mfma_f32_32x32x16_bf16 v[48:63], a[16:19], v[120:123], v[48:63]
buffer_load_dwordx4 v[116:119], v1, s[4:7], s67 offen offset:1024 sc1
v_mfma_f32_32x32x16_bf16 v[64:79], a[20:23], v[120:123], v[64:79]
buffer_load_dwordx4 v[120:123], v1, s[4:7], s67 offen offset:2048 sc1
s_waitcnt vmcnt(12)
v_mfma_f32_32x32x16_bf16 v[48:63], a[24:27], v[124:127], v[48:63]
v_mfma_f32_32x32x16_bf16 v[64:79], a[28:31], v[124:127], v[64:79]
buffer_load_dwordx4 v[124:127], v1, s[4:7], s67 offen offset:3072 sc1
v_mov_b32 v108, 4
s_waitcnt vmcnt(12)
s_mov_b64 exec, 1
buffer_store_dword v108, v1, s[4:7], s45 offen
s_mov_b64 exec, -1
s_waitcnt vmcnt(12)
v_mfma_f32_32x32x16_bf16 v[48:63], a[32:35], v[128:131], v[48:63]
v_mfma_f32_32x32x16_bf16 v[64:79], a[36:39], v[128:131], v[64:79]
s_add_u32 s67, s83, 0
buffer_load_dwordx4 v[128:131], v1, s[4:7], s67 offen offset:0 sc1
s_waitcnt vmcnt(12)
v_mfma_f32_32x32x16_bf16 v[48:63], a[40:43], v[132:135], v[48:63]
v_mfma_f32_32x32x16_bf16 v[64:79], a[44:47], v[132:135], v[64:79]
buffer_load_dwordx4 v[132:135], v1, s[4:7], s67 offen offset:1024 sc1
s_waitcnt vmcnt(12)
v_mfma_f32_32x32x16_bf16 v[48:63], a[48:51], v[136:139], v[48:63]
v_mfma_f32_32x32x16_bf16 v[64:79], a[52:55], v[136:139], v[64:79]
buffer_load_dwordx4 v[136:139], v1, s[4:7], s67 offen offset:2048 sc1
s_waitcnt vmcnt(12)
v_mfma_f32_32x32x16_bf16 v[48:63], a[56:59], v[140:143], v[48:63]
v_mfma_f32_32x32x16_bf16 v[64:79], a[60:63], v[140:143], v[64:79]
buffer_load_dwordx4 v[140:143], v1, s[4:7], s67 offen offset:3072 sc1
s_waitcnt vmcnt(12)
v_mfma_f32_32x32x16_bf16 v[48:63], a[64:67], v[144:147], v[48:63]
v_mfma_f32_32x32x16_bf16 v[64:79], a[68:71], v[144:147], v[64:79]
s_add_u32 s67, s44, 0
buffer_load_dwordx4 v[144:147], v1, s[4:7], s67 offen offset:0 sc1
s_waitcnt vmcnt(12)
v_mfma_f32_32x32x16_bf16 v[48:63], a[72:75], v[148:151], v[48:63]
v_mfma_f32_32x32x16_bf16 v[64:79], a[76:79], v[148:151], v[64:79]
buffer_load_dwordx4 v[148:151], v1, s[4:7], s67 offen offset:1024 sc1
s_waitcnt vmcnt(12)
v_mfma_f32_32x32x16_bf16 v[48:63], a[80:83], v[152:155], v[48:63]
v_mfma_f32_32x32x16_bf16 v[64:79], a[84:87], v[152:155], v[64:79]
buffer_load_dwordx4 v[152:155], v1, s[4:7], s67 offen offset:2048 sc1
s_waitcnt vmcnt(12)
v_mfma_f32_32x32x16_bf16 v[48:63], a[88:91], v[156:159], v[48:63]
v_mfma_f32_32x32x16_bf16 v[64:79], a[92:95], v[156:159], v[64:79]
buffer_load_dwordx4 v[156:159], v1, s[4:7], s67 offen offset:3072 sc1
s_waitcnt vmcnt(12)
v_mfma_f32_32x32x16_bf16 v[48:63], a[96:99], v[112:115], v[48:63]
v_mfma_f32_32x32x16_bf16 v[64:79], a[100:103], v[112:115], v[64:79]
s_add_u32 s67, s100, 0
buffer_load_dwordx4 v[112:115], v1, s[4:7], s67 offen offset:0 sc1
s_waitcnt vmcnt(12)
v_mfma_f32_32x32x16_bf16 v[48:63], a[104:107], v[116:119], v[48:63]
v_mfma_f32_32x32x16_bf16 v[64:79], a[108:111], v[116:119], v[64:79]
buffer_load_dwordx4 v[116:119], v1, s[4:7], s67 offen offset:1024 sc1
s_waitcnt vmcnt(12)
v_mfma_f32_32x32x16_bf16 v[48:63], a[112:115], v[120:123], v[48:63]
v_mfma_f32_32x32x16_bf16 v[64:79], a[116:119], v[120:123], v[64:79]
buffer_load_dwordx4 v[120:123], v1, s[4:7], s67 offen offset:2048 sc1
s_waitcnt vmcnt(12)
v_mfma_f32_32x32x16_bf16 v[48:63], a[120:123], v[124:127], v[48:63]
v_mfma_f32_32x32x16_bf16 v[64:79], a[124:127], v[124:127], v[64:79]
buffer_load_dwordx4 v[124:127], v1, s[4:7], s67 offen offset:3072 sc1
s_waitcnt vmcnt(11)
v_mfma_f32_32x32x16_bf16 v[48:63], a[128:131], v[128:131], v[48:63]
v_mfma_f32_32x32x16_bf16 v[64:79], a[132:135], v[128:131], v[64:79]
s_waitcnt vmcnt(10)
v_mfma_f32_32x32x16_bf16 v[48:63], a[136:139], v[132:135], v[48:63]
v_mfma_f32_32x32x16_bf16 v[64:79], a[140:143], v[132:135], v[64:79]
s_waitcnt vmcnt(9)
v_mfma_f32_32x32x16_bf16 v[48:63], a[144:147], v[136:139], v[48:63]
v_mfma_f32_32x32x16_bf16 v[64:79], a[148:151], v[136:139], v[64:79]
s_waitcnt vmcnt(8)
v_mfma_f32_32x32x16_bf16 v[48:63], a[152:155], v[140:143], v[48:63]
v_mfma_f32_32x32x16_bf16 v[64:79], a[156:159], v[140:143], v[64:79]
v_lshrrev_b32 v15, 2, v1
buffer_load_dword v15, v15, s[4:7], s37 offen sc1
s_waitcnt vmcnt(8)
v_mfma_f32_32x32x16_bf16 v[48:63], a[160:163], v[144:147], v[48:63]
s_waitcnt vmcnt(7)
v_mfma_f32_32x32x16_bf16 v[48:63], a[168:171], v[148:151], v[48:63]
s_waitcnt vmcnt(6)
v_mfma_f32_32x32x16_bf16 v[48:63], a[176:179], v[152:155], v[48:63]
s_waitcnt vmcnt(5)
v_mfma_f32_32x32x16_bf16 v[48:63], a[184:187], v[156:159], v[48:63]
v_mfma_f32_32x32x16_bf16 v[64:79], a[164:167], v[144:147], v[64:79]
s_waitcnt vmcnt(4)
v_mfma_f32_32x32x16_bf16 v[48:63], a[192:195], v[112:115], v[48:63]
v_mfma_f32_32x32x16_bf16 v[64:79], a[172:175], v[148:151], v[64:79]
s_waitcnt vmcnt(3)
v_mfma_f32_32x32x16_bf16 v[48:63], a[200:203], v[116:119], v[48:63]
v_mfma_f32_32x32x16_bf16 v[64:79], a[180:183], v[152:155], v[64:79]
v_mfma_f32_32x32x16_bf16 v[64:79], a[188:191], v[156:159], v[64:79]
s_waitcnt vmcnt(2)
v_mfma_f32_32x32x16_bf16 v[48:63], a[208:211], v[120:123], v[48:63]
v_mfma_f32_32x32x16_bf16 v[64:79], a[196:199], v[112:115], v[64:79]
s_waitcnt vmcnt(0)
v_cmp_gt_u32 vcc, 4, v15
s_nop 0
s_and_b64 vcc, vcc, s[28:29]
s_cbranch_scc1 re_59
re_59b:
s_add_u32 s67, s74, 114688
buffer_load_dwordx4 v[128:131], v1, s[4:7], s67 offen offset:0 sc1
buffer_load_dwordx4 v[132:135], v1, s[4:7], s67 offen offset:1024 sc1
v_mfma_f32_32x32x16_bf16 v[48:63], a[216:219], v[124:127], v[48:63]
buffer_load_dwordx4 v[136:139], v1, s[4:7], s67 offen offset:2048 sc1
v_mfma_f32_32x32x16_bf16 v[64:79], a[204:207], v[116:119], v[64:79]
buffer_load_dwordx4 v[140:143], v1, s[4:7], s67 offen offset:3072 sc1
s_nop 3
ds_write_b128 v10, v[48:51] offset:0
s_add_u32 s67, s0, 114688
buffer_load_dwordx4 v[144:147], v1, s[4:7], s67 offen offset:0 sc1
v_mfma_f32_32x32x16_bf16 v[64:79], a[212:215], v[120:123], v[64:79]
ds_write_b128 v11, v[52:55] offset:1024
buffer_load_dwordx4 v[148:151], v1, s[4:7], s67 offen offset:1024 sc1
v_mfma_f32_32x32x16_bf16 v[64:79], a[220:223], v[124:127], v[64:79]
ds_write_b128 v10, v[56:59] offset:2048
ds_write_b128 v11, v[60:63] offset:3072
buffer_load_dwordx4 v[152:155], v1, s[4:7], s67 offen offset:2048 sc1
s_nop 8
ds_write_b128 v10, v[64:67] offset:16384
buffer_load_dwordx4 v[156:159], v1, s[4:7], s67 offen offset:3072 sc1
ds_write_b128 v11, v[68:71] offset:17408
s_waitcnt lgkmcnt(2)
s_barrier
s_add_u32 s67, s1, 114688
buffer_load_dwordx4 v[112:115], v1, s[4:7], s67 offen offset:0 sc1
ds_read_b128 v[48:51], v12 offset:0
ds_read_b128 v[52:55], v12 offset:4096
ds_read_b128 v[56:59], v12 offset:8192
ds_read_b128 v[60:63], v12 offset:12288
ds_write_b128 v10, v[72:75] offset:18432
buffer_load_dwordx4 v[116:119], v1, s[4:7], s67 offen offset:1024 sc1
ds_write_b128 v11, v[76:79] offset:19456
s_waitcnt lgkmcnt(4)
v_pk_add_f32 v[48:49], v[48:49], v[52:53]
buffer_load_dwordx4 v[120:123], v1, s[4:7], s67 offen offset:2048 sc1
v_pk_add_f32 v[50:51], v[50:51], v[54:55]
s_waitcnt lgkmcnt(2)
v_pk_add_f32 v[56:57], v[56:57], v[60:61]
v_pk_add_f32 v[58:59], v[58:59], v[62:63]
v_pk_add_f32 v[24:25], v[24:25], v[48:49]
v_pk_add_f32 v[26:27], v[26:27], v[50:51]
v_pk_add_f32 v[24:25], v[24:25], v[56:57]
s_waitcnt vmcnt(10)
v_mfma_f32_32x32x16_bf16 v[80:95], a[0:3], v[128:131], 0
buffer_load_dwordx4 v[124:127], v1, s[4:7], s67 offen offset:3072 sc1
v_add_f32 v26, v26, v58
v_add_f32 v27, v27, v59
v_mfma_f32_32x32x16_bf16 v[96:111], a[4:7], v[128:131], 0
pg_9:
s_cbranch_execz pg_back
v_bfe_u32 v52, v1, 4, 3
v_lshlrev_b32 v52, 10, v52
v_lshrrev_b32 v53, 7, v1
s_add_u32 s67, s82, 114688
buffer_load_dwordx4 v[128:131], v1, s[4:7], s67 offen offset:0 sc1
s_waitcnt vmcnt(11)
v_mfma_f32_32x32x16_bf16 v[80:95], a[8:11], v[132:135], v[80:95]
v_lshl_add_u32 v52, v53, 4, v52
v_cvt_pk_bf16_f32 v48, v24, v25
v_cvt_pk_bf16_f32 v49, v26, v27
s_waitcnt lgkmcnt(0)
s_barrier
v_mfma_f32_32x32x16_bf16 v[96:111], a[12:15], v[132:135], v[96:111]
ds_read_b128 v[64:67], v12 offset:16384
buffer_load_dwordx4 v[132:135], v1, s[4:7], s67 offen offset:1024 sc1
s_waitcnt vmcnt(11)
v_mfma_f32_32x32x16_bf16 v[80:95], a[16:19], v[136:139], v[80:95]
ds_read_b128 v[68:71], v12 offset:20480
ds_read_b128 v[72:75], v12 offset:24576
ds_read_b128 v[76:79], v12 offset:28672
v_mfma_f32_32x32x16_bf16 v[96:111], a[20:23], v[136:139], v[96:111]
buffer_load_dwordx4 v[136:139], v1, s[4:7], s67 offen offset:2048 sc1
s_waitcnt vmcnt(11)
v_mfma_f32_32x32x16_bf16 v[80:95], a[24:27], v[140:143], v[80:95]
s_waitcnt lgkmcnt(2)
v_add_f32 v64, v64, v68
v_add_f32 v65, v65, v69
v_add_f32 v66, v66, v70
v_add_f32 v67, v67, v71
v_mfma_f32_32x32x16_bf16 v[96:111], a[28:31], v[140:143], v[96:111]
buffer_load_dwordx4 v[140:143], v1, s[4:7], s67 offen offset:3072 sc1
s_waitcnt lgkmcnt(0)
v_add_f32 v72, v72, v76
v_add_f32 v73, v73, v77
s_waitcnt vmcnt(11)
v_mfma_f32_32x32x16_bf16 v[80:95], a[32:35], v[144:147], v[80:95]
v_add_f32 v74, v74, v78
v_add_f32 v75, v75, v79
v_add_f32 v28, v28, v64
v_add_f32 v29, v29, v65
v_add_f32 v30, v30, v66
v_add_f32 v31, v31, v67
v_mfma_f32_32x32x16_bf16 v[96:111], a[36:39], v[144:147], v[96:111]
s_add_u32 s67, s83, 114688
buffer_load_dwordx4 v[144:147], v1, s[4:7], s67 offen offset:0 sc1
v_add_f32 v28, v28, v72
v_add_f32 v29, v29, v73
s_waitcnt vmcnt(11)
v_mfma_f32_32x32x16_bf16 v[80:95], a[40:43], v[148:151], v[80:95]
v_add_f32 v30, v30, v74
v_add_f32 v31, v31, v75
v_cvt_pk_bf16_f32 v50, v28, v29
v_cvt_pk_bf16_f32 v51, v30, v31
s_add_u32 s62, s35, 0
buffer_store_dwordx4 v[48:51], v52, s[8:11], s62 offen nt
v_mfma_f32_32x32x16_bf16 v[96:111], a[44:47], v[148:151], v[96:111]
s_waitcnt vmcnt(11)
v_mfma_f32_32x32x16_bf16 v[80:95], a[48:51], v[152:155], v[80:95]
buffer_load_dwordx4 v[148:151], v1, s[4:7], s67 offen offset:1024 sc1
v_mfma_f32_32x32x16_bf16 v[96:111], a[52:55], v[152:155], v[96:111]
s_waitcnt vmcnt(11)
v_mfma_f32_32x32x16_bf16 v[80:95], a[56:59], v[156:159], v[80:95]
buffer_load_dwordx4 v[152:155], v1, s[4:7], s67 offen offset:2048 sc1
v_mfma_f32_32x32x16_bf16 v[96:111], a[60:63], v[156:159], v[96:111]
s_waitcnt vmcnt(11)
v_mfma_f32_32x32x16_bf16 v[80:95], a[64:67], v[112:115], v[80:95]
buffer_load_dwordx4 v[156:159], v1, s[4:7], s67 offen offset:3072 sc1
v_mfma_f32_32x32x16_bf16 v[96:111], a[68:71], v[112:115], v[96:111]
s_waitcnt vmcnt(11)
v_mfma_f32_32x32x16_bf16 v[80:95], a[72:75], v[116:119], v[80:95]
s_add_u32 s67, s44, 114688
buffer_load_dwordx4 v[112:115], v1, s[4:7], s67 offen offset:0 sc1
v_mfma_f32_32x32x16_bf16 v[96:111], a[76:79], v[116:119], v[96:111]
s_waitcnt vmcnt(11)
v_mfma_f32_32x32x16_bf16 v[80:95], a[80:83], v[120:123], v[80:95]
buffer_load_dwordx4 v[116:119], v1, s[4:7], s67 offen offset:1024 sc1
v_mfma_f32_32x32x16_bf16 v[96:111], a[84:87], v[120:123], v[96:111]
s_waitcnt vmcnt(11)
v_mfma_f32_32x32x16_bf16 v[80:95], a[88:91], v[124:127], v[80:95]
buffer_load_dwordx4 v[120:123], v1, s[4:7], s67 offen offset:2048 sc1
v_mfma_f32_32x32x16_bf16 v[96:111], a[92:95], v[124:127], v[96:111]
s_waitcnt vmcnt(11)
v_mfma_f32_32x32x16_bf16 v[80:95], a[96:99], v[128:131], v[80:95]
buffer_load_dwordx4 v[124:127], v1, s[4:7], s67 offen offset:3072 sc1
v_mfma_f32_32x32x16_bf16 v[96:111], a[100:103], v[128:131], v[96:111]
s_waitcnt vmcnt(11)
v_mfma_f32_32x32x16_bf16 v[80:95], a[104:107], v[132:135], v[80:95]
s_add_u32 s67, s100, 114688
buffer_load_dwordx4 v[128:131], v1, s[4:7], s67 offen offset:0 sc1
v_mfma_f32_32x32x16_bf16 v[96:111], a[108:111], v[132:135], v[96:111]
s_waitcnt vmcnt(11)
v_mfma_f32_32x32x16_bf16 v[80:95], a[112:115], v[136:139], v[80:95]
buffer_load_dwordx4 v[132:135], v1, s[4:7], s67 offen offset:1024 sc1
v_mfma_f32_32x32x16_bf16 v[96:111], a[116:119], v[136:139], v[96:111]
s_waitcnt vmcnt(11)
v_mfma_f32_32x32x16_bf16 v[80:95], a[120:123], v[140:143], v[80:95]
buffer_load_dwordx4 v[136:139], v1, s[4:7], s67 offen offset:2048 sc1
v_mfma_f32_32x32x16_bf16 v[96:111], a[124:127], v[140:143], v[96:111]
s_waitcnt vmcnt(11)
v_mfma_f32_32x32x16_bf16 v[80:95], a[128:131], v[144:147], v[80:95]
buffer_load_dwordx4 v[140:143], v1, s[4:7], s67 offen offset:3072 sc1
v_mfma_f32_32x32x16_bf16 v[96:111], a[132:135], v[144:147], v[96:111]
s_waitcnt vmcnt(10)
v_mfma_f32_32x32x16_bf16 v[80:95], a[136:139], v[148:151], v[80:95]
v_mfma_f32_32x32x16_bf16 v[96:111], a[140:143], v[148:151], v[96:111]
s_waitcnt vmcnt(9)
v_mfma_f32_32x32x16_bf16 v[80:95], a[144:147], v[152:155], v[80:95]
v_mfma_f32_32x32x16_bf16 v[96:111], a[148:151], v[152:155], v[96:111]
s_waitcnt vmcnt(8)
v_mfma_f32_32x32x16_bf16 v[80:95], a[152:155], v[156:159], v[80:95]
v_mfma_f32_32x32x16_bf16 v[96:111], a[156:159], v[156:159], v[96:111]
s_waitcnt vmcnt(7)
v_mfma_f32_32x32x16_bf16 v[80:95], a[160:163], v[112:115], v[80:95]
v_mfma_f32_32x32x16_bf16 v[96:111], a[164:167], v[112:115], v[96:111]
s_waitcnt vmcnt(6)
v_mfma_f32_32x32x16_bf16 v[80:95], a[168:171], v[116:119], v[80:95]
v_mfma_f32_32x32x16_bf16 v[96:111], a[172:175], v[116:119], v[96:111]
s_waitcnt vmcnt(5)
v_mfma_f32_32x32x16_bf16 v[80:95], a[176:179], v[120:123], v[80:95]
v_mfma_f32_32x32x16_bf16 v[96:111], a[180:183], v[120:123], v[96:111]
s_waitcnt vmcnt(4)
v_mfma_f32_32x32x16_bf16 v[80:95], a[184:187], v[124:127], v[80:95]
v_mfma_f32_32x32x16_bf16 v[96:111], a[188:191], v[124:127], v[96:111]
s_waitcnt vmcnt(3)
v_mfma_f32_32x32x16_bf16 v[80:95], a[192:195], v[128:131], v[80:95]
v_mfma_f32_32x32x16_bf16 v[96:111], a[196:199], v[128:131], v[96:111]
s_waitcnt vmcnt(2)
v_mfma_f32_32x32x16_bf16 v[80:95], a[200:203], v[132:135], v[80:95]
v_mfma_f32_32x32x16_bf16 v[96:111], a[204:207], v[132:135], v[96:111]
s_waitcnt vmcnt(1)
v_mfma_f32_32x32x16_bf16 v[80:95], a[208:211], v[136:139], v[80:95]
v_mfma_f32_32x32x16_bf16 v[96:111], a[212:215], v[136:139], v[96:111]
s_waitcnt vmcnt(0)
v_mfma_f32_32x32x16_bf16 v[80:95], a[216:219], v[140:143], v[80:95]
v_mfma_f32_32x32x16_bf16 v[96:111], a[220:223], v[140:143], v[96:111]
s_nop 4
ds_write_b128 v10, v[80:83] offset:0
ds_write_b128 v11, v[84:87] offset:1024
ds_write_b128 v10, v[88:91] offset:2048
ds_write_b128 v11, v[92:95] offset:3072
s_waitcnt lgkmcnt(0)
s_barrier
s_nop 0
ds_write_b128 v10, v[96:99] offset:16384
ds_write_b128 v11, v[100:103] offset:17408
ds_read_b128 v[80:83], v12 offset:0
ds_read_b128 v[84:87], v12 offset:4096
ds_read_b128 v[88:91], v12 offset:8192
ds_read_b128 v[92:95], v12 offset:12288
ds_write_b128 v10, v[104:107] offset:18432
ds_write_b128 v11, v[108:111] offset:19456
s_waitcnt lgkmcnt(4)
v_pk_add_f32 v[80:81], v[80:81], v[84:85]
v_pk_add_f32 v[82:83], v[82:83], v[86:87]
s_waitcnt lgkmcnt(2)
v_pk_add_f32 v[88:89], v[88:89], v[92:93]
v_pk_add_f32 v[90:91], v[90:91], v[94:95]
v_pk_add_f32 v[32:33], v[32:33], v[80:81]
v_pk_add_f32 v[34:35], v[34:35], v[82:83]
v_pk_add_f32 v[32:33], v[32:33], v[88:89]
v_pk_add_f32 v[34:35], v[34:35], v[90:91]
s_waitcnt lgkmcnt(0)
s_barrier
ds_read_b128 v[96:99], v12 offset:16384
ds_read_b128 v[100:103], v12 offset:20480
ds_read_b128 v[104:107], v12 offset:24576
ds_read_b128 v[108:111], v12 offset:28672
v_bfe_u32 v84, v1, 4, 3
v_lshlrev_b32 v84, 10, v84
v_lshrrev_b32 v85, 7, v1
v_lshl_add_u32 v84, v85, 4, v84
v_cvt_pk_bf16_f32 v80, v32, v33
v_cvt_pk_bf16_f32 v81, v34, v35
s_waitcnt lgkmcnt(2)
v_pk_add_f32 v[96:97], v[96:97], v[100:101]
v_pk_add_f32 v[98:99], v[98:99], v[102:103]
v_pk_add_f32 v[36:37], v[36:37], v[96:97]
v_pk_add_f32 v[38:39], v[38:39], v[98:99]
s_waitcnt lgkmcnt(0)
v_pk_add_f32 v[104:105], v[104:105], v[108:109]
v_pk_add_f32 v[106:107], v[106:107], v[110:111]
v_pk_add_f32 v[36:37], v[36:37], v[104:105]
v_pk_add_f32 v[38:39], v[38:39], v[106:107]
v_cvt_pk_bf16_f32 v82, v36, v37
v_cvt_pk_bf16_f32 v83, v38, v39
s_add_u32 s62, s35, 1048576
buffer_store_dwordx4 v[80:83], v84, s[8:11], s62 offen nt
fast_end_2:
s_endpgm
slow_3:
s_waitcnt vmcnt(0) lgkmcnt(0)
s_nop 7
s_nop 7
v_mov_b32 v152, -1
v_mov_b32 v153, -1
v_mov_b32 v154, -1
v_mov_b32 v155, -1
v_lshlrev_b32 v46, 3, v1
s_mov_b64 exec, 0x3f
buffer_load_dword v47, v46, s[4:7], s75 offen sc1
s_mov_b64 exec, -1
v_lshlrev_b32 v24, 16, v28
v_and_b32 v25, s36, v28
v_pk_mul_f32 v[150:151], v[24:25], v[24:25]
v_lshlrev_b32 v26, 16, v29
v_and_b32 v27, s36, v29
v_pk_add_f32 v[148:149], v[24:25], v[26:27]
v_pk_fma_f32 v[150:151], v[26:27], v[26:27], v[150:151] op_sel:[0,0,0] op_sel_hi:[1,1,1]
v_lshlrev_b32 v28, 16, v30
v_and_b32 v29, s36, v30
v_pk_add_f32 v[148:149], v[148:149], v[28:29]
v_pk_fma_f32 v[150:151], v[28:29], v[28:29], v[150:151] op_sel:[0,0,0] op_sel_hi:[1,1,1]
v_lshlrev_b32 v30, 16, v31
v_and_b32 v31, s36, v31
v_pk_add_f32 v[148:149], v[148:149], v[30:31]
v_pk_fma_f32 v[150:151], v[30:31], v[30:31], v[150:151] op_sel:[0,0,0] op_sel_hi:[1,1,1]
v_add_f32 v148, v148, v149
v_add_f32 v150, v150, v151
v_lshlrev_b32 v32, 16, v36
v_and_b32 v33, s36, v36
v_permlane32_swap_b32 v148, v150
v_add_f32 v148, v148, v150
v_mov_b32 v150, v148
v_lshlrev_b32 v34, 16, v37
v_and_b32 v35, s36, v37
v_permlane16_swap_b32 v148, v150
v_add_f32 v148, v148, v150
v_lshlrev_b32 v36, 16, v38
v_and_b32 v37, s36, v38
v_add_f32_dpp v148, v148, v148 row_ror:8 row_mask:0xf bank_mask:0xf
v_lshlrev_b32 v38, 16, v39
v_and_b32 v39, s36, v39
s_lshl_b32 s60, s12, 12
s_add_u32 s60, s60, 131072
v_add_u32 v20, s60, v1
s_add_u32 s60, s46, 131072
v_add_u32 v21, s60, v1
v_pk_add_f32 v[156:157], v[32:33], v[34:35]
v_pk_mul_f32 v[158:159], v[32:33], v[32:33]
v_pk_fma_f32 v[158:159], v[34:35], v[34:35], v[158:159] op_sel:[0,0,0] op_sel_hi:[1,1,1]
v_pk_add_f32 v[156:157], v[156:157], v[36:37]
v_pk_fma_f32 v[158:159], v[36:37], v[36:37], v[158:159] op_sel:[0,0,0] op_sel_hi:[1,1,1]
v_pk_add_f32 v[156:157], v[156:157], v[38:39]
v_pk_fma_f32 v[158:159], v[38:39], v[38:39], v[158:159] op_sel:[0,0,0] op_sel_hi:[1,1,1]
v_add_f32 v156, v156, v157
v_add_f32 v158, v158, v159
s_and_b32 s76, s77, 63
s_mul_i32 s76, s76, 7168
s_add_u32 s76, s76, s15
v_permlane32_swap_b32 v156, v158
v_add_f32 v156, v156, v158
v_mov_b32 v158, v156
s_barrier
s_nop 0
v_permlane16_swap_b32 v156, v158
v_add_f32 v156, v156, v158
ds_read_b64_tr_b16 v[160:161], v41 offset:0
ds_read_b64_tr_b16 v[162:163], v41 offset:256
v_add_f32_dpp v156, v156, v156 row_ror:8 row_mask:0xf bank_mask:0xf
ds_read_b64_tr_b16 v[164:165], v41 offset:4096
ds_read_b64_tr_b16 v[166:167], v41 offset:4352
ds_read_b64_tr_b16 v[168:169], v41 offset:8192
ds_read_b64_tr_b16 v[170:171], v41 offset:8448
ds_read_b64_tr_b16 v[172:173], v41 offset:12288
ds_read_b64_tr_b16 v[174:175], v41 offset:12544
ds_read_b64_tr_b16 v[176:177], v41 offset:16384
ds_read_b64_tr_b16 v[178:179], v41 offset:16640
ds_read_b64_tr_b16 v[180:181], v41 offset:20480
ds_read_b64_tr_b16 v[182:183], v41 offset:20736
s_waitcnt lgkmcnt(0)
s_barrier
ds_read_b128 v[96:99], v40 offset:128
ds_read_b128 v[128:131], v44 offset:3712
ds_read_b128 v[100:103], v40 offset:640
ds_read_b128 v[132:135], v44 offset:3200
ds_read_b128 v[104:107], v40 offset:1152
ds_read_b128 v[136:139], v44 offset:2688
ds_read_b128 v[108:111], v40 offset:1664
ds_read_b128 v[140:143], v44 offset:2176
ds_read_b128 v[240:243], v40 offset:192
ds_read_b128 a[240:243], v44 offset:3776
ds_read_b128 v[244:247], v40 offset:704
s_add_u32 s62, s34, 1966080
buffer_store_dwordx4 v[152:155], v1, s[4:7], s62 offen sc1
ds_read_b128 a[244:247], v44 offset:3264
ds_read_b128 v[248:251], v40 offset:1216
ds_read_b128 a[248:251], v44 offset:2752
s_add_u32 s62, s34, 1998848
buffer_store_dwordx4 v[152:155], v1, s[4:7], s62 offen sc1
ds_read_b128 v[252:255], v40 offset:1728
ds_read_b128 a[252:255], v44 offset:2240
s_add_u32 s62, s41, 0
buffer_store_dwordx4 v[152:155], v4, s[4:7], s62 offen sc1
ds_read_b128 v[80:83], v40 offset:0
ds_read_b128 v[112:115], v44 offset:3584
s_add_u32 s62, s41, 32768
buffer_store_dwordx4 v[152:155], v4, s[4:7], s62 offen sc1
ds_read_b128 v[84:87], v40 offset:512
ds_read_b128 v[116:119], v44 offset:3072
ds_read_b128 v[88:91], v40 offset:1024
ds_read_b128 v[120:123], v44 offset:2560
ds_read_b128 v[92:95], v40 offset:1536
ds_read_b128 v[124:127], v44 offset:2048
s_waitcnt lgkmcnt(15)
v_mfma_f32_16x16x32_bf16 v[48:51], v[96:99], v[128:131], 0
ds_read_b128 v[224:227], v40 offset:64
s_mul_i32 s50, s70, 81920
s_mul_i32 s65, s70, -114688
s_waitcnt lgkmcnt(15)
v_mfma_f32_16x16x32_bf16 v[52:55], v[96:99], v[132:135], 0
ds_read_b128 a[224:227], v44 offset:3648
s_add_u32 s65, s65, 57344
ds_read_b128 v[228:231], v40 offset:576
v_mfma_f32_16x16x32_bf16 v[52:55], v[100:103], v[128:131], v[52:55]
s_add_u32 s50, s50, s15
ds_read_b128 a[228:231], v44 offset:3136
s_lshl_b32 s60, s71, 8
s_add_u32 s50, s50, s60
ds_read_b128 v[232:235], v40 offset:1088
v_mfma_f32_16x16x32_bf16 v[56:59], v[100:103], v[132:135], 0
s_add_u32 s17, s49, 32768
s_and_b32 s92, s30, 0x80000001
ds_read_b128 a[232:235], v44 offset:2624
s_waitcnt lgkmcnt(15)
v_mfma_f32_16x16x32_bf16 v[56:59], v[96:99], v[136:139], v[56:59]
ds_read_b128 v[236:239], v40 offset:1600
s_mov_b32 s93, s92
s_cmp_eq_u32 s81, 15
s_cselect_b32 s66, s20, 0
ds_read_b128 a[236:239], v44 offset:2112
v_mfma_f32_16x16x32_bf16 v[60:63], v[100:103], v[136:139], 0
ds_read_b128 v[100:103], v40 offset:2560
s_lshl_b32 s51, s70, 12
s_add_u32 s51, s51, s15
v_mfma_f32_16x16x32_bf16 v[56:59], v[104:107], v[128:131], v[56:59]
ds_read_b128 v[136:139], v44 offset:512
s_mul_i32 s72, s70, 229376
s_mul_i32 s60, s13, 7168
s_add_u32 s72, s72, s60
v_mfma_f32_16x16x32_bf16 v[60:63], v[104:107], v[132:135], v[60:63]
ds_read_b128 v[132:135], v44 offset:1024
ds_read_b128 v[104:107], v40 offset:3072
s_waitcnt lgkmcnt(15)
v_mfma_f32_16x16x32_bf16 v[60:63], v[96:99], v[140:143], v[60:63]
ds_read_b128 v[96:99], v40 offset:2048
s_add_u32 s72, s72, s15
s_add_u32 s72, s72, 1310720
v_mfma_f32_16x16x32_bf16 v[60:63], v[108:111], v[128:131], v[60:63]
s_waitcnt vmcnt(2)
s_add_u32 s62, s42, 540672
buffer_store_dword v148, v8, s[4:7], s62 offen offset:0 sc1
s_add_u32 s62, s42, 540672
buffer_store_dword v156, v8, s[4:7], s62 offen offset:2048 sc1
ds_read_b128 v[128:131], v44 offset:1536
ds_read_b128 v[108:111], v40 offset:3584
v_lshlrev_b32 v46, 3, v1
s_lshl_b32 s38, s2, 2
s_add_u32 s38, s38, s12
s_mul_i32 s38, s38, 512
s_mov_b64 exec, 0xf
buffer_load_dword v47, v46, s[88:91], s38 offen
s_mov_b64 exec, -1
v_lshlrev_b32 v46, 3, v1
s_lshl_b32 s38, s2, 2
s_add_u32 s38, s38, s12
s_mul_i32 s38, s38, 1792
s_mov_b64 exec, 0x3fff
buffer_load_dword v47, v46, s[56:59], s38 offen
s_mov_b64 exec, -1
v_lshlrev_b32 v46, 3, v1
s_lshl_b32 s38, s2, 2
s_add_u32 s38, s38, s12
s_mul_i32 s38, s38, 1792
s_mov_b64 exec, 0x3fff
buffer_load_dword v47, v46, s[52:55], s38 offen
s_mov_b64 exec, -1
ds_read_b128 v[140:143], v44 offset:0
s_waitcnt lgkmcnt(15)
v_mfma_f32_16x16x32_bf16 v[48:51], v[240:243], a[240:243], v[48:51]
ds_read_b64_tr_b16 v[184:185], v41 offset:24576
ds_read_b64_tr_b16 v[186:187], v41 offset:24832
ds_read_b64_tr_b16 v[188:189], v41 offset:28672
s_waitcnt lgkmcnt(15)
v_mfma_f32_16x16x32_bf16 v[52:55], v[240:243], a[244:247], v[52:55]
ds_read_b64_tr_b16 v[190:191], v41 offset:28928
ds_read_b64_tr_b16 v[192:193], v41 offset:32768
ds_read_b64_tr_b16 v[194:195], v41 offset:33024
v_mfma_f32_16x16x32_bf16 v[52:55], v[244:247], a[240:243], v[52:55]
ds_read_b64_tr_b16 v[196:197], v41 offset:36864
ds_read_b64_tr_b16 v[198:199], v41 offset:37120
ds_read_b64_tr_b16 v[200:201], v41 offset:40960
v_mfma_f32_16x16x32_bf16 v[56:59], v[244:247], a[244:247], v[56:59]
ds_read_b64_tr_b16 v[202:203], v41 offset:41216
ds_read_b64_tr_b16 v[204:205], v41 offset:45056
ds_read_b64_tr_b16 v[206:207], v41 offset:45312
s_waitcnt lgkmcnt(15)
v_mfma_f32_16x16x32_bf16 v[56:59], v[240:243], a[248:251], v[56:59]
ds_read_b64_tr_b16 v[208:209], v41 offset:49152
ds_read_b64_tr_b16 v[210:211], v41 offset:49408
ds_read_b64_tr_b16 v[212:213], v41 offset:53248
v_mfma_f32_16x16x32_bf16 v[60:63], v[244:247], a[248:251], v[60:63]
ds_read_b128 v[244:247], v40 offset:2624
ds_read_b128 a[248:251], v44 offset:576
v_mfma_f32_16x16x32_bf16 v[56:59], v[248:251], a[240:243], v[56:59]
ds_read_b64_tr_b16 v[214:215], v41 offset:53504
ds_read_b64_tr_b16 v[216:217], v41 offset:57344
ds_read_b64_tr_b16 v[218:219], v41 offset:57600
v_mfma_f32_16x16x32_bf16 v[60:63], v[248:251], a[244:247], v[60:63]
ds_read_b128 a[244:247], v44 offset:1088
ds_read_b128 v[248:251], v40 offset:3136
s_waitcnt lgkmcnt(15)
v_mfma_f32_16x16x32_bf16 v[60:63], v[240:243], a[252:255], v[60:63]
ds_read_b128 v[240:243], v40 offset:2112
ds_read_b128 a[252:255], v44 offset:64
v_mfma_f32_16x16x32_bf16 v[60:63], v[252:255], a[240:243], v[60:63]
ds_read_b128 a[240:243], v44 offset:1600
ds_read_b128 v[252:255], v40 offset:3648
s_waitcnt lgkmcnt(15)
v_mfma_f32_16x16x32_bf16 v[48:51], v[80:83], v[112:115], v[48:51]
ds_read_b64_tr_b16 v[220:221], v41 offset:61440
ds_read_b64_tr_b16 v[222:223], v41 offset:61696
v_subrev_u32 v41, 36864, v41
s_waitcnt lgkmcnt(15)
v_mfma_f32_16x16x32_bf16 v[52:55], v[80:83], v[116:119], v[52:55]
s_add_u32 s73, s72, 3072
s_lshl_b32 s60, s71, 12
s_add_u32 s72, s72, s60
v_mfma_f32_16x16x32_bf16 v[52:55], v[84:87], v[112:115], v[52:55]
v_mfma_f32_16x16x32_bf16 v[56:59], v[84:87], v[116:119], v[56:59]
s_waitcnt lgkmcnt(15)
v_mfma_f32_16x16x32_bf16 v[56:59], v[80:83], v[120:123], v[56:59]
v_mfma_f32_16x16x32_bf16 v[60:63], v[84:87], v[120:123], v[60:63]
v_mfma_f32_16x16x32_bf16 v[56:59], v[88:91], v[112:115], v[56:59]
v_mfma_f32_16x16x32_bf16 v[60:63], v[88:91], v[116:119], v[60:63]
s_waitcnt lgkmcnt(15)
v_mfma_f32_16x16x32_bf16 v[60:63], v[80:83], v[124:127], v[60:63]
s_waitcnt lgkmcnt(0)
s_barrier
v_mfma_f32_16x16x32_bf16 v[60:63], v[92:95], v[112:115], v[60:63]
v_mfma_f32_16x16x32_bf16 v[48:51], v[144:147], v[112:115], v[48:51]
v_mfma_f32_16x16x32_bf16 v[52:55], v[144:147], v[116:119], v[52:55]
v_mfma_f32_16x16x32_bf16 v[56:59], v[144:147], v[120:123], v[56:59]
v_mfma_f32_16x16x32_bf16 v[60:63], v[144:147], v[124:127], v[60:63]
v_mfma_f32_16x16x32_bf16 v[48:51], v[224:227], a[224:227], v[48:51]
v_mfma_f32_16x16x32_bf16 v[52:55], v[224:227], a[228:231], v[52:55]
v_bfe_u32 v18, v1, 4, 3
v_lshlrev_b32 v18, 7, v18
buffer_load_dword v18, v18, s[4:7], s101 offen offset:2048 sc1
v_mfma_f32_16x16x32_bf16 v[52:55], v[228:231], a[224:227], v[52:55]
s_nop 0
ds_write_b128 v20, v[48:51] offset:16384
v_mfma_f32_16x16x32_bf16 v[56:59], v[228:231], a[228:231], v[56:59]
s_nop 4
ds_write_b128 v20, v[52:55] offset:17408
v_mfma_f32_16x16x32_bf16 v[56:59], v[224:227], a[232:235], v[56:59]
v_mfma_f32_16x16x32_bf16 v[60:63], v[228:231], a[232:235], v[60:63]
v_mfma_f32_16x16x32_bf16 v[56:59], v[232:235], a[224:227], v[56:59]
v_mfma_f32_16x16x32_bf16 v[60:63], v[232:235], a[228:231], v[60:63]
v_mfma_f32_16x16x32_bf16 v[60:63], v[224:227], a[236:239], v[60:63]
s_nop 1
ds_write_b128 v20, v[56:59] offset:18432
v_mfma_f32_16x16x32_bf16 v[60:63], v[236:239], a[224:227], v[60:63]
v_mfma_f32_16x16x32_bf16 v[64:67], v[88:91], v[120:123], 0
v_mfma_f32_16x16x32_bf16 v[64:67], v[84:87], v[124:127], v[64:67]
s_nop 1
ds_write_b128 v20, v[60:63] offset:19456
v_mfma_f32_16x16x32_bf16 v[68:71], v[88:91], v[124:127], 0
v_mfma_f32_16x16x32_bf16 v[64:67], v[92:95], v[116:119], v[64:67]
v_mfma_f32_16x16x32_bf16 v[68:71], v[92:95], v[120:123], v[68:71]
v_mfma_f32_16x16x32_bf16 v[72:75], v[92:95], v[124:127], 0
s_waitcnt lgkmcnt(0)
s_barrier
v_mfma_f32_16x16x32_bf16 v[64:67], v[80:83], v[128:131], v[64:67]
ds_read_b128 v[48:51], v21 offset:16384
ds_read_b128 v[52:55], v21 offset:20480
v_mfma_f32_16x16x32_bf16 v[68:71], v[84:87], v[128:131], v[68:71]
ds_read_b128 v[56:59], v21 offset:24576
ds_read_b128 v[60:63], v21 offset:28672
v_mfma_f32_16x16x32_bf16 v[72:75], v[88:91], v[128:131], v[72:75]
v_mfma_f32_16x16x32_bf16 v[76:79], v[92:95], v[128:131], 0
ds_read_b128 v[92:95], v40 offset:1664
v_mfma_f32_16x16x32_bf16 v[64:67], v[96:99], v[112:115], v[64:67]
v_mfma_f32_16x16x32_bf16 v[68:71], v[96:99], v[116:119], v[68:71]
s_waitcnt lgkmcnt(3)
v_add_f32 v48, v48, v52
v_add_f32 v49, v49, v53
v_mfma_f32_16x16x32_bf16 v[72:75], v[96:99], v[120:123], v[72:75]
v_add_f32 v50, v50, v54
v_add_f32 v51, v51, v55
v_mfma_f32_16x16x32_bf16 v[76:79], v[96:99], v[124:127], v[76:79]
ds_read_b128 v[124:127], v44 offset:2176
ds_read_b128 v[96:99], v40 offset:2176
v_mfma_f32_16x16x32_bf16 v[68:71], v[80:83], v[132:135], v[68:71]
s_waitcnt lgkmcnt(3)
v_add_f32 v56, v56, v60
v_add_f32 v57, v57, v61
v_mfma_f32_16x16x32_bf16 v[72:75], v[84:87], v[132:135], v[72:75]
v_add_f32 v58, v58, v62
v_add_f32 v59, v59, v63
v_mfma_f32_16x16x32_bf16 v[76:79], v[88:91], v[132:135], v[76:79]
ds_read_b128 v[88:91], v40 offset:1152
v_cvt_pk_bf16_f32 v52, v48, v56
v_cvt_pk_bf16_f32 v53, v49, v57
v_mfma_f32_16x16x32_bf16 v[68:71], v[100:103], v[112:115], v[68:71]
v_cvt_pk_bf16_f32 v54, v50, v58
v_cvt_pk_bf16_f32 v55, v51, v59
v_mfma_f32_16x16x32_bf16 v[72:75], v[100:103], v[116:119], v[72:75]
v_min_u32 v52, -2, v52
v_mfma_f32_16x16x32_bf16 v[76:79], v[100:103], v[120:123], v[76:79]
ds_read_b128 v[120:123], v44 offset:2688
ds_read_b128 v[100:103], v40 offset:2688
v_mfma_f32_16x16x32_bf16 v[72:75], v[80:83], v[136:139], v[72:75]
v_mfma_f32_16x16x32_bf16 v[76:79], v[84:87], v[136:139], v[76:79]
ds_read_b128 v[84:87], v40 offset:640
v_mfma_f32_16x16x32_bf16 v[72:75], v[104:107], v[112:115], v[72:75]
v_mfma_f32_16x16x32_bf16 v[76:79], v[104:107], v[116:119], v[76:79]
ds_read_b128 v[116:119], v44 offset:3200
ds_read_b128 v[104:107], v40 offset:3200
v_mfma_f32_16x16x32_bf16 v[76:79], v[80:83], v[140:143], v[76:79]
ds_read_b128 v[80:83], v40 offset:128
v_mfma_f32_16x16x32_bf16 v[76:79], v[108:111], v[112:115], v[76:79]
ds_read_b128 v[112:115], v44 offset:3712
ds_read_b128 v[108:111], v40 offset:3712
v_mfma_f32_16x16x32_bf16 v[64:67], v[144:147], v[128:131], v[64:67]
ds_read_b128 v[128:131], v44 offset:1664
v_mfma_f32_16x16x32_bf16 v[68:71], v[144:147], v[132:135], v[68:71]
ds_read_b128 v[132:135], v44 offset:1152
v_mfma_f32_16x16x32_bf16 v[72:75], v[144:147], v[136:139], v[72:75]
ds_read_b128 v[136:139], v44 offset:640
v_mfma_f32_16x16x32_bf16 v[76:79], v[144:147], v[140:143], v[76:79]
ds_read_b128 v[140:143], v44 offset:128
v_mfma_f32_16x16x32_bf16 v[64:67], v[232:235], a[232:235], v[64:67]
v_mfma_f32_16x16x32_bf16 v[64:67], v[228:231], a[236:239], v[64:67]
v_mfma_f32_16x16x32_bf16 v[68:71], v[232:235], a[236:239], v[68:71]
v_mfma_f32_16x16x32_bf16 v[64:67], v[236:239], a[228:231], v[64:67]
v_mfma_f32_16x16x32_bf16 v[68:71], v[236:239], a[232:235], v[68:71]
v_mfma_f32_16x16x32_bf16 v[72:75], v[236:239], a[236:239], v[72:75]
v_mfma_f32_16x16x32_bf16 v[64:67], v[224:227], a[240:243], v[64:67]
v_mfma_f32_16x16x32_bf16 v[68:71], v[228:231], a[240:243], v[68:71]
v_mfma_f32_16x16x32_bf16 v[72:75], v[232:235], a[240:243], v[72:75]
v_mfma_f32_16x16x32_bf16 v[76:79], v[236:239], a[240:243], v[76:79]
ds_read_b128 v[236:239], v40 offset:1728
ds_read_b128 a[240:243], v44 offset:1728
v_mfma_f32_16x16x32_bf16 v[64:67], v[240:243], a[224:227], v[64:67]
v_mfma_f32_16x16x32_bf16 v[68:71], v[240:243], a[228:231], v[68:71]
v_mfma_f32_16x16x32_bf16 v[72:75], v[240:243], a[232:235], v[72:75]
v_mfma_f32_16x16x32_bf16 v[76:79], v[240:243], a[236:239], v[76:79]
ds_read_b128 a[236:239], v44 offset:2240
ds_read_b128 v[240:243], v40 offset:2240
v_mfma_f32_16x16x32_bf16 v[68:71], v[224:227], a[244:247], v[68:71]
v_mfma_f32_16x16x32_bf16 v[72:75], v[228:231], a[244:247], v[72:75]
v_mfma_f32_16x16x32_bf16 v[76:79], v[232:235], a[244:247], v[76:79]
ds_read_b128 v[232:235], v40 offset:1216
ds_read_b128 a[244:247], v44 offset:1216
v_mfma_f32_16x16x32_bf16 v[68:71], v[244:247], a[224:227], v[68:71]
v_mfma_f32_16x16x32_bf16 v[72:75], v[244:247], a[228:231], v[72:75]
v_mfma_f32_16x16x32_bf16 v[76:79], v[244:247], a[232:235], v[76:79]
ds_read_b128 a[232:235], v44 offset:2752
ds_read_b128 v[244:247], v40 offset:2752
v_mfma_f32_16x16x32_bf16 v[72:75], v[224:227], a[248:251], v[72:75]
v_mfma_f32_16x16x32_bf16 v[76:79], v[228:231], a[248:251], v[76:79]
ds_read_b128 v[228:231], v40 offset:704
ds_read_b128 a[248:251], v44 offset:704
v_mfma_f32_16x16x32_bf16 v[72:75], v[248:251], a[224:227], v[72:75]
v_mfma_f32_16x16x32_bf16 v[76:79], v[248:251], a[228:231], v[76:79]
ds_read_b128 a[228:231], v44 offset:3264
ds_read_b128 v[248:251], v40 offset:3264
v_mfma_f32_16x16x32_bf16 v[76:79], v[224:227], a[252:255], v[76:79]
ds_read_b128 v[224:227], v40 offset:192
ds_read_b128 a[252:255], v44 offset:192
v_mfma_f32_16x16x32_bf16 v[76:79], v[252:255], a[224:227], v[76:79]
ds_read_b128 a[224:227], v44 offset:3776
ds_read_b128 v[252:255], v40 offset:3776
s_waitcnt lgkmcnt(15)
v_mfma_f32_16x16x32_bf16 v[64:67], v[88:91], v[120:123], v[64:67]
s_add_u32 s60, s46, 151552
v_add_u32 v40, s60, v1
s_waitcnt lgkmcnt(15)
v_mfma_f32_16x16x32_bf16 v[64:67], v[84:87], v[124:127], v[64:67]
v_mfma_f32_16x16x32_bf16 v[68:71], v[88:91], v[124:127], v[68:71]
s_waitcnt lgkmcnt(15)
v_mfma_f32_16x16x32_bf16 v[64:67], v[92:95], v[116:119], v[64:67]
v_mfma_f32_16x16x32_bf16 v[68:71], v[92:95], v[120:123], v[68:71]
s_lshl2_add_u32 m0, s46, 77824
s_xor_b32 s3, s80, 131072
buffer_load_dwordx4 v42, s[88:91], s3 offen offset:0 lds
v_mfma_f32_16x16x32_bf16 v[72:75], v[92:95], v[124:127], v[72:75]
s_waitcnt lgkmcnt(15)
v_mfma_f32_16x16x32_bf16 v[64:67], v[80:83], v[128:131], v[64:67]
buffer_load_dwordx4 v11, s[88:91], s3 offen offset:1024 lds
s_waitcnt vmcnt(2)
v_cmp_eq_u32 vcc, 0, v18
s_cbranch_vccnz re_60
re_60b:
v_mfma_f32_16x16x32_bf16 v[68:71], v[84:87], v[128:131], v[68:71]
buffer_store_dwordx4 v[52:55], v45, s[4:7], s78 offen sc1
v_mfma_f32_16x16x32_bf16 v[72:75], v[88:91], v[128:131], v[72:75]
s_add_u32 s3, s3, 14336
buffer_load_dwordx4 v42, s[88:91], s3 offen offset:2048 lds
v_mfma_f32_16x16x32_bf16 v[76:79], v[92:95], v[128:131], v[76:79]
buffer_load_dwordx4 v11, s[88:91], s3 offen offset:3072 lds
v_mfma_f32_16x16x32_bf16 v[64:67], v[96:99], v[112:115], v[64:67]
v_mfma_f32_16x16x32_bf16 v[68:71], v[96:99], v[116:119], v[68:71]
v_mfma_f32_16x16x32_bf16 v[72:75], v[96:99], v[120:123], v[72:75]
v_mfma_f32_16x16x32_bf16 v[76:79], v[96:99], v[124:127], v[76:79]
v_mov_b32 v96, 0x3f803f80
v_mov_b32 v97, 0x3f803f80
s_waitcnt lgkmcnt(15)
v_mfma_f32_16x16x32_bf16 v[68:71], v[80:83], v[132:135], v[68:71]
v_mov_b32 v98, 0x3f803f80
v_mov_b32 v99, 0x3f803f80
v_mfma_f32_16x16x32_bf16 v[72:75], v[84:87], v[132:135], v[72:75]
v_mfma_f32_16x16x32_bf16 v[76:79], v[88:91], v[132:135], v[76:79]
v_mfma_f32_16x16x32_bf16 v[68:71], v[100:103], v[112:115], v[68:71]
v_mfma_f32_16x16x32_bf16 v[72:75], v[100:103], v[116:119], v[72:75]
s_add_u32 s62, s43, 540672
buffer_load_dwordx2 v[56:57], v7, s[4:7], s62 offen offset:0 sc1
v_mfma_f32_16x16x32_bf16 v[76:79], v[100:103], v[120:123], v[76:79]
s_add_u32 s62, s43, 540672
buffer_load_dwordx2 v[48:49], v7, s[4:7], s62 offen offset:2048 sc1
s_waitcnt lgkmcnt(15)
v_mfma_f32_16x16x32_bf16 v[72:75], v[80:83], v[136:139], v[72:75]
s_lshl2_add_u32 m0, s46, 94208
s_xor_b32 s3, s80, 393216
buffer_load_dwordx4 v42, s[88:91], s3 offen offset:0 lds
v_mfma_f32_16x16x32_bf16 v[76:79], v[84:87], v[136:139], v[76:79]
buffer_load_dwordx4 v11, s[88:91], s3 offen offset:1024 lds
v_mfma_f32_16x16x32_bf16 v[72:75], v[104:107], v[112:115], v[72:75]
v_mfma_f32_16x16x32_bf16 v[76:79], v[104:107], v[116:119], v[76:79]
s_add_u32 s3, s3, 14336
buffer_load_dwordx4 v42, s[88:91], s3 offen offset:2048 lds
s_waitcnt lgkmcnt(15)
v_mfma_f32_16x16x32_bf16 v[76:79], v[80:83], v[140:143], v[76:79]
v_lshrrev_b32 v104, 8, v1
v_lshl_add_u32 v104, v104, 4, s26
v_mfma_f32_16x16x32_bf16 v[76:79], v[108:111], v[112:115], v[76:79]
s_waitcnt lgkmcnt(9)
v_mfma_f32_16x16x32_bf16 v[64:67], v[232:235], a[232:235], v[64:67]
buffer_load_dwordx4 v11, s[88:91], s3 offen offset:3072 lds
s_waitcnt lgkmcnt(7)
v_mfma_f32_16x16x32_bf16 v[64:67], v[228:231], a[236:239], v[64:67]
v_mfma_f32_16x16x32_bf16 v[68:71], v[232:235], a[236:239], v[68:71]
s_waitcnt lgkmcnt(5)
v_mfma_f32_16x16x32_bf16 v[64:67], v[236:239], a[228:231], v[64:67]
v_mfma_f32_16x16x32_bf16 v[68:71], v[236:239], a[232:235], v[68:71]
v_mfma_f32_16x16x32_bf16 v[72:75], v[236:239], a[236:239], v[72:75]
s_waitcnt lgkmcnt(3)
v_mfma_f32_16x16x32_bf16 v[64:67], v[224:227], a[240:243], v[64:67]
v_mfma_f32_16x16x32_bf16 v[68:71], v[228:231], a[240:243], v[68:71]
v_mfma_f32_16x16x32_bf16 v[72:75], v[232:235], a[240:243], v[72:75]
v_mfma_f32_16x16x32_bf16 v[76:79], v[236:239], a[240:243], v[76:79]
s_waitcnt lgkmcnt(1)
v_mfma_f32_16x16x32_bf16 v[64:67], v[240:243], a[224:227], v[64:67]
v_mfma_f32_16x16x32_bf16 v[68:71], v[240:243], a[228:231], v[68:71]
v_mfma_f32_16x16x32_bf16 v[72:75], v[240:243], a[232:235], v[72:75]
s_nop 1
ds_write_b128 v20, v[64:67] offset:0
v_mfma_f32_16x16x32_bf16 v[76:79], v[240:243], a[236:239], v[76:79]
s_lshl2_add_u32 m0, s46, 110592
s_xor_b32 s3, s80, 0
buffer_load_dwordx4 v42, s[88:91], s3 offen offset:0 lds
v_mfma_f32_16x16x32_bf16 v[68:71], v[224:227], a[244:247], v[68:71]
v_mfma_f32_16x16x32_bf16 v[72:75], v[228:231], a[244:247], v[72:75]
v_mfma_f32_16x16x32_bf16 v[76:79], v[232:235], a[244:247], v[76:79]
v_mfma_f32_16x16x32_bf16 v[68:71], v[244:247], a[224:227], v[68:71]
buffer_load_dwordx4 v11, s[88:91], s3 offen offset:1024 lds
v_mfma_f32_16x16x32_bf16 v[72:75], v[244:247], a[228:231], v[72:75]
s_add_u32 s3, s3, 14336
buffer_load_dwordx4 v42, s[88:91], s3 offen offset:2048 lds
s_nop 2
ds_write_b128 v20, v[68:71] offset:1024
v_mfma_f32_16x16x32_bf16 v[76:79], v[244:247], a[232:235], v[76:79]
v_mfma_f32_16x16x32_bf16 v[72:75], v[224:227], a[248:251], v[72:75]
v_mfma_f32_16x16x32_bf16 v[76:79], v[228:231], a[248:251], v[76:79]
v_mfma_f32_16x16x32_bf16 v[72:75], v[248:251], a[224:227], v[72:75]
v_mfma_f32_16x16x32_bf16 v[76:79], v[248:251], a[228:231], v[76:79]
buffer_load_dwordx4 v11, s[88:91], s3 offen offset:3072 lds
v_mfma_f32_16x16x32_bf16 v[76:79], v[224:227], a[252:255], v[76:79]
s_nop 1
ds_write_b128 v20, v[72:75] offset:2048
s_waitcnt lgkmcnt(3)
v_mfma_f32_16x16x32_bf16 v[76:79], v[252:255], a[224:227], v[76:79]
v_mfma_f32_16x16x32_bf16 v[100:103], v[160:163], v[96:99], 0
v_mfma_f32_16x16x32_bf16 v[100:103], v[164:167], v[96:99], v[100:103]
s_nop 1
ds_write_b128 v20, v[76:79] offset:3072
v_mfma_f32_16x16x32_bf16 v[100:103], v[168:171], v[96:99], v[100:103]
v_mfma_f32_16x16x32_bf16 v[100:103], v[172:175], v[96:99], v[100:103]
v_mfma_f32_16x16x32_bf16 v[100:103], v[176:179], v[96:99], v[100:103]
v_mfma_f32_16x16x32_bf16 v[100:103], v[180:183], v[96:99], v[100:103]
s_waitcnt lgkmcnt(0)
s_barrier
ds_read_b128 v[64:67], v21 offset:0
ds_read_b128 v[68:71], v21 offset:4096
ds_read_b128 v[72:75], v21 offset:8192
ds_read_b128 v[76:79], v21 offset:12288
s_lshl2_add_u32 m0, s46, 61440
s_xor_b32 s3, s80, 262144
buffer_load_dwordx4 v42, s[88:91], s3 offen offset:0 lds
v_mfma_f32_16x16x32_bf16 v[100:103], v[184:187], v[96:99], v[100:103]
s_waitcnt lgkmcnt(2)
v_add_f32 v64, v64, v68
v_add_f32 v65, v65, v69
v_pk_add_f32 v[66:67], v[66:67], v[70:71]
s_waitcnt lgkmcnt(0)
v_pk_add_f32 v[72:73], v[72:73], v[76:77]
v_pk_add_f32 v[74:75], v[74:75], v[78:79]
v_cvt_pk_bf16_f32 v68, v64, v72
v_cvt_pk_bf16_f32 v69, v65, v73
v_cvt_pk_bf16_f32 v70, v66, v74
v_cvt_pk_bf16_f32 v71, v67, v75
v_min_u32 v68, -2, v68
buffer_store_dwordx4 v[68:71], v45, s[4:7], s79 offen sc1
s_waitcnt vmcnt(10)
v_max3_u32 v58, v56, v57, v48
v_max_u32 v58, v58, v49
v_cmp_eq_u32 vcc, -1, v58
s_cbranch_vccnz re_61
re_61b:
v_permlane32_swap_b32 v56, v57
v_add_f32 v56, v56, v57
v_mov_b32 v57, v56
buffer_load_dwordx4 v11, s[88:91], s3 offen offset:1024 lds
s_nop 0
v_permlane16_swap_b32 v56, v57
v_add_f32 v56, v56, v57
s_add_u32 s3, s3, 14336
buffer_load_dwordx4 v42, s[88:91], s3 offen offset:2048 lds
v_add_f32_dpp v56, v56, v56 row_ror:8 row_mask:0xf bank_mask:0xf
v_mul_f32 v56, 0x3b000000, v56
v_mov_b32 v57, v56
buffer_load_dwordx4 v11, s[88:91], s3 offen offset:3072 lds
s_nop 0
v_permlane32_swap_b32 v56, v57
v_fma_f32 v57, -v56, v56, v57
v_max_f32 v57, 0, v57
v_add_f32 v58, 0x3727c5ac, v57
v_rsq_f32 v58, v58
v_permlane32_swap_b32 v48, v49
v_mul_f32 v59, -v56, v58
v_pk_fma_f32 v[144:145], v[24:25], v[58:59], v[58:59] op_sel:[0,0,1] op_sel_hi:[1,0,1]
v_pk_fma_f32 v[146:147], v[26:27], v[58:59], v[58:59] op_sel:[0,0,1] op_sel_hi:[1,0,1]
v_pk_fma_f32 v[148:149], v[28:29], v[58:59], v[58:59] op_sel:[0,0,1] op_sel_hi:[1,0,1]
v_pk_fma_f32 v[150:151], v[30:31], v[58:59], v[58:59] op_sel:[0,0,1] op_sel_hi:[1,0,1]
v_add_f32 v48, v48, v49
v_mov_b32 v49, v48
v_lshrrev_b32 v68, 9, v1
v_lshl_add_u32 v68, v68, 5, s26
v_permlane16_swap_b32 v48, v49
v_add_f32 v48, v48, v49
v_add_u32 v76, s25, v1
v_mfma_f32_16x16x32_bf16 v[100:103], v[188:191], v[96:99], v[100:103]
v_add_f32_dpp v48, v48, v48 row_ror:8 row_mask:0xf bank_mask:0xf
v_mul_f32 v48, 0x3b000000, v48
v_mov_b32 v49, v48
v_mfma_f32_16x16x32_bf16 v[100:103], v[192:195], v[96:99], v[100:103]
s_nop 0
v_permlane32_swap_b32 v48, v49
v_fma_f32 v49, -v48, v48, v49
v_max_f32 v49, 0, v49
v_add_f32 v50, 0x3727c5ac, v49
v_rsq_f32 v50, v50
v_mfma_f32_16x16x32_bf16 v[100:103], v[196:199], v[96:99], v[100:103]
v_mul_f32 v51, -v48, v50
v_fma_f32 v152, v32, v50, v51
v_fma_f32 v153, v33, v50, v51
v_pk_fma_f32 v[154:155], v[34:35], v[50:51], v[50:51] op_sel:[0,0,1] op_sel_hi:[1,0,1]
v_pk_fma_f32 v[156:157], v[36:37], v[50:51], v[50:51] op_sel:[0,0,1] op_sel_hi:[1,0,1]
v_pk_fma_f32 v[158:159], v[38:39], v[50:51], v[50:51] op_sel:[0,0,1] op_sel_hi:[1,0,1]
s_nop 0
v_mfma_f32_16x16x32_bf16 v[100:103], v[200:203], v[96:99], v[100:103]
s_add_u32 s60, s34, 1835008
buffer_load_dwordx4 v[60:63], v1, s[4:7], s60 offen sc1
s_mov_b32 exec_hi, 0x00ffffff
s_xor_b32 s38, s18, 0
s_mul_i32 s38, s38, 7168
s_add_u32 m0, s39, s38
s_lshl4_add_u32 s38, s38, s16
buffer_load_dwordx4 v16, s[56:59], s38 offen lds
s_add_u32 m0, m0, 896
s_add_u32 s38, s38, 28672
buffer_load_dwordx4 v16, s[56:59], s38 offen lds
s_mov_b32 exec_hi, -1
s_mov_b32 exec_hi, 0x00ffffff
s_xor_b32 s38, s18, 1
s_mul_i32 s38, s38, 7168
s_add_u32 m0, s39, s38
s_lshl4_add_u32 s38, s38, s16
buffer_load_dwordx4 v16, s[56:59], s38 offen lds
s_add_u32 m0, m0, 896
s_add_u32 s38, s38, 28672
buffer_load_dwordx4 v16, s[56:59], s38 offen lds
s_mov_b32 exec_hi, -1
v_mfma_f32_16x16x32_bf16 v[100:103], v[204:207], v[96:99], v[100:103]
v_mov_b32 v45, 0x3f803f80
v_mfma_f32_16x16x32_bf16 v[100:103], v[208:211], v[96:99], v[100:103]
v_mfma_f32_16x16x32_bf16 v[100:103], v[212:215], v[96:99], v[100:103]
v_mfma_f32_16x16x32_bf16 v[100:103], v[216:219], v[96:99], v[100:103]
v_mfma_f32_16x16x32_bf16 v[100:103], v[220:223], v[96:99], v[100:103]
s_nop 7
ds_write_b128 v104, v[100:103]
ds_read_b128 v[64:67], v68 offset:0
ds_read_b128 v[68:71], v68 offset:16
s_mov_b32 exec_hi, 0x00ffffff
s_xor_b32 s38, s18, 2
s_mul_i32 s38, s38, 7168
s_add_u32 m0, s39, s38
s_lshl4_add_u32 s38, s38, s16
buffer_load_dwordx4 v16, s[56:59], s38 offen lds
s_add_u32 m0, m0, 896
s_add_u32 s38, s38, 28672
buffer_load_dwordx4 v16, s[56:59], s38 offen lds
s_mov_b32 exec_hi, -1
v_lshrrev_b32 v100, 9, v1
v_lshl_add_u32 v100, v100, 5, s26
ds_read_b128 v[96:99], v100 offset:0
ds_read_b128 v[100:103], v100 offset:16
s_mov_b32 exec_hi, 0x00ffffff
s_xor_b32 s38, s18, 3
s_mul_i32 s38, s38, 7168
s_add_u32 m0, s39, s38
s_lshl4_add_u32 s38, s38, s16
buffer_load_dwordx4 v16, s[56:59], s38 offen lds
s_add_u32 m0, m0, 896
s_add_u32 s38, s38, 28672
buffer_load_dwordx4 v16, s[56:59], s38 offen lds
s_mov_b32 exec_hi, -1
s_waitcnt vmcnt(9)
s_barrier
ds_read_b64_tr_b16 v[224:225], v41 offset:16384
ds_read_b64_tr_b16 v[226:227], v41 offset:16640
ds_read_b64_tr_b16 v[228:229], v41 offset:20480
ds_read_b64_tr_b16 v[230:231], v41 offset:20736
s_waitcnt vmcnt(8)
v_cmp_eq_u32 vcc, -1, v60
s_cbranch_vccnz re_62
re_62b:
ds_write_b128 v40, v[60:63] offset:0
ds_read_b64_tr_b16 v[232:233], v41 offset:24576
ds_read_b64_tr_b16 v[234:235], v41 offset:24832
ds_read_b64_tr_b16 v[236:237], v41 offset:28672
ds_read_b64_tr_b16 v[238:239], v41 offset:28928
ds_read_b64_tr_b16 v[240:241], v41 offset:32768
ds_read_b64_tr_b16 v[242:243], v41 offset:33024
ds_read_b64_tr_b16 v[244:245], v41 offset:36864
ds_read_b64_tr_b16 v[246:247], v41 offset:37120
ds_read_b64_tr_b16 v[248:249], v41 offset:40960
ds_read_b64_tr_b16 v[250:251], v41 offset:41216
ds_read_b64_tr_b16 v[252:253], v41 offset:45056
ds_read_b64_tr_b16 v[254:255], v41 offset:45312
s_waitcnt lgkmcnt(12)
s_barrier
ds_read_b32 v48, v2 offset:0
ds_read_b32 v49, v2 offset:128
ds_read_b32 v50, v2 offset:256
ds_read_b32 v51, v2 offset:384
ds_read_b64_tr_b16 a[224:225], v41 offset:49152
ds_read_b64_tr_b16 a[226:227], v41 offset:49408
ds_read_b64_tr_b16 a[228:229], v41 offset:53248
ds_read_b64_tr_b16 a[230:231], v41 offset:53504
ds_read_b64_tr_b16 a[232:233], v41 offset:57344
ds_read_b64_tr_b16 a[234:235], v41 offset:57600
ds_read_b64_tr_b16 a[236:237], v41 offset:61440
ds_read_b64_tr_b16 a[238:239], v41 offset:61696
ds_read_b64_tr_b16 a[240:241], v41 offset:0
ds_read_b64_tr_b16 a[242:243], v41 offset:256
ds_read_b64_tr_b16 a[244:245], v41 offset:4096
s_waitcnt lgkmcnt(14)
v_lshlrev_b32 v52, 16, v48
v_and_b32 v53, s36, v48
s_waitcnt lgkmcnt(13)
v_lshlrev_b32 v54, 16, v49
v_and_b32 v55, s36, v49
s_waitcnt lgkmcnt(12)
v_lshlrev_b32 v56, 16, v50
v_and_b32 v57, s36, v50
s_waitcnt lgkmcnt(11)
v_lshlrev_b32 v58, 16, v51
v_and_b32 v59, s36, v51
v_pk_fma_f32 v[24:25], v[144:145], v[52:53], v[24:25] op_sel:[0,0,0] op_sel_hi:[1,1,1]
v_pk_fma_f32 v[26:27], v[146:147], v[54:55], v[26:27] op_sel:[0,0,0] op_sel_hi:[1,1,1]
v_pk_fma_f32 v[28:29], v[148:149], v[56:57], v[28:29] op_sel:[0,0,0] op_sel_hi:[1,1,1]
v_pk_fma_f32 v[30:31], v[150:151], v[58:59], v[30:31] op_sel:[0,0,0] op_sel_hi:[1,1,1]
v_cvt_pk_bf16_f32 v60, v24, v25
v_cvt_pk_bf16_f32 v61, v26, v27
v_cvt_pk_bf16_f32 v62, v28, v29
v_cvt_pk_bf16_f32 v63, v30, v31
s_add_u32 s62, s40, 1966080
buffer_store_dwordx4 v[60:63], v3, s[4:7], s62 offen sc1
v_pk_add_f32 v[52:53], v[24:25], v[26:27]
v_pk_mul_f32 v[54:55], v[24:25], v[24:25]
v_pk_fma_f32 v[54:55], v[26:27], v[26:27], v[54:55] op_sel:[0,0,0] op_sel_hi:[1,1,1]
v_pk_add_f32 v[52:53], v[52:53], v[28:29]
s_add_u32 s60, s34, 1867776
buffer_load_dwordx4 v[108:111], v1, s[4:7], s60 offen sc1
v_pk_fma_f32 v[54:55], v[28:29], v[28:29], v[54:55] op_sel:[0,0,0] op_sel_hi:[1,1,1]
v_pk_add_f32 v[52:53], v[52:53], v[30:31]
v_pk_fma_f32 v[54:55], v[30:31], v[30:31], v[54:55] op_sel:[0,0,0] op_sel_hi:[1,1,1]
v_add_f32 v52, v52, v53
v_add_f32 v54, v54, v55
ds_read_b64_tr_b16 a[246:247], v41 offset:4352
ds_read_b64_tr_b16 a[248:249], v41 offset:8192
v_permlane32_swap_b32 v52, v54
v_add_f32 v52, v52, v54
v_mov_b32 v54, v52
ds_read_b64_tr_b16 a[250:251], v41 offset:8448
ds_read_b64_tr_b16 a[252:253], v41 offset:12288
v_permlane16_swap_b32 v52, v54
v_add_f32 v52, v52, v54
ds_read_b64_tr_b16 a[254:255], v41 offset:12544
s_add_u32 s62, s34, 1835008
buffer_store_dwordx4 v[48:51], v1, s[4:7], s62 offen
v_add_f32_dpp v52, v52, v52 row_ror:8 row_mask:0xf bank_mask:0xf
s_add_u32 s62, s42, 524288
buffer_store_dword v52, v8, s[4:7], s62 offen offset:0 sc1
s_waitcnt lgkmcnt(0)
s_barrier
s_lshl2_add_u32 m0, s46, 77824
s_lshl4_add_u32 s3, s74, s49
buffer_load_dwordx4 v42, s[52:55], s3 offen offset:0 lds
buffer_load_dwordx4 v11, s[52:55], s3 offen offset:1024 lds
s_add_u32 s3, s3, 14336
buffer_load_dwordx4 v42, s[52:55], s3 offen offset:2048 lds
buffer_load_dwordx4 v11, s[52:55], s3 offen offset:3072 lds
s_lshl2_add_u32 m0, s46, 94208
s_lshl4_add_u32 s3, s74, s17
buffer_load_dwordx4 v42, s[52:55], s3 offen offset:0 lds
buffer_load_dwordx4 v11, s[52:55], s3 offen offset:1024 lds
s_add_u32 s3, s3, 14336
buffer_load_dwordx4 v42, s[52:55], s3 offen offset:2048 lds
buffer_load_dwordx4 v11, s[52:55], s3 offen offset:3072 lds
s_waitcnt vmcnt(10)
v_cmp_eq_u32 vcc, -1, v108
s_cbranch_vccnz re_63
re_63b:
ds_write_b128 v40, v[108:111] offset:4096
v_add_u32 v108, s25, v1
s_waitcnt lgkmcnt(0)
s_barrier
ds_read_b32 v80, v2 offset:4096
ds_read_b32 v81, v2 offset:4224
ds_read_b32 v82, v2 offset:4352
ds_read_b32 v83, v2 offset:4480
s_waitcnt lgkmcnt(3)
v_lshlrev_b32 v84, 16, v80
v_and_b32 v85, s36, v80
s_waitcnt lgkmcnt(2)
v_lshlrev_b32 v86, 16, v81
v_and_b32 v87, s36, v81
s_waitcnt lgkmcnt(1)
v_lshlrev_b32 v88, 16, v82
v_and_b32 v89, s36, v82
s_add_u32 m0, s23, 16384
s_xor_b32 s38, s47, 1966080
buffer_load_dwordx4 v1, s[4:7], s38 offen offset:0 sc1 lds
buffer_load_dwordx4 v1, s[4:7], s38 offen offset:1024 sc1 lds
s_waitcnt lgkmcnt(0)
v_lshlrev_b32 v90, 16, v83
v_and_b32 v91, s36, v83
v_pk_fma_f32 v[32:33], v[152:153], v[84:85], v[32:33] op_sel:[0,0,0] op_sel_hi:[1,1,1]
s_add_u32 m0, s23, 24576
s_xor_b32 s38, s47, 1974272
buffer_load_dwordx4 v1, s[4:7], s38 offen offset:0 sc1 lds
buffer_load_dwordx4 v1, s[4:7], s38 offen offset:1024 sc1 lds
v_pk_fma_f32 v[34:35], v[154:155], v[86:87], v[34:35] op_sel:[0,0,0] op_sel_hi:[1,1,1]
v_pk_fma_f32 v[36:37], v[156:157], v[88:89], v[36:37] op_sel:[0,0,0] op_sel_hi:[1,1,1]
v_pk_fma_f32 v[38:39], v[158:159], v[90:91], v[38:39] op_sel:[0,0,0] op_sel_hi:[1,1,1]
s_add_u32 m0, s23, 0
s_xor_b32 s38, s47, 1982464
buffer_load_dwordx4 v1, s[4:7], s38 offen offset:0 sc1 lds
buffer_load_dwordx4 v1, s[4:7], s38 offen offset:1024 sc1 lds
v_cvt_pk_bf16_f32 v92, v32, v33
v_cvt_pk_bf16_f32 v93, v34, v35
v_cvt_pk_bf16_f32 v94, v36, v37
v_cvt_pk_bf16_f32 v95, v38, v39
v_pk_add_f32 v[84:85], v[32:33], v[34:35]
v_pk_mul_f32 v[86:87], v[32:33], v[32:33]
v_pk_fma_f32 v[86:87], v[34:35], v[34:35], v[86:87] op_sel:[0,0,0] op_sel_hi:[1,1,1]
v_pk_add_f32 v[84:85], v[84:85], v[36:37]
v_pk_fma_f32 v[86:87], v[36:37], v[36:37], v[86:87] op_sel:[0,0,0] op_sel_hi:[1,1,1]
v_pk_add_f32 v[84:85], v[84:85], v[38:39]
s_add_u32 s62, s40, 1998848
buffer_store_dwordx4 v[92:95], v3, s[4:7], s62 offen sc1
v_pk_fma_f32 v[86:87], v[38:39], v[38:39], v[86:87] op_sel:[0,0,0] op_sel_hi:[1,1,1]
v_add_f32 v84, v84, v85
v_add_f32 v86, v86, v87
s_waitcnt vmcnt(13)
ds_read_b64_tr_b16 a[0:1], v43 offset:0
v_permlane32_swap_b32 v84, v86
v_add_f32 v84, v84, v86
v_mov_b32 v86, v84
ds_read_b64_tr_b16 a[4:5], v43 offset:8
ds_read_b64_tr_b16 a[2:3], v43 offset:256
v_permlane16_swap_b32 v84, v86
v_add_f32 v84, v84, v86
ds_read_b64_tr_b16 a[6:7], v43 offset:264
s_waitcnt vmcnt(11)
ds_read_b64_tr_b16 a[8:9], v43 offset:2048
v_add_f32_dpp v84, v84, v84 row_ror:8 row_mask:0xf bank_mask:0xf
s_add_u32 s62, s42, 524288
buffer_store_dword v84, v8, s[4:7], s62 offen offset:2048 sc1
ds_read_b64_tr_b16 a[12:13], v43 offset:2056
ds_read_b64_tr_b16 a[10:11], v43 offset:2304
ds_read_b64_tr_b16 a[14:15], v43 offset:2312
s_waitcnt vmcnt(10)
ds_read_b64_tr_b16 a[16:17], v43 offset:16384
ds_read_b64_tr_b16 a[20:21], v43 offset:16392
ds_read_b64_tr_b16 a[18:19], v43 offset:16640
ds_read_b64_tr_b16 a[22:23], v43 offset:16648
s_add_u32 s62, s34, 1867776
buffer_store_dwordx4 v[80:83], v1, s[4:7], s62 offen
s_add_u32 m0, s23, 8192
s_xor_b32 s38, s47, 1990656
buffer_load_dwordx4 v1, s[4:7], s38 offen offset:0 sc1 lds
buffer_load_dwordx4 v1, s[4:7], s38 offen offset:1024 sc1 lds
s_waitcnt vmcnt(11)
ds_read_b64_tr_b16 a[24:25], v43 offset:18432
ds_read_b64_tr_b16 a[28:29], v43 offset:18440
ds_read_b64_tr_b16 a[26:27], v43 offset:18688
ds_read_b64_tr_b16 a[30:31], v43 offset:18696
s_waitcnt vmcnt(9)
ds_read2st64_b32 v[72:73], v0 offset0:64 offset1:68
s_waitcnt lgkmcnt(0)
v_max_u32 v72, v72, v73
v_cmp_eq_u32 vcc, -1, v72
s_cbranch_vccnz re_64
re_64b:
s_add_u32 s62, s43, 524288
buffer_load_dwordx4 v[56:59], v1, s[4:7], s62 offen offset:0 sc1
buffer_load_dwordx4 v[60:63], v1, s[4:7], s62 offen offset:1024 sc1
s_lshl2_add_u32 m0, s46, 77824
s_lshl4_add_u32 s3, s0, s49
buffer_load_dwordx4 v42, s[52:55], s3 offen offset:0 lds
s_barrier
ds_read_b128 v[112:115], v23 offset:16384
ds_read_b128 v[116:119], v23 offset:16640
ds_read_b128 v[120:123], v23 offset:18432
ds_read_b128 v[124:127], v23 offset:18688
ds_read_b128 v[128:131], v23 offset:20480
ds_read_b128 v[132:135], v23 offset:20736
ds_read_b128 v[136:139], v23 offset:22528
ds_read_b128 v[140:143], v23 offset:22784
buffer_load_dwordx4 v11, s[52:55], s3 offen offset:1024 lds
s_waitcnt lgkmcnt(6)
v_mfma_f32_16x16x32_bf16 v[48:51], v[160:163], v[112:115], 0
ds_read_b128 v[76:79], v76 offset:16384
s_waitcnt vmcnt(11)
ds_read2st64_b32 v[72:73], v0 offset0:96 offset1:100
s_add_u32 s3, s3, 14336
buffer_load_dwordx4 v42, s[52:55], s3 offen offset:2048 lds
v_mfma_f32_16x16x32_bf16 v[52:55], v[160:163], v[116:119], 0
s_waitcnt vmcnt(10)
ds_read2st64_b32 v[74:75], v0 offset0:0 offset1:4
buffer_load_dwordx4 v11, s[52:55], s3 offen offset:3072 lds
s_waitcnt lgkmcnt(7)
v_mfma_f32_16x16x32_bf16 v[48:51], v[164:167], v[120:123], v[48:51]
v_mfma_f32_16x16x32_bf16 v[52:55], v[164:167], v[124:127], v[52:55]
s_waitcnt lgkmcnt(5)
v_mfma_f32_16x16x32_bf16 v[48:51], v[168:171], v[128:131], v[48:51]
v_mfma_f32_16x16x32_bf16 v[52:55], v[168:171], v[132:135], v[52:55]
s_waitcnt lgkmcnt(0)
v_max3_u32 v72, v72, v73, v74
v_max_u32 v72, v72, v75
v_cmp_eq_u32 vcc, -1, v72
s_cbranch_vccnz re_65
re_65b:
v_mfma_f32_16x16x32_bf16 v[48:51], v[172:175], v[136:139], v[48:51]
s_barrier
ds_read_b128 v[112:115], v23 offset:24576
ds_read_b128 v[116:119], v23 offset:24832
ds_read_b128 v[120:123], v23 offset:26624
ds_read_b128 v[124:127], v23 offset:26880
ds_read_b128 v[128:131], v23 offset:28672
ds_read_b128 v[132:135], v23 offset:28928
ds_read_b128 v[136:139], v23 offset:30720
v_mfma_f32_16x16x32_bf16 v[52:55], v[172:175], v[140:143], v[52:55]
ds_read_b128 v[140:143], v23 offset:30976
s_waitcnt vmcnt(4)
v_add_f32 v56, v56, v60
v_add_f32 v57, v57, v61
v_pk_add_f32 v[58:59], v[58:59], v[62:63]
v_pk_add_f32 v[56:57], v[56:57], v[58:59]
v_lshlrev_b32 v74, 16, v77
s_waitcnt lgkmcnt(6)
v_mfma_f32_16x16x32_bf16 v[48:51], v[176:179], v[112:115], v[48:51]
ds_read_b128 v[112:115], v23 offset:0
v_permlane32_swap_b32 v56, v57
s_add_u32 m0, s23, 32768
s_xor_b32 s38, s47, 1998848
buffer_load_dwordx4 v1, s[4:7], s38 offen offset:0 sc1 lds
buffer_load_dwordx4 v1, s[4:7], s38 offen offset:1024 sc1 lds
v_mfma_f32_16x16x32_bf16 v[52:55], v[176:179], v[116:119], v[52:55]
ds_read_b128 v[116:119], v23 offset:256
v_add_f32 v56, v56, v57
s_waitcnt lgkmcnt(6)
v_mfma_f32_16x16x32_bf16 v[48:51], v[180:183], v[120:123], v[48:51]
ds_read_b128 v[120:123], v23 offset:2048
s_add_u32 m0, s23, 16384
s_xor_b32 s38, s47, 2007040
buffer_load_dwordx4 v1, s[4:7], s38 offen offset:0 sc1 lds
buffer_load_dwordx4 v1, s[4:7], s38 offen offset:1024 sc1 lds
v_mfma_f32_16x16x32_bf16 v[52:55], v[180:183], v[124:127], v[52:55]
ds_read_b128 v[124:127], v23 offset:2304
s_lshl2_add_u32 m0, s46, 94208
s_lshl4_add_u32 s3, s0, s17
buffer_load_dwordx4 v42, s[52:55], s3 offen offset:0 lds
s_waitcnt lgkmcnt(6)
v_mfma_f32_16x16x32_bf16 v[48:51], v[184:187], v[128:131], v[48:51]
ds_read_b128 v[128:131], v23 offset:4096
v_cmp_u_f32 vcc, v56, v56
s_cbranch_vccnz re_67
re_67b:
buffer_load_dwordx4 v11, s[52:55], s3 offen offset:1024 lds
v_mfma_f32_16x16x32_bf16 v[52:55], v[184:187], v[132:135], v[52:55]
ds_read_b128 v[132:135], v23 offset:4352
v_mul_f32 v56, 0x3b000000, v56
s_add_u32 s3, s3, 14336
buffer_load_dwordx4 v42, s[52:55], s3 offen offset:2048 lds
s_waitcnt lgkmcnt(6)
v_mfma_f32_16x16x32_bf16 v[48:51], v[188:191], v[136:139], v[48:51]
ds_read_b128 v[136:139], v23 offset:6144
v_mov_b32 v57, v56
v_and_b32 v75, s36, v77
v_mfma_f32_16x16x32_bf16 v[52:55], v[188:191], v[140:143], v[52:55]
ds_read_b128 v[140:143], v23 offset:6400
v_permlane32_swap_b32 v56, v57
s_waitcnt lgkmcnt(6)
v_mfma_f32_16x16x32_bf16 v[48:51], v[192:195], v[112:115], v[48:51]
ds_read2st64_b32 v[72:73], v0 offset0:32 offset1:36
v_fma_f32 v57, -v56, v56, v57
v_max_f32 v57, 0, v57
v_mfma_f32_16x16x32_bf16 v[52:55], v[192:195], v[116:119], v[52:55]
v_add_f32 v58, 0x3727c5ac, v57
v_rsq_f32 v58, v58
s_waitcnt lgkmcnt(5)
v_mfma_f32_16x16x32_bf16 v[48:51], v[196:199], v[120:123], v[48:51]
v_mul_f32 v59, v58, v58
v_sub_f32 v46, 0, v56
v_mfma_f32_16x16x32_bf16 v[52:55], v[196:199], v[124:127], v[52:55]
v_mul_f32 v59, v59, v57
v_mov_b32 v20, v58
s_waitcnt lgkmcnt(3)
v_mfma_f32_16x16x32_bf16 v[48:51], v[200:203], v[128:131], v[48:51]
v_add_f32 v59, 0x3727c5ac, v59
buffer_load_dwordx4 v11, s[52:55], s3 offen offset:3072 lds
v_mfma_f32_16x16x32_bf16 v[52:55], v[200:203], v[132:135], v[52:55]
v_rsq_f32 v59, v59
s_waitcnt lgkmcnt(1)
v_mfma_f32_16x16x32_bf16 v[48:51], v[204:207], v[136:139], v[48:51]
v_mul_f32 v21, v46, v58
v_mul_f32 v59, v59, v58
v_mfma_f32_16x16x32_bf16 v[52:55], v[204:207], v[140:143], v[52:55]
v_mul_f32 v19, 0xc0135761, v59
v_mul_f32 v18, v59, v59
v_rcp_f32 v47, v59
v_mul_f32 v18, v18, v19
v_mul_f32 v18, 0x3d372713, v18
s_waitcnt vmcnt(10)
ds_read_b64_tr_b16 a[32:33], v43 offset:0
ds_read_b64_tr_b16 a[36:37], v43 offset:8
ds_read_b64_tr_b16 a[34:35], v43 offset:256
ds_read_b64_tr_b16 a[38:39], v43 offset:264
v_and_b32 v77, s36, v78
v_pk_fma_f32 v[74:75], v[74:75], v[20:21], v[20:21] op_sel:[0,0,1] op_sel_hi:[1,0,1]
s_waitcnt lgkmcnt(4)
v_max_u32 v72, v72, v73
v_cmp_eq_u32 vcc, -1, v72
s_cbranch_vccnz re_66
re_66b:
v_lshlrev_b32 v72, 16, v76
v_and_b32 v73, s36, v76
v_lshlrev_b32 v76, 16, v78
v_lshlrev_b32 v78, 16, v79
v_and_b32 v79, s36, v79
v_pk_fma_f32 v[72:73], v[72:73], v[20:21], v[20:21] op_sel:[0,0,1] op_sel_hi:[1,0,1]
v_pk_fma_f32 v[76:77], v[76:77], v[20:21], v[20:21] op_sel:[0,0,1] op_sel_hi:[1,0,1]
v_pk_fma_f32 v[78:79], v[78:79], v[20:21], v[20:21] op_sel:[0,0,1] op_sel_hi:[1,0,1]
s_barrier
s_add_u32 m0, s23, 24576
s_xor_b32 s38, s47, 2015232
buffer_load_dwordx4 v1, s[4:7], s38 offen offset:0 sc1 lds
buffer_load_dwordx4 v1, s[4:7], s38 offen offset:1024 sc1 lds
ds_read_b128 v[112:115], v23 offset:8192
ds_read_b128 v[116:119], v23 offset:8448
ds_read_b128 v[120:123], v23 offset:10240
ds_read_b128 v[124:127], v23 offset:10496
ds_read_b128 v[128:131], v23 offset:12288
s_add_u32 m0, s23, 0
s_xor_b32 s38, s47, 2023424
buffer_load_dwordx4 v1, s[4:7], s38 offen offset:0 sc1 lds
buffer_load_dwordx4 v1, s[4:7], s38 offen offset:1024 sc1 lds
ds_read_b128 v[132:135], v23 offset:12544
ds_read_b128 v[136:139], v23 offset:14336
ds_read_b128 v[140:143], v23 offset:14592
s_waitcnt vmcnt(12)
ds_read_b64_tr_b16 a[40:41], v43 offset:2048
ds_read_b64_tr_b16 a[44:45], v43 offset:2056
ds_read_b64_tr_b16 a[42:43], v43 offset:2304
s_add_u32 s62, s43, 524288
buffer_load_dwordx4 v[88:91], v1, s[4:7], s62 offen offset:2048 sc1
buffer_load_dwordx4 v[92:95], v1, s[4:7], s62 offen offset:3072 sc1
ds_read_b64_tr_b16 a[46:47], v43 offset:2312
s_waitcnt vmcnt(12)
ds_read2st64_b32 v[104:105], v0 offset0:128 offset1:132
s_waitcnt lgkmcnt(11)
v_mfma_f32_16x16x32_bf16 v[48:51], v[208:211], v[112:115], v[48:51]
v_permlane16_swap_b32 v72, v76
s_lshl2_add_u32 m0, s46, 77824
s_lshl4_add_u32 s3, s1, s49
buffer_load_dwordx4 v42, s[52:55], s3 offen offset:0 lds
s_waitcnt lgkmcnt(5)
s_barrier
v_mfma_f32_16x16x32_bf16 v[52:55], v[208:211], v[116:119], v[52:55]
v_permlane16_swap_b32 v73, v77
v_mfma_f32_16x16x32_bf16 v[48:51], v[212:215], v[120:123], v[48:51]
v_permlane16_swap_b32 v74, v78
v_mfma_f32_16x16x32_bf16 v[52:55], v[212:215], v[124:127], v[52:55]
v_permlane16_swap_b32 v75, v79
v_mfma_f32_16x16x32_bf16 v[48:51], v[216:219], v[128:131], v[48:51]
buffer_load_dwordx4 v11, s[52:55], s3 offen offset:1024 lds
v_mfma_f32_16x16x32_bf16 v[52:55], v[216:219], v[132:135], v[52:55]
v_mfma_f32_16x16x32_bf16 v[48:51], v[220:223], v[136:139], v[48:51]
v_mfma_f32_16x16x32_bf16 v[52:55], v[220:223], v[140:143], v[52:55]
s_add_u32 s3, s3, 14336
s_waitcnt lgkmcnt(1)
buffer_load_dwordx4 v42, s[52:55], s3 offen offset:2048 lds
s_waitcnt vmcnt(11)
ds_read_b64_tr_b16 a[48:49], v43 offset:16384
ds_read_b64_tr_b16 a[52:53], v43 offset:16392
ds_read_b64_tr_b16 a[50:51], v43 offset:16640
ds_read_b64_tr_b16 a[54:55], v43 offset:16648
v_permlane16_swap_b32 v48, v52
v_permlane16_swap_b32 v49, v53
v_permlane16_swap_b32 v50, v54
v_permlane16_swap_b32 v51, v55
v_pk_fma_f32 v[48:49], v[64:65], v[46:47], v[48:49] op_sel:[0,0,0] op_sel_hi:[1,0,1]
v_pk_fma_f32 v[50:51], v[66:67], v[46:47], v[50:51] op_sel:[0,0,0] op_sel_hi:[1,0,1]
buffer_load_dwordx4 v11, s[52:55], s3 offen offset:3072 lds
v_pk_fma_f32 v[52:53], v[68:69], v[46:47], v[52:53] op_sel:[0,0,0] op_sel_hi:[1,0,1]
v_pk_fma_f32 v[54:55], v[70:71], v[46:47], v[54:55] op_sel:[0,0,0] op_sel_hi:[1,0,1]
v_pk_mul_f32 v[56:57], v[48:49], v[48:49]
v_pk_mul_f32 v[58:59], v[50:51], v[50:51]
v_pk_mul_f32 v[60:61], v[52:53], v[52:53]
v_pk_mul_f32 v[62:63], v[54:55], v[54:55]
v_pk_fma_f32 v[56:57], v[56:57], v[18:19], v[18:19] op_sel:[0,0,1] op_sel_hi:[1,0,1]
v_pk_fma_f32 v[58:59], v[58:59], v[18:19], v[18:19] op_sel:[0,0,1] op_sel_hi:[1,0,1]
v_pk_fma_f32 v[60:61], v[60:61], v[18:19], v[18:19] op_sel:[0,0,1] op_sel_hi:[1,0,1]
v_pk_fma_f32 v[62:63], v[62:63], v[18:19], v[18:19] op_sel:[0,0,1] op_sel_hi:[1,0,1]
v_pk_mul_f32 v[56:57], v[56:57], v[48:49]
v_pk_mul_f32 v[58:59], v[58:59], v[50:51]
v_pk_mul_f32 v[60:61], v[60:61], v[52:53]
v_pk_mul_f32 v[62:63], v[62:63], v[54:55]
v_exp_f32 v56, v56
v_exp_f32 v57, v57
s_lshl2_add_u32 m0, s46, 94208
s_lshl4_add_u32 s3, s1, s17
s_waitcnt lgkmcnt(0)
buffer_load_dwordx4 v42, s[52:55], s3 offen offset:0 lds
buffer_load_dwordx4 v11, s[52:55], s3 offen offset:1024 lds
s_waitcnt vmcnt(12)
ds_read_b64_tr_b16 a[56:57], v43 offset:18432
ds_read_b64_tr_b16 a[60:61], v43 offset:18440
ds_read_b64_tr_b16 a[58:59], v43 offset:18688
ds_read_b64_tr_b16 a[62:63], v43 offset:18696
v_exp_f32 v58, v58
v_exp_f32 v59, v59
v_exp_f32 v60, v60
v_exp_f32 v61, v61
v_exp_f32 v62, v62
v_exp_f32 v63, v63
v_pk_fma_f32 v[56:57], v[56:57], v[46:47], v[46:47] op_sel:[0,1,1] op_sel_hi:[1,1,1]
v_pk_fma_f32 v[58:59], v[58:59], v[46:47], v[46:47] op_sel:[0,1,1] op_sel_hi:[1,1,1]
v_pk_fma_f32 v[60:61], v[60:61], v[46:47], v[46:47] op_sel:[0,1,1] op_sel_hi:[1,1,1]
s_add_u32 s3, s3, 14336
s_waitcnt lgkmcnt(0)
buffer_load_dwordx4 v42, s[52:55], s3 offen offset:2048 lds
buffer_load_dwordx4 v11, s[52:55], s3 offen offset:3072 lds
v_pk_fma_f32 v[62:63], v[62:63], v[46:47], v[46:47] op_sel:[0,1,1] op_sel_hi:[1,1,1]
v_rcp_f32 v56, v56
v_rcp_f32 v57, v57
v_rcp_f32 v58, v58
v_rcp_f32 v59, v59
v_rcp_f32 v60, v60
v_rcp_f32 v61, v61
v_rcp_f32 v62, v62
v_rcp_f32 v63, v63
v_pk_mul_f32 v[56:57], v[56:57], v[48:49]
v_pk_mul_f32 v[58:59], v[58:59], v[50:51]
v_pk_mul_f32 v[60:61], v[60:61], v[52:53]
v_pk_mul_f32 v[62:63], v[62:63], v[54:55]
v_cvt_pk_bf16_f32 v64, v56, v57
v_cvt_pk_bf16_f32 v65, v58, v59
v_cvt_pk_bf16_f32 v66, v60, v61
v_cvt_pk_bf16_f32 v67, v62, v63
s_cmp_lg_u32 s27, 0
s_cbranch_scc1 sh_68
buffer_store_dwordx4 v[64:67], v5, s[4:7], s32 offen offset:0 sc1
sh_68b:
s_add_u32 s62, s41, 0
buffer_store_dwordx4 v[64:67], v4, s[4:7], s62 offen sc1
v_max_u32 v104, v104, v105
v_cmp_eq_u32 vcc, -1, v104
s_cbranch_vccnz re_69
re_69b:
s_barrier
ds_read_b128 v[112:115], v23 offset:32768
ds_read_b128 v[116:119], v23 offset:33024
ds_read_b128 v[120:123], v23 offset:34816
ds_read_b128 v[124:127], v23 offset:35072
ds_read_b128 v[128:131], v23 offset:36864
ds_read_b128 v[132:135], v23 offset:37120
ds_read_b128 v[136:139], v23 offset:38912
ds_read_b128 v[140:143], v23 offset:39168
ds_read2st64_b32 v[104:105], v0 offset0:64 offset1:68
s_waitcnt vmcnt(14)
ds_read2st64_b32 v[106:107], v0 offset0:96 offset1:100
s_mov_b32 exec_hi, 0x00ffffff
s_xor_b32 s38, s18, 4
s_mul_i32 s38, s38, 7168
s_add_u32 m0, s39, s38
s_lshl4_add_u32 s38, s38, s16
buffer_load_dwordx4 v16, s[56:59], s38 offen lds
s_add_u32 m0, m0, 896
s_add_u32 s38, s38, 28672
buffer_load_dwordx4 v16, s[56:59], s38 offen lds
s_mov_b32 exec_hi, -1
s_waitcnt lgkmcnt(8)
v_mfma_f32_16x16x32_bf16 v[80:83], v[160:163], v[112:115], 0
s_mov_b32 exec_hi, 0x00ffffff
s_xor_b32 s38, s18, 5
s_mul_i32 s38, s38, 7168
s_add_u32 m0, s39, s38
s_lshl4_add_u32 s38, s38, s16
buffer_load_dwordx4 v16, s[56:59], s38 offen lds
s_add_u32 m0, m0, 896
s_add_u32 s38, s38, 28672
buffer_load_dwordx4 v16, s[56:59], s38 offen lds
s_mov_b32 exec_hi, -1
s_waitcnt vmcnt(12)
ds_read_b64_tr_b16 a[64:65], v43 offset:0
ds_read_b64_tr_b16 a[68:69], v43 offset:8
ds_read_b64_tr_b16 a[66:67], v43 offset:256
ds_read_b64_tr_b16 a[70:71], v43 offset:264
v_mfma_f32_16x16x32_bf16 v[84:87], v[160:163], v[116:119], 0
s_mov_b32 exec_hi, 0x00ffffff
s_xor_b32 s38, s18, 6
s_mul_i32 s38, s38, 7168
s_add_u32 m0, s39, s38
s_lshl4_add_u32 s38, s38, s16
buffer_load_dwordx4 v16, s[56:59], s38 offen lds
s_add_u32 m0, m0, 896
s_add_u32 s38, s38, 28672
buffer_load_dwordx4 v16, s[56:59], s38 offen lds
s_mov_b32 exec_hi, -1
s_waitcnt lgkmcnt(10)
v_mfma_f32_16x16x32_bf16 v[80:83], v[164:167], v[120:123], v[80:83]
ds_read_b128 v[108:111], v108 offset:32768
s_waitcnt lgkmcnt(5)
v_max3_u32 v104, v104, v105, v106
v_max_u32 v104, v104, v107
v_cmp_eq_u32 vcc, -1, v104
s_cbranch_vccnz re_70
re_70b:
s_waitcnt vmcnt(12)
ds_read_b64_tr_b16 a[72:73], v43 offset:2048
ds_read_b64_tr_b16 a[76:77], v43 offset:2056
ds_read_b64_tr_b16 a[74:75], v43 offset:2304
ds_read_b64_tr_b16 a[78:79], v43 offset:2312
v_mfma_f32_16x16x32_bf16 v[84:87], v[164:167], v[124:127], v[84:87]
s_waitcnt lgkmcnt(4)
s_barrier
ds_read_b128 v[144:147], v23 offset:16384
ds_read_b128 v[148:151], v23 offset:16640
ds_read_b128 v[152:155], v23 offset:18432
ds_read_b128 v[156:159], v23 offset:18688
ds_read_b128 v[112:115], v23 offset:20480
ds_read_b128 v[116:119], v23 offset:20736
ds_read_b128 v[120:123], v23 offset:22528
ds_read_b128 v[124:127], v23 offset:22784
v_mfma_f32_16x16x32_bf16 v[80:83], v[168:171], v[128:131], v[80:83]
ds_read_b128 v[128:131], v23 offset:24576
ds_read2st64_b32 v[104:105], v0 offset0:0 offset1:4
s_waitcnt vmcnt(10)
ds_read_b64_tr_b16 a[80:81], v43 offset:16384
ds_read_b64_tr_b16 a[84:85], v43 offset:16392
ds_read_b64_tr_b16 a[82:83], v43 offset:16640
v_mfma_f32_16x16x32_bf16 v[84:87], v[168:171], v[132:135], v[84:87]
ds_read_b64_tr_b16 a[86:87], v43 offset:16648
s_mov_b32 exec_hi, 0x00ffffff
s_xor_b32 s38, s18, 7
s_mul_i32 s38, s38, 7168
s_add_u32 m0, s39, s38
s_lshl4_add_u32 s38, s38, s16
buffer_load_dwordx4 v16, s[56:59], s38 offen lds
s_add_u32 m0, m0, 896
s_add_u32 s38, s38, 28672
buffer_load_dwordx4 v16, s[56:59], s38 offen lds
s_mov_b32 exec_hi, -1
ds_read_b128 v[132:135], v23 offset:24832
v_mfma_f32_16x16x32_bf16 v[80:83], v[172:175], v[136:139], v[80:83]
ds_read_b128 v[136:139], v23 offset:26624
v_add_f32 v88, v88, v92
v_add_f32 v89, v89, v93
s_waitcnt vmcnt(10)
ds_read_b64_tr_b16 a[88:89], v43 offset:18432
ds_read_b64_tr_b16 a[92:93], v43 offset:18440
ds_read_b64_tr_b16 a[90:91], v43 offset:18688
ds_read_b64_tr_b16 a[94:95], v43 offset:18696
v_mfma_f32_16x16x32_bf16 v[84:87], v[172:175], v[140:143], v[84:87]
ds_read_b128 v[140:143], v23 offset:26880
s_waitcnt lgkmcnt(11)
v_max_u32 v104, v104, v105
v_cmp_eq_u32 vcc, -1, v104
s_cbranch_vccnz re_71
re_71b:
v_mfma_f32_16x16x32_bf16 v[80:83], v[176:179], v[144:147], v[80:83]
ds_read_b128 v[144:147], v23 offset:28672
v_add_f32 v90, v90, v94
v_add_f32 v91, v91, v95
v_mfma_f32_16x16x32_bf16 v[84:87], v[176:179], v[148:151], v[84:87]
ds_read_b128 v[148:151], v23 offset:28928
v_add_f32 v88, v88, v90
v_add_f32 v89, v89, v91
v_mfma_f32_16x16x32_bf16 v[80:83], v[180:183], v[152:155], v[80:83]
ds_read_b128 v[152:155], v23 offset:30720
v_permlane32_swap_b32 v88, v89
v_mfma_f32_16x16x32_bf16 v[84:87], v[180:183], v[156:159], v[84:87]
ds_read_b128 v[156:159], v23 offset:30976
v_add_f32 v88, v88, v89
v_cmp_u_f32 vcc, v88, v88
s_cbranch_vccnz re_72
re_72b:
s_waitcnt lgkmcnt(5)
s_barrier
v_mfma_f32_16x16x32_bf16 v[80:83], v[184:187], v[112:115], v[80:83]
s_mov_b32 exec_hi, 0x00ffffff
s_xor_b32 s38, s18, 8
s_mul_i32 s38, s38, 7168
s_add_u32 m0, s39, s38
s_lshl4_add_u32 s38, s38, s16
buffer_load_dwordx4 v16, s[56:59], s38 offen lds
s_add_u32 m0, m0, 896
s_add_u32 s38, s38, 28672
buffer_load_dwordx4 v16, s[56:59], s38 offen lds
s_mov_b32 exec_hi, -1
v_mfma_f32_16x16x32_bf16 v[84:87], v[184:187], v[116:119], v[84:87]
s_waitcnt lgkmcnt(0)
s_barrier
ds_read_b128 v[112:115], v23 offset:0
ds_read_b128 v[116:119], v23 offset:256
v_mfma_f32_16x16x32_bf16 v[80:83], v[188:191], v[120:123], v[80:83]
ds_read_b128 v[120:123], v23 offset:2048
v_mul_f32 v88, 0x3b000000, v88
v_mov_b32 v89, v88
v_mfma_f32_16x16x32_bf16 v[84:87], v[188:191], v[124:127], v[84:87]
ds_read_b128 v[124:127], v23 offset:2304
v_permlane32_swap_b32 v88, v89
v_mfma_f32_16x16x32_bf16 v[80:83], v[192:195], v[128:131], v[80:83]
ds_read_b128 v[128:131], v23 offset:4096
v_fma_f32 v89, -v88, v88, v89
v_max_f32 v89, 0, v89
v_mfma_f32_16x16x32_bf16 v[84:87], v[192:195], v[132:135], v[84:87]
ds_read_b128 v[132:135], v23 offset:4352
v_add_f32 v90, 0x3727c5ac, v89
v_rsq_f32 v90, v90
v_mfma_f32_16x16x32_bf16 v[80:83], v[196:199], v[136:139], v[80:83]
ds_read_b128 v[136:139], v23 offset:6144
v_mul_f32 v91, v90, v90
v_sub_f32 v46, 0, v88
v_mfma_f32_16x16x32_bf16 v[84:87], v[196:199], v[140:143], v[84:87]
ds_read_b128 v[140:143], v23 offset:6400
v_mul_f32 v91, v91, v89
v_mov_b32 v20, v90
v_mfma_f32_16x16x32_bf16 v[80:83], v[200:203], v[144:147], v[80:83]
v_add_f32 v91, 0x3727c5ac, v91
v_rsq_f32 v91, v91
v_mfma_f32_16x16x32_bf16 v[84:87], v[200:203], v[148:151], v[84:87]
v_mul_f32 v21, v46, v90
v_mul_f32 v91, v91, v90
s_add_u32 m0, s23, 8192
s_xor_b32 s38, s22, 139264
buffer_load_dwordx4 v1, s[4:7], s38 offen offset:0 sc1 lds
buffer_load_dwordx4 v1, s[4:7], s38 offen offset:1024 sc1 lds
s_waitcnt lgkmcnt(0)
s_barrier
v_mfma_f32_16x16x32_bf16 v[80:83], v[204:207], v[152:155], v[80:83]
s_add_u32 m0, s23, 32768
s_xor_b32 s38, s22, 155648
buffer_load_dwordx4 v1, s[4:7], s38 offen offset:0 sc1 lds
buffer_load_dwordx4 v1, s[4:7], s38 offen offset:1024 sc1 lds
v_mfma_f32_16x16x32_bf16 v[84:87], v[204:207], v[156:159], v[84:87]
v_mul_f32 v19, 0xc0135761, v91
v_mul_f32 v18, v91, v91
v_mfma_f32_16x16x32_bf16 v[80:83], v[208:211], v[112:115], v[80:83]
v_rcp_f32 v47, v91
v_cndmask_b32 v44, v1, v6, s[92:93]
s_add_u32 m0, s23, 16384
s_xor_b32 s38, s22, 131072
buffer_load_dwordx4 v44, s[4:7], s38 offen offset:0 sc1 lds
buffer_load_dwordx4 v44, s[4:7], s38 offen offset:1024 sc1 lds
v_mfma_f32_16x16x32_bf16 v[84:87], v[208:211], v[116:119], v[84:87]
v_mul_f32 v18, v18, v19
v_mul_f32 v18, 0x3d372713, v18
v_mfma_f32_16x16x32_bf16 v[80:83], v[212:215], v[120:123], v[80:83]
v_lshlrev_b32 v104, 16, v108
v_and_b32 v105, s36, v108
v_mfma_f32_16x16x32_bf16 v[84:87], v[212:215], v[124:127], v[84:87]
v_lshlrev_b32 v106, 16, v109
v_and_b32 v107, s36, v109
v_mfma_f32_16x16x32_bf16 v[80:83], v[216:219], v[128:131], v[80:83]
s_add_u32 m0, s23, 24576
s_xor_b32 s38, s22, 147456
buffer_load_dwordx4 v6, s[4:7], s38 offen offset:0 sc1 lds
buffer_load_dwordx4 v6, s[4:7], s38 offen offset:1024 sc1 lds
v_mfma_f32_16x16x32_bf16 v[84:87], v[216:219], v[132:135], v[84:87]
v_lshlrev_b32 v108, 16, v110
v_and_b32 v109, s36, v110
v_mfma_f32_16x16x32_bf16 v[80:83], v[220:223], v[136:139], v[80:83]
v_lshlrev_b32 v110, 16, v111
v_and_b32 v111, s36, v111
v_mfma_f32_16x16x32_bf16 v[84:87], v[220:223], v[140:143], v[84:87]
v_fma_f32 v104, v104, v20, v21
v_fma_f32 v105, v105, v20, v21
v_fma_f32 v106, v106, v20, v21
v_fma_f32 v107, v107, v20, v21
v_pk_fma_f32 v[108:109], v[108:109], v[20:21], v[20:21] op_sel:[0,0,1] op_sel_hi:[1,0,1]
v_pk_fma_f32 v[110:111], v[110:111], v[20:21], v[20:21] op_sel:[0,0,1] op_sel_hi:[1,0,1]
s_nop 0
v_permlane16_swap_b32 v104, v108
v_permlane16_swap_b32 v80, v84
v_permlane16_swap_b32 v81, v85
v_permlane16_swap_b32 v82, v86
v_permlane16_swap_b32 v83, v87
v_pk_fma_f32 v[80:81], v[96:97], v[46:47], v[80:81] op_sel:[0,0,0] op_sel_hi:[1,0,1]
v_pk_fma_f32 v[82:83], v[98:99], v[46:47], v[82:83] op_sel:[0,0,0] op_sel_hi:[1,0,1]
v_pk_fma_f32 v[84:85], v[100:101], v[46:47], v[84:85] op_sel:[0,0,0] op_sel_hi:[1,0,1]
v_pk_fma_f32 v[86:87], v[102:103], v[46:47], v[86:87] op_sel:[0,0,0] op_sel_hi:[1,0,1]
v_pk_mul_f32 v[88:89], v[80:81], v[80:81]
v_pk_mul_f32 v[90:91], v[82:83], v[82:83]
v_pk_mul_f32 v[92:93], v[84:85], v[84:85]
v_pk_mul_f32 v[94:95], v[86:87], v[86:87]
v_pk_fma_f32 v[88:89], v[88:89], v[18:19], v[18:19] op_sel:[0,0,1] op_sel_hi:[1,0,1]
v_pk_fma_f32 v[90:91], v[90:91], v[18:19], v[18:19] op_sel:[0,0,1] op_sel_hi:[1,0,1]
v_pk_fma_f32 v[92:93], v[92:93], v[18:19], v[18:19] op_sel:[0,0,1] op_sel_hi:[1,0,1]
v_pk_fma_f32 v[94:95], v[94:95], v[18:19], v[18:19] op_sel:[0,0,1] op_sel_hi:[1,0,1]
v_pk_mul_f32 v[88:89], v[88:89], v[80:81]
v_pk_mul_f32 v[90:91], v[90:91], v[82:83]
v_pk_mul_f32 v[92:93], v[92:93], v[84:85]
v_pk_mul_f32 v[94:95], v[94:95], v[86:87]
v_exp_f32 v88, v88
v_exp_f32 v89, v89
v_exp_f32 v90, v90
v_exp_f32 v91, v91
v_exp_f32 v92, v92
v_exp_f32 v93, v93
v_exp_f32 v94, v94
v_exp_f32 v95, v95
v_pk_fma_f32 v[88:89], v[88:89], v[46:47], v[46:47] op_sel:[0,1,1] op_sel_hi:[1,1,1]
v_pk_fma_f32 v[90:91], v[90:91], v[46:47], v[46:47] op_sel:[0,1,1] op_sel_hi:[1,1,1]
v_pk_fma_f32 v[92:93], v[92:93], v[46:47], v[46:47] op_sel:[0,1,1] op_sel_hi:[1,1,1]
v_pk_fma_f32 v[94:95], v[94:95], v[46:47], v[46:47] op_sel:[0,1,1] op_sel_hi:[1,1,1]
v_rcp_f32 v88, v88
v_rcp_f32 v89, v89
v_rcp_f32 v90, v90
s_waitcnt vmcnt(6)
ds_read2st64_b32 v[56:57], v0 offset0:32 offset1:36
s_waitcnt vmcnt(4)
ds_read2st64_b32 v[58:59], v0 offset0:128 offset1:132
v_rcp_f32 v91, v91
v_rcp_f32 v92, v92
v_rcp_f32 v93, v93
v_rcp_f32 v94, v94
v_rcp_f32 v95, v95
v_pk_mul_f32 v[88:89], v[88:89], v[80:81]
v_pk_mul_f32 v[90:91], v[90:91], v[82:83]
v_pk_mul_f32 v[92:93], v[92:93], v[84:85]
v_pk_mul_f32 v[94:95], v[94:95], v[86:87]
v_cvt_pk_bf16_f32 v96, v88, v89
v_cvt_pk_bf16_f32 v97, v90, v91
v_cvt_pk_bf16_f32 v98, v92, v93
v_cvt_pk_bf16_f32 v99, v94, v95
s_cmp_lg_u32 s27, 0
s_cbranch_scc1 sh_73
buffer_store_dwordx4 v[96:99], v5, s[4:7], s33 offen offset:0 sc1
sh_73b:
s_add_u32 s62, s41, 32768
buffer_store_dwordx4 v[96:99], v4, s[4:7], s62 offen sc1
s_waitcnt lgkmcnt(0)
v_max3_u32 v56, v56, v57, v58
v_max_u32 v56, v56, v59
v_cmp_eq_u32 vcc, -1, v56
s_cbranch_vccnz re_74
re_74b:
s_barrier
s_mov_b32 exec_hi, 0x00ffffff
s_xor_b32 s38, s18, 9
s_mul_i32 s38, s38, 7168
s_add_u32 m0, s39, s38
s_lshl4_add_u32 s38, s38, s16
buffer_load_dwordx4 v16, s[56:59], s38 offen lds
s_add_u32 m0, m0, 896
s_add_u32 s38, s38, 28672
buffer_load_dwordx4 v16, s[56:59], s38 offen lds
s_mov_b32 exec_hi, -1
ds_read_b128 v[112:115], v23 offset:8192
ds_read_b128 v[116:119], v23 offset:8448
s_mov_b32 exec_hi, 0x00ffffff
s_xor_b32 s38, s18, 10
s_mul_i32 s38, s38, 7168
s_add_u32 m0, s39, s38
s_lshl4_add_u32 s38, s38, s16
buffer_load_dwordx4 v16, s[56:59], s38 offen lds
s_add_u32 m0, m0, 896
s_add_u32 s38, s38, 28672
buffer_load_dwordx4 v16, s[56:59], s38 offen lds
s_mov_b32 exec_hi, -1
ds_read_b128 v[120:123], v23 offset:10240
s_cmp_eq_u32 s66, 0
s_cbranch_scc1 skip_75
v_cndmask_b32 v44, v1, v6, s[92:93]
s_add_u32 m0, s23, 16384
s_xor_b32 s38, s22, 131072
buffer_load_dwordx4 v44, s[4:7], s38 offen offset:0 sc1 lds
buffer_load_dwordx4 v44, s[4:7], s38 offen offset:1024 sc1 lds
s_add_u32 m0, s23, 24576
s_xor_b32 s38, s22, 147456
buffer_load_dwordx4 v6, s[4:7], s38 offen offset:0 sc1 lds
buffer_load_dwordx4 v6, s[4:7], s38 offen offset:1024 sc1 lds
skip_75:
s_waitcnt lgkmcnt(1)
v_mfma_f32_16x16x32_bf16 v[48:51], v[224:227], v[112:115], v[72:75]
s_mov_b32 exec_hi, 0x00ffffff
s_xor_b32 s38, s18, 11
s_mul_i32 s38, s38, 7168
s_add_u32 m0, s39, s38
s_lshl4_add_u32 s38, s38, s16
buffer_load_dwordx4 v16, s[56:59], s38 offen lds
s_add_u32 m0, m0, 896
s_add_u32 s38, s38, 28672
buffer_load_dwordx4 v16, s[56:59], s38 offen lds
s_mov_b32 exec_hi, -1
v_mfma_f32_16x16x32_bf16 v[52:55], v[224:227], v[116:119], v[76:79]
s_mov_b32 exec_hi, 0x00ffffff
s_xor_b32 s38, s18, 12
s_mul_i32 s38, s38, 7168
s_add_u32 m0, s39, s38
s_lshl4_add_u32 s38, s38, s16
buffer_load_dwordx4 v16, s[56:59], s38 offen lds
s_add_u32 m0, m0, 896
s_add_u32 s38, s38, 28672
buffer_load_dwordx4 v16, s[56:59], s38 offen lds
s_mov_b32 exec_hi, -1
v_mov_b32 v78, 0
v_mov_b32 v79, 0
ds_read_b128 v[124:127], v23 offset:10496
ds_read_b128 v[128:131], v23 offset:12288
ds_read_b128 v[132:135], v23 offset:12544
ds_read_b128 v[136:139], v23 offset:14336
ds_read_b128 v[140:143], v23 offset:14592
s_mov_b32 exec_hi, 0x00ffffff
s_xor_b32 s38, s18, 13
s_mul_i32 s38, s38, 7168
s_add_u32 m0, s39, s38
s_lshl4_add_u32 s38, s38, s16
buffer_load_dwordx4 v16, s[56:59], s38 offen lds
s_add_u32 m0, m0, 896
s_add_u32 s38, s38, 28672
buffer_load_dwordx4 v16, s[56:59], s38 offen lds
s_mov_b32 exec_hi, -1
s_waitcnt lgkmcnt(4)
v_mfma_f32_16x16x32_bf16 v[48:51], v[228:231], v[120:123], v[48:51]
ds_read_b128 v[112:115], v23 offset:32768
ds_read_b128 v[116:119], v23 offset:33024
v_mfma_f32_16x16x32_bf16 v[52:55], v[228:231], v[124:127], v[52:55]
ds_read_b128 v[120:123], v23 offset:34816
ds_read_b128 v[124:127], v23 offset:35072
s_waitcnt lgkmcnt(6)
v_mfma_f32_16x16x32_bf16 v[48:51], v[232:235], v[128:131], v[48:51]
ds_read_b128 v[128:131], v23 offset:36864
v_permlane16_swap_b32 v105, v109
v_mfma_f32_16x16x32_bf16 v[52:55], v[232:235], v[132:135], v[52:55]
ds_read_b128 v[132:135], v23 offset:37120
v_permlane16_swap_b32 v106, v110
s_waitcnt lgkmcnt(6)
v_mfma_f32_16x16x32_bf16 v[48:51], v[236:239], v[136:139], v[48:51]
ds_read_b128 v[136:139], v23 offset:38912
s_waitcnt vmcnt(6)
ds_read2st64_b32 v[56:57], v0 offset0:64 offset1:68
s_waitcnt vmcnt(6)
ds_read2st64_b32 v[58:59], v0 offset0:96 offset1:100
v_mfma_f32_16x16x32_bf16 v[52:55], v[236:239], v[140:143], v[52:55]
ds_read_b128 v[140:143], v23 offset:39168
v_permlane16_swap_b32 v107, v111
s_waitcnt lgkmcnt(8)
v_mfma_f32_16x16x32_bf16 v[48:51], v[240:243], v[112:115], v[48:51]
v_mfma_f32_16x16x32_bf16 v[52:55], v[240:243], v[116:119], v[52:55]
s_waitcnt lgkmcnt(6)
v_mfma_f32_16x16x32_bf16 v[48:51], v[244:247], v[120:123], v[48:51]
v_mfma_f32_16x16x32_bf16 v[52:55], v[244:247], v[124:127], v[52:55]
s_waitcnt lgkmcnt(1)
v_max3_u32 v56, v56, v57, v58
v_max_u32 v56, v56, v59
v_cmp_eq_u32 vcc, -1, v56
s_cbranch_vccnz re_76
re_76b:
s_waitcnt lgkmcnt(0)
s_barrier
v_mfma_f32_16x16x32_bf16 v[48:51], v[248:251], v[128:131], v[48:51]
ds_read_b128 v[112:115], v23 offset:16384
ds_read_b128 v[116:119], v23 offset:16640
v_mfma_f32_16x16x32_bf16 v[52:55], v[248:251], v[132:135], v[52:55]
ds_read_b128 v[120:123], v23 offset:18432
ds_read_b128 v[124:127], v23 offset:18688
v_mfma_f32_16x16x32_bf16 v[48:51], v[252:255], v[136:139], v[48:51]
ds_read_b128 v[128:131], v23 offset:20480
ds_read_b128 v[132:135], v23 offset:20736
v_mfma_f32_16x16x32_bf16 v[52:55], v[252:255], v[140:143], v[52:55]
ds_read_b128 v[136:139], v23 offset:22528
ds_read_b128 v[140:143], v23 offset:22784
s_waitcnt lgkmcnt(6)
v_mfma_f32_16x16x32_bf16 v[48:51], a[224:227], v[112:115], v[48:51]
ds_read_b128 v[112:115], v23 offset:24576
v_mfma_f32_16x16x32_bf16 v[52:55], a[224:227], v[116:119], v[52:55]
ds_read_b128 v[116:119], v23 offset:24832
s_add_u32 m0, s23, 0
s_xor_b32 s38, s22, 172032
buffer_load_dwordx4 v1, s[4:7], s38 offen offset:0 sc1 lds
buffer_load_dwordx4 v1, s[4:7], s38 offen offset:1024 sc1 lds
s_waitcnt lgkmcnt(6)
v_mfma_f32_16x16x32_bf16 v[48:51], a[228:231], v[120:123], v[48:51]
ds_read_b128 v[120:123], v23 offset:26624
s_mov_b64 exec, 0x3f
buffer_load_dword a223, v15, s[4:7], s75 offen sc1
s_mov_b64 exec, -1
v_mfma_f32_16x16x32_bf16 v[52:55], a[228:231], v[124:127], v[52:55]
ds_read_b128 v[124:127], v23 offset:26880
s_waitcnt lgkmcnt(6)
v_mfma_f32_16x16x32_bf16 v[48:51], a[232:235], v[128:131], v[48:51]
ds_read_b128 v[128:131], v23 offset:28672
s_add_u32 m0, s23, 8192
s_xor_b32 s38, s22, 188416
buffer_load_dwordx4 v1, s[4:7], s38 offen offset:0 sc1 lds
buffer_load_dwordx4 v1, s[4:7], s38 offen offset:1024 sc1 lds
v_mfma_f32_16x16x32_bf16 v[52:55], a[232:235], v[132:135], v[52:55]
ds_read_b128 v[132:135], v23 offset:28928
s_waitcnt lgkmcnt(6)
v_mfma_f32_16x16x32_bf16 v[48:51], a[236:239], v[136:139], v[48:51]
ds_read_b128 v[136:139], v23 offset:30720
v_cndmask_b32 v44, v1, v6, s[92:93]
s_add_u32 m0, s23, 32768
s_xor_b32 s38, s22, 163840
buffer_load_dwordx4 v44, s[4:7], s38 offen offset:0 sc1 lds
buffer_load_dwordx4 v44, s[4:7], s38 offen offset:1024 sc1 lds
v_mfma_f32_16x16x32_bf16 v[52:55], a[236:239], v[140:143], v[52:55]
ds_read_b128 v[140:143], v23 offset:30976
s_waitcnt lgkmcnt(6)
v_mfma_f32_16x16x32_bf16 v[48:51], a[240:243], v[112:115], v[48:51]
v_mfma_f32_16x16x32_bf16 v[52:55], a[240:243], v[116:119], v[52:55]
s_waitcnt lgkmcnt(4)
v_mfma_f32_16x16x32_bf16 v[48:51], a[244:247], v[120:123], v[48:51]
v_mfma_f32_16x16x32_bf16 v[52:55], a[244:247], v[124:127], v[52:55]
s_waitcnt lgkmcnt(2)
v_mfma_f32_16x16x32_bf16 v[48:51], a[248:251], v[128:131], v[48:51]
v_mfma_f32_16x16x32_bf16 v[52:55], a[248:251], v[132:135], v[52:55]
s_waitcnt lgkmcnt(0)
v_mfma_f32_16x16x32_bf16 v[48:51], a[252:255], v[136:139], v[48:51]
v_mfma_f32_16x16x32_bf16 v[52:55], a[252:255], v[140:143], v[52:55]
s_nop 4
v_cvt_pk_bf16_f32 v56, v48, v49
v_xor_b32 v48, s24, v1
v_cvt_pk_bf16_f32 v57, v50, v51
v_cvt_pk_bf16_f32 v58, v52, v53
v_cvt_pk_bf16_f32 v59, v54, v55
s_nop 0
v_permlane16_swap_b32 v56, v58
v_permlane16_swap_b32 v57, v59
ds_write_b128 v48, v[56:59]
s_add_u32 s62, s34, 1966080
buffer_store_dwordx4 v[56:59], v1, s[4:7], s62 offen sc1
s_waitcnt lgkmcnt(0)
s_barrier
ds_read_b128 v[52:55], v12 offset:40960
s_add_u32 m0, s23, 16384
s_xor_b32 s38, s22, 180224
buffer_load_dwordx4 v6, s[4:7], s38 offen offset:0 sc1 lds
buffer_load_dwordx4 v6, s[4:7], s38 offen offset:1024 sc1 lds
s_waitcnt lgkmcnt(0)
v_lshlrev_b32 v48, 16, v52
v_and_b32 v49, s36, v52
v_lshlrev_b32 v50, 16, v53
v_and_b32 v51, s36, v53
v_lshlrev_b32 v52, 16, v54
v_and_b32 v53, s36, v54
v_lshlrev_b32 v54, 16, v55
v_and_b32 v55, s36, v55
v_pk_add_f32 v[60:61], v[48:49], v[50:51]
v_pk_mul_f32 v[62:63], v[48:49], v[48:49]
v_pk_fma_f32 v[62:63], v[50:51], v[50:51], v[62:63] op_sel:[0,0,0] op_sel_hi:[1,1,1]
v_pk_add_f32 v[60:61], v[60:61], v[52:53]
v_pk_fma_f32 v[62:63], v[52:53], v[52:53], v[62:63] op_sel:[0,0,0] op_sel_hi:[1,1,1]
v_pk_add_f32 v[60:61], v[60:61], v[54:55]
v_pk_fma_f32 v[62:63], v[54:55], v[54:55], v[62:63] op_sel:[0,0,0] op_sel_hi:[1,1,1]
v_add_f32 v60, v60, v61
v_add_f32 v62, v62, v63
v_pk_add_f32 v[24:25], v[24:25], v[48:49]
v_pk_add_f32 v[26:27], v[26:27], v[50:51]
v_permlane32_swap_b32 v60, v62
v_add_f32 v60, v60, v62
v_mov_b32 v62, v60
v_pk_add_f32 v[28:29], v[28:29], v[52:53]
v_pk_add_f32 v[30:31], v[30:31], v[54:55]
v_permlane16_swap_b32 v60, v62
v_add_f32 v60, v60, v62
s_nop 1
v_add_f32_dpp v60, v60, v60 row_ror:8 row_mask:0xf bank_mask:0xf
s_waitcnt vmcnt(8)
ds_read2st64_b32 v[20:21], v0 offset0:0 offset1:4
s_waitcnt vmcnt(2)
s_barrier
s_add_u32 s62, s42, 532480
buffer_store_dword v60, v8, s[4:7], s62 offen offset:0 sc1
s_waitcnt lgkmcnt(0)
v_max_u32 v20, v20, v21
v_cmp_eq_u32 vcc, -1, v20
s_cbranch_vccnz re_77
re_77b:
s_barrier
ds_read_b128 v[88:91], v23 offset:0
ds_read_b128 v[92:95], v23 offset:256
ds_read_b128 v[96:99], v23 offset:2048
ds_read_b128 v[100:103], v23 offset:2304
ds_read2st64_b32 v[20:21], v0 offset0:32 offset1:36
s_mov_b32 exec_hi, 0x00ffffff
s_xor_b32 s38, s18, 14
s_mul_i32 s38, s38, 7168
s_add_u32 m0, s39, s38
s_lshl4_add_u32 s38, s38, s16
buffer_load_dwordx4 v16, s[56:59], s38 offen lds
s_add_u32 m0, m0, 896
s_add_u32 s38, s38, 28672
buffer_load_dwordx4 v16, s[56:59], s38 offen lds
s_mov_b32 exec_hi, -1
s_waitcnt vmcnt(3)
ds_read2st64_b32 v[46:47], v0 offset0:64 offset1:68
s_waitcnt lgkmcnt(1)
v_max_u32 v20, v20, v21
v_cmp_eq_u32 vcc, -1, v20
s_cbranch_vccnz re_78
re_78b:
ds_read2st64_b32 v[20:21], v0 offset0:128 offset1:132
v_mfma_f32_16x16x32_bf16 v[80:83], v[224:227], v[88:91], v[104:107]
ds_read_b128 v[88:91], v23 offset:4096
s_mov_b32 exec_hi, 0x00ffffff
s_xor_b32 s38, s18, 15
s_mul_i32 s38, s38, 7168
s_add_u32 m0, s39, s38
s_lshl4_add_u32 s38, s38, s16
buffer_load_dwordx4 v16, s[56:59], s38 offen lds
s_add_u32 m0, m0, 896
s_add_u32 s38, s38, 28672
buffer_load_dwordx4 v16, s[56:59], s38 offen lds
s_mov_b32 exec_hi, -1
s_waitcnt lgkmcnt(1)
v_max3_u32 v20, v20, v21, v46
v_max_u32 v20, v20, v47
v_cmp_eq_u32 vcc, -1, v20
s_cbranch_vccnz re_79
re_79b:
v_cndmask_b32 v44, 0, 64, s[30:31]
v_add_u32 v6, v6, v44
v_mfma_f32_16x16x32_bf16 v[84:87], v[224:227], v[92:95], v[108:111]
ds_read_b128 v[92:95], v23 offset:4352
v_mov_b32 v44, 0x3f803f80
v_mov_b32 v46, 0x3f803f80
v_mfma_f32_16x16x32_bf16 v[80:83], v[228:231], v[96:99], v[80:83]
ds_read_b128 v[96:99], v23 offset:6144
v_mov_b32 v47, 0x3f803f80
v_mfma_f32_16x16x32_bf16 v[84:87], v[228:231], v[100:103], v[84:87]
ds_read_b128 v[100:103], v23 offset:6400
s_waitcnt lgkmcnt(2)
v_mfma_f32_16x16x32_bf16 v[80:83], v[232:235], v[88:91], v[80:83]
v_mfma_f32_16x16x32_bf16 v[84:87], v[232:235], v[92:95], v[84:87]
s_waitcnt lgkmcnt(0)
s_barrier
ds_read_b128 v[88:91], v23 offset:8192
ds_read_b128 v[92:95], v23 offset:8448
v_mfma_f32_16x16x32_bf16 v[80:83], v[236:239], v[96:99], v[80:83]
ds_read_b128 v[96:99], v23 offset:10240
v_mfma_f32_16x16x32_bf16 v[84:87], v[236:239], v[100:103], v[84:87]
ds_read_b128 v[100:103], v23 offset:10496
s_waitcnt lgkmcnt(2)
v_mfma_f32_16x16x32_bf16 v[80:83], v[240:243], v[88:91], v[80:83]
ds_read_b128 v[88:91], v23 offset:12288
v_mfma_f32_16x16x32_bf16 v[84:87], v[240:243], v[92:95], v[84:87]
ds_read_b128 v[92:95], v23 offset:12544
s_waitcnt lgkmcnt(2)
v_mfma_f32_16x16x32_bf16 v[80:83], v[244:247], v[96:99], v[80:83]
ds_read_b128 v[96:99], v23 offset:14336
v_mfma_f32_16x16x32_bf16 v[84:87], v[244:247], v[100:103], v[84:87]
ds_read_b128 v[100:103], v23 offset:14592
s_waitcnt lgkmcnt(2)
v_mfma_f32_16x16x32_bf16 v[80:83], v[248:251], v[88:91], v[80:83]
v_mfma_f32_16x16x32_bf16 v[84:87], v[248:251], v[92:95], v[84:87]
s_waitcnt lgkmcnt(0)
s_barrier
ds_read_b128 v[88:91], v23 offset:32768
ds_read_b128 v[92:95], v23 offset:33024
v_mfma_f32_16x16x32_bf16 v[80:83], v[252:255], v[96:99], v[80:83]
ds_read_b128 v[96:99], v23 offset:34816
v_mfma_f32_16x16x32_bf16 v[84:87], v[252:255], v[100:103], v[84:87]
ds_read_b128 v[100:103], v23 offset:35072
s_waitcnt lgkmcnt(2)
v_mfma_f32_16x16x32_bf16 v[80:83], a[224:227], v[88:91], v[80:83]
ds_read_b128 v[88:91], v23 offset:36864
v_mfma_f32_16x16x32_bf16 v[84:87], a[224:227], v[92:95], v[84:87]
ds_read_b128 v[92:95], v23 offset:37120
s_waitcnt lgkmcnt(2)
v_mfma_f32_16x16x32_bf16 v[80:83], a[228:231], v[96:99], v[80:83]
ds_read_b128 v[96:99], v23 offset:38912
v_mfma_f32_16x16x32_bf16 v[84:87], a[228:231], v[100:103], v[84:87]
ds_read_b128 v[100:103], v23 offset:39168
s_lshl_b32 s60, s71, 8
v_xor_b32 v112, s60, v1
s_add_u32 s62, s51, 532480
buffer_load_dwordx4 v[116:119], v112, s[4:7], s62 offen offset:1024 sc1
buffer_load_dwordx4 v[112:115], v112, s[4:7], s62 offen offset:0 sc1
s_waitcnt lgkmcnt(2)
v_mfma_f32_16x16x32_bf16 v[80:83], a[232:235], v[88:91], v[80:83]
ds_read_b128 v[88:91], v23 offset:16384
s_lshl2_add_u32 m0, s46, 114688
s_lshl4_add_u32 s3, s82, s49
buffer_load_dwordx4 v42, s[52:55], s3 offen offset:0 lds
v_mfma_f32_16x16x32_bf16 v[84:87], a[232:235], v[92:95], v[84:87]
ds_read_b128 v[92:95], v23 offset:16640
s_waitcnt lgkmcnt(2)
v_mfma_f32_16x16x32_bf16 v[80:83], a[236:239], v[96:99], v[80:83]
ds_read_b128 v[96:99], v23 offset:18432
buffer_load_dwordx4 v11, s[52:55], s3 offen offset:1024 lds
v_mfma_f32_16x16x32_bf16 v[84:87], a[236:239], v[100:103], v[84:87]
ds_read_b128 v[100:103], v23 offset:18688
s_add_u32 s3, s3, 14336
buffer_load_dwordx4 v42, s[52:55], s3 offen offset:2048 lds
s_waitcnt lgkmcnt(2)
v_mfma_f32_16x16x32_bf16 v[80:83], a[240:243], v[88:91], v[80:83]
ds_read_b128 v[88:91], v23 offset:20480
buffer_load_dwordx4 v11, s[52:55], s3 offen offset:3072 lds
v_mfma_f32_16x16x32_bf16 v[84:87], a[240:243], v[92:95], v[84:87]
ds_read_b128 v[92:95], v23 offset:20736
s_waitcnt lgkmcnt(2)
v_mfma_f32_16x16x32_bf16 v[80:83], a[244:247], v[96:99], v[80:83]
ds_read_b128 v[96:99], v23 offset:22528
s_waitcnt vmcnt(6)
s_barrier
v_mfma_f32_16x16x32_bf16 v[84:87], a[244:247], v[100:103], v[84:87]
ds_read_b128 v[100:103], v23 offset:22784
ds_read_b64_tr_b16 v[144:145], v13 offset:0
ds_read_b64_tr_b16 v[146:147], v13 offset:1792
s_waitcnt lgkmcnt(4)
v_mfma_f32_16x16x32_bf16 v[80:83], a[248:251], v[88:91], v[80:83]
ds_read_b64_tr_b16 v[148:149], v13 offset:32
ds_read_b64_tr_b16 v[150:151], v13 offset:1824
ds_read_b64_tr_b16 v[152:153], v13 offset:64
v_mfma_f32_16x16x32_bf16 v[84:87], a[248:251], v[92:95], v[84:87]
ds_read_b64_tr_b16 v[154:155], v13 offset:1856
ds_read_b64_tr_b16 v[156:157], v14 offset:0
ds_read_b64_tr_b16 v[158:159], v14 offset:1792
s_waitcnt lgkmcnt(8)
v_mfma_f32_16x16x32_bf16 v[80:83], a[252:255], v[96:99], v[80:83]
v_mfma_f32_16x16x32_bf16 v[84:87], a[252:255], v[100:103], v[84:87]
s_waitcnt vmcnt(4)
v_add_f32 v112, v112, v116
v_add_f32 v113, v113, v117
v_pk_add_f32 v[114:115], v[114:115], v[118:119]
v_pk_add_f32 v[112:113], v[112:113], v[114:115]
v_cvt_pk_bf16_f32 v88, v80, v81
v_xor_b32 v80, s24, v1
v_permlane32_swap_b32 v112, v113
v_add_f32 v112, v112, v113
v_cmp_u_f32 vcc, v112, v112
s_cbranch_vccnz re_80
re_80b:
s_xor_b32 s64, s50, 1966080
s_sub_u32 s64, s64, 114688
buffer_load_dwordx4 v[120:123], v23, s[4:7], s64 offen offset:0 sc1
v_mul_f32 v112, 0x3b000000, v112
v_mov_b32 v113, v112
s_xor_b32 s67, s64, 256
buffer_load_dwordx4 v[124:127], v23, s[4:7], s67 offen offset:0 sc1
v_permlane32_swap_b32 v112, v113
buffer_load_dwordx4 v[128:131], v23, s[4:7], s64 offen offset:2048 sc1
v_fma_f32 v113, -v112, v112, v113
s_xor_b32 s64, s50, 1970176
s_sub_u32 s64, s64, 114688
buffer_load_dwordx4 v[136:139], v23, s[4:7], s64 offen offset:0 sc1
v_max_f32 v113, 0, v113
v_add_f32 v114, 0x3727c5ac, v113
v_rsq_f32 v114, v114
v_cvt_pk_bf16_f32 v113, -v112, -v112
buffer_load_dwordx4 v[132:135], v23, s[4:7], s67 offen offset:2048 sc1
v_lshlrev_b32 v113, 16, v113
v_sub_f32 v113, -v112, v113
v_mul_f32 v19, 0xc0135761, v114
v_mul_f32 v18, v114, v114
s_xor_b32 s67, s64, 256
buffer_load_dwordx4 v[140:143], v23, s[4:7], s67 offen offset:0 sc1
v_rcp_f32 v40, v114
v_mul_f32 v18, v18, v19
v_mul_f32 v18, 0x3d372713, v18
v_cvt_pk_bf16_f32 v22, -v112, v113
v_cvt_pk_bf16_f32 v89, v82, v83
v_cvt_pk_bf16_f32 v90, v84, v85
v_cvt_pk_bf16_f32 v91, v86, v87
s_nop 0
v_permlane16_swap_b32 v88, v90
v_permlane16_swap_b32 v89, v91
buffer_load_dwordx4 v[112:115], v23, s[4:7], s64 offen offset:2048 sc1
ds_write_b128 v80, v[88:91]
s_add_u32 s62, s34, 1998848
buffer_store_dwordx4 v[88:91], v1, s[4:7], s62 offen sc1
s_waitcnt lgkmcnt(0)
s_barrier
ds_read_b128 v[84:87], v12 offset:40960
buffer_load_dwordx4 v[116:119], v23, s[4:7], s67 offen offset:2048 sc1
s_waitcnt lgkmcnt(0)
v_lshlrev_b32 v80, 16, v84
v_and_b32 v81, s36, v84
v_lshlrev_b32 v82, 16, v85
s_lshl2_add_u32 m0, s46, 131072
s_lshl4_add_u32 s3, s82, s17
buffer_load_dwordx4 v42, s[52:55], s3 offen offset:0 lds
s_waitcnt vmcnt(12)
ds_read_b64_tr_b16 a[96:97], v43 offset:36864
ds_read_b64_tr_b16 a[100:101], v43 offset:36872
ds_read_b64_tr_b16 a[98:99], v43 offset:37120
ds_read_b64_tr_b16 a[102:103], v43 offset:37128
v_and_b32 v83, s36, v85
v_lshlrev_b32 v84, 16, v86
v_and_b32 v85, s36, v86
v_lshlrev_b32 v86, 16, v87
v_and_b32 v87, s36, v87
v_pk_add_f32 v[92:93], v[80:81], v[82:83]
buffer_load_dwordx4 v11, s[52:55], s3 offen offset:1024 lds
v_pk_mul_f32 v[94:95], v[80:81], v[80:81]
v_pk_fma_f32 v[94:95], v[82:83], v[82:83], v[94:95] op_sel:[0,0,0] op_sel_hi:[1,1,1]
v_pk_add_f32 v[92:93], v[92:93], v[84:85]
v_pk_fma_f32 v[94:95], v[84:85], v[84:85], v[94:95] op_sel:[0,0,0] op_sel_hi:[1,1,1]
v_pk_add_f32 v[92:93], v[92:93], v[86:87]
v_pk_fma_f32 v[94:95], v[86:87], v[86:87], v[94:95] op_sel:[0,0,0] op_sel_hi:[1,1,1]
v_add_f32 v92, v92, v93
v_add_f32 v94, v94, v95
v_pk_add_f32 v[32:33], v[32:33], v[80:81]
v_pk_add_f32 v[34:35], v[34:35], v[82:83]
s_xor_b32 s64, s50, 1974272
s_sub_u32 s64, s64, 114688
buffer_load_dwordx4 v[80:83], v23, s[4:7], s64 offen offset:0 sc1
v_permlane32_swap_b32 v92, v94
s_waitcnt vmcnt(11)
v_mfma_f32_16x16x32_bf16 v[48:51], v[144:147], v[120:123], 0
ds_read_b64_tr_b16 a[104:105], v43 offset:38912
ds_read_b64_tr_b16 a[108:109], v43 offset:38920
ds_read_b64_tr_b16 a[106:107], v43 offset:39168
s_waitcnt vmcnt(10)
v_mfma_f32_16x16x32_bf16 v[52:55], v[144:147], v[124:127], 0
ds_read_b64_tr_b16 v[144:145], v13 offset:7168
s_add_u32 s3, s3, 14336
buffer_load_dwordx4 v42, s[52:55], s3 offen offset:2048 lds
v_mfma_f32_16x16x32_bf16 v[56:59], v[148:151], v[120:123], 0
ds_read_b64_tr_b16 v[146:147], v13 offset:8960
ds_read_b64_tr_b16 a[110:111], v43 offset:39176
v_add_f32 v92, v92, v94
v_mfma_f32_16x16x32_bf16 v[60:63], v[148:151], v[124:127], 0
ds_read_b64_tr_b16 v[148:149], v13 offset:7200
v_mov_b32 v94, v92
v_add_f32 v36, v36, v84
v_add_f32 v37, v37, v85
v_mfma_f32_16x16x32_bf16 v[64:67], v[152:155], v[120:123], 0
ds_read_b64_tr_b16 v[150:151], v13 offset:8992
v_permlane16_swap_b32 v92, v94
v_mfma_f32_16x16x32_bf16 v[68:71], v[152:155], v[124:127], 0
ds_read_b64_tr_b16 v[152:153], v13 offset:7232
buffer_load_dwordx4 v[124:127], v23, s[4:7], s64 offen offset:2048 sc1
v_mfma_f32_16x16x32_bf16 v[72:75], v[156:159], v[120:123], 0
ds_read_b64_tr_b16 v[154:155], v13 offset:9024
ds_read_b64_tr_b16 v[156:157], v14 offset:7168
v_add_f32 v92, v92, v94
s_waitcnt vmcnt(11) lgkmcnt(6)
v_mfma_f32_16x16x32_bf16 v[48:51], v[144:147], v[128:131], v[48:51]
ds_read_b64_tr_b16 v[158:159], v14 offset:8960
v_add_f32_dpp v92, v92, v92 row_ror:8 row_mask:0xf bank_mask:0xf
v_add_f32 v38, v38, v86
v_add_f32 v39, v39, v87
s_waitcnt vmcnt(9)
v_mfma_f32_16x16x32_bf16 v[52:55], v[144:147], v[132:135], v[52:55]
ds_read_b64_tr_b16 v[144:145], v13 offset:14336
s_xor_b32 s67, s64, 256
buffer_load_dwordx4 v[120:123], v23, s[4:7], s67 offen offset:0 sc1
s_waitcnt lgkmcnt(5)
v_mfma_f32_16x16x32_bf16 v[56:59], v[148:151], v[128:131], v[56:59]
ds_read_b64_tr_b16 v[146:147], v13 offset:16128
s_waitcnt vmcnt(7)
s_barrier
v_mfma_f32_16x16x32_bf16 v[60:63], v[148:151], v[132:135], v[60:63]
ds_read_b64_tr_b16 v[148:149], v13 offset:14368
s_add_u32 s62, s42, 532480
buffer_store_dword v92, v8, s[4:7], s62 offen offset:2048 sc1
s_waitcnt lgkmcnt(5)
v_mfma_f32_16x16x32_bf16 v[64:67], v[152:155], v[128:131], v[64:67]
ds_read_b64_tr_b16 v[150:151], v13 offset:16160
buffer_load_dwordx4 v[84:87], v23, s[4:7], s67 offen offset:2048 sc1
v_mfma_f32_16x16x32_bf16 v[68:71], v[152:155], v[132:135], v[68:71]
ds_read_b64_tr_b16 v[152:153], v13 offset:14400
s_waitcnt lgkmcnt(5)
v_mfma_f32_16x16x32_bf16 v[72:75], v[156:159], v[128:131], v[72:75]
ds_read_b64_tr_b16 v[154:155], v13 offset:16192
ds_read_b64_tr_b16 v[156:157], v14 offset:14336
s_xor_b32 s64, s50, 1978368
s_sub_u32 s64, s64, 114688
buffer_load_dwordx4 v[128:131], v23, s[4:7], s64 offen offset:0 sc1
s_waitcnt lgkmcnt(5)
v_mfma_f32_16x16x32_bf16 v[48:51], v[144:147], v[136:139], v[48:51]
ds_read_b64_tr_b16 v[158:159], v14 offset:16128
v_mfma_f32_16x16x32_bf16 v[52:55], v[144:147], v[140:143], v[52:55]
v_mfma_f32_16x16x32_bf16 v[96:99], v[44:47], v[144:147], 0
ds_read_b64_tr_b16 v[144:145], v13 offset:21504
s_xor_b32 s67, s64, 256
buffer_load_dwordx4 v[132:135], v23, s[4:7], s67 offen offset:0 sc1
s_waitcnt lgkmcnt(5)
v_mfma_f32_16x16x32_bf16 v[56:59], v[148:151], v[136:139], v[56:59]
ds_read_b64_tr_b16 v[146:147], v13 offset:23296
v_mfma_f32_16x16x32_bf16 v[60:63], v[148:151], v[140:143], v[60:63]
v_mfma_f32_16x16x32_bf16 v[100:103], v[44:47], v[148:151], 0
ds_read_b64_tr_b16 v[148:149], v13 offset:21536
s_waitcnt lgkmcnt(5)
v_mfma_f32_16x16x32_bf16 v[64:67], v[152:155], v[136:139], v[64:67]
ds_read_b64_tr_b16 v[150:151], v13 offset:23328
buffer_load_dwordx4 v[88:91], v23, s[4:7], s64 offen offset:2048 sc1
v_mfma_f32_16x16x32_bf16 v[68:71], v[152:155], v[140:143], v[68:71]
v_mfma_f32_16x16x32_bf16 v[104:107], v[44:47], v[152:155], 0
ds_read_b64_tr_b16 v[152:153], v13 offset:21568
s_waitcnt lgkmcnt(5)
v_mfma_f32_16x16x32_bf16 v[72:75], v[156:159], v[136:139], v[72:75]
ds_read_b64_tr_b16 v[154:155], v13 offset:23360
s_xor_b32 s64, s50, 1982464
s_sub_u32 s64, s64, 114688
buffer_load_dwordx4 v[140:143], v23, s[4:7], s64 offen offset:0 sc1
v_mfma_f32_16x16x32_bf16 v[108:111], v[44:47], v[156:159], 0
ds_read_b64_tr_b16 v[156:157], v14 offset:21504
s_waitcnt lgkmcnt(5)
v_mfma_f32_16x16x32_bf16 v[48:51], v[144:147], v[112:115], v[48:51]
ds_read_b64_tr_b16 v[158:159], v14 offset:23296
s_waitcnt vmcnt(12)
v_mfma_f32_16x16x32_bf16 v[52:55], v[144:147], v[116:119], v[52:55]
v_mfma_f32_16x16x32_bf16 v[96:99], v[44:47], v[144:147], v[96:99]
ds_read_b64_tr_b16 v[144:145], v13 offset:28672
buffer_load_dwordx4 v[136:139], v23, s[4:7], s67 offen offset:2048 sc1
s_waitcnt lgkmcnt(5)
v_mfma_f32_16x16x32_bf16 v[56:59], v[148:151], v[112:115], v[56:59]
ds_read_b64_tr_b16 v[146:147], v13 offset:30464
v_mfma_f32_16x16x32_bf16 v[60:63], v[148:151], v[116:119], v[60:63]
v_mfma_f32_16x16x32_bf16 v[100:103], v[44:47], v[148:151], v[100:103]
ds_read_b64_tr_b16 v[148:149], v13 offset:28704
s_waitcnt lgkmcnt(5)
v_mfma_f32_16x16x32_bf16 v[64:67], v[152:155], v[112:115], v[64:67]
ds_read_b64_tr_b16 v[150:151], v13 offset:30496
s_xor_b32 s67, s64, 256
buffer_load_dwordx4 v[92:95], v23, s[4:7], s67 offen offset:0 sc1
v_mfma_f32_16x16x32_bf16 v[68:71], v[152:155], v[116:119], v[68:71]
v_mfma_f32_16x16x32_bf16 v[104:107], v[44:47], v[152:155], v[104:107]
ds_read_b64_tr_b16 v[152:153], v13 offset:28736
s_waitcnt lgkmcnt(5)
v_mfma_f32_16x16x32_bf16 v[72:75], v[156:159], v[112:115], v[72:75]
ds_read_b64_tr_b16 v[154:155], v13 offset:30528
v_mfma_f32_16x16x32_bf16 v[108:111], v[44:47], v[156:159], v[108:111]
ds_read_b64_tr_b16 v[156:157], v14 offset:28672
buffer_load_dwordx4 v[112:115], v23, s[4:7], s64 offen offset:2048 sc1
s_waitcnt vmcnt(12) lgkmcnt(5)
v_mfma_f32_16x16x32_bf16 v[48:51], v[144:147], v[80:83], v[48:51]
ds_read_b64_tr_b16 v[158:159], v14 offset:30464
ds_read_b64_tr_b16 a[112:113], v43 offset:53248
ds_read_b64_tr_b16 a[116:117], v43 offset:53256
ds_read_b64_tr_b16 a[114:115], v43 offset:53504
ds_read_b64_tr_b16 a[118:119], v43 offset:53512
buffer_load_dwordx4 v[116:119], v23, s[4:7], s67 offen offset:2048 sc1
s_waitcnt vmcnt(10)
v_mfma_f32_16x16x32_bf16 v[52:55], v[144:147], v[120:123], v[52:55]
buffer_load_dwordx4 v11, s[52:55], s3 offen offset:3072 lds
v_mfma_f32_16x16x32_bf16 v[96:99], v[44:47], v[144:147], v[96:99]
ds_read_b64_tr_b16 v[144:145], v13 offset:35840
s_waitcnt lgkmcnt(9)
v_mfma_f32_16x16x32_bf16 v[56:59], v[148:151], v[80:83], v[56:59]
ds_read_b64_tr_b16 v[146:147], v13 offset:37632
v_mfma_f32_16x16x32_bf16 v[60:63], v[148:151], v[120:123], v[60:63]
s_lshl2_add_u32 m0, s46, 114688
s_lshl4_add_u32 s3, s83, s49
buffer_load_dwordx4 v42, s[52:55], s3 offen offset:0 lds
v_mfma_f32_16x16x32_bf16 v[100:103], v[44:47], v[148:151], v[100:103]
ds_read_b64_tr_b16 v[148:149], v13 offset:35872
s_waitcnt lgkmcnt(9)
v_mfma_f32_16x16x32_bf16 v[64:67], v[152:155], v[80:83], v[64:67]
ds_read_b64_tr_b16 v[150:151], v13 offset:37664
v_mfma_f32_16x16x32_bf16 v[68:71], v[152:155], v[120:123], v[68:71]
v_mfma_f32_16x16x32_bf16 v[104:107], v[44:47], v[152:155], v[104:107]
ds_read_b64_tr_b16 v[152:153], v13 offset:35904
s_xor_b32 s64, s50, 1986560
s_sub_u32 s64, s64, 114688
buffer_load_dwordx4 v[120:123], v23, s[4:7], s64 offen offset:0 sc1
s_waitcnt lgkmcnt(9)
v_mfma_f32_16x16x32_bf16 v[72:75], v[156:159], v[80:83], v[72:75]
ds_read_b64_tr_b16 v[154:155], v13 offset:37696
v_mfma_f32_16x16x32_bf16 v[108:111], v[44:47], v[156:159], v[108:111]
ds_read_b64_tr_b16 v[156:157], v14 offset:35840
s_waitcnt lgkmcnt(5)
v_mfma_f32_16x16x32_bf16 v[48:51], v[144:147], v[124:127], v[48:51]
ds_read_b64_tr_b16 v[158:159], v14 offset:37632
buffer_load_dwordx4 v[80:83], v23, s[4:7], s64 offen offset:2048 sc1
s_waitcnt vmcnt(12)
v_mfma_f32_16x16x32_bf16 v[52:55], v[144:147], v[84:87], v[52:55]
v_mfma_f32_16x16x32_bf16 v[96:99], v[44:47], v[144:147], v[96:99]
ds_read_b64_tr_b16 v[144:145], v13 offset:43008
s_waitcnt lgkmcnt(5)
v_mfma_f32_16x16x32_bf16 v[56:59], v[148:151], v[124:127], v[56:59]
ds_read_b64_tr_b16 v[146:147], v13 offset:44800
v_mfma_f32_16x16x32_bf16 v[60:63], v[148:151], v[84:87], v[60:63]
buffer_load_dwordx4 v11, s[52:55], s3 offen offset:1024 lds
v_mfma_f32_16x16x32_bf16 v[100:103], v[44:47], v[148:151], v[100:103]
ds_read_b64_tr_b16 v[148:149], v13 offset:43040
s_waitcnt lgkmcnt(5)
v_mfma_f32_16x16x32_bf16 v[64:67], v[152:155], v[124:127], v[64:67]
ds_read_b64_tr_b16 v[150:151], v13 offset:44832
v_mfma_f32_16x16x32_bf16 v[68:71], v[152:155], v[84:87], v[68:71]
v_mfma_f32_16x16x32_bf16 v[104:107], v[44:47], v[152:155], v[104:107]
ds_read_b64_tr_b16 v[152:153], v13 offset:43072
s_add_u32 s3, s3, 14336
buffer_load_dwordx4 v42, s[52:55], s3 offen offset:2048 lds
s_waitcnt lgkmcnt(5)
v_mfma_f32_16x16x32_bf16 v[72:75], v[156:159], v[124:127], v[72:75]
ds_read_b64_tr_b16 v[154:155], v13 offset:44864
v_mfma_f32_16x16x32_bf16 v[108:111], v[44:47], v[156:159], v[108:111]
ds_read_b64_tr_b16 v[156:157], v14 offset:43008
s_waitcnt vmcnt(13) lgkmcnt(5)
v_mfma_f32_16x16x32_bf16 v[48:51], v[144:147], v[128:131], v[48:51]
ds_read_b64_tr_b16 v[158:159], v14 offset:44800
s_xor_b32 s67, s64, 256
buffer_load_dwordx4 v[124:127], v23, s[4:7], s67 offen offset:0 sc1
s_waitcnt vmcnt(13)
v_mfma_f32_16x16x32_bf16 v[52:55], v[144:147], v[132:135], v[52:55]
v_mfma_f32_16x16x32_bf16 v[96:99], v[44:47], v[144:147], v[96:99]
ds_read_b64_tr_b16 v[144:145], v13 offset:50176
s_waitcnt lgkmcnt(5)
v_mfma_f32_16x16x32_bf16 v[56:59], v[148:151], v[128:131], v[56:59]
ds_read_b64_tr_b16 v[146:147], v13 offset:51968
v_mfma_f32_16x16x32_bf16 v[60:63], v[148:151], v[132:135], v[60:63]
s_xor_b32 s64, s50, 1990656
s_sub_u32 s64, s64, 114688
buffer_load_dwordx4 v[84:87], v23, s[4:7], s64 offen offset:0 sc1
v_mfma_f32_16x16x32_bf16 v[100:103], v[44:47], v[148:151], v[100:103]
ds_read_b64_tr_b16 v[148:149], v13 offset:50208
s_waitcnt lgkmcnt(5)
v_mfma_f32_16x16x32_bf16 v[64:67], v[152:155], v[128:131], v[64:67]
ds_read_b64_tr_b16 v[150:151], v13 offset:52000
v_mfma_f32_16x16x32_bf16 v[68:71], v[152:155], v[132:135], v[68:71]
v_mfma_f32_16x16x32_bf16 v[104:107], v[44:47], v[152:155], v[104:107]
ds_read_b64_tr_b16 v[152:153], v13 offset:50240
buffer_load_dwordx4 v11, s[52:55], s3 offen offset:3072 lds
s_waitcnt lgkmcnt(5)
v_mfma_f32_16x16x32_bf16 v[72:75], v[156:159], v[128:131], v[72:75]
ds_read_b64_tr_b16 v[154:155], v13 offset:52032
v_mfma_f32_16x16x32_bf16 v[108:111], v[44:47], v[156:159], v[108:111]
ds_read_b64_tr_b16 v[156:157], v14 offset:50176
s_waitcnt vmcnt(14) lgkmcnt(5)
v_mfma_f32_16x16x32_bf16 v[48:51], v[144:147], v[88:91], v[48:51]
ds_read_b64_tr_b16 v[158:159], v14 offset:51968
s_waitcnt vmcnt(12)
v_mfma_f32_16x16x32_bf16 v[52:55], v[144:147], v[136:139], v[52:55]
v_mfma_f32_16x16x32_bf16 v[96:99], v[44:47], v[144:147], v[96:99]
v_add_u32 v13, s65, v13
ds_read_b64_tr_b16 v[144:145], v13 offset:0
s_waitcnt lgkmcnt(5)
v_mfma_f32_16x16x32_bf16 v[56:59], v[148:151], v[88:91], v[56:59]
ds_read_b64_tr_b16 v[146:147], v13 offset:1792
v_mfma_f32_16x16x32_bf16 v[60:63], v[148:151], v[136:139], v[60:63]
s_lshl_b32 s60, s71, 8
v_xor_b32 v128, s60, v1
s_add_u32 s62, s51, 532480
buffer_load_dwordx4 v[132:135], v128, s[4:7], s62 offen offset:3072 sc1
buffer_load_dwordx4 v[128:131], v128, s[4:7], s62 offen offset:2048 sc1
v_mfma_f32_16x16x32_bf16 v[100:103], v[44:47], v[148:151], v[100:103]
ds_read_b64_tr_b16 v[148:149], v13 offset:32
s_waitcnt lgkmcnt(5)
v_mfma_f32_16x16x32_bf16 v[64:67], v[152:155], v[88:91], v[64:67]
ds_read_b64_tr_b16 v[150:151], v13 offset:1824
v_mfma_f32_16x16x32_bf16 v[68:71], v[152:155], v[136:139], v[68:71]
v_mfma_f32_16x16x32_bf16 v[104:107], v[44:47], v[152:155], v[104:107]
ds_read_b64_tr_b16 v[152:153], v13 offset:64
buffer_load_dwordx4 v[136:139], v23, s[4:7], s67 offen offset:2048 sc1
s_waitcnt lgkmcnt(5)
v_mfma_f32_16x16x32_bf16 v[72:75], v[156:159], v[88:91], v[72:75]
ds_read_b64_tr_b16 v[154:155], v13 offset:1856
v_mfma_f32_16x16x32_bf16 v[108:111], v[44:47], v[156:159], v[108:111]
v_add_u32 v14, s65, v14
ds_read_b64_tr_b16 v[156:157], v14 offset:0
s_waitcnt lgkmcnt(5)
v_mfma_f32_16x16x32_bf16 v[48:51], v[144:147], v[140:143], v[48:51]
ds_read_b64_tr_b16 v[158:159], v14 offset:1792
s_waitcnt vmcnt(14)
v_mfma_f32_16x16x32_bf16 v[52:55], v[144:147], v[92:95], v[52:55]
v_mfma_f32_16x16x32_bf16 v[96:99], v[44:47], v[144:147], v[96:99]
ds_read_b64_tr_b16 v[144:145], v13 offset:7168
s_waitcnt vmcnt(11)
ds_read_b64_tr_b16 a[120:121], v43 offset:55296
s_waitcnt lgkmcnt(6)
v_mfma_f32_16x16x32_bf16 v[56:59], v[148:151], v[140:143], v[56:59]
ds_read_b64_tr_b16 v[146:147], v13 offset:8960
ds_read_b64_tr_b16 a[124:125], v43 offset:55304
ds_read_b64_tr_b16 a[122:123], v43 offset:55552
v_mfma_f32_16x16x32_bf16 v[60:63], v[148:151], v[92:95], v[60:63]
ds_read_b64_tr_b16 a[126:127], v43 offset:55560
v_mfma_f32_16x16x32_bf16 v[100:103], v[44:47], v[148:151], v[100:103]
ds_read_b64_tr_b16 v[148:149], v13 offset:7200
s_waitcnt lgkmcnt(9)
v_mfma_f32_16x16x32_bf16 v[64:67], v[152:155], v[140:143], v[64:67]
ds_read_b64_tr_b16 v[150:151], v13 offset:8992
v_mfma_f32_16x16x32_bf16 v[68:71], v[152:155], v[92:95], v[68:71]
s_lshl2_add_u32 m0, s46, 131072
s_lshl4_add_u32 s3, s83, s17
buffer_load_dwordx4 v42, s[52:55], s3 offen offset:0 lds
v_mfma_f32_16x16x32_bf16 v[104:107], v[44:47], v[152:155], v[104:107]
ds_read_b64_tr_b16 v[152:153], v13 offset:7232
buffer_load_dwordx4 v11, s[52:55], s3 offen offset:1024 lds
s_waitcnt lgkmcnt(9)
v_mfma_f32_16x16x32_bf16 v[72:75], v[156:159], v[140:143], v[72:75]
ds_read_b64_tr_b16 v[154:155], v13 offset:9024
s_xor_b32 s67, s64, 256
buffer_load_dwordx4 v[140:143], v23, s[4:7], s67 offen offset:0 sc1
v_mfma_f32_16x16x32_bf16 v[108:111], v[44:47], v[156:159], v[108:111]
ds_read_b64_tr_b16 v[156:157], v14 offset:7168
s_waitcnt lgkmcnt(8)
v_mfma_f32_16x16x32_bf16 v[48:51], v[144:147], v[112:115], v[48:51]
ds_read_b64_tr_b16 v[158:159], v14 offset:8960
v_mfma_f32_16x16x32_bf16 v[52:55], v[144:147], v[116:119], v[52:55]
v_mfma_f32_16x16x32_bf16 v[96:99], v[44:47], v[144:147], v[96:99]
ds_read_b64_tr_b16 v[144:145], v13 offset:14336
s_waitcnt lgkmcnt(5)
v_mfma_f32_16x16x32_bf16 v[56:59], v[148:151], v[112:115], v[56:59]
ds_read_b64_tr_b16 v[146:147], v13 offset:16128
v_mfma_f32_16x16x32_bf16 v[60:63], v[148:151], v[116:119], v[60:63]
s_lshl_b32 s60, s12, 8
s_add_u32 s60, s60, 159744
v_lshrrev_b32 v98, 2, v1
v_add_u32 v98, s60, v98
v_mfma_f32_16x16x32_bf16 v[100:103], v[44:47], v[148:151], v[100:103]
ds_read_b64_tr_b16 v[148:149], v13 offset:14368
s_waitcnt lgkmcnt(5)
v_mfma_f32_16x16x32_bf16 v[64:67], v[152:155], v[112:115], v[64:67]
ds_read_b64_tr_b16 v[150:151], v13 offset:16160
s_add_u32 s3, s3, 14336
buffer_load_dwordx4 v42, s[52:55], s3 offen offset:2048 lds
v_mfma_f32_16x16x32_bf16 v[68:71], v[152:155], v[116:119], v[68:71]
buffer_load_dwordx4 v[116:119], v23, s[4:7], s67 offen offset:2048 sc1
v_mfma_f32_16x16x32_bf16 v[104:107], v[44:47], v[152:155], v[104:107]
ds_read_b64_tr_b16 v[152:153], v13 offset:14400
s_waitcnt vmcnt(12)
ds_read_b64_tr_b16 a[128:129], v43 offset:36864
s_waitcnt lgkmcnt(6)
v_mfma_f32_16x16x32_bf16 v[72:75], v[156:159], v[112:115], v[72:75]
ds_read_b64_tr_b16 v[154:155], v13 offset:16192
buffer_load_dwordx4 v[112:115], v23, s[4:7], s64 offen offset:2048 sc1
v_mfma_f32_16x16x32_bf16 v[108:111], v[44:47], v[156:159], v[108:111]
ds_read_b64_tr_b16 v[156:157], v14 offset:14336
ds_read_b64_tr_b16 a[132:133], v43 offset:36872
ds_read_b64_tr_b16 a[130:131], v43 offset:37120
s_waitcnt lgkmcnt(8)
v_mfma_f32_16x16x32_bf16 v[48:51], v[144:147], v[120:123], v[48:51]
ds_read_b64_tr_b16 v[158:159], v14 offset:16128
buffer_load_dwordx4 v11, s[52:55], s3 offen offset:3072 lds
s_waitcnt vmcnt(12)
v_mfma_f32_16x16x32_bf16 v[52:55], v[144:147], v[124:127], v[52:55]
ds_read_b64_tr_b16 v[144:145], v13 offset:21504
ds_read_b64_tr_b16 a[134:135], v43 offset:37128
v_mov_b32 v110, 0
s_waitcnt lgkmcnt(9)
v_mfma_f32_16x16x32_bf16 v[56:59], v[148:151], v[120:123], v[56:59]
ds_read_b64_tr_b16 v[146:147], v13 offset:23296
v_mov_b32 v111, 0
s_mov_b64 vcc, 0xffff
s_lshl_b64 vcc, vcc, 16
v_cndmask_b32 v96, v96, v100, vcc
v_mfma_f32_16x16x32_bf16 v[60:63], v[148:151], v[124:127], v[60:63]
ds_read_b64_tr_b16 v[148:149], v13 offset:21536
s_mov_b64 vcc, 0xffff
s_lshl_b64 vcc, vcc, 32
v_cndmask_b32 v96, v96, v104, vcc
s_waitcnt lgkmcnt(8)
v_mfma_f32_16x16x32_bf16 v[64:67], v[152:155], v[120:123], v[64:67]
ds_read_b64_tr_b16 v[150:151], v13 offset:23328
s_mov_b64 vcc, 0xffff
s_lshl_b64 vcc, vcc, 48
v_cndmask_b32 v96, v96, v108, vcc
v_mfma_f32_16x16x32_bf16 v[68:71], v[152:155], v[124:127], v[68:71]
ds_read_b64_tr_b16 v[152:153], v13 offset:21568
v_mov_b32 v124, v22
v_mov_b32 v126, 0
s_waitcnt lgkmcnt(6)
v_mfma_f32_16x16x32_bf16 v[72:75], v[156:159], v[120:123], v[72:75]
ds_read_b64_tr_b16 v[154:155], v13 offset:23360
ds_read_b64_tr_b16 v[156:157], v14 offset:21504
v_mov_b32 v120, v22
s_waitcnt lgkmcnt(5)
v_mfma_f32_16x16x32_bf16 v[48:51], v[144:147], v[80:83], v[48:51]
ds_read_b64_tr_b16 v[158:159], v14 offset:23296
v_permlane16_swap_b32 v120, v124
v_mov_b32 v122, 0
s_waitcnt vmcnt(7)
v_mfma_f32_16x16x32_bf16 v[52:55], v[144:147], v[136:139], v[52:55]
ds_read_b64_tr_b16 v[144:145], v13 offset:28672
v_mov_b32 v123, 0
v_mov_b32 v127, 0
s_waitcnt lgkmcnt(5)
v_mfma_f32_16x16x32_bf16 v[56:59], v[148:151], v[80:83], v[56:59]
ds_read_b64_tr_b16 v[146:147], v13 offset:30464
v_mov_b32 v121, v120
v_mov_b32 v125, v124
v_mfma_f32_16x16x32_bf16 v[60:63], v[148:151], v[136:139], v[60:63]
ds_read_b64_tr_b16 v[148:149], v13 offset:28704
v_add_f32 v128, v128, v132
v_add_f32 v129, v129, v133
s_waitcnt lgkmcnt(5)
v_mfma_f32_16x16x32_bf16 v[64:67], v[152:155], v[80:83], v[64:67]
ds_read_b64_tr_b16 v[150:151], v13 offset:30496
v_add_f32 v130, v130, v134
v_add_f32 v131, v131, v135
v_mfma_f32_16x16x32_bf16 v[68:71], v[152:155], v[136:139], v[68:71]
ds_read_b64_tr_b16 v[152:153], v13 offset:28736
v_add_f32 v128, v128, v130
v_add_f32 v129, v129, v131
s_waitcnt lgkmcnt(5)
v_mfma_f32_16x16x32_bf16 v[72:75], v[156:159], v[80:83], v[72:75]
ds_read_b64_tr_b16 v[154:155], v13 offset:30528
ds_read_b64_tr_b16 v[156:157], v14 offset:28672
v_permlane32_swap_b32 v128, v129
s_waitcnt lgkmcnt(5)
v_mfma_f32_16x16x32_bf16 v[48:51], v[144:147], v[84:87], v[48:51]
ds_read_b64_tr_b16 v[158:159], v14 offset:30464
v_add_f32 v128, v128, v129
v_cmp_u_f32 vcc, v128, v128
s_cbranch_vccnz re_81
re_81b:
v_mul_f32 v128, 0x3b000000, v128
v_mov_b32 v129, v128
ds_read_b64_tr_b16 a[136:137], v43 offset:38912
ds_read_b64_tr_b16 a[140:141], v43 offset:38920
v_permlane32_swap_b32 v128, v129
v_fma_f32 v129, -v128, v128, v129
v_max_f32 v129, 0, v129
v_add_f32 v130, 0x3727c5ac, v129
v_rsq_f32 v130, v130
v_cvt_pk_bf16_f32 v129, -v128, -v128
v_lshlrev_b32 v129, 16, v129
v_sub_f32 v129, -v128, v129
v_mul_f32 v21, 0xc0135761, v130
v_mul_f32 v20, v130, v130
v_rcp_f32 v41, v130
v_mul_f32 v20, v20, v21
v_mul_f32 v20, 0x3d372713, v20
v_cvt_pk_bf16_f32 v2, -v128, v129
s_xor_b32 s64, s50, 1994752
s_sub_u32 s64, s64, 114688
buffer_load_dwordx4 v[128:131], v23, s[4:7], s64 offen offset:0 sc1
s_xor_b32 s67, s64, 256
buffer_load_dwordx4 v[132:135], v23, s[4:7], s67 offen offset:0 sc1
ds_read_b64_tr_b16 a[138:139], v43 offset:39168
buffer_load_dwordx4 v[136:139], v23, s[4:7], s64 offen offset:2048 sc1
ds_read_b64_tr_b16 a[142:143], v43 offset:39176
ds_write_b32 v98, v96
v_xor_b32 v98, 512, v98
s_barrier
s_waitcnt vmcnt(7)
v_mfma_f32_16x16x32_bf16 v[52:55], v[144:147], v[140:143], v[52:55]
ds_read_b64_tr_b16 v[144:145], v13 offset:35840
ds_read_b64_tr_b16 a[144:145], v43 offset:53248
ds_read_b64_tr_b16 a[148:149], v43 offset:53256
s_waitcnt lgkmcnt(12)
v_mfma_f32_16x16x32_bf16 v[56:59], v[148:151], v[84:87], v[56:59]
ds_read_b64_tr_b16 v[146:147], v13 offset:37632
ds_read_b64_tr_b16 a[146:147], v43 offset:53504
ds_read_b64_tr_b16 a[150:151], v43 offset:53512
v_mfma_f32_16x16x32_bf16 v[60:63], v[148:151], v[140:143], v[60:63]
ds_read_b64_tr_b16 v[148:149], v13 offset:35872
s_waitcnt lgkmcnt(7)
s_barrier
v_mfma_f32_16x16x32_bf16 v[64:67], v[152:155], v[84:87], v[64:67]
ds_read_b64_tr_b16 v[150:151], v13 offset:37664
ds_read_b32 v97, v98
v_mfma_f32_16x16x32_bf16 v[68:71], v[152:155], v[140:143], v[68:71]
ds_read_b64_tr_b16 v[152:153], v13 offset:35904
buffer_load_dwordx4 v[140:143], v23, s[4:7], s67 offen offset:2048 sc1
v_mfma_f32_16x16x32_bf16 v[72:75], v[156:159], v[84:87], v[72:75]
ds_read_b64_tr_b16 v[154:155], v13 offset:37696
ds_read_b64_tr_b16 v[156:157], v14 offset:35840
s_waitcnt vmcnt(5) lgkmcnt(8)
v_mfma_f32_16x16x32_bf16 v[48:51], v[144:147], v[112:115], v[48:51]
ds_read_b64_tr_b16 v[158:159], v14 offset:37632
s_waitcnt lgkmcnt(4)
v_add_f32 v96, v96, v97
v_mfma_f32_16x16x32_bf16 v[52:55], v[144:147], v[116:119], v[52:55]
ds_read_b64_tr_b16 v[144:145], v13 offset:43008
v_cvt_pk_bf16_f32 v16, v96, v96
v_lshlrev_b32 v97, 16, v16
v_mfma_f32_16x16x32_bf16 v[56:59], v[148:151], v[112:115], v[56:59]
ds_read_b64_tr_b16 v[146:147], v13 offset:44800
v_sub_f32 v96, v96, v97
v_cvt_pk_bf16_f32 v17, v96, v96
v_mfma_f32_16x16x32_bf16 v[60:63], v[148:151], v[116:119], v[60:63]
ds_read_b64_tr_b16 v[148:149], v13 offset:43040
s_mov_b64 vcc, 0xffff
s_lshl_b64 vcc, vcc, 0
v_cndmask_b32 v76, 0, v16, vcc
v_cndmask_b32 v77, 0, v17, vcc
s_waitcnt lgkmcnt(5)
v_mfma_f32_16x16x32_bf16 v[64:67], v[152:155], v[112:115], v[64:67]
ds_read_b64_tr_b16 v[150:151], v13 offset:44832
s_mov_b64 vcc, 0xffff
s_lshl_b64 vcc, vcc, 0
v_cndmask_b32 v108, 0, v16, vcc
v_cndmask_b32 v109, 0, v17, vcc
v_mfma_f32_16x16x32_bf16 v[68:71], v[152:155], v[116:119], v[68:71]
ds_read_b64_tr_b16 v[152:153], v13 offset:43072
s_waitcnt lgkmcnt(5)
v_mfma_f32_16x16x32_bf16 v[72:75], v[156:159], v[112:115], v[72:75]
ds_read_b64_tr_b16 v[154:155], v13 offset:44864
ds_read_b64_tr_b16 v[156:157], v14 offset:43008
s_xor_b32 s64, s50, 1998848
s_sub_u32 s64, s64, 114688
buffer_load_dwordx4 v[112:115], v23, s[4:7], s64 offen offset:0 sc1
v_mfma_f32_16x16x32_bf16 v[48:51], v[76:79], v[120:123], v[48:51]
s_xor_b32 s67, s64, 256
buffer_load_dwordx4 v[116:119], v23, s[4:7], s67 offen offset:0 sc1
v_mfma_f32_16x16x32_bf16 v[52:55], v[76:79], v[124:127], v[52:55]
s_mov_b64 vcc, 0xffff
s_lshl_b64 vcc, vcc, 16
v_cndmask_b32 v76, 0, v16, vcc
v_cndmask_b32 v77, 0, v17, vcc
s_waitcnt vmcnt(5) lgkmcnt(5)
v_mfma_f32_16x16x32_bf16 v[48:51], v[144:147], v[128:131], v[48:51]
ds_read_b64_tr_b16 v[158:159], v14 offset:44800
ds_read_b64_tr_b16 a[152:153], v43 offset:55296
ds_read_b64_tr_b16 a[156:157], v43 offset:55304
v_mfma_f32_16x16x32_bf16 v[56:59], v[76:79], v[120:123], v[56:59]
ds_read_b64_tr_b16 a[154:155], v43 offset:55552
ds_read_b64_tr_b16 a[158:159], v43 offset:55560
v_mfma_f32_16x16x32_bf16 v[60:63], v[76:79], v[124:127], v[60:63]
s_mov_b64 vcc, 0xffff
s_lshl_b64 vcc, vcc, 32
v_cndmask_b32 v76, 0, v16, vcc
v_cndmask_b32 v77, 0, v17, vcc
s_waitcnt vmcnt(4)
v_mfma_f32_16x16x32_bf16 v[52:55], v[144:147], v[132:135], v[52:55]
ds_read_b64_tr_b16 v[144:145], v13 offset:50176
v_mfma_f32_16x16x32_bf16 v[64:67], v[76:79], v[120:123], v[64:67]
v_mfma_f32_16x16x32_bf16 v[68:71], v[76:79], v[124:127], v[68:71]
s_mov_b64 vcc, 0xffff
s_lshl_b64 vcc, vcc, 48
v_cndmask_b32 v76, 0, v16, vcc
v_cndmask_b32 v77, 0, v17, vcc
s_waitcnt lgkmcnt(9)
v_mfma_f32_16x16x32_bf16 v[56:59], v[148:151], v[128:131], v[56:59]
ds_read_b64_tr_b16 v[146:147], v13 offset:51968
buffer_load_dwordx4 v[124:127], v23, s[4:7], s67 offen offset:2048 sc1
v_mfma_f32_16x16x32_bf16 v[72:75], v[76:79], v[120:123], v[72:75]
buffer_load_dwordx4 v[120:123], v23, s[4:7], s64 offen offset:2048 sc1
v_mfma_f32_16x16x32_bf16 v[60:63], v[148:151], v[132:135], v[60:63]
ds_read_b64_tr_b16 v[148:149], v13 offset:50208
s_waitcnt lgkmcnt(9)
v_mfma_f32_16x16x32_bf16 v[64:67], v[152:155], v[128:131], v[64:67]
ds_read_b64_tr_b16 v[150:151], v13 offset:52000
v_mfma_f32_16x16x32_bf16 v[68:71], v[152:155], v[132:135], v[68:71]
ds_read_b64_tr_b16 v[152:153], v13 offset:50240
v_mov_b32 v132, v2
v_mov_b32 v134, 0
s_waitcnt lgkmcnt(9)
v_mfma_f32_16x16x32_bf16 v[72:75], v[156:159], v[128:131], v[72:75]
ds_read_b64_tr_b16 v[154:155], v13 offset:52032
ds_read_b64_tr_b16 v[156:157], v14 offset:50176
v_subrev_u32 v13, s65, v13
s_waitcnt vmcnt(5) lgkmcnt(5)
v_mfma_f32_16x16x32_bf16 v[48:51], v[144:147], v[136:139], v[48:51]
ds_read_b64_tr_b16 v[158:159], v14 offset:51968
v_subrev_u32 v14, s65, v14
v_mov_b32 v128, v2
s_waitcnt vmcnt(4)
v_mfma_f32_16x16x32_bf16 v[52:55], v[144:147], v[140:143], v[52:55]
ds_read_b64_tr_b16 v[144:145], v13 offset:0
v_permlane16_swap_b32 v128, v132
s_waitcnt lgkmcnt(5)
v_mfma_f32_16x16x32_bf16 v[56:59], v[148:151], v[136:139], v[56:59]
ds_read_b64_tr_b16 v[146:147], v13 offset:1792
v_mov_b32 v130, 0
v_mov_b32 v131, 0
v_mfma_f32_16x16x32_bf16 v[60:63], v[148:151], v[140:143], v[60:63]
ds_read_b64_tr_b16 v[148:149], v13 offset:32
v_mov_b32 v135, 0
v_mov_b32 v129, v128
s_waitcnt lgkmcnt(5)
v_mfma_f32_16x16x32_bf16 v[64:67], v[152:155], v[136:139], v[64:67]
ds_read_b64_tr_b16 v[150:151], v13 offset:1824
v_mov_b32 v133, v132
v_permlane16_swap_b32 v48, v52
v_mfma_f32_16x16x32_bf16 v[68:71], v[152:155], v[140:143], v[68:71]
ds_read_b64_tr_b16 v[152:153], v13 offset:64
ds_read_b64_tr_b16 v[154:155], v13 offset:1856
v_permlane16_swap_b32 v49, v53
s_waitcnt lgkmcnt(6)
v_mfma_f32_16x16x32_bf16 v[72:75], v[156:159], v[136:139], v[72:75]
s_xor_b32 s64, s50, 2002944
s_sub_u32 s64, s64, 114688
buffer_load_dwordx4 v[136:139], v23, s[4:7], s64 offen offset:0 sc1
s_waitcnt vmcnt(4) lgkmcnt(4)
v_mfma_f32_16x16x32_bf16 v[80:83], v[144:147], v[112:115], 0
s_xor_b32 s67, s64, 256
buffer_load_dwordx4 v[140:143], v23, s[4:7], s67 offen offset:0 sc1
s_waitcnt vmcnt(4)
v_mfma_f32_16x16x32_bf16 v[84:87], v[144:147], v[116:119], 0
ds_read_b64_tr_b16 v[144:145], v13 offset:7168
ds_read_b64_tr_b16 v[156:157], v14 offset:0
ds_read_b64_tr_b16 v[158:159], v14 offset:1792
s_waitcnt lgkmcnt(5)
v_mfma_f32_16x16x32_bf16 v[88:91], v[148:151], v[112:115], 0
ds_read_b64_tr_b16 v[146:147], v13 offset:8960
v_permlane16_swap_b32 v50, v54
v_mfma_f32_16x16x32_bf16 v[92:95], v[148:151], v[116:119], 0
ds_read_b64_tr_b16 v[148:149], v13 offset:7200
v_permlane16_swap_b32 v51, v55
s_waitcnt lgkmcnt(5)
v_mfma_f32_16x16x32_bf16 v[96:99], v[152:155], v[112:115], 0
ds_read_b64_tr_b16 v[150:151], v13 offset:8992
v_mul_f32 v44, v48, v48
v_mul_f32 v45, v49, v49
v_mfma_f32_16x16x32_bf16 v[100:103], v[152:155], v[116:119], 0
ds_read_b64_tr_b16 v[152:153], v13 offset:7232
buffer_load_dwordx4 v[116:119], v23, s[4:7], s67 offen offset:2048 sc1
s_waitcnt lgkmcnt(4)
v_mfma_f32_16x16x32_bf16 v[104:107], v[156:159], v[112:115], 0
ds_read_b64_tr_b16 v[154:155], v13 offset:9024
ds_read_b64_tr_b16 v[156:157], v14 offset:7168
buffer_load_dwordx4 v[112:115], v23, s[4:7], s64 offen offset:2048 sc1
s_waitcnt vmcnt(4) lgkmcnt(5)
v_mfma_f32_16x16x32_bf16 v[80:83], v[144:147], v[120:123], v[80:83]
ds_read_b64_tr_b16 v[158:159], v14 offset:8960
v_mul_f32 v46, v50, v50
v_mul_f32 v47, v51, v51
v_mfma_f32_16x16x32_bf16 v[84:87], v[144:147], v[124:127], v[84:87]
ds_read_b64_tr_b16 v[144:145], v13 offset:14336
v_fma_f32 v44, v44, v18, v19
v_fma_f32 v45, v45, v18, v19
s_waitcnt lgkmcnt(5)
v_mfma_f32_16x16x32_bf16 v[88:91], v[148:151], v[120:123], v[88:91]
ds_read_b64_tr_b16 v[146:147], v13 offset:16128
v_fma_f32 v46, v46, v18, v19
v_fma_f32 v47, v47, v18, v19
v_mfma_f32_16x16x32_bf16 v[92:95], v[148:151], v[124:127], v[92:95]
ds_read_b64_tr_b16 v[148:149], v13 offset:14368
v_mul_f32 v44, v44, v48
v_mul_f32 v45, v45, v49
s_waitcnt lgkmcnt(5)
v_mfma_f32_16x16x32_bf16 v[96:99], v[152:155], v[120:123], v[96:99]
ds_read_b64_tr_b16 v[150:151], v13 offset:16160
v_mul_f32 v46, v46, v50
v_mul_f32 v47, v47, v51
v_mfma_f32_16x16x32_bf16 v[100:103], v[152:155], v[124:127], v[100:103]
ds_read_b64_tr_b16 v[152:153], v13 offset:14400
v_exp_f32 v44, v44
s_waitcnt lgkmcnt(5)
v_mfma_f32_16x16x32_bf16 v[104:107], v[156:159], v[120:123], v[104:107]
ds_read_b64_tr_b16 v[154:155], v13 offset:16192
ds_read_b64_tr_b16 v[156:157], v14 offset:14336
s_xor_b32 s64, s50, 2007040
s_sub_u32 s64, s64, 114688
buffer_load_dwordx4 v[120:123], v23, s[4:7], s64 offen offset:0 sc1
v_mfma_f32_16x16x32_bf16 v[80:83], v[108:111], v[128:131], v[80:83]
v_exp_f32 v45, v45
v_mfma_f32_16x16x32_bf16 v[84:87], v[108:111], v[132:135], v[84:87]
s_mov_b64 vcc, 0xffff
s_lshl_b64 vcc, vcc, 16
v_cndmask_b32 v108, 0, v16, vcc
v_cndmask_b32 v109, 0, v17, vcc
s_waitcnt vmcnt(4) lgkmcnt(5)
v_mfma_f32_16x16x32_bf16 v[80:83], v[144:147], v[136:139], v[80:83]
ds_read_b64_tr_b16 v[158:159], v14 offset:16128
v_exp_f32 v46, v46
s_lshl2_add_u32 m0, s46, 114688
s_lshl4_add_u32 s3, s44, s49
buffer_load_dwordx4 v42, s[52:55], s3 offen offset:0 lds
buffer_load_dwordx4 v11, s[52:55], s3 offen offset:1024 lds
v_mfma_f32_16x16x32_bf16 v[88:91], v[108:111], v[128:131], v[88:91]
s_add_u32 s3, s3, 14336
buffer_load_dwordx4 v42, s[52:55], s3 offen offset:2048 lds
v_mfma_f32_16x16x32_bf16 v[92:95], v[108:111], v[132:135], v[92:95]
s_mov_b64 vcc, 0xffff
s_lshl_b64 vcc, vcc, 32
v_cndmask_b32 v108, 0, v16, vcc
v_cndmask_b32 v109, 0, v17, vcc
buffer_load_dwordx4 v11, s[52:55], s3 offen offset:3072 lds
s_nop 0
v_mfma_f32_16x16x32_bf16 v[96:99], v[108:111], v[128:131], v[96:99]
v_exp_f32 v47, v47
v_mfma_f32_16x16x32_bf16 v[100:103], v[108:111], v[132:135], v[100:103]
s_mov_b64 vcc, 0xffff
s_lshl_b64 vcc, vcc, 48
v_cndmask_b32 v108, 0, v16, vcc
v_cndmask_b32 v109, 0, v17, vcc
s_xor_b32 s67, s64, 256
buffer_load_dwordx4 v[132:135], v23, s[4:7], s67 offen offset:0 sc1
v_mfma_f32_16x16x32_bf16 v[104:107], v[108:111], v[128:131], v[104:107]
v_fma_f32 v44, v44, v40, v40
v_fma_f32 v45, v45, v40, v40
s_waitcnt vmcnt(8)
v_mfma_f32_16x16x32_bf16 v[84:87], v[144:147], v[140:143], v[84:87]
ds_read_b64_tr_b16 v[144:145], v13 offset:21504
v_fma_f32 v46, v46, v40, v40
v_fma_f32 v47, v47, v40, v40
s_waitcnt lgkmcnt(5)
v_mfma_f32_16x16x32_bf16 v[88:91], v[148:151], v[136:139], v[88:91]
ds_read_b64_tr_b16 v[146:147], v13 offset:23296
v_rcp_f32 v44, v44
v_mfma_f32_16x16x32_bf16 v[92:95], v[148:151], v[140:143], v[92:95]
ds_read_b64_tr_b16 v[148:149], v13 offset:21536
v_rcp_f32 v45, v45
s_waitcnt lgkmcnt(5)
v_mfma_f32_16x16x32_bf16 v[96:99], v[152:155], v[136:139], v[96:99]
ds_read_b64_tr_b16 v[150:151], v13 offset:23328
v_rcp_f32 v46, v46
v_mfma_f32_16x16x32_bf16 v[100:103], v[152:155], v[140:143], v[100:103]
ds_read_b64_tr_b16 v[152:153], v13 offset:21568
buffer_load_dwordx4 v[140:143], v23, s[4:7], s67 offen offset:2048 sc1
s_waitcnt lgkmcnt(5)
v_mfma_f32_16x16x32_bf16 v[104:107], v[156:159], v[136:139], v[104:107]
ds_read_b64_tr_b16 v[154:155], v13 offset:23360
ds_read_b64_tr_b16 v[156:157], v14 offset:21504
buffer_load_dwordx4 v[136:139], v23, s[4:7], s64 offen offset:2048 sc1
s_waitcnt vmcnt(8) lgkmcnt(5)
v_mfma_f32_16x16x32_bf16 v[80:83], v[144:147], v[112:115], v[80:83]
ds_read_b64_tr_b16 v[158:159], v14 offset:23296
v_rcp_f32 v47, v47
v_mfma_f32_16x16x32_bf16 v[84:87], v[144:147], v[116:119], v[84:87]
ds_read_b64_tr_b16 v[144:145], v13 offset:28672
v_mul_f32 v44, v44, v48
v_mul_f32 v45, v45, v49
s_waitcnt lgkmcnt(5)
v_mfma_f32_16x16x32_bf16 v[88:91], v[148:151], v[112:115], v[88:91]
ds_read_b64_tr_b16 v[146:147], v13 offset:30464
v_mul_f32 v46, v46, v50
v_mul_f32 v47, v47, v51
v_mfma_f32_16x16x32_bf16 v[92:95], v[148:151], v[116:119], v[92:95]
ds_read_b64_tr_b16 v[148:149], v13 offset:28704
v_cvt_pk_bf16_f32 v48, v44, v45
v_cvt_pk_bf16_f32 v49, v46, v47
s_waitcnt lgkmcnt(5)
v_mfma_f32_16x16x32_bf16 v[96:99], v[152:155], v[112:115], v[96:99]
ds_read_b64_tr_b16 v[150:151], v13 offset:30496
v_mul_f32 v76, v52, v52
v_mul_f32 v77, v53, v53
v_mfma_f32_16x16x32_bf16 v[100:103], v[152:155], v[116:119], v[100:103]
ds_read_b64_tr_b16 v[152:153], v13 offset:28736
v_mul_f32 v78, v54, v54
v_mul_f32 v79, v55, v55
s_waitcnt lgkmcnt(5)
v_mfma_f32_16x16x32_bf16 v[104:107], v[156:159], v[112:115], v[104:107]
ds_read_b64_tr_b16 v[154:155], v13 offset:30528
ds_read_b64_tr_b16 v[156:157], v14 offset:28672
s_xor_b32 s64, s50, 2011136
s_sub_u32 s64, s64, 114688
buffer_load_dwordx4 v[112:115], v23, s[4:7], s64 offen offset:0 sc1
s_xor_b32 s67, s64, 256
buffer_load_dwordx4 v[116:119], v23, s[4:7], s67 offen offset:0 sc1
s_waitcnt vmcnt(9) lgkmcnt(5)
v_mfma_f32_16x16x32_bf16 v[80:83], v[144:147], v[120:123], v[80:83]
ds_read_b64_tr_b16 v[158:159], v14 offset:30464
v_fma_f32 v76, v76, v18, v19
v_fma_f32 v77, v77, v18, v19
v_fma_f32 v78, v78, v18, v19
v_fma_f32 v79, v79, v18, v19
v_pk_mul_f32 v[76:77], v[76:77], v[52:53]
v_pk_mul_f32 v[78:79], v[78:79], v[54:55]
v_exp_f32 v76, v76
v_exp_f32 v77, v77
v_exp_f32 v78, v78
v_exp_f32 v79, v79
v_pk_fma_f32 v[76:77], v[76:77], v[40:41], v[40:41] op_sel:[0,0,0] op_sel_hi:[1,0,0]
v_pk_fma_f32 v[78:79], v[78:79], v[40:41], v[40:41] op_sel:[0,0,0] op_sel_hi:[1,0,0]
v_rcp_f32 v76, v76
v_rcp_f32 v77, v77
v_rcp_f32 v78, v78
v_rcp_f32 v79, v79
v_mov_b32 v124, -1
v_mov_b32 v125, -1
v_pk_mul_f32 v[76:77], v[76:77], v[52:53]
v_mov_b32 v126, -1
v_pk_mul_f32 v[78:79], v[78:79], v[54:55]
v_mov_b32 v127, -1
s_add_u32 s62, s34, 131072
buffer_store_dwordx4 v[124:127], v1, s[4:7], s62 offen sc1
s_add_u32 s62, s34, 163840
buffer_store_dwordx4 v[124:127], v1, s[4:7], s62 offen sc1
v_cvt_pk_bf16_f32 v50, v76, v77
v_cvt_pk_bf16_f32 v51, v78, v79
s_lshl_b32 s60, s71, 8
v_xor_b32 v52, s60, v1
s_add_u32 s62, s72, 0
buffer_store_dwordx4 v[48:51], v52, s[4:7], s62 offen offset:0 sc1
v_permlane16_swap_b32 v56, v60
s_nop 0
buffer_load_dwordx4 v[48:51], v23, s[4:7], s64 offen offset:2048 sc1
v_permlane16_swap_b32 v57, v61
v_permlane16_swap_b32 v58, v62
v_permlane16_swap_b32 v59, v63
v_pk_mul_f32 v[44:45], v[56:57], v[56:57]
v_pk_mul_f32 v[46:47], v[58:59], v[58:59]
v_pk_fma_f32 v[44:45], v[44:45], v[18:19], v[18:19] op_sel:[0,0,1] op_sel_hi:[1,0,1]
v_pk_fma_f32 v[46:47], v[46:47], v[18:19], v[18:19] op_sel:[0,0,1] op_sel_hi:[1,0,1]
v_pk_mul_f32 v[44:45], v[44:45], v[56:57]
v_pk_mul_f32 v[46:47], v[46:47], v[58:59]
v_exp_f32 v44, v44
buffer_load_dwordx4 v[52:55], v23, s[4:7], s67 offen offset:2048 sc1
v_exp_f32 v45, v45
v_exp_f32 v46, v46
v_exp_f32 v47, v47
s_waitcnt vmcnt(12)
ds_read_b64_tr_b16 a[160:161], v43 offset:36864
ds_read_b64_tr_b16 a[164:165], v43 offset:36872
ds_read_b64_tr_b16 a[162:163], v43 offset:37120
ds_read_b64_tr_b16 a[166:167], v43 offset:37128
v_pk_fma_f32 v[44:45], v[44:45], v[40:41], v[40:41] op_sel:[0,0,0] op_sel_hi:[1,0,0]
v_pk_fma_f32 v[46:47], v[46:47], v[40:41], v[40:41] op_sel:[0,0,0] op_sel_hi:[1,0,0]
v_rcp_f32 v44, v44
v_rcp_f32 v45, v45
v_rcp_f32 v46, v46
v_rcp_f32 v47, v47
v_pk_mul_f32 v[44:45], v[44:45], v[56:57]
v_pk_mul_f32 v[46:47], v[46:47], v[58:59]
v_cvt_pk_bf16_f32 v56, v44, v45
v_cvt_pk_bf16_f32 v57, v46, v47
v_pk_mul_f32 v[76:77], v[60:61], v[60:61]
v_pk_mul_f32 v[78:79], v[62:63], v[62:63]
v_pk_fma_f32 v[76:77], v[76:77], v[18:19], v[18:19] op_sel:[0,0,1] op_sel_hi:[1,0,1]
v_pk_fma_f32 v[78:79], v[78:79], v[18:19], v[18:19] op_sel:[0,0,1] op_sel_hi:[1,0,1]
v_pk_mul_f32 v[76:77], v[76:77], v[60:61]
v_pk_mul_f32 v[78:79], v[78:79], v[62:63]
v_exp_f32 v76, v76
v_exp_f32 v77, v77
v_exp_f32 v78, v78
v_exp_f32 v79, v79
v_pk_fma_f32 v[76:77], v[76:77], v[40:41], v[40:41] op_sel:[0,0,0] op_sel_hi:[1,0,0]
v_pk_fma_f32 v[78:79], v[78:79], v[40:41], v[40:41] op_sel:[0,0,0] op_sel_hi:[1,0,0]
v_rcp_f32 v76, v76
v_rcp_f32 v77, v77
s_waitcnt vmcnt(10)
ds_read_b64_tr_b16 a[168:169], v43 offset:38912
ds_read_b64_tr_b16 a[172:173], v43 offset:38920
ds_read_b64_tr_b16 a[170:171], v43 offset:39168
ds_read_b64_tr_b16 a[174:175], v43 offset:39176
s_waitcnt vmcnt(9)
v_mfma_f32_16x16x32_bf16 v[84:87], v[144:147], v[132:135], v[84:87]
ds_read_b64_tr_b16 v[144:145], v13 offset:35840
v_rcp_f32 v78, v78
s_waitcnt lgkmcnt(13)
v_mfma_f32_16x16x32_bf16 v[88:91], v[148:151], v[120:123], v[88:91]
ds_read_b64_tr_b16 v[146:147], v13 offset:37632
v_rcp_f32 v79, v79
v_mfma_f32_16x16x32_bf16 v[92:95], v[148:151], v[132:135], v[92:95]
ds_read_b64_tr_b16 v[148:149], v13 offset:35872
v_mul_f32 v76, v76, v60
v_mul_f32 v77, v77, v61
s_waitcnt lgkmcnt(13)
v_mfma_f32_16x16x32_bf16 v[96:99], v[152:155], v[120:123], v[96:99]
ds_read_b64_tr_b16 v[150:151], v13 offset:37664
v_mul_f32 v78, v78, v62
v_mul_f32 v79, v79, v63
v_mfma_f32_16x16x32_bf16 v[100:103], v[152:155], v[132:135], v[100:103]
ds_read_b64_tr_b16 v[152:153], v13 offset:35904
v_cvt_pk_bf16_f32 v58, v76, v77
v_cvt_pk_bf16_f32 v59, v78, v79
s_waitcnt lgkmcnt(13)
v_mfma_f32_16x16x32_bf16 v[104:107], v[156:159], v[120:123], v[104:107]
ds_read_b64_tr_b16 v[154:155], v13 offset:37696
ds_read_b64_tr_b16 v[156:157], v14 offset:35840
s_xor_b32 s64, s50, 2015232
s_sub_u32 s64, s64, 114688
buffer_load_dwordx4 v[120:123], v23, s[4:7], s64 offen offset:0 sc1
s_xor_b32 s67, s64, 256
buffer_load_dwordx4 v[124:127], v23, s[4:7], s67 offen offset:0 sc1
s_waitcnt vmcnt(9) lgkmcnt(5)
v_mfma_f32_16x16x32_bf16 v[80:83], v[144:147], v[136:139], v[80:83]
ds_read_b64_tr_b16 v[158:159], v14 offset:37632
buffer_load_dwordx4 v[128:131], v23, s[4:7], s64 offen offset:2048 sc1
v_mfma_f32_16x16x32_bf16 v[84:87], v[144:147], v[140:143], v[84:87]
ds_read_b64_tr_b16 v[144:145], v13 offset:43008
s_lshl_b32 s60, s71, 8
v_xor_b32 v60, s60, v1
s_add_u32 s62, s72, 0
buffer_store_dwordx4 v[56:59], v60, s[4:7], s62 offen offset:1024 sc1
s_waitcnt lgkmcnt(5)
v_mfma_f32_16x16x32_bf16 v[88:91], v[148:151], v[136:139], v[88:91]
ds_read_b64_tr_b16 v[146:147], v13 offset:44800
buffer_load_dwordx4 v[132:135], v23, s[4:7], s67 offen offset:2048 sc1
v_mfma_f32_16x16x32_bf16 v[92:95], v[148:151], v[140:143], v[92:95]
ds_read_b64_tr_b16 v[148:149], v13 offset:43040
v_permlane16_swap_b32 v64, v68
s_waitcnt lgkmcnt(5)
v_mfma_f32_16x16x32_bf16 v[96:99], v[152:155], v[136:139], v[96:99]
ds_read_b64_tr_b16 v[150:151], v13 offset:44832
v_permlane16_swap_b32 v65, v69
v_mfma_f32_16x16x32_bf16 v[100:103], v[152:155], v[140:143], v[100:103]
ds_read_b64_tr_b16 v[152:153], v13 offset:43072
s_xor_b32 s64, s50, 2019328
s_sub_u32 s64, s64, 114688
buffer_load_dwordx4 v[56:59], v23, s[4:7], s64 offen offset:0 sc1
s_waitcnt lgkmcnt(5)
v_mfma_f32_16x16x32_bf16 v[104:107], v[156:159], v[136:139], v[104:107]
ds_read_b64_tr_b16 v[154:155], v13 offset:44864
ds_read_b64_tr_b16 v[156:157], v14 offset:43008
v_permlane16_swap_b32 v66, v70
s_waitcnt vmcnt(12) lgkmcnt(5)
v_mfma_f32_16x16x32_bf16 v[80:83], v[144:147], v[112:115], v[80:83]
ds_read_b64_tr_b16 v[158:159], v14 offset:44800
s_xor_b32 s67, s64, 256
buffer_load_dwordx4 v[60:63], v23, s[4:7], s67 offen offset:0 sc1
s_waitcnt vmcnt(12)
v_mfma_f32_16x16x32_bf16 v[84:87], v[144:147], v[116:119], v[84:87]
ds_read_b64_tr_b16 v[144:145], v13 offset:50176
v_permlane16_swap_b32 v67, v71
s_waitcnt lgkmcnt(5)
v_mfma_f32_16x16x32_bf16 v[88:91], v[148:151], v[112:115], v[88:91]
ds_read_b64_tr_b16 v[146:147], v13 offset:51968
v_mul_f32 v44, v64, v64
v_mul_f32 v45, v65, v65
v_mfma_f32_16x16x32_bf16 v[92:95], v[148:151], v[116:119], v[92:95]
ds_read_b64_tr_b16 v[148:149], v13 offset:50208
v_mul_f32 v46, v66, v66
v_mul_f32 v47, v67, v67
s_waitcnt lgkmcnt(5)
v_mfma_f32_16x16x32_bf16 v[96:99], v[152:155], v[112:115], v[96:99]
ds_read_b64_tr_b16 v[150:151], v13 offset:52000
buffer_load_dwordx4 v[136:139], v23, s[4:7], s64 offen offset:2048 sc1
v_mfma_f32_16x16x32_bf16 v[100:103], v[152:155], v[116:119], v[100:103]
ds_read_b64_tr_b16 v[152:153], v13 offset:50240
v_fma_f32 v44, v44, v18, v19
v_fma_f32 v45, v45, v18, v19
s_waitcnt lgkmcnt(5)
v_mfma_f32_16x16x32_bf16 v[104:107], v[156:159], v[112:115], v[104:107]
ds_read_b64_tr_b16 v[154:155], v13 offset:52032
ds_read_b64_tr_b16 v[156:157], v14 offset:50176
v_fma_f32 v46, v46, v18, v19
v_fma_f32 v47, v47, v18, v19
s_xor_b32 s64, s50, 2023424
s_sub_u32 s64, s64, 114688
buffer_load_dwordx4 v[112:115], v23, s[4:7], s64 offen offset:0 sc1
v_pk_mul_f32 v[44:45], v[44:45], v[64:65]
v_pk_mul_f32 v[46:47], v[46:47], v[66:67]
v_exp_f32 v44, v44
v_exp_f32 v45, v45
v_exp_f32 v46, v46
v_exp_f32 v47, v47
v_pk_fma_f32 v[44:45], v[44:45], v[40:41], v[40:41] op_sel:[0,0,0] op_sel_hi:[1,0,0]
v_pk_fma_f32 v[46:47], v[46:47], v[40:41], v[40:41] op_sel:[0,0,0] op_sel_hi:[1,0,0]
v_rcp_f32 v44, v44
buffer_load_dwordx4 v[140:143], v23, s[4:7], s67 offen offset:2048 sc1
v_rcp_f32 v45, v45
v_rcp_f32 v46, v46
v_rcp_f32 v47, v47
v_pk_mul_f32 v[44:45], v[44:45], v[64:65]
v_pk_mul_f32 v[46:47], v[46:47], v[66:67]
v_cvt_pk_bf16_f32 v64, v44, v45
v_cvt_pk_bf16_f32 v65, v46, v47
v_pk_mul_f32 v[76:77], v[68:69], v[68:69]
v_pk_mul_f32 v[78:79], v[70:71], v[70:71]
v_pk_fma_f32 v[76:77], v[76:77], v[18:19], v[18:19] op_sel:[0,0,1] op_sel_hi:[1,0,1]
v_pk_fma_f32 v[78:79], v[78:79], v[18:19], v[18:19] op_sel:[0,0,1] op_sel_hi:[1,0,1]
v_pk_mul_f32 v[76:77], v[76:77], v[68:69]
v_pk_mul_f32 v[78:79], v[78:79], v[70:71]
v_exp_f32 v76, v76
v_exp_f32 v77, v77
v_exp_f32 v78, v78
v_exp_f32 v79, v79
v_pk_fma_f32 v[76:77], v[76:77], v[40:41], v[40:41] op_sel:[0,0,0] op_sel_hi:[1,0,0]
v_pk_fma_f32 v[78:79], v[78:79], v[40:41], v[40:41] op_sel:[0,0,0] op_sel_hi:[1,0,0]
v_rcp_f32 v76, v76
v_rcp_f32 v77, v77
v_rcp_f32 v78, v78
v_rcp_f32 v79, v79
v_pk_mul_f32 v[76:77], v[76:77], v[68:69]
s_xor_b32 s67, s64, 256
buffer_load_dwordx4 v[116:119], v23, s[4:7], s67 offen offset:0 sc1
s_waitcnt vmcnt(12) lgkmcnt(5)
v_mfma_f32_16x16x32_bf16 v[80:83], v[144:147], v[48:51], v[80:83]
ds_read_b64_tr_b16 v[158:159], v14 offset:51968
v_mul_f32 v78, v78, v70
v_mul_f32 v79, v79, v71
s_waitcnt vmcnt(11)
v_mfma_f32_16x16x32_bf16 v[84:87], v[144:147], v[52:55], v[84:87]
v_add_u32 v13, s65, v13
ds_read_b64_tr_b16 v[144:145], v13 offset:0
s_waitcnt lgkmcnt(5)
v_mfma_f32_16x16x32_bf16 v[88:91], v[148:151], v[48:51], v[88:91]
ds_read_b64_tr_b16 v[146:147], v13 offset:1792
v_cvt_pk_bf16_f32 v66, v76, v77
v_cvt_pk_bf16_f32 v67, v78, v79
v_mfma_f32_16x16x32_bf16 v[92:95], v[148:151], v[52:55], v[92:95]
ds_read_b64_tr_b16 v[148:149], v13 offset:32
s_lshl_b32 s60, s71, 8
v_xor_b32 v68, s60, v1
s_add_u32 s62, s72, 0
buffer_store_dwordx4 v[64:67], v68, s[4:7], s62 offen offset:2048 sc1
s_waitcnt lgkmcnt(5)
v_mfma_f32_16x16x32_bf16 v[96:99], v[152:155], v[48:51], v[96:99]
ds_read_b64_tr_b16 v[150:151], v13 offset:1824
buffer_load_dwordx4 v[64:67], v23, s[4:7], s64 offen offset:2048 sc1
v_mfma_f32_16x16x32_bf16 v[100:103], v[152:155], v[52:55], v[100:103]
ds_read_b64_tr_b16 v[152:153], v13 offset:64
buffer_load_dwordx4 v[68:71], v23, s[4:7], s67 offen offset:2048 sc1
s_waitcnt lgkmcnt(5)
v_mfma_f32_16x16x32_bf16 v[104:107], v[156:159], v[48:51], v[104:107]
ds_read_b64_tr_b16 v[154:155], v13 offset:1856
v_add_u32 v14, s65, v14
ds_read_b64_tr_b16 v[156:157], v14 offset:0
s_waitcnt vmcnt(13) lgkmcnt(5)
v_mfma_f32_16x16x32_bf16 v[80:83], v[144:147], v[120:123], v[80:83]
ds_read_b64_tr_b16 v[158:159], v14 offset:1792
v_mov_b32 v76, v18
v_mul_f32 v44, v72, v72
v_mul_f32 v45, v73, v73
s_waitcnt vmcnt(12)
v_mfma_f32_16x16x32_bf16 v[84:87], v[144:147], v[124:127], v[84:87]
ds_read_b64_tr_b16 v[144:145], v13 offset:7168
v_permlane16_swap_b32 v18, v76
s_waitcnt lgkmcnt(5)
v_mfma_f32_16x16x32_bf16 v[88:91], v[148:151], v[120:123], v[88:91]
ds_read_b64_tr_b16 v[146:147], v13 offset:8960
v_mov_b32 v76, v19
v_mul_f32 v46, v74, v74
v_mul_f32 v47, v75, v75
v_mfma_f32_16x16x32_bf16 v[92:95], v[148:151], v[124:127], v[92:95]
ds_read_b64_tr_b16 v[148:149], v13 offset:7200
v_permlane16_swap_b32 v19, v76
s_waitcnt lgkmcnt(5)
v_mfma_f32_16x16x32_bf16 v[96:99], v[152:155], v[120:123], v[96:99]
ds_read_b64_tr_b16 v[150:151], v13 offset:8992
v_mov_b32 v76, v40
v_fma_f32 v44, v44, v18, v19
v_fma_f32 v45, v45, v18, v19
v_mfma_f32_16x16x32_bf16 v[100:103], v[152:155], v[124:127], v[100:103]
ds_read_b64_tr_b16 v[152:153], v13 offset:7232
v_permlane16_swap_b32 v40, v76
s_waitcnt lgkmcnt(5)
v_mfma_f32_16x16x32_bf16 v[104:107], v[156:159], v[120:123], v[104:107]
ds_read_b64_tr_b16 v[154:155], v13 offset:9024
ds_read_b64_tr_b16 v[156:157], v14 offset:7168
s_xor_b32 s64, s50, 2027520
s_sub_u32 s64, s64, 114688
buffer_load_dwordx4 v[120:123], v23, s[4:7], s64 offen offset:0 sc1
s_waitcnt vmcnt(12) lgkmcnt(5)
v_mfma_f32_16x16x32_bf16 v[80:83], v[144:147], v[128:131], v[80:83]
ds_read_b64_tr_b16 v[158:159], v14 offset:8960
s_xor_b32 s67, s64, 256
buffer_load_dwordx4 v[124:127], v23, s[4:7], s67 offen offset:0 sc1
v_pk_fma_f32 v[46:47], v[46:47], v[18:19], v[18:19] op_sel:[0,0,1] op_sel_hi:[1,0,1]
v_pk_mul_f32 v[44:45], v[44:45], v[72:73]
v_pk_mul_f32 v[46:47], v[46:47], v[74:75]
v_exp_f32 v44, v44
v_exp_f32 v45, v45
v_exp_f32 v46, v46
v_exp_f32 v47, v47
v_pk_fma_f32 v[44:45], v[44:45], v[40:41], v[40:41] op_sel:[0,0,0] op_sel_hi:[1,0,0]
v_pk_fma_f32 v[46:47], v[46:47], v[40:41], v[40:41] op_sel:[0,0,0] op_sel_hi:[1,0,0]
v_rcp_f32 v44, v44
v_rcp_f32 v45, v45
v_rcp_f32 v46, v46
v_rcp_f32 v47, v47
v_pk_mul_f32 v[44:45], v[44:45], v[72:73]
v_pk_mul_f32 v[46:47], v[46:47], v[74:75]
v_cvt_pk_bf16_f32 v72, v44, v45
v_cvt_pk_bf16_f32 v73, v46, v47
v_mov_b32 v74, v72
v_mov_b32 v75, v73
s_nop 0
v_permlane16_swap_b32 v72, v74
v_permlane16_swap_b32 v73, v75
s_waitcnt vmcnt(11)
v_mfma_f32_16x16x32_bf16 v[84:87], v[144:147], v[132:135], v[84:87]
ds_read_b64_tr_b16 v[144:145], v13 offset:14336
s_lshl_b32 s60, s71, 8
v_xor_b32 v77, s60, v1
s_add_u32 s62, s73, 0
s_mov_b32 exec_lo, 0xffff
s_mov_b32 exec_hi, 0xffff
buffer_store_dwordx4 v[72:75], v77, s[4:7], s62 offen sc1
s_mov_b64 exec, -1
s_waitcnt lgkmcnt(5)
v_mfma_f32_16x16x32_bf16 v[88:91], v[148:151], v[128:131], v[88:91]
ds_read_b64_tr_b16 v[146:147], v13 offset:16128
v_mfma_f32_16x16x32_bf16 v[92:95], v[148:151], v[132:135], v[92:95]
ds_read_b64_tr_b16 v[148:149], v13 offset:14368
s_waitcnt lgkmcnt(5)
v_mfma_f32_16x16x32_bf16 v[96:99], v[152:155], v[128:131], v[96:99]
ds_read_b64_tr_b16 v[150:151], v13 offset:16160
v_mfma_f32_16x16x32_bf16 v[100:103], v[152:155], v[132:135], v[100:103]
ds_read_b64_tr_b16 v[152:153], v13 offset:14400
buffer_load_dwordx4 v[132:135], v23, s[4:7], s67 offen offset:2048 sc1
s_waitcnt lgkmcnt(5)
v_mfma_f32_16x16x32_bf16 v[104:107], v[156:159], v[128:131], v[104:107]
ds_read_b64_tr_b16 v[154:155], v13 offset:16192
ds_read_b64_tr_b16 v[156:157], v14 offset:14336
buffer_load_dwordx4 v[128:131], v23, s[4:7], s64 offen offset:2048 sc1
s_waitcnt vmcnt(13) lgkmcnt(5)
v_mfma_f32_16x16x32_bf16 v[80:83], v[144:147], v[56:59], v[80:83]
ds_read_b64_tr_b16 v[158:159], v14 offset:16128
s_waitcnt vmcnt(12)
v_mfma_f32_16x16x32_bf16 v[84:87], v[144:147], v[60:63], v[84:87]
ds_read_b64_tr_b16 v[144:145], v13 offset:21504
s_waitcnt lgkmcnt(5)
v_mfma_f32_16x16x32_bf16 v[88:91], v[148:151], v[56:59], v[88:91]
ds_read_b64_tr_b16 v[146:147], v13 offset:23296
v_mfma_f32_16x16x32_bf16 v[92:95], v[148:151], v[60:63], v[92:95]
ds_read_b64_tr_b16 v[148:149], v13 offset:21536
s_waitcnt lgkmcnt(5)
v_mfma_f32_16x16x32_bf16 v[96:99], v[152:155], v[56:59], v[96:99]
ds_read_b64_tr_b16 v[150:151], v13 offset:23328
v_mfma_f32_16x16x32_bf16 v[100:103], v[152:155], v[60:63], v[100:103]
ds_read_b64_tr_b16 v[152:153], v13 offset:21568
s_waitcnt lgkmcnt(5)
v_mfma_f32_16x16x32_bf16 v[104:107], v[156:159], v[56:59], v[104:107]
ds_read_b64_tr_b16 v[154:155], v13 offset:23360
ds_read_b64_tr_b16 v[156:157], v14 offset:21504
s_waitcnt vmcnt(11) lgkmcnt(5)
v_mfma_f32_16x16x32_bf16 v[80:83], v[144:147], v[136:139], v[80:83]
ds_read_b64_tr_b16 v[158:159], v14 offset:23296
s_waitcnt vmcnt(9)
v_mfma_f32_16x16x32_bf16 v[84:87], v[144:147], v[140:143], v[84:87]
ds_read_b64_tr_b16 v[144:145], v13 offset:28672
s_waitcnt lgkmcnt(5)
v_mfma_f32_16x16x32_bf16 v[88:91], v[148:151], v[136:139], v[88:91]
ds_read_b64_tr_b16 v[146:147], v13 offset:30464
v_mfma_f32_16x16x32_bf16 v[92:95], v[148:151], v[140:143], v[92:95]
ds_read_b64_tr_b16 v[148:149], v13 offset:28704
s_waitcnt lgkmcnt(5)
v_mfma_f32_16x16x32_bf16 v[96:99], v[152:155], v[136:139], v[96:99]
ds_read_b64_tr_b16 v[150:151], v13 offset:30496
v_mfma_f32_16x16x32_bf16 v[100:103], v[152:155], v[140:143], v[100:103]
ds_read_b64_tr_b16 v[152:153], v13 offset:28736
s_waitcnt lgkmcnt(5)
v_mfma_f32_16x16x32_bf16 v[104:107], v[156:159], v[136:139], v[104:107]
ds_read_b64_tr_b16 v[154:155], v13 offset:30528
ds_read_b64_tr_b16 v[156:157], v14 offset:28672
s_waitcnt lgkmcnt(5)
v_mfma_f32_16x16x32_bf16 v[80:83], v[144:147], v[112:115], v[80:83]
ds_read_b64_tr_b16 v[158:159], v14 offset:30464
s_waitcnt vmcnt(8)
v_mfma_f32_16x16x32_bf16 v[84:87], v[144:147], v[116:119], v[84:87]
ds_read_b64_tr_b16 v[144:145], v13 offset:35840
s_waitcnt lgkmcnt(5)
v_mfma_f32_16x16x32_bf16 v[88:91], v[148:151], v[112:115], v[88:91]
ds_read_b64_tr_b16 v[146:147], v13 offset:37632
v_mfma_f32_16x16x32_bf16 v[92:95], v[148:151], v[116:119], v[92:95]
ds_read_b64_tr_b16 v[148:149], v13 offset:35872
s_waitcnt lgkmcnt(5)
v_mfma_f32_16x16x32_bf16 v[96:99], v[152:155], v[112:115], v[96:99]
ds_read_b64_tr_b16 v[150:151], v13 offset:37664
s_lshl2_add_u32 m0, s46, 131072
s_lshl4_add_u32 s3, s44, s17
buffer_load_dwordx4 v42, s[52:55], s3 offen offset:0 lds
buffer_load_dwordx4 v11, s[52:55], s3 offen offset:1024 lds
v_mfma_f32_16x16x32_bf16 v[100:103], v[152:155], v[116:119], v[100:103]
ds_read_b64_tr_b16 v[152:153], v13 offset:35904
s_add_u32 s3, s3, 14336
buffer_load_dwordx4 v42, s[52:55], s3 offen offset:2048 lds
s_waitcnt lgkmcnt(5)
v_mfma_f32_16x16x32_bf16 v[104:107], v[156:159], v[112:115], v[104:107]
ds_read_b64_tr_b16 v[154:155], v13 offset:37696
ds_read_b64_tr_b16 v[156:157], v14 offset:35840
buffer_load_dwordx4 v11, s[52:55], s3 offen offset:3072 lds
s_lshl2_add_u32 m0, s46, 114688
s_lshl4_add_u32 s3, s100, s49
buffer_load_dwordx4 v42, s[52:55], s3 offen offset:0 lds
s_waitcnt vmcnt(11) lgkmcnt(5)
v_mfma_f32_16x16x32_bf16 v[80:83], v[144:147], v[64:67], v[80:83]
ds_read_b64_tr_b16 v[158:159], v14 offset:37632
s_waitcnt vmcnt(10)
v_mfma_f32_16x16x32_bf16 v[84:87], v[144:147], v[68:71], v[84:87]
ds_read_b64_tr_b16 v[144:145], v13 offset:43008
buffer_load_dwordx4 v11, s[52:55], s3 offen offset:1024 lds
s_waitcnt lgkmcnt(5)
v_mfma_f32_16x16x32_bf16 v[88:91], v[148:151], v[64:67], v[88:91]
ds_read_b64_tr_b16 v[146:147], v13 offset:44800
v_mfma_f32_16x16x32_bf16 v[92:95], v[148:151], v[68:71], v[92:95]
ds_read_b64_tr_b16 v[148:149], v13 offset:43040
s_waitcnt lgkmcnt(5)
v_mfma_f32_16x16x32_bf16 v[96:99], v[152:155], v[64:67], v[96:99]
ds_read_b64_tr_b16 v[150:151], v13 offset:44832
s_add_u32 s3, s3, 14336
buffer_load_dwordx4 v42, s[52:55], s3 offen offset:2048 lds
v_mfma_f32_16x16x32_bf16 v[100:103], v[152:155], v[68:71], v[100:103]
ds_read_b64_tr_b16 v[152:153], v13 offset:43072
s_waitcnt lgkmcnt(5)
v_mfma_f32_16x16x32_bf16 v[104:107], v[156:159], v[64:67], v[104:107]
ds_read_b64_tr_b16 v[154:155], v13 offset:44864
ds_read_b64_tr_b16 v[156:157], v14 offset:43008
s_waitcnt vmcnt(11) lgkmcnt(5)
v_mfma_f32_16x16x32_bf16 v[80:83], v[144:147], v[120:123], v[80:83]
ds_read_b64_tr_b16 v[158:159], v14 offset:44800
s_waitcnt vmcnt(10)
v_mfma_f32_16x16x32_bf16 v[84:87], v[144:147], v[124:127], v[84:87]
ds_read_b64_tr_b16 v[144:145], v13 offset:50176
buffer_load_dwordx4 v11, s[52:55], s3 offen offset:3072 lds
s_waitcnt lgkmcnt(5)
v_mfma_f32_16x16x32_bf16 v[88:91], v[148:151], v[120:123], v[88:91]
ds_read_b64_tr_b16 v[146:147], v13 offset:51968
v_mfma_f32_16x16x32_bf16 v[92:95], v[148:151], v[124:127], v[92:95]
ds_read_b64_tr_b16 v[148:149], v13 offset:50208
s_waitcnt lgkmcnt(5)
v_mfma_f32_16x16x32_bf16 v[96:99], v[152:155], v[120:123], v[96:99]
ds_read_b64_tr_b16 v[150:151], v13 offset:52000
v_mfma_f32_16x16x32_bf16 v[100:103], v[152:155], v[124:127], v[100:103]
ds_read_b64_tr_b16 v[152:153], v13 offset:50240
s_waitcnt lgkmcnt(5)
v_mfma_f32_16x16x32_bf16 v[104:107], v[156:159], v[120:123], v[104:107]
ds_read_b64_tr_b16 v[154:155], v13 offset:52032
ds_read_b64_tr_b16 v[156:157], v14 offset:50176
v_subrev_u32 v13, s65, v13
s_waitcnt vmcnt(8) lgkmcnt(5)
v_mfma_f32_16x16x32_bf16 v[80:83], v[144:147], v[128:131], v[80:83]
ds_read_b64_tr_b16 v[158:159], v14 offset:51968
v_mov_b32 v76, 1
s_mov_b64 exec, 1
buffer_store_dword v76, v1, s[4:7], s45 offen sc1
s_mov_b64 exec, -1
v_mfma_f32_16x16x32_bf16 v[84:87], v[144:147], v[132:135], v[84:87]
v_subrev_u32 v14, s65, v14
s_waitcnt lgkmcnt(4)
v_mfma_f32_16x16x32_bf16 v[88:91], v[148:151], v[128:131], v[88:91]
v_mfma_f32_16x16x32_bf16 v[92:95], v[148:151], v[132:135], v[92:95]
s_nop 1
v_permlane16_swap_b32 v80, v84
v_permlane16_swap_b32 v81, v85
v_permlane16_swap_b32 v82, v86
v_permlane16_swap_b32 v83, v87
v_pk_mul_f32 v[44:45], v[80:81], v[80:81]
v_pk_mul_f32 v[46:47], v[82:83], v[82:83]
v_pk_fma_f32 v[44:45], v[44:45], v[20:21], v[20:21] op_sel:[0,0,1] op_sel_hi:[1,0,1]
v_pk_fma_f32 v[46:47], v[46:47], v[20:21], v[20:21] op_sel:[0,0,1] op_sel_hi:[1,0,1]
v_pk_mul_f32 v[44:45], v[44:45], v[80:81]
v_pk_mul_f32 v[46:47], v[46:47], v[82:83]
v_exp_f32 v44, v44
v_exp_f32 v45, v45
v_exp_f32 v46, v46
v_exp_f32 v47, v47
v_pk_fma_f32 v[44:45], v[44:45], v[40:41], v[40:41] op_sel:[0,1,1] op_sel_hi:[1,1,1]
v_pk_fma_f32 v[46:47], v[46:47], v[40:41], v[40:41] op_sel:[0,1,1] op_sel_hi:[1,1,1]
v_rcp_f32 v44, v44
v_rcp_f32 v45, v45
v_rcp_f32 v46, v46
v_rcp_f32 v47, v47
v_pk_mul_f32 v[44:45], v[44:45], v[80:81]
v_pk_mul_f32 v[46:47], v[46:47], v[82:83]
v_cvt_pk_bf16_f32 v80, v44, v45
v_cvt_pk_bf16_f32 v81, v46, v47
v_pk_mul_f32 v[108:109], v[84:85], v[84:85]
v_pk_mul_f32 v[110:111], v[86:87], v[86:87]
v_pk_fma_f32 v[108:109], v[108:109], v[20:21], v[20:21] op_sel:[0,0,1] op_sel_hi:[1,0,1]
v_pk_fma_f32 v[110:111], v[110:111], v[20:21], v[20:21] op_sel:[0,0,1] op_sel_hi:[1,0,1]
v_pk_mul_f32 v[108:109], v[108:109], v[84:85]
v_pk_mul_f32 v[110:111], v[110:111], v[86:87]
v_exp_f32 v108, v108
v_exp_f32 v109, v109
v_exp_f32 v110, v110
v_exp_f32 v111, v111
v_pk_fma_f32 v[108:109], v[108:109], v[40:41], v[40:41] op_sel:[0,1,1] op_sel_hi:[1,1,1]
v_pk_fma_f32 v[110:111], v[110:111], v[40:41], v[40:41] op_sel:[0,1,1] op_sel_hi:[1,1,1]
v_rcp_f32 v108, v108
v_rcp_f32 v109, v109
v_rcp_f32 v110, v110
v_rcp_f32 v111, v111
v_pk_mul_f32 v[108:109], v[108:109], v[84:85]
v_pk_mul_f32 v[110:111], v[110:111], v[86:87]
v_cvt_pk_bf16_f32 v82, v108, v109
v_cvt_pk_bf16_f32 v83, v110, v111
s_lshl_b32 s60, s71, 8
v_xor_b32 v84, s60, v1
s_add_u32 s62, s72, 114688
buffer_store_dwordx4 v[80:83], v84, s[4:7], s62 offen offset:0 sc1
v_permlane16_swap_b32 v88, v92
v_permlane16_swap_b32 v89, v93
v_permlane16_swap_b32 v90, v94
v_permlane16_swap_b32 v91, v95
v_pk_mul_f32 v[44:45], v[88:89], v[88:89]
v_pk_mul_f32 v[46:47], v[90:91], v[90:91]
v_pk_fma_f32 v[44:45], v[44:45], v[20:21], v[20:21] op_sel:[0,0,1] op_sel_hi:[1,0,1]
v_pk_fma_f32 v[46:47], v[46:47], v[20:21], v[20:21] op_sel:[0,0,1] op_sel_hi:[1,0,1]
v_pk_mul_f32 v[44:45], v[44:45], v[88:89]
v_pk_mul_f32 v[46:47], v[46:47], v[90:91]
v_exp_f32 v44, v44
v_exp_f32 v45, v45
v_exp_f32 v46, v46
v_exp_f32 v47, v47
v_pk_fma_f32 v[44:45], v[44:45], v[40:41], v[40:41] op_sel:[0,1,1] op_sel_hi:[1,1,1]
v_pk_fma_f32 v[46:47], v[46:47], v[40:41], v[40:41] op_sel:[0,1,1] op_sel_hi:[1,1,1]
v_rcp_f32 v44, v44
v_rcp_f32 v45, v45
v_rcp_f32 v46, v46
v_rcp_f32 v47, v47
v_pk_mul_f32 v[44:45], v[44:45], v[88:89]
v_pk_mul_f32 v[46:47], v[46:47], v[90:91]
v_cvt_pk_bf16_f32 v88, v44, v45
v_cvt_pk_bf16_f32 v89, v46, v47
v_pk_mul_f32 v[108:109], v[92:93], v[92:93]
v_pk_mul_f32 v[110:111], v[94:95], v[94:95]
v_pk_fma_f32 v[108:109], v[108:109], v[20:21], v[20:21] op_sel:[0,0,1] op_sel_hi:[1,0,1]
v_pk_fma_f32 v[110:111], v[110:111], v[20:21], v[20:21] op_sel:[0,0,1] op_sel_hi:[1,0,1]
v_pk_mul_f32 v[108:109], v[108:109], v[92:93]
v_pk_mul_f32 v[110:111], v[110:111], v[94:95]
v_exp_f32 v108, v108
v_exp_f32 v109, v109
v_exp_f32 v110, v110
v_exp_f32 v111, v111
v_pk_fma_f32 v[108:109], v[108:109], v[40:41], v[40:41] op_sel:[0,1,1] op_sel_hi:[1,1,1]
v_pk_fma_f32 v[110:111], v[110:111], v[40:41], v[40:41] op_sel:[0,1,1] op_sel_hi:[1,1,1]
v_rcp_f32 v108, v108
v_rcp_f32 v109, v109
v_rcp_f32 v110, v110
v_rcp_f32 v111, v111
v_pk_mul_f32 v[108:109], v[108:109], v[92:93]
v_pk_mul_f32 v[110:111], v[110:111], v[94:95]
v_cvt_pk_bf16_f32 v90, v108, v109
v_cvt_pk_bf16_f32 v91, v110, v111
s_lshl_b32 s60, s71, 8
v_xor_b32 v92, s60, v1
s_add_u32 s62, s72, 114688
buffer_store_dwordx4 v[88:91], v92, s[4:7], s62 offen offset:1024 sc1
s_waitcnt vmcnt(9)
ds_read_b64_tr_b16 a[176:177], v43 offset:53248
ds_read_b64_tr_b16 a[180:181], v43 offset:53256
ds_read_b64_tr_b16 a[178:179], v43 offset:53504
ds_read_b64_tr_b16 a[182:183], v43 offset:53512
s_waitcnt vmcnt(7)
ds_read_b64_tr_b16 a[184:185], v43 offset:55296
ds_read_b64_tr_b16 a[188:189], v43 offset:55304
ds_read_b64_tr_b16 a[186:187], v43 offset:55552
ds_read_b64_tr_b16 a[190:191], v43 offset:55560
s_waitcnt lgkmcnt(10)
v_mfma_f32_16x16x32_bf16 v[96:99], v[152:155], v[128:131], v[96:99]
s_waitcnt vmcnt(5)
ds_read_b64_tr_b16 a[192:193], v43 offset:36864
ds_read_b64_tr_b16 a[196:197], v43 offset:36872
v_mfma_f32_16x16x32_bf16 v[100:103], v[152:155], v[132:135], v[100:103]
ds_read_b64_tr_b16 a[194:195], v43 offset:37120
ds_read_b64_tr_b16 a[198:199], v43 offset:37128
s_waitcnt lgkmcnt(12)
v_mfma_f32_16x16x32_bf16 v[104:107], v[156:159], v[128:131], v[104:107]
s_nop 3
v_permlane16_swap_b32 v96, v100
v_permlane16_swap_b32 v97, v101
v_permlane16_swap_b32 v98, v102
v_permlane16_swap_b32 v99, v103
v_pk_mul_f32 v[44:45], v[96:97], v[96:97]
v_pk_mul_f32 v[46:47], v[98:99], v[98:99]
v_pk_fma_f32 v[44:45], v[44:45], v[20:21], v[20:21] op_sel:[0,0,1] op_sel_hi:[1,0,1]
v_pk_fma_f32 v[46:47], v[46:47], v[20:21], v[20:21] op_sel:[0,0,1] op_sel_hi:[1,0,1]
v_pk_mul_f32 v[44:45], v[44:45], v[96:97]
v_pk_mul_f32 v[46:47], v[46:47], v[98:99]
v_exp_f32 v44, v44
v_exp_f32 v45, v45
v_exp_f32 v46, v46
v_exp_f32 v47, v47
v_pk_fma_f32 v[44:45], v[44:45], v[40:41], v[40:41] op_sel:[0,1,1] op_sel_hi:[1,1,1]
v_pk_fma_f32 v[46:47], v[46:47], v[40:41], v[40:41] op_sel:[0,1,1] op_sel_hi:[1,1,1]
v_rcp_f32 v44, v44
v_rcp_f32 v45, v45
v_rcp_f32 v46, v46
v_rcp_f32 v47, v47
v_pk_mul_f32 v[44:45], v[44:45], v[96:97]
v_pk_mul_f32 v[46:47], v[46:47], v[98:99]
v_cvt_pk_bf16_f32 v96, v44, v45
v_cvt_pk_bf16_f32 v97, v46, v47
v_pk_mul_f32 v[108:109], v[100:101], v[100:101]
v_pk_mul_f32 v[110:111], v[102:103], v[102:103]
v_pk_fma_f32 v[108:109], v[108:109], v[20:21], v[20:21] op_sel:[0,0,1] op_sel_hi:[1,0,1]
v_pk_fma_f32 v[110:111], v[110:111], v[20:21], v[20:21] op_sel:[0,0,1] op_sel_hi:[1,0,1]
v_pk_mul_f32 v[108:109], v[108:109], v[100:101]
v_pk_mul_f32 v[110:111], v[110:111], v[102:103]
v_exp_f32 v108, v108
v_exp_f32 v109, v109
v_exp_f32 v110, v110
v_exp_f32 v111, v111
v_pk_fma_f32 v[108:109], v[108:109], v[40:41], v[40:41] op_sel:[0,1,1] op_sel_hi:[1,1,1]
v_pk_fma_f32 v[110:111], v[110:111], v[40:41], v[40:41] op_sel:[0,1,1] op_sel_hi:[1,1,1]
v_rcp_f32 v108, v108
v_rcp_f32 v109, v109
v_rcp_f32 v110, v110
v_rcp_f32 v111, v111
v_pk_mul_f32 v[108:109], v[108:109], v[100:101]
v_pk_mul_f32 v[110:111], v[110:111], v[102:103]
v_cvt_pk_bf16_f32 v98, v108, v109
v_cvt_pk_bf16_f32 v99, v110, v111
s_lshl_b32 s60, s71, 8
v_xor_b32 v100, s60, v1
s_add_u32 s62, s72, 114688
buffer_store_dwordx4 v[96:99], v100, s[4:7], s62 offen offset:2048 sc1
v_mov_b32 v108, v20
v_pk_mul_f32 v[44:45], v[104:105], v[104:105]
v_pk_mul_f32 v[46:47], v[106:107], v[106:107]
v_permlane16_swap_b32 v20, v108
v_mov_b32 v108, v21
s_waitcnt vmcnt(4)
ds_read_b64_tr_b16 a[200:201], v43 offset:38912
v_permlane16_swap_b32 v21, v108
v_mov_b32 v108, v41
v_pk_fma_f32 v[44:45], v[44:45], v[20:21], v[20:21] op_sel:[0,0,1] op_sel_hi:[1,0,1]
v_pk_fma_f32 v[46:47], v[46:47], v[20:21], v[20:21] op_sel:[0,0,1] op_sel_hi:[1,0,1]
v_permlane16_swap_b32 v41, v108
v_pk_mul_f32 v[44:45], v[44:45], v[104:105]
v_pk_mul_f32 v[46:47], v[46:47], v[106:107]
v_exp_f32 v44, v44
v_exp_f32 v45, v45
v_exp_f32 v46, v46
v_exp_f32 v47, v47
v_pk_fma_f32 v[44:45], v[44:45], v[40:41], v[40:41] op_sel:[0,1,1] op_sel_hi:[1,1,1]
v_pk_fma_f32 v[46:47], v[46:47], v[40:41], v[40:41] op_sel:[0,1,1] op_sel_hi:[1,1,1]
v_rcp_f32 v44, v44
v_rcp_f32 v45, v45
v_rcp_f32 v46, v46
v_rcp_f32 v47, v47
v_pk_mul_f32 v[44:45], v[44:45], v[104:105]
v_pk_mul_f32 v[46:47], v[46:47], v[106:107]
v_cvt_pk_bf16_f32 v104, v44, v45
v_cvt_pk_bf16_f32 v105, v46, v47
v_mov_b32 v106, v104
v_mov_b32 v107, v105
v_lshrrev_b32 v15, 2, v1
buffer_load_dword v15, v15, s[4:7], s37 offen sc1
v_permlane16_swap_b32 v104, v106
v_permlane16_swap_b32 v105, v107
s_lshl_b32 s60, s71, 8
v_xor_b32 v109, s60, v1
s_add_u32 s62, s73, 114688
s_mov_b32 exec_lo, 0xffff
s_mov_b32 exec_hi, 0xffff
buffer_store_dwordx4 v[104:107], v109, s[4:7], s62 offen sc1
s_mov_b64 exec, -1
s_lshl2_add_u32 m0, s46, 131072
s_lshl4_add_u32 s3, s100, s17
s_waitcnt lgkmcnt(9)
buffer_load_dwordx4 v42, s[52:55], s3 offen offset:0 lds
buffer_load_dwordx4 v11, s[52:55], s3 offen offset:1024 lds
ds_read_b64_tr_b16 a[204:205], v43 offset:38920
ds_read_b64_tr_b16 a[202:203], v43 offset:39168
s_add_u32 s3, s3, 14336
s_waitcnt lgkmcnt(7)
buffer_load_dwordx4 v42, s[52:55], s3 offen offset:2048 lds
ds_read_b64_tr_b16 a[206:207], v43 offset:39176
v_mov_b32 v44, -1
buffer_load_dwordx4 v11, s[52:55], s3 offen offset:3072 lds
s_lshl2_add_u32 s60, s46, 114688
v_add_u32 v10, s60, v1
v_xor_b32 v11, 0x80, v10
v_mov_b32 v45, -1
v_mov_b32 v46, -1
v_mov_b32 v47, -1
s_waitcnt vmcnt(5)
v_cmp_gt_u32 vcc, 1, v15
s_nop 0
s_and_b64 vcc, vcc, s[28:29]
s_cbranch_scc1 re_82
re_82b:
s_add_u32 s67, s74, 0
buffer_load_dwordx4 v[112:115], v1, s[4:7], s67 offen offset:0 sc1
buffer_load_dwordx4 v[116:119], v1, s[4:7], s67 offen offset:1024 sc1
buffer_load_dwordx4 v[120:123], v1, s[4:7], s67 offen offset:2048 sc1
buffer_load_dwordx4 v[124:127], v1, s[4:7], s67 offen offset:3072 sc1
s_add_u32 s67, s0, 0
buffer_load_dwordx4 v[128:131], v1, s[4:7], s67 offen offset:0 sc1
buffer_load_dwordx4 v[132:135], v1, s[4:7], s67 offen offset:1024 sc1
s_waitcnt vmcnt(8)
ds_read_b64_tr_b16 a[208:209], v43 offset:53248
ds_read_b64_tr_b16 a[212:213], v43 offset:53256
ds_read_b64_tr_b16 a[210:211], v43 offset:53504
ds_read_b64_tr_b16 a[214:215], v43 offset:53512
v_mov_b32 v108, 2
s_mov_b64 exec, 1
buffer_store_dword v108, v1, s[4:7], s45 offen sc1
s_mov_b64 exec, -1
buffer_load_dwordx4 v[136:139], v1, s[4:7], s67 offen offset:2048 sc1
s_waitcnt vmcnt(8)
ds_read_b64_tr_b16 a[216:217], v43 offset:55296
ds_read_b64_tr_b16 a[220:221], v43 offset:55304
ds_read_b64_tr_b16 a[218:219], v43 offset:55552
ds_read_b64_tr_b16 a[222:223], v43 offset:55560
buffer_load_dwordx4 v[140:143], v1, s[4:7], s67 offen offset:3072 sc1
s_add_u32 s67, s1, 0
buffer_load_dwordx4 v[144:147], v1, s[4:7], s67 offen offset:0 sc1
s_waitcnt lgkmcnt(0)
s_barrier
buffer_load_dwordx4 v[148:151], v1, s[4:7], s67 offen offset:1024 sc1
buffer_load_dwordx4 v[152:155], v1, s[4:7], s67 offen offset:2048 sc1
s_waitcnt vmcnt(11)
v_mfma_f32_32x32x16_bf16 v[48:63], a[0:3], v[112:115], 0
buffer_load_dwordx4 v[156:159], v1, s[4:7], s67 offen offset:3072 sc1
v_mfma_f32_32x32x16_bf16 v[64:79], a[4:7], v[112:115], 0
s_waitcnt vmcnt(11)
v_mfma_f32_32x32x16_bf16 v[48:63], a[8:11], v[116:119], v[48:63]
s_add_u32 s67, s82, 0
buffer_load_dwordx4 v[112:115], v1, s[4:7], s67 offen offset:0 sc1
v_mfma_f32_32x32x16_bf16 v[64:79], a[12:15], v[116:119], v[64:79]
s_waitcnt vmcnt(11)
v_mfma_f32_32x32x16_bf16 v[48:63], a[16:19], v[120:123], v[48:63]
buffer_load_dwordx4 v[116:119], v1, s[4:7], s67 offen offset:1024 sc1
v_mfma_f32_32x32x16_bf16 v[64:79], a[20:23], v[120:123], v[64:79]
s_waitcnt vmcnt(11)
v_mfma_f32_32x32x16_bf16 v[48:63], a[24:27], v[124:127], v[48:63]
buffer_load_dwordx4 v[120:123], v1, s[4:7], s67 offen offset:2048 sc1
v_mfma_f32_32x32x16_bf16 v[64:79], a[28:31], v[124:127], v[64:79]
s_waitcnt vmcnt(11)
v_mfma_f32_32x32x16_bf16 v[48:63], a[32:35], v[128:131], v[48:63]
buffer_load_dwordx4 v[124:127], v1, s[4:7], s67 offen offset:3072 sc1
v_mfma_f32_32x32x16_bf16 v[64:79], a[36:39], v[128:131], v[64:79]
s_waitcnt vmcnt(11)
v_mfma_f32_32x32x16_bf16 v[48:63], a[40:43], v[132:135], v[48:63]
s_add_u32 s67, s83, 0
buffer_load_dwordx4 v[128:131], v1, s[4:7], s67 offen offset:0 sc1
v_mfma_f32_32x32x16_bf16 v[64:79], a[44:47], v[132:135], v[64:79]
buffer_load_dwordx4 v[132:135], v1, s[4:7], s67 offen offset:1024 sc1
s_waitcnt vmcnt(11)
v_mfma_f32_32x32x16_bf16 v[48:63], a[48:51], v[136:139], v[48:63]
v_mfma_f32_32x32x16_bf16 v[64:79], a[52:55], v[136:139], v[64:79]
buffer_load_dwordx4 v[136:139], v1, s[4:7], s67 offen offset:2048 sc1
s_waitcnt vmcnt(11)
v_mfma_f32_32x32x16_bf16 v[48:63], a[56:59], v[140:143], v[48:63]
v_mfma_f32_32x32x16_bf16 v[64:79], a[60:63], v[140:143], v[64:79]
buffer_load_dwordx4 v[140:143], v1, s[4:7], s67 offen offset:3072 sc1
s_waitcnt vmcnt(11)
v_mfma_f32_32x32x16_bf16 v[48:63], a[64:67], v[144:147], v[48:63]
v_mfma_f32_32x32x16_bf16 v[64:79], a[68:71], v[144:147], v[64:79]
s_add_u32 s67, s44, 0
buffer_load_dwordx4 v[144:147], v1, s[4:7], s67 offen offset:0 sc1
s_waitcnt vmcnt(11)
v_mfma_f32_32x32x16_bf16 v[48:63], a[72:75], v[148:151], v[48:63]
v_mfma_f32_32x32x16_bf16 v[64:79], a[76:79], v[148:151], v[64:79]
v_lshrrev_b32 v15, 2, v1
buffer_load_dword v15, v15, s[4:7], s37 offen sc1
s_waitcnt vmcnt(11)
v_mfma_f32_32x32x16_bf16 v[48:63], a[80:83], v[152:155], v[48:63]
buffer_load_dwordx4 v[148:151], v1, s[4:7], s67 offen offset:1024 sc1
v_mfma_f32_32x32x16_bf16 v[64:79], a[84:87], v[152:155], v[64:79]
s_waitcnt vmcnt(11)
v_mfma_f32_32x32x16_bf16 v[48:63], a[88:91], v[156:159], v[48:63]
buffer_load_dwordx4 v[152:155], v1, s[4:7], s67 offen offset:2048 sc1
v_mfma_f32_32x32x16_bf16 v[64:79], a[92:95], v[156:159], v[64:79]
s_waitcnt vmcnt(11)
v_mfma_f32_32x32x16_bf16 v[48:63], a[96:99], v[112:115], v[48:63]
buffer_load_dwordx4 v[156:159], v1, s[4:7], s67 offen offset:3072 sc1
v_mfma_f32_32x32x16_bf16 v[64:79], a[100:103], v[112:115], v[64:79]
s_waitcnt vmcnt(11)
v_mfma_f32_32x32x16_bf16 v[48:63], a[104:107], v[116:119], v[48:63]
s_add_u32 s67, s100, 0
buffer_load_dwordx4 v[112:115], v1, s[4:7], s67 offen offset:0 sc1
v_mfma_f32_32x32x16_bf16 v[64:79], a[108:111], v[116:119], v[64:79]
s_waitcnt vmcnt(11)
v_mfma_f32_32x32x16_bf16 v[48:63], a[112:115], v[120:123], v[48:63]
buffer_load_dwordx4 v[116:119], v1, s[4:7], s67 offen offset:1024 sc1
v_mfma_f32_32x32x16_bf16 v[64:79], a[116:119], v[120:123], v[64:79]
s_waitcnt vmcnt(11)
v_mfma_f32_32x32x16_bf16 v[48:63], a[120:123], v[124:127], v[48:63]
buffer_load_dwordx4 v[120:123], v1, s[4:7], s67 offen offset:2048 sc1
v_mfma_f32_32x32x16_bf16 v[64:79], a[124:127], v[124:127], v[64:79]
s_waitcnt vmcnt(11)
v_mfma_f32_32x32x16_bf16 v[48:63], a[128:131], v[128:131], v[48:63]
buffer_load_dwordx4 v[124:127], v1, s[4:7], s67 offen offset:3072 sc1
v_mfma_f32_32x32x16_bf16 v[64:79], a[132:135], v[128:131], v[64:79]
s_waitcnt vmcnt(11)
v_mfma_f32_32x32x16_bf16 v[48:63], a[136:139], v[132:135], v[48:63]
v_mfma_f32_32x32x16_bf16 v[64:79], a[140:143], v[132:135], v[64:79]
s_waitcnt vmcnt(10)
v_mfma_f32_32x32x16_bf16 v[48:63], a[144:147], v[136:139], v[48:63]
v_mfma_f32_32x32x16_bf16 v[64:79], a[148:151], v[136:139], v[64:79]
s_waitcnt vmcnt(9)
v_mfma_f32_32x32x16_bf16 v[48:63], a[152:155], v[140:143], v[48:63]
v_mfma_f32_32x32x16_bf16 v[64:79], a[156:159], v[140:143], v[64:79]
s_waitcnt vmcnt(7)
v_cmp_gt_u32 vcc, 2, v15
s_nop 0
s_and_b64 vcc, vcc, -1
s_cbranch_scc1 re_83
re_83b:
s_add_u32 s67, s74, 114688
buffer_load_dwordx4 v[128:131], v1, s[4:7], s67 offen offset:0 sc1
buffer_load_dwordx4 v[132:135], v1, s[4:7], s67 offen offset:1024 sc1
v_mfma_f32_32x32x16_bf16 v[48:63], a[160:163], v[144:147], v[48:63]
buffer_load_dwordx4 v[136:139], v1, s[4:7], s67 offen offset:2048 sc1
v_mfma_f32_32x32x16_bf16 v[64:79], a[164:167], v[144:147], v[64:79]
buffer_load_dwordx4 v[140:143], v1, s[4:7], s67 offen offset:3072 sc1
s_waitcnt vmcnt(10)
v_mfma_f32_32x32x16_bf16 v[48:63], a[168:171], v[148:151], v[48:63]
s_add_u32 s67, s0, 114688
buffer_load_dwordx4 v[144:147], v1, s[4:7], s67 offen offset:0 sc1
v_mfma_f32_32x32x16_bf16 v[64:79], a[172:175], v[148:151], v[64:79]
s_add_u32 s62, s34, 1966080
buffer_store_dwordx4 v[44:47], v1, s[4:7], s62 offen sc1
s_waitcnt vmcnt(11)
v_mfma_f32_32x32x16_bf16 v[48:63], a[176:179], v[152:155], v[48:63]
v_mfma_f32_32x32x16_bf16 v[64:79], a[180:183], v[152:155], v[64:79]
s_add_u32 s62, s34, 1998848
buffer_store_dwordx4 v[44:47], v1, s[4:7], s62 offen sc1
s_waitcnt vmcnt(11)
v_mfma_f32_32x32x16_bf16 v[48:63], a[184:187], v[156:159], v[48:63]
v_mfma_f32_32x32x16_bf16 v[64:79], a[188:191], v[156:159], v[64:79]
buffer_load_dwordx4 v[148:151], v1, s[4:7], s67 offen offset:1024 sc1
s_waitcnt vmcnt(11)
v_mfma_f32_32x32x16_bf16 v[48:63], a[192:195], v[112:115], v[48:63]
v_mfma_f32_32x32x16_bf16 v[64:79], a[196:199], v[112:115], v[64:79]
buffer_load_dwordx4 v[152:155], v1, s[4:7], s67 offen offset:2048 sc1
s_waitcnt vmcnt(11)
v_mfma_f32_32x32x16_bf16 v[48:63], a[200:203], v[116:119], v[48:63]
v_mfma_f32_32x32x16_bf16 v[64:79], a[204:207], v[116:119], v[64:79]
buffer_load_dwordx4 v[156:159], v1, s[4:7], s67 offen offset:3072 sc1
s_waitcnt vmcnt(11)
v_mfma_f32_32x32x16_bf16 v[48:63], a[208:211], v[120:123], v[48:63]
v_mfma_f32_32x32x16_bf16 v[64:79], a[212:215], v[120:123], v[64:79]
s_add_u32 s67, s1, 114688
buffer_load_dwordx4 v[112:115], v1, s[4:7], s67 offen offset:0 sc1
s_waitcnt vmcnt(11)
v_mfma_f32_32x32x16_bf16 v[48:63], a[216:219], v[124:127], v[48:63]
v_mfma_f32_32x32x16_bf16 v[64:79], a[220:223], v[124:127], v[64:79]
buffer_load_dwordx4 v[116:119], v1, s[4:7], s67 offen offset:1024 sc1
s_nop 3
ds_write_b128 v10, v[48:51] offset:0
ds_write_b128 v11, v[52:55] offset:1024
s_waitcnt vmcnt(11)
v_mfma_f32_32x32x16_bf16 v[80:95], a[0:3], v[128:131], 0
buffer_load_dwordx4 v[120:123], v1, s[4:7], s67 offen offset:2048 sc1
ds_write_b128 v10, v[56:59] offset:2048
v_mfma_f32_32x32x16_bf16 v[96:111], a[4:7], v[128:131], 0
ds_write_b128 v11, v[60:63] offset:3072
buffer_load_dwordx4 v[124:127], v1, s[4:7], s67 offen offset:3072 sc1
s_waitcnt vmcnt(12)
v_mfma_f32_32x32x16_bf16 v[80:95], a[8:11], v[132:135], v[80:95]
ds_write_b128 v10, v[64:67] offset:16384
s_add_u32 s67, s82, 114688
buffer_load_dwordx4 v[128:131], v1, s[4:7], s67 offen offset:0 sc1
v_mfma_f32_32x32x16_bf16 v[96:111], a[12:15], v[132:135], v[96:111]
ds_write_b128 v11, v[68:71] offset:17408
s_waitcnt lgkmcnt(2)
s_barrier
buffer_load_dwordx4 v[132:135], v1, s[4:7], s67 offen offset:1024 sc1
ds_write_b128 v10, v[72:75] offset:18432
ds_write_b128 v11, v[76:79] offset:19456
s_waitcnt vmcnt(13)
v_mfma_f32_32x32x16_bf16 v[80:95], a[16:19], v[136:139], v[80:95]
ds_read_b128 v[48:51], v12 offset:0
ds_read_b128 v[52:55], v12 offset:4096
ds_read_b128 v[56:59], v12 offset:8192
ds_read_b128 v[60:63], v12 offset:12288
v_mfma_f32_32x32x16_bf16 v[96:111], a[20:23], v[136:139], v[96:111]
buffer_load_dwordx4 v[136:139], v1, s[4:7], s67 offen offset:2048 sc1
s_waitcnt vmcnt(13)
v_mfma_f32_32x32x16_bf16 v[80:95], a[24:27], v[140:143], v[80:95]
s_waitcnt lgkmcnt(2)
v_add_f32 v48, v48, v52
v_add_f32 v49, v49, v53
v_mfma_f32_32x32x16_bf16 v[96:111], a[28:31], v[140:143], v[96:111]
buffer_load_dwordx4 v[140:143], v1, s[4:7], s67 offen offset:3072 sc1
s_waitcnt vmcnt(11) lgkmcnt(0)
s_barrier
v_mfma_f32_32x32x16_bf16 v[80:95], a[32:35], v[144:147], v[80:95]
v_add_f32 v50, v50, v54
v_add_f32 v51, v51, v55
v_add_f32 v56, v56, v60
v_add_f32 v57, v57, v61
v_add_f32 v58, v58, v62
v_add_f32 v59, v59, v63
v_mfma_f32_32x32x16_bf16 v[96:111], a[36:39], v[144:147], v[96:111]
s_add_u32 s67, s83, 114688
buffer_load_dwordx4 v[144:147], v1, s[4:7], s67 offen offset:0 sc1
s_waitcnt vmcnt(11)
v_mfma_f32_32x32x16_bf16 v[80:95], a[40:43], v[148:151], v[80:95]
v_add_f32 v24, v24, v48
v_add_f32 v25, v25, v49
v_add_f32 v26, v26, v50
v_add_f32 v27, v27, v51
v_add_f32 v24, v24, v56
v_add_f32 v25, v25, v57
v_mfma_f32_32x32x16_bf16 v[96:111], a[44:47], v[148:151], v[96:111]
buffer_load_dwordx4 v[148:151], v1, s[4:7], s67 offen offset:1024 sc1
v_add_f32 v26, v26, v58
v_add_f32 v27, v27, v59
ds_read_b128 v[64:67], v12 offset:16384
s_waitcnt vmcnt(11)
v_mfma_f32_32x32x16_bf16 v[80:95], a[48:51], v[152:155], v[80:95]
ds_read_b128 v[68:71], v12 offset:20480
ds_read_b128 v[72:75], v12 offset:24576
ds_read_b128 v[76:79], v12 offset:28672
v_add_f32 v48, v24, v26
v_add_f32 v49, v25, v27
v_mfma_f32_32x32x16_bf16 v[96:111], a[52:55], v[152:155], v[96:111]
buffer_load_dwordx4 v[152:155], v1, s[4:7], s67 offen offset:2048 sc1
v_mul_f32 v50, v24, v24
v_mul_f32 v51, v25, v25
v_fmac_f32 v50, v26, v26
v_fmac_f32 v51, v27, v27
s_waitcnt vmcnt(11)
v_mfma_f32_32x32x16_bf16 v[80:95], a[56:59], v[156:159], v[80:95]
s_waitcnt lgkmcnt(2)
v_add_f32 v64, v64, v68
v_add_f32 v65, v65, v69
v_add_f32 v66, v66, v70
v_add_f32 v67, v67, v71
v_add_f32 v28, v28, v64
v_add_f32 v29, v29, v65
v_mfma_f32_32x32x16_bf16 v[96:111], a[60:63], v[156:159], v[96:111]
buffer_load_dwordx4 v[156:159], v1, s[4:7], s67 offen offset:3072 sc1
s_waitcnt lgkmcnt(0)
v_add_f32 v72, v72, v76
v_add_f32 v73, v73, v77
s_waitcnt vmcnt(11)
v_mfma_f32_32x32x16_bf16 v[80:95], a[64:67], v[112:115], v[80:95]
v_add_f32 v74, v74, v78
v_add_f32 v75, v75, v79
v_add_f32 v30, v30, v66
v_add_f32 v31, v31, v67
s_add_u32 s62, s34, 1835008
buffer_load_dwordx4 v[64:67], v1, s[4:7], s62 offen sc1
v_mfma_f32_32x32x16_bf16 v[96:111], a[68:71], v[112:115], v[96:111]
s_add_u32 s67, s44, 114688
buffer_load_dwordx4 v[112:115], v1, s[4:7], s67 offen offset:0 sc1
v_add_f32 v28, v28, v72
v_add_f32 v29, v29, v73
s_waitcnt vmcnt(12)
v_mfma_f32_32x32x16_bf16 v[80:95], a[72:75], v[116:119], v[80:95]
v_add_f32 v30, v30, v74
v_add_f32 v31, v31, v75
v_add_f32 v48, v48, v28
v_add_f32 v49, v49, v29
v_fmac_f32 v50, v28, v28
v_fmac_f32 v51, v29, v29
v_mfma_f32_32x32x16_bf16 v[96:111], a[76:79], v[116:119], v[96:111]
buffer_load_dwordx4 v[116:119], v1, s[4:7], s67 offen offset:1024 sc1
v_add_f32 v48, v48, v30
v_add_f32 v49, v49, v31
v_fmac_f32 v50, v30, v30
v_fmac_f32 v51, v31, v31
s_waitcnt vmcnt(12)
v_mfma_f32_32x32x16_bf16 v[80:95], a[80:83], v[120:123], v[80:95]
v_add_f32 v48, v48, v49
v_add_f32 v50, v50, v51
s_nop 1
v_permlane32_swap_b32 v48, v50
v_mfma_f32_32x32x16_bf16 v[96:111], a[84:87], v[120:123], v[96:111]
buffer_load_dwordx4 v[120:123], v1, s[4:7], s67 offen offset:2048 sc1
v_add_f32 v48, v48, v50
v_mov_b32 v50, v48
s_waitcnt vmcnt(12)
v_mfma_f32_32x32x16_bf16 v[80:95], a[88:91], v[124:127], v[80:95]
v_permlane16_swap_b32 v48, v50
v_add_f32 v48, v48, v50
s_nop 1
v_add_f32_dpp v48, v48, v48 row_ror:8 row_mask:0xf bank_mask:0xf
v_mfma_f32_32x32x16_bf16 v[96:111], a[92:95], v[124:127], v[96:111]
buffer_load_dwordx4 v[124:127], v1, s[4:7], s67 offen offset:3072 sc1
s_waitcnt vmcnt(12)
v_mfma_f32_32x32x16_bf16 v[80:95], a[96:99], v[128:131], v[80:95]
s_add_u32 s62, s42, 565248
buffer_store_dword v48, v8, s[4:7], s62 offen offset:0 sc1
v_mfma_f32_32x32x16_bf16 v[96:111], a[100:103], v[128:131], v[96:111]
s_add_u32 s67, s100, 114688
buffer_load_dwordx4 v[128:131], v1, s[4:7], s67 offen offset:0 sc1
s_waitcnt vmcnt(13)
v_mfma_f32_32x32x16_bf16 v[80:95], a[104:107], v[132:135], v[80:95]
v_mfma_f32_32x32x16_bf16 v[96:111], a[108:111], v[132:135], v[96:111]
buffer_load_dwordx4 v[132:135], v1, s[4:7], s67 offen offset:1024 sc1
s_waitcnt vmcnt(13)
v_mfma_f32_32x32x16_bf16 v[80:95], a[112:115], v[136:139], v[80:95]
v_mfma_f32_32x32x16_bf16 v[96:111], a[116:119], v[136:139], v[96:111]
buffer_load_dwordx4 v[136:139], v1, s[4:7], s67 offen offset:2048 sc1
s_waitcnt vmcnt(13)
v_mfma_f32_32x32x16_bf16 v[80:95], a[120:123], v[140:143], v[80:95]
v_mfma_f32_32x32x16_bf16 v[96:111], a[124:127], v[140:143], v[96:111]
buffer_load_dwordx4 v[140:143], v1, s[4:7], s67 offen offset:3072 sc1
s_waitcnt vmcnt(13)
v_mfma_f32_32x32x16_bf16 v[80:95], a[128:131], v[144:147], v[80:95]
v_mfma_f32_32x32x16_bf16 v[96:111], a[132:135], v[144:147], v[96:111]
s_waitcnt vmcnt(12)
v_mfma_f32_32x32x16_bf16 v[80:95], a[136:139], v[148:151], v[80:95]
s_waitcnt vmcnt(9)
v_lshlrev_b32 v68, 16, v64
v_mfma_f32_32x32x16_bf16 v[96:111], a[140:143], v[148:151], v[96:111]
v_and_b32 v69, s36, v64
v_lshlrev_b32 v70, 16, v65
v_and_b32 v71, s36, v65
v_lshlrev_b32 v72, 16, v66
v_and_b32 v73, s36, v66
v_lshlrev_b32 v74, 16, v67
v_mfma_f32_32x32x16_bf16 v[80:95], a[144:147], v[152:155], v[80:95]
v_and_b32 v75, s36, v67
v_mfma_f32_32x32x16_bf16 v[96:111], a[148:151], v[152:155], v[96:111]
v_mfma_f32_32x32x16_bf16 v[80:95], a[152:155], v[156:159], v[80:95]
v_mfma_f32_32x32x16_bf16 v[96:111], a[156:159], v[156:159], v[96:111]
s_waitcnt vmcnt(8)
v_mfma_f32_32x32x16_bf16 v[80:95], a[160:163], v[112:115], v[80:95]
v_mfma_f32_32x32x16_bf16 v[96:111], a[164:167], v[112:115], v[96:111]
s_waitcnt vmcnt(7)
v_mfma_f32_32x32x16_bf16 v[80:95], a[168:171], v[116:119], v[80:95]
v_mfma_f32_32x32x16_bf16 v[96:111], a[172:175], v[116:119], v[96:111]
s_waitcnt vmcnt(6)
v_mfma_f32_32x32x16_bf16 v[80:95], a[176:179], v[120:123], v[80:95]
s_add_u32 s62, s43, 565248
buffer_load_dwordx2 v[52:53], v7, s[4:7], s62 offen offset:0 sc1
v_mfma_f32_32x32x16_bf16 v[96:111], a[180:183], v[120:123], v[96:111]
s_waitcnt vmcnt(6)
v_mfma_f32_32x32x16_bf16 v[80:95], a[184:187], v[124:127], v[80:95]
v_mfma_f32_32x32x16_bf16 v[96:111], a[188:191], v[124:127], v[96:111]
s_waitcnt vmcnt(4)
v_mfma_f32_32x32x16_bf16 v[80:95], a[192:195], v[128:131], v[80:95]
v_mfma_f32_32x32x16_bf16 v[96:111], a[196:199], v[128:131], v[96:111]
s_waitcnt vmcnt(3)
v_mfma_f32_32x32x16_bf16 v[80:95], a[200:203], v[132:135], v[80:95]
v_mfma_f32_32x32x16_bf16 v[96:111], a[204:207], v[132:135], v[96:111]
s_waitcnt vmcnt(2)
v_mfma_f32_32x32x16_bf16 v[80:95], a[208:211], v[136:139], v[80:95]
v_mfma_f32_32x32x16_bf16 v[96:111], a[212:215], v[136:139], v[96:111]
s_waitcnt vmcnt(1)
v_mfma_f32_32x32x16_bf16 v[80:95], a[216:219], v[140:143], v[80:95]
s_waitcnt vmcnt(0)
v_max_u32 v54, v52, v53
v_cmp_eq_u32 vcc, -1, v54
s_cbranch_vccnz re_84
re_84b:
v_mfma_f32_32x32x16_bf16 v[96:111], a[220:223], v[140:143], v[96:111]
v_permlane32_swap_b32 v52, v53
s_nop 3
ds_write_b128 v10, v[80:83] offset:0
ds_write_b128 v11, v[84:87] offset:1024
v_add_f32 v52, v52, v53
v_mov_b32 v53, v52
s_nop 1
v_permlane16_swap_b32 v52, v53
v_add_f32 v52, v52, v53
ds_write_b128 v10, v[88:91] offset:2048
s_nop 0
v_add_f32_dpp v52, v52, v52 row_ror:8 row_mask:0xf bank_mask:0xf
v_mul_f32 v52, 0x3b000000, v52
v_mov_b32 v53, v52
s_nop 1
v_permlane32_swap_b32 v52, v53
ds_write_b128 v11, v[92:95] offset:3072
v_fma_f32 v53, -v52, v52, v53
v_max_f32 v53, 0, v53
v_add_f32 v54, 0x3727c5ac, v53
v_rsq_f32 v54, v54
s_nop 0
v_mul_f32 v55, -v52, v54
v_pk_fma_f32 v[56:57], v[24:25], v[54:55], v[54:55] op_sel:[0,0,1] op_sel_hi:[1,0,1]
v_pk_fma_f32 v[58:59], v[26:27], v[54:55], v[54:55] op_sel:[0,0,1] op_sel_hi:[1,0,1]
v_pk_fma_f32 v[60:61], v[28:29], v[54:55], v[54:55] op_sel:[0,0,1] op_sel_hi:[1,0,1]
v_pk_fma_f32 v[62:63], v[30:31], v[54:55], v[54:55] op_sel:[0,0,1] op_sel_hi:[1,0,1]
v_pk_fma_f32 v[24:25], v[56:57], v[68:69], v[24:25] op_sel:[0,0,0] op_sel_hi:[1,1,1]
v_pk_fma_f32 v[26:27], v[58:59], v[70:71], v[26:27] op_sel:[0,0,0] op_sel_hi:[1,1,1]
v_pk_fma_f32 v[28:29], v[60:61], v[72:73], v[28:29] op_sel:[0,0,0] op_sel_hi:[1,1,1]
v_pk_fma_f32 v[30:31], v[62:63], v[74:75], v[30:31] op_sel:[0,0,0] op_sel_hi:[1,1,1]
v_cvt_pk_bf16_f32 v76, v24, v25
v_cvt_pk_bf16_f32 v77, v26, v27
v_cvt_pk_bf16_f32 v78, v28, v29
v_cvt_pk_bf16_f32 v79, v30, v31
s_add_u32 s62, s40, 1966080
buffer_store_dwordx4 v[76:79], v3, s[4:7], s62 offen sc1
s_waitcnt lgkmcnt(0)
s_barrier
ds_write_b128 v10, v[96:99] offset:16384
ds_write_b128 v11, v[100:103] offset:17408
ds_read_b128 v[80:83], v12 offset:0
ds_read_b128 v[84:87], v12 offset:4096
ds_read_b128 v[88:91], v12 offset:8192
ds_read_b128 v[92:95], v12 offset:12288
ds_write_b128 v10, v[104:107] offset:18432
v_add_u32 v76, s25, v1
v_pk_add_f32 v[68:69], v[24:25], v[26:27]
v_pk_mul_f32 v[70:71], v[24:25], v[24:25]
ds_write_b128 v11, v[108:111] offset:19456
s_waitcnt lgkmcnt(4)
v_pk_add_f32 v[80:81], v[80:81], v[84:85]
v_pk_add_f32 v[82:83], v[82:83], v[86:87]
s_waitcnt lgkmcnt(2)
v_pk_add_f32 v[88:89], v[88:89], v[92:93]
v_pk_add_f32 v[90:91], v[90:91], v[94:95]
v_pk_add_f32 v[32:33], v[32:33], v[80:81]
v_pk_add_f32 v[34:35], v[34:35], v[82:83]
v_pk_add_f32 v[32:33], v[32:33], v[88:89]
v_pk_add_f32 v[34:35], v[34:35], v[90:91]
s_waitcnt lgkmcnt(0)
s_barrier
ds_read_b128 v[96:99], v12 offset:16384
ds_read_b128 v[100:103], v12 offset:20480
ds_read_b128 v[104:107], v12 offset:24576
ds_read_b128 v[108:111], v12 offset:28672
v_pk_add_f32 v[80:81], v[32:33], v[34:35]
v_pk_mul_f32 v[82:83], v[32:33], v[32:33]
v_pk_fma_f32 v[82:83], v[34:35], v[34:35], v[82:83] op_sel:[0,0,0] op_sel_hi:[1,1,1]
v_pk_fma_f32 v[70:71], v[26:27], v[26:27], v[70:71] op_sel:[0,0,0] op_sel_hi:[1,1,1]
v_pk_add_f32 v[68:69], v[68:69], v[28:29]
v_pk_fma_f32 v[70:71], v[28:29], v[28:29], v[70:71] op_sel:[0,0,0] op_sel_hi:[1,1,1]
v_pk_add_f32 v[68:69], v[68:69], v[30:31]
s_waitcnt lgkmcnt(2)
v_pk_add_f32 v[96:97], v[96:97], v[100:101]
v_pk_add_f32 v[98:99], v[98:99], v[102:103]
v_pk_add_f32 v[36:37], v[36:37], v[96:97]
v_pk_add_f32 v[38:39], v[38:39], v[98:99]
s_add_u32 s62, s34, 1867776
buffer_load_dwordx4 v[96:99], v1, s[4:7], s62 offen sc1
s_waitcnt lgkmcnt(0)
v_pk_add_f32 v[104:105], v[104:105], v[108:109]
v_pk_add_f32 v[106:107], v[106:107], v[110:111]
v_pk_add_f32 v[36:37], v[36:37], v[104:105]
v_pk_add_f32 v[38:39], v[38:39], v[106:107]
v_pk_add_f32 v[80:81], v[80:81], v[36:37]
v_pk_fma_f32 v[82:83], v[36:37], v[36:37], v[82:83] op_sel:[0,0,0] op_sel_hi:[1,1,1]
v_pk_add_f32 v[80:81], v[80:81], v[38:39]
s_add_u32 m0, s23, 32768
s_xor_b32 s38, s47, 1966080
buffer_load_dwordx4 v1, s[4:7], s38 offen offset:0 sc1 lds
buffer_load_dwordx4 v1, s[4:7], s38 offen offset:1024 sc1 lds
v_pk_fma_f32 v[82:83], v[38:39], v[38:39], v[82:83] op_sel:[0,0,0] op_sel_hi:[1,1,1]
v_add_f32 v80, v80, v81
v_add_f32 v82, v82, v83
v_pk_fma_f32 v[70:71], v[30:31], v[30:31], v[70:71] op_sel:[0,0,0] op_sel_hi:[1,1,1]
v_add_f32 v68, v68, v69
v_permlane32_swap_b32 v80, v82
v_add_f32 v80, v80, v82
s_add_u32 m0, s23, 0
s_xor_b32 s38, s47, 1974272
buffer_load_dwordx4 v1, s[4:7], s38 offen offset:0 sc1 lds
buffer_load_dwordx4 v1, s[4:7], s38 offen offset:1024 sc1 lds
v_mov_b32 v82, v80
v_add_f32 v70, v70, v71
s_nop 0
v_permlane16_swap_b32 v80, v82
v_add_f32 v80, v80, v82
v_permlane32_swap_b32 v68, v70
s_nop 0
v_add_f32_dpp v80, v80, v80 row_ror:8 row_mask:0xf bank_mask:0xf
s_add_u32 s62, s42, 565248
buffer_store_dword v80, v8, s[4:7], s62 offen offset:2048 sc1
v_add_f32 v68, v68, v70
v_mov_b32 v70, v68
s_nop 1
v_permlane16_swap_b32 v68, v70
v_add_f32 v68, v68, v70
s_nop 1
v_add_f32_dpp v68, v68, v68 row_ror:8 row_mask:0xf bank_mask:0xf
s_add_u32 m0, s23, 8192
s_xor_b32 s38, s47, 1982464
buffer_load_dwordx4 v1, s[4:7], s38 offen offset:0 sc1 lds
buffer_load_dwordx4 v1, s[4:7], s38 offen offset:1024 sc1 lds
s_waitcnt vmcnt(7)
v_lshlrev_b32 v100, 16, v96
v_and_b32 v101, s36, v96
v_lshlrev_b32 v102, 16, v97
v_and_b32 v103, s36, v97
v_lshlrev_b32 v104, 16, v98
v_and_b32 v105, s36, v98
v_lshlrev_b32 v106, 16, v99
v_and_b32 v107, s36, v99
s_add_u32 s62, s42, 548864
buffer_store_dword v68, v8, s[4:7], s62 offen offset:0 sc1
v_lshrrev_b32 v68, 9, v1
v_lshl_add_u32 v68, v68, 5, s26
ds_read_b128 v[64:67], v68 offset:0
ds_read_b128 v[68:71], v68 offset:16
s_waitcnt vmcnt(6)
ds_read2st64_b32 v[72:73], v0 offset0:128 offset1:132
s_waitcnt lgkmcnt(0)
v_max_u32 v72, v72, v73
v_cmp_eq_u32 vcc, -1, v72
s_cbranch_vccnz re_86
re_86b:
s_barrier
ds_read_b128 v[112:115], v23 offset:32768
ds_read_b128 v[116:119], v23 offset:33024
ds_read_b128 v[120:123], v23 offset:34816
ds_read_b128 v[124:127], v23 offset:35072
ds_read_b128 v[128:131], v23 offset:36864
ds_read_b128 v[132:135], v23 offset:37120
ds_read_b128 v[136:139], v23 offset:38912
ds_read_b128 v[140:143], v23 offset:39168
s_add_u32 m0, s23, 16384
s_xor_b32 s38, s47, 1990656
buffer_load_dwordx4 v1, s[4:7], s38 offen offset:0 sc1 lds
buffer_load_dwordx4 v1, s[4:7], s38 offen offset:1024 sc1 lds
s_waitcnt vmcnt(6)
ds_read2st64_b32 v[72:73], v0 offset0:0 offset1:4
ds_read_b128 v[76:79], v76 offset:32768
s_waitcnt lgkmcnt(8)
v_mfma_f32_16x16x32_bf16 v[48:51], v[160:163], v[112:115], 0
s_waitcnt vmcnt(3)
ds_read2st64_b32 v[74:75], v0 offset0:32 offset1:36
v_mfma_f32_16x16x32_bf16 v[52:55], v[160:163], v[116:119], 0
s_waitcnt lgkmcnt(7)
v_mfma_f32_16x16x32_bf16 v[48:51], v[164:167], v[120:123], v[48:51]
v_mfma_f32_16x16x32_bf16 v[52:55], v[164:167], v[124:127], v[52:55]
s_waitcnt lgkmcnt(5)
v_mfma_f32_16x16x32_bf16 v[48:51], v[168:171], v[128:131], v[48:51]
s_add_u32 s62, s43, 565248
buffer_load_dwordx2 v[84:85], v7, s[4:7], s62 offen offset:2048 sc1
s_waitcnt lgkmcnt(0)
v_max3_u32 v72, v72, v73, v74
v_max_u32 v72, v72, v75
v_cmp_eq_u32 vcc, -1, v72
s_cbranch_vccnz re_87
re_87b:
s_barrier
ds_read_b128 v[144:147], v23 offset:0
ds_read_b128 v[148:151], v23 offset:256
ds_read_b128 v[152:155], v23 offset:2048
ds_read_b128 v[156:159], v23 offset:2304
ds_read_b128 v[112:115], v23 offset:4096
ds_read_b128 v[116:119], v23 offset:4352
ds_read_b128 v[120:123], v23 offset:6144
ds_read_b128 v[124:127], v23 offset:6400
ds_read_b128 v[128:131], v23 offset:8192
v_mfma_f32_16x16x32_bf16 v[52:55], v[168:171], v[132:135], v[52:55]
ds_read_b128 v[132:135], v23 offset:8448
s_add_u32 s62, s43, 548864
buffer_load_dwordx4 v[56:59], v1, s[4:7], s62 offen offset:0 sc1
buffer_load_dwordx4 v[60:63], v1, s[4:7], s62 offen offset:1024 sc1
v_mfma_f32_16x16x32_bf16 v[48:51], v[172:175], v[136:139], v[48:51]
ds_read_b128 v[136:139], v23 offset:10240
s_waitcnt vmcnt(3)
ds_read2st64_b32 v[72:73], v0 offset0:64 offset1:68
s_waitcnt vmcnt(2)
v_max_u32 v86, v84, v85
v_cmp_eq_u32 vcc, -1, v86
s_cbranch_vccnz re_85
re_85b:
v_permlane32_swap_b32 v84, v85
v_add_f32 v84, v84, v85
v_mov_b32 v85, v84
v_mfma_f32_16x16x32_bf16 v[52:55], v[172:175], v[140:143], v[52:55]
ds_read_b128 v[140:143], v23 offset:10496
v_permlane16_swap_b32 v84, v85
v_add_f32 v84, v84, v85
s_waitcnt lgkmcnt(11)
v_mfma_f32_16x16x32_bf16 v[48:51], v[176:179], v[144:147], v[48:51]
ds_read_b128 v[144:147], v23 offset:12288
v_add_f32_dpp v84, v84, v84 row_ror:8 row_mask:0xf bank_mask:0xf
v_mul_f32 v84, 0x3b000000, v84
v_mov_b32 v85, v84
v_mfma_f32_16x16x32_bf16 v[52:55], v[176:179], v[148:151], v[52:55]
ds_read_b128 v[148:151], v23 offset:12544
v_permlane32_swap_b32 v84, v85
v_fma_f32 v85, -v84, v84, v85
v_max_f32 v85, 0, v85
v_add_f32 v86, 0x3727c5ac, v85
v_rsq_f32 v86, v86
s_waitcnt lgkmcnt(11)
v_mfma_f32_16x16x32_bf16 v[48:51], v[180:183], v[152:155], v[48:51]
ds_read_b128 v[152:155], v23 offset:14336
v_mul_f32 v87, -v84, v86
v_fma_f32 v88, v32, v86, v87
v_fma_f32 v89, v33, v86, v87
v_pk_fma_f32 v[90:91], v[34:35], v[86:87], v[86:87] op_sel:[0,0,1] op_sel_hi:[1,0,1]
v_pk_fma_f32 v[92:93], v[36:37], v[86:87], v[86:87] op_sel:[0,0,1] op_sel_hi:[1,0,1]
v_pk_fma_f32 v[94:95], v[38:39], v[86:87], v[86:87] op_sel:[0,0,1] op_sel_hi:[1,0,1]
v_pk_fma_f32 v[32:33], v[88:89], v[100:101], v[32:33] op_sel:[0,0,0] op_sel_hi:[1,1,1]
v_pk_fma_f32 v[34:35], v[90:91], v[102:103], v[34:35] op_sel:[0,0,0] op_sel_hi:[1,1,1]
v_pk_fma_f32 v[36:37], v[92:93], v[104:105], v[36:37] op_sel:[0,0,0] op_sel_hi:[1,1,1]
v_pk_fma_f32 v[38:39], v[94:95], v[106:107], v[38:39] op_sel:[0,0,0] op_sel_hi:[1,1,1]
v_cvt_pk_bf16_f32 v108, v32, v33
v_cvt_pk_bf16_f32 v109, v34, v35
v_cvt_pk_bf16_f32 v110, v36, v37
v_cvt_pk_bf16_f32 v111, v38, v39
s_add_u32 s62, s40, 1998848
buffer_store_dwordx4 v[108:111], v3, s[4:7], s62 offen sc1
s_nop 1
v_add_u32 v108, s25, v1
v_pk_add_f32 v[100:101], v[32:33], v[34:35]
v_pk_mul_f32 v[102:103], v[32:33], v[32:33]
v_pk_fma_f32 v[102:103], v[34:35], v[34:35], v[102:103] op_sel:[0,0,0] op_sel_hi:[1,1,1]
v_pk_add_f32 v[100:101], v[100:101], v[36:37]
v_pk_fma_f32 v[102:103], v[36:37], v[36:37], v[102:103] op_sel:[0,0,0] op_sel_hi:[1,1,1]
v_pk_add_f32 v[100:101], v[100:101], v[38:39]
v_pk_fma_f32 v[102:103], v[38:39], v[38:39], v[102:103] op_sel:[0,0,0] op_sel_hi:[1,1,1]
v_add_f32 v100, v100, v101
v_add_f32 v102, v102, v103
v_mfma_f32_16x16x32_bf16 v[52:55], v[180:183], v[156:159], v[52:55]
ds_read_b128 v[156:159], v23 offset:14592
v_permlane32_swap_b32 v100, v102
v_add_f32 v100, v100, v102
v_mov_b32 v102, v100
s_waitcnt lgkmcnt(11)
v_mfma_f32_16x16x32_bf16 v[48:51], v[184:187], v[112:115], v[48:51]
v_permlane16_swap_b32 v100, v102
v_add_f32 v100, v100, v102
s_waitcnt lgkmcnt(5)
v_max_u32 v72, v72, v73
v_cmp_eq_u32 vcc, -1, v72
s_cbranch_vccnz re_88
re_88b:
v_add_f32_dpp v100, v100, v100 row_ror:8 row_mask:0xf bank_mask:0xf
s_add_u32 s62, s42, 548864
buffer_store_dword v100, v8, s[4:7], s62 offen offset:2048 sc1
v_mfma_f32_16x16x32_bf16 v[52:55], v[184:187], v[116:119], v[52:55]
s_waitcnt lgkmcnt(0)
s_barrier
ds_read_b128 v[112:115], v23 offset:16384
ds_read_b128 v[116:119], v23 offset:16640
v_mfma_f32_16x16x32_bf16 v[48:51], v[188:191], v[120:123], v[48:51]
ds_read_b128 v[120:123], v23 offset:18432
v_lshrrev_b32 v100, 9, v1
v_lshl_add_u32 v100, v100, 5, s26
v_mfma_f32_16x16x32_bf16 v[52:55], v[188:191], v[124:127], v[52:55]
ds_read_b128 v[124:127], v23 offset:18688
ds_read_b128 v[96:99], v100 offset:0
v_mfma_f32_16x16x32_bf16 v[48:51], v[192:195], v[128:131], v[48:51]
ds_read_b128 v[128:131], v23 offset:20480
ds_read_b128 v[100:103], v100 offset:16
v_mfma_f32_16x16x32_bf16 v[52:55], v[192:195], v[132:135], v[52:55]
ds_read_b128 v[132:135], v23 offset:20736
s_waitcnt vmcnt(2)
v_add_f32 v56, v56, v60
v_add_f32 v57, v57, v61
v_mfma_f32_16x16x32_bf16 v[48:51], v[196:199], v[136:139], v[48:51]
ds_read_b128 v[136:139], v23 offset:22528
v_add_f32 v58, v58, v62
v_add_f32 v59, v59, v63
v_mfma_f32_16x16x32_bf16 v[52:55], v[196:199], v[140:143], v[52:55]
ds_read_b128 v[140:143], v23 offset:22784
v_add_f32 v56, v56, v58
v_add_f32 v57, v57, v59
v_mfma_f32_16x16x32_bf16 v[48:51], v[200:203], v[144:147], v[48:51]
s_nop 0
v_permlane32_swap_b32 v56, v57
v_mfma_f32_16x16x32_bf16 v[52:55], v[200:203], v[148:151], v[52:55]
v_add_f32 v56, v56, v57
v_cmp_u_f32 vcc, v56, v56
s_cbranch_vccnz re_89
re_89b:
v_mfma_f32_16x16x32_bf16 v[48:51], v[204:207], v[152:155], v[48:51]
v_mul_f32 v56, 0x3b000000, v56
v_mov_b32 v57, v56
v_mfma_f32_16x16x32_bf16 v[52:55], v[204:207], v[156:159], v[52:55]
s_waitcnt lgkmcnt(0)
s_barrier
v_mfma_f32_16x16x32_bf16 v[48:51], v[208:211], v[112:115], v[48:51]
v_permlane32_swap_b32 v56, v57
v_mfma_f32_16x16x32_bf16 v[52:55], v[208:211], v[116:119], v[52:55]
v_fma_f32 v57, -v56, v56, v57
v_max_f32 v57, 0, v57
v_mfma_f32_16x16x32_bf16 v[48:51], v[212:215], v[120:123], v[48:51]
v_add_f32 v58, 0x3727c5ac, v57
v_rsq_f32 v58, v58
v_mfma_f32_16x16x32_bf16 v[52:55], v[212:215], v[124:127], v[52:55]
v_mul_f32 v59, v58, v58
v_sub_f32 v46, 0, v56
v_mfma_f32_16x16x32_bf16 v[48:51], v[216:219], v[128:131], v[48:51]
v_mul_f32 v59, v59, v57
v_mov_b32 v20, v58
v_mfma_f32_16x16x32_bf16 v[52:55], v[216:219], v[132:135], v[52:55]
v_add_f32 v59, 0x3727c5ac, v59
v_rsq_f32 v59, v59
v_mfma_f32_16x16x32_bf16 v[48:51], v[220:223], v[136:139], v[48:51]
v_mul_f32 v21, v46, v58
v_mul_f32 v59, v59, v58
v_mfma_f32_16x16x32_bf16 v[52:55], v[220:223], v[140:143], v[52:55]
v_mul_f32 v19, 0xc0135761, v59
v_mul_f32 v18, v59, v59
v_rcp_f32 v47, v59
v_mul_f32 v18, v18, v19
v_mul_f32 v18, 0x3d372713, v18
v_lshlrev_b32 v72, 16, v76
v_and_b32 v73, s36, v76
s_nop 0
v_permlane16_swap_b32 v48, v52
v_permlane16_swap_b32 v49, v53
v_permlane16_swap_b32 v50, v54
s_add_u32 m0, s23, 24576
s_xor_b32 s38, s47, 1998848
buffer_load_dwordx4 v1, s[4:7], s38 offen offset:0 sc1 lds
buffer_load_dwordx4 v1, s[4:7], s38 offen offset:1024 sc1 lds
v_permlane16_swap_b32 v51, v55
v_pk_fma_f32 v[48:49], v[64:65], v[46:47], v[48:49] op_sel:[0,0,0] op_sel_hi:[1,0,1]
v_pk_fma_f32 v[50:51], v[66:67], v[46:47], v[50:51] op_sel:[0,0,0] op_sel_hi:[1,0,1]
s_add_u32 m0, s23, 32768
s_xor_b32 s38, s47, 2007040
buffer_load_dwordx4 v1, s[4:7], s38 offen offset:0 sc1 lds
buffer_load_dwordx4 v1, s[4:7], s38 offen offset:1024 sc1 lds
v_pk_fma_f32 v[52:53], v[68:69], v[46:47], v[52:53] op_sel:[0,0,0] op_sel_hi:[1,0,1]
v_pk_fma_f32 v[54:55], v[70:71], v[46:47], v[54:55] op_sel:[0,0,0] op_sel_hi:[1,0,1]
v_pk_mul_f32 v[56:57], v[48:49], v[48:49]
s_add_u32 m0, s23, 0
s_xor_b32 s38, s47, 2015232
buffer_load_dwordx4 v1, s[4:7], s38 offen offset:0 sc1 lds
buffer_load_dwordx4 v1, s[4:7], s38 offen offset:1024 sc1 lds
v_pk_mul_f32 v[58:59], v[50:51], v[50:51]
v_pk_mul_f32 v[60:61], v[52:53], v[52:53]
v_pk_mul_f32 v[62:63], v[54:55], v[54:55]
v_pk_fma_f32 v[56:57], v[56:57], v[18:19], v[18:19] op_sel:[0,0,1] op_sel_hi:[1,0,1]
v_pk_fma_f32 v[58:59], v[58:59], v[18:19], v[18:19] op_sel:[0,0,1] op_sel_hi:[1,0,1]
v_pk_fma_f32 v[60:61], v[60:61], v[18:19], v[18:19] op_sel:[0,0,1] op_sel_hi:[1,0,1]
v_pk_fma_f32 v[62:63], v[62:63], v[18:19], v[18:19] op_sel:[0,0,1] op_sel_hi:[1,0,1]
v_pk_mul_f32 v[56:57], v[56:57], v[48:49]
v_pk_mul_f32 v[58:59], v[58:59], v[50:51]
v_pk_mul_f32 v[60:61], v[60:61], v[52:53]
v_pk_mul_f32 v[62:63], v[62:63], v[54:55]
v_exp_f32 v56, v56
v_exp_f32 v57, v57
v_exp_f32 v58, v58
v_exp_f32 v59, v59
v_exp_f32 v60, v60
v_exp_f32 v61, v61
s_add_u32 m0, s23, 8192
s_xor_b32 s38, s47, 2023424
buffer_load_dwordx4 v1, s[4:7], s38 offen offset:0 sc1 lds
buffer_load_dwordx4 v1, s[4:7], s38 offen offset:1024 sc1 lds
v_exp_f32 v62, v62
v_exp_f32 v63, v63
v_pk_fma_f32 v[56:57], v[56:57], v[46:47], v[46:47] op_sel:[0,1,1] op_sel_hi:[1,1,1]
v_pk_fma_f32 v[58:59], v[58:59], v[46:47], v[46:47] op_sel:[0,1,1] op_sel_hi:[1,1,1]
v_pk_fma_f32 v[60:61], v[60:61], v[46:47], v[46:47] op_sel:[0,1,1] op_sel_hi:[1,1,1]
v_pk_fma_f32 v[62:63], v[62:63], v[46:47], v[46:47] op_sel:[0,1,1] op_sel_hi:[1,1,1]
v_rcp_f32 v56, v56
s_waitcnt vmcnt(6)
ds_read2st64_b32 v[104:105], v0 offset0:96 offset1:100
v_rcp_f32 v57, v57
v_rcp_f32 v58, v58
v_rcp_f32 v59, v59
v_rcp_f32 v60, v60
v_rcp_f32 v61, v61
v_rcp_f32 v62, v62
v_rcp_f32 v63, v63
v_pk_mul_f32 v[56:57], v[56:57], v[48:49]
v_pk_mul_f32 v[58:59], v[58:59], v[50:51]
s_add_u32 s62, s43, 548864
buffer_load_dwordx4 v[88:91], v1, s[4:7], s62 offen offset:2048 sc1
buffer_load_dwordx4 v[92:95], v1, s[4:7], s62 offen offset:3072 sc1
v_pk_mul_f32 v[60:61], v[60:61], v[52:53]
v_pk_mul_f32 v[62:63], v[62:63], v[54:55]
v_cvt_pk_bf16_f32 v64, v56, v57
v_cvt_pk_bf16_f32 v65, v58, v59
v_cvt_pk_bf16_f32 v66, v60, v61
v_cvt_pk_bf16_f32 v67, v62, v63
v_lshlrev_b32 v74, 16, v77
v_and_b32 v75, s36, v77
v_lshlrev_b32 v76, 16, v78
s_waitcnt vmcnt(6)
ds_read2st64_b32 v[106:107], v0 offset0:128 offset1:132
s_cmp_lg_u32 s27, 0
s_cbranch_scc1 sh_90
buffer_store_dwordx4 v[64:67], v5, s[4:7], s32 offen offset:64 sc1
sh_90b:
s_add_u32 s62, s41, 0
buffer_store_dwordx4 v[64:67], v4, s[4:7], s62 offen sc1
v_and_b32 v77, s36, v78
s_waitcnt lgkmcnt(0)
v_max3_u32 v104, v104, v105, v106
v_max_u32 v104, v104, v107
v_cmp_eq_u32 vcc, -1, v104
s_cbranch_vccnz re_91
re_91b:
s_barrier
s_waitcnt vmcnt(6)
ds_read2st64_b32 v[104:105], v0 offset0:0 offset1:4
ds_read_b128 v[108:111], v108 offset:24576
ds_read_b128 v[112:115], v23 offset:24576
ds_read_b128 v[116:119], v23 offset:24832
ds_read_b128 v[120:123], v23 offset:26624
ds_read_b128 v[124:127], v23 offset:26880
ds_read_b128 v[128:131], v23 offset:28672
ds_read_b128 v[132:135], v23 offset:28928
ds_read_b128 v[136:139], v23 offset:30720
ds_read_b128 v[140:143], v23 offset:30976
ds_read_b128 v[144:147], v23 offset:32768
ds_read_b128 v[148:151], v23 offset:33024
ds_read_b128 v[152:155], v23 offset:34816
ds_read_b128 v[156:159], v23 offset:35072
v_lshlrev_b32 v78, 16, v79
v_and_b32 v79, s36, v79
s_waitcnt vmcnt(4)
ds_read2st64_b32 v[106:107], v0 offset0:32 offset1:36
s_waitcnt lgkmcnt(11)
v_mfma_f32_16x16x32_bf16 v[80:83], v[160:163], v[112:115], 0
ds_read_b128 v[112:115], v23 offset:36864
v_fma_f32 v72, v72, v20, v21
v_fma_f32 v73, v73, v20, v21
v_mfma_f32_16x16x32_bf16 v[84:87], v[160:163], v[116:119], 0
ds_read_b128 v[116:119], v23 offset:37120
v_fma_f32 v74, v74, v20, v21
v_fma_f32 v75, v75, v20, v21
s_waitcnt lgkmcnt(11)
v_mfma_f32_16x16x32_bf16 v[80:83], v[164:167], v[120:123], v[80:83]
ds_read_b128 v[120:123], v23 offset:38912
v_fma_f32 v76, v76, v20, v21
v_fma_f32 v77, v77, v20, v21
v_mfma_f32_16x16x32_bf16 v[84:87], v[164:167], v[124:127], v[84:87]
ds_read_b128 v[124:127], v23 offset:39168
v_fma_f32 v78, v78, v20, v21
v_fma_f32 v79, v79, v20, v21
s_waitcnt lgkmcnt(11)
v_mfma_f32_16x16x32_bf16 v[80:83], v[168:171], v[128:131], v[80:83]
v_permlane16_swap_b32 v72, v76
v_mfma_f32_16x16x32_bf16 v[84:87], v[168:171], v[132:135], v[84:87]
s_waitcnt vmcnt(2)
v_add_f32 v88, v88, v92
v_add_f32 v89, v89, v93
s_waitcnt lgkmcnt(9)
v_mfma_f32_16x16x32_bf16 v[80:83], v[172:175], v[136:139], v[80:83]
v_add_f32 v90, v90, v94
v_add_f32 v91, v91, v95
s_waitcnt lgkmcnt(4)
v_max3_u32 v104, v104, v105, v106
v_max_u32 v104, v104, v107
v_cmp_eq_u32 vcc, -1, v104
s_cbranch_vccnz re_92
re_92b:
v_mfma_f32_16x16x32_bf16 v[84:87], v[172:175], v[140:143], v[84:87]
v_add_f32 v88, v88, v90
v_add_f32 v89, v89, v91
v_mfma_f32_16x16x32_bf16 v[80:83], v[176:179], v[144:147], v[80:83]
s_waitcnt lgkmcnt(0)
s_barrier
v_mfma_f32_16x16x32_bf16 v[84:87], v[176:179], v[148:151], v[84:87]
ds_read_b128 v[128:131], v23 offset:0
ds_read_b128 v[132:135], v23 offset:256
v_mfma_f32_16x16x32_bf16 v[80:83], v[180:183], v[152:155], v[80:83]
ds_read_b128 v[136:139], v23 offset:2048
ds_read_b128 v[140:143], v23 offset:2304
v_mfma_f32_16x16x32_bf16 v[84:87], v[180:183], v[156:159], v[84:87]
ds_read_b128 v[144:147], v23 offset:4096
ds_read_b128 v[148:151], v23 offset:4352
v_mfma_f32_16x16x32_bf16 v[80:83], v[184:187], v[112:115], v[80:83]
ds_read_b128 v[152:155], v23 offset:6144
ds_read_b128 v[156:159], v23 offset:6400
v_mfma_f32_16x16x32_bf16 v[84:87], v[184:187], v[116:119], v[84:87]
ds_read_b128 v[112:115], v23 offset:8192
ds_read_b128 v[116:119], v23 offset:8448
v_mfma_f32_16x16x32_bf16 v[80:83], v[188:191], v[120:123], v[80:83]
ds_read_b128 v[120:123], v23 offset:10240
v_permlane32_swap_b32 v88, v89
v_mfma_f32_16x16x32_bf16 v[84:87], v[188:191], v[124:127], v[84:87]
ds_read_b128 v[124:127], v23 offset:10496
s_add_u32 m0, s23, 16384
s_xor_b32 s38, s22, 139264
buffer_load_dwordx4 v1, s[4:7], s38 offen offset:0 sc1 lds
buffer_load_dwordx4 v1, s[4:7], s38 offen offset:1024 sc1 lds
s_waitcnt lgkmcnt(10)
v_mfma_f32_16x16x32_bf16 v[80:83], v[192:195], v[128:131], v[80:83]
ds_read_b128 v[128:131], v23 offset:12288
v_add_f32 v88, v88, v89
v_cmp_u_f32 vcc, v88, v88
s_cbranch_vccnz re_93
re_93b:
s_add_u32 m0, s23, 24576
s_xor_b32 s38, s22, 155648
buffer_load_dwordx4 v1, s[4:7], s38 offen offset:0 sc1 lds
buffer_load_dwordx4 v1, s[4:7], s38 offen offset:1024 sc1 lds
v_mfma_f32_16x16x32_bf16 v[84:87], v[192:195], v[132:135], v[84:87]
ds_read_b128 v[132:135], v23 offset:12544
v_mul_f32 v88, 0x3b000000, v88
v_mov_b32 v89, v88
v_cndmask_b32 v44, v1, v6, s[92:93]
s_add_u32 m0, s23, 32768
s_xor_b32 s38, s22, 131072
buffer_load_dwordx4 v44, s[4:7], s38 offen offset:0 sc1 lds
buffer_load_dwordx4 v44, s[4:7], s38 offen offset:1024 sc1 lds
s_waitcnt lgkmcnt(10)
v_mfma_f32_16x16x32_bf16 v[80:83], v[196:199], v[136:139], v[80:83]
ds_read_b128 v[136:139], v23 offset:14336
v_permlane32_swap_b32 v88, v89
v_mfma_f32_16x16x32_bf16 v[84:87], v[196:199], v[140:143], v[84:87]
ds_read_b128 v[140:143], v23 offset:14592
v_fma_f32 v89, -v88, v88, v89
v_max_f32 v89, 0, v89
s_waitcnt lgkmcnt(10)
v_mfma_f32_16x16x32_bf16 v[80:83], v[200:203], v[144:147], v[80:83]
ds_read_b64_tr_b16 v[144:145], v13 offset:0
v_add_f32 v90, 0x3727c5ac, v89
v_rsq_f32 v90, v90
v_mfma_f32_16x16x32_bf16 v[84:87], v[200:203], v[148:151], v[84:87]
ds_read_b64_tr_b16 v[146:147], v13 offset:1792
v_mul_f32 v91, v90, v90
v_sub_f32 v46, 0, v88
s_waitcnt lgkmcnt(10)
v_mfma_f32_16x16x32_bf16 v[80:83], v[204:207], v[152:155], v[80:83]
ds_read_b64_tr_b16 v[148:149], v13 offset:32
v_mul_f32 v91, v91, v89
v_mov_b32 v20, v90
v_mfma_f32_16x16x32_bf16 v[84:87], v[204:207], v[156:159], v[84:87]
s_waitcnt lgkmcnt(3)
s_barrier
s_add_u32 m0, s23, 0
s_xor_b32 s38, s22, 147456
buffer_load_dwordx4 v6, s[4:7], s38 offen offset:0 sc1 lds
buffer_load_dwordx4 v6, s[4:7], s38 offen offset:1024 sc1 lds
v_mfma_f32_16x16x32_bf16 v[80:83], v[208:211], v[112:115], v[80:83]
s_waitcnt vmcnt(6)
ds_read2st64_b32 v[56:57], v0 offset0:64 offset1:68
v_add_f32 v91, 0x3727c5ac, v91
v_mfma_f32_16x16x32_bf16 v[84:87], v[208:211], v[116:119], v[84:87]
ds_read_b64_tr_b16 v[150:151], v13 offset:1824
v_rsq_f32 v91, v91
v_mfma_f32_16x16x32_bf16 v[80:83], v[212:215], v[120:123], v[80:83]
ds_read_b64_tr_b16 v[152:153], v13 offset:64
v_mul_f32 v21, v46, v90
v_mul_f32 v91, v91, v90
v_mfma_f32_16x16x32_bf16 v[84:87], v[212:215], v[124:127], v[84:87]
ds_read_b64_tr_b16 v[154:155], v13 offset:1856
v_mul_f32 v19, 0xc0135761, v91
v_mul_f32 v18, v91, v91
v_mfma_f32_16x16x32_bf16 v[80:83], v[216:219], v[128:131], v[80:83]
ds_read_b64_tr_b16 v[156:157], v14 offset:0
v_rcp_f32 v47, v91
v_mfma_f32_16x16x32_bf16 v[84:87], v[216:219], v[132:135], v[84:87]
s_waitcnt vmcnt(4)
ds_read2st64_b32 v[58:59], v0 offset0:96 offset1:100
v_mul_f32 v18, v18, v19
v_mfma_f32_16x16x32_bf16 v[80:83], v[220:223], v[136:139], v[80:83]
ds_read_b64_tr_b16 v[158:159], v14 offset:1792
v_mul_f32 v18, 0x3d372713, v18
v_lshlrev_b32 v104, 16, v108
v_mfma_f32_16x16x32_bf16 v[84:87], v[220:223], v[140:143], v[84:87]
v_and_b32 v105, s36, v108
v_lshlrev_b32 v106, 16, v109
v_and_b32 v107, s36, v109
v_lshlrev_b32 v108, 16, v110
v_and_b32 v109, s36, v110
v_lshlrev_b32 v110, 16, v111
v_and_b32 v111, s36, v111
v_pk_fma_f32 v[104:105], v[104:105], v[20:21], v[20:21] op_sel:[0,0,1] op_sel_hi:[1,0,1]
v_permlane16_swap_b32 v80, v84
v_permlane16_swap_b32 v81, v85
v_permlane16_swap_b32 v82, v86
v_permlane16_swap_b32 v83, v87
v_pk_fma_f32 v[80:81], v[96:97], v[46:47], v[80:81] op_sel:[0,0,0] op_sel_hi:[1,0,1]
v_pk_fma_f32 v[82:83], v[98:99], v[46:47], v[82:83] op_sel:[0,0,0] op_sel_hi:[1,0,1]
v_pk_fma_f32 v[84:85], v[100:101], v[46:47], v[84:85] op_sel:[0,0,0] op_sel_hi:[1,0,1]
v_pk_fma_f32 v[86:87], v[102:103], v[46:47], v[86:87] op_sel:[0,0,0] op_sel_hi:[1,0,1]
v_pk_mul_f32 v[88:89], v[80:81], v[80:81]
v_pk_mul_f32 v[90:91], v[82:83], v[82:83]
v_pk_mul_f32 v[92:93], v[84:85], v[84:85]
v_pk_mul_f32 v[94:95], v[86:87], v[86:87]
v_pk_fma_f32 v[88:89], v[88:89], v[18:19], v[18:19] op_sel:[0,0,1] op_sel_hi:[1,0,1]
v_pk_fma_f32 v[90:91], v[90:91], v[18:19], v[18:19] op_sel:[0,0,1] op_sel_hi:[1,0,1]
v_pk_fma_f32 v[92:93], v[92:93], v[18:19], v[18:19] op_sel:[0,0,1] op_sel_hi:[1,0,1]
v_pk_fma_f32 v[94:95], v[94:95], v[18:19], v[18:19] op_sel:[0,0,1] op_sel_hi:[1,0,1]
v_pk_mul_f32 v[88:89], v[88:89], v[80:81]
v_pk_mul_f32 v[90:91], v[90:91], v[82:83]
v_pk_mul_f32 v[92:93], v[92:93], v[84:85]
v_pk_mul_f32 v[94:95], v[94:95], v[86:87]
v_exp_f32 v88, v88
v_exp_f32 v89, v89
v_exp_f32 v90, v90
v_exp_f32 v91, v91
v_exp_f32 v92, v92
v_exp_f32 v93, v93
v_exp_f32 v94, v94
v_exp_f32 v95, v95
v_pk_fma_f32 v[88:89], v[88:89], v[46:47], v[46:47] op_sel:[0,1,1] op_sel_hi:[1,1,1]
v_pk_fma_f32 v[90:91], v[90:91], v[46:47], v[46:47] op_sel:[0,1,1] op_sel_hi:[1,1,1]
v_pk_fma_f32 v[92:93], v[92:93], v[46:47], v[46:47] op_sel:[0,1,1] op_sel_hi:[1,1,1]
v_pk_fma_f32 v[94:95], v[94:95], v[46:47], v[46:47] op_sel:[0,1,1] op_sel_hi:[1,1,1]
v_rcp_f32 v88, v88
v_rcp_f32 v89, v89
v_rcp_f32 v90, v90
v_rcp_f32 v91, v91
v_rcp_f32 v92, v92
v_rcp_f32 v93, v93
v_rcp_f32 v94, v94
v_rcp_f32 v95, v95
v_pk_mul_f32 v[88:89], v[88:89], v[80:81]
v_pk_mul_f32 v[90:91], v[90:91], v[82:83]
v_pk_mul_f32 v[92:93], v[92:93], v[84:85]
v_pk_mul_f32 v[94:95], v[94:95], v[86:87]
v_cvt_pk_bf16_f32 v96, v88, v89
v_cvt_pk_bf16_f32 v97, v90, v91
v_cvt_pk_bf16_f32 v98, v92, v93
v_cvt_pk_bf16_f32 v99, v94, v95
s_cmp_lg_u32 s27, 0
s_cbranch_scc1 sh_94
buffer_store_dwordx4 v[96:99], v5, s[4:7], s33 offen offset:64 sc1
sh_94b:
s_add_u32 s62, s41, 32768
buffer_store_dwordx4 v[96:99], v4, s[4:7], s62 offen sc1
s_waitcnt lgkmcnt(1)
v_max3_u32 v56, v56, v57, v58
v_max_u32 v56, v56, v59
v_cmp_eq_u32 vcc, -1, v56
s_cbranch_vccnz re_95
re_95b:
s_barrier
ds_read_b128 v[112:115], v23 offset:16384
ds_read_b128 v[116:119], v23 offset:16640
ds_read_b128 v[120:123], v23 offset:18432
ds_read_b128 v[124:127], v23 offset:18688
ds_read_b128 v[128:131], v23 offset:20480
ds_read_b128 v[132:135], v23 offset:20736
ds_read_b128 v[136:139], v23 offset:22528
ds_read_b128 v[140:143], v23 offset:22784
v_pk_fma_f32 v[106:107], v[106:107], v[20:21], v[20:21] op_sel:[0,0,1] op_sel_hi:[1,0,1]
v_pk_fma_f32 v[108:109], v[108:109], v[20:21], v[20:21] op_sel:[0,0,1] op_sel_hi:[1,0,1]
v_pk_fma_f32 v[110:111], v[110:111], v[20:21], v[20:21] op_sel:[0,0,1] op_sel_hi:[1,0,1]
s_nop 0
v_permlane16_swap_b32 v104, v108
v_permlane16_swap_b32 v105, v109
v_permlane16_swap_b32 v106, v110
v_permlane16_swap_b32 v107, v111
s_cmp_eq_u32 s66, 0
s_cbranch_scc1 skip_96
v_cndmask_b32 v44, v1, v6, s[92:93]
s_add_u32 m0, s23, 32768
s_xor_b32 s38, s22, 131072
buffer_load_dwordx4 v44, s[4:7], s38 offen offset:0 sc1 lds
buffer_load_dwordx4 v44, s[4:7], s38 offen offset:1024 sc1 lds
s_add_u32 m0, s23, 0
s_xor_b32 s38, s22, 147456
buffer_load_dwordx4 v6, s[4:7], s38 offen offset:0 sc1 lds
buffer_load_dwordx4 v6, s[4:7], s38 offen offset:1024 sc1 lds
skip_96:
v_permlane16_swap_b32 v73, v77
v_permlane16_swap_b32 v74, v78
v_permlane16_swap_b32 v75, v79
s_waitcnt lgkmcnt(6)
s_nop 0
v_mfma_f32_16x16x32_bf16 v[48:51], v[224:227], v[112:115], v[72:75]
ds_read_b128 v[112:115], v23 offset:24576
v_mfma_f32_16x16x32_bf16 v[52:55], v[224:227], v[116:119], v[76:79]
ds_read_b128 v[116:119], v23 offset:24832
s_nop 1
v_mov_b32 v78, 0
v_mov_b32 v79, 0
s_waitcnt lgkmcnt(6)
v_mfma_f32_16x16x32_bf16 v[48:51], v[228:231], v[120:123], v[48:51]
ds_read_b128 v[120:123], v23 offset:26624
s_mov_b64 vcc, 0xffff
s_lshl_b64 vcc, vcc, 0
v_cndmask_b32 v76, 0, v16, vcc
v_cndmask_b32 v77, 0, v17, vcc
v_mfma_f32_16x16x32_bf16 v[52:55], v[228:231], v[124:127], v[52:55]
ds_read_b128 v[124:127], v23 offset:26880
s_waitcnt lgkmcnt(6)
v_mfma_f32_16x16x32_bf16 v[48:51], v[232:235], v[128:131], v[48:51]
ds_read_b128 v[128:131], v23 offset:28672
v_mfma_f32_16x16x32_bf16 v[52:55], v[232:235], v[132:135], v[52:55]
ds_read_b128 v[132:135], v23 offset:28928
s_waitcnt lgkmcnt(6)
v_mfma_f32_16x16x32_bf16 v[48:51], v[236:239], v[136:139], v[48:51]
ds_read_b128 v[136:139], v23 offset:30720
v_mfma_f32_16x16x32_bf16 v[52:55], v[236:239], v[140:143], v[52:55]
ds_read_b128 v[140:143], v23 offset:30976
s_waitcnt lgkmcnt(6)
v_mfma_f32_16x16x32_bf16 v[48:51], v[240:243], v[112:115], v[48:51]
v_mfma_f32_16x16x32_bf16 v[52:55], v[240:243], v[116:119], v[52:55]
s_waitcnt lgkmcnt(4)
v_mfma_f32_16x16x32_bf16 v[48:51], v[244:247], v[120:123], v[48:51]
v_mfma_f32_16x16x32_bf16 v[52:55], v[244:247], v[124:127], v[52:55]
s_waitcnt lgkmcnt(2)
v_mfma_f32_16x16x32_bf16 v[48:51], v[248:251], v[128:131], v[48:51]
v_mfma_f32_16x16x32_bf16 v[52:55], v[248:251], v[132:135], v[52:55]
s_waitcnt lgkmcnt(0)
v_mfma_f32_16x16x32_bf16 v[48:51], v[252:255], v[136:139], v[48:51]
v_mfma_f32_16x16x32_bf16 v[52:55], v[252:255], v[140:143], v[52:55]
s_waitcnt vmcnt(0)
ds_read2st64_b32 v[56:57], v0 offset0:128 offset1:132
s_waitcnt vmcnt(0)
ds_read2st64_b32 v[58:59], v0 offset0:0 offset1:4
s_add_u32 m0, s23, 8192
s_xor_b32 s38, s22, 172032
buffer_load_dwordx4 v1, s[4:7], s38 offen offset:0 sc1 lds
buffer_load_dwordx4 v1, s[4:7], s38 offen offset:1024 sc1 lds
s_waitcnt lgkmcnt(0)
v_max3_u32 v56, v56, v57, v58
v_max_u32 v56, v56, v59
v_cmp_eq_u32 vcc, -1, v56
s_cbranch_vccnz re_97
re_97b:
s_barrier
s_add_u32 m0, s23, 16384
s_xor_b32 s38, s22, 188416
buffer_load_dwordx4 v1, s[4:7], s38 offen offset:0 sc1 lds
buffer_load_dwordx4 v1, s[4:7], s38 offen offset:1024 sc1 lds
ds_read_b128 v[112:115], v23 offset:32768
ds_read_b128 v[116:119], v23 offset:33024
ds_read_b128 v[120:123], v23 offset:34816
ds_read_b128 v[124:127], v23 offset:35072
ds_read_b128 v[128:131], v23 offset:36864
ds_read_b128 v[132:135], v23 offset:37120
ds_read_b128 v[136:139], v23 offset:38912
v_cndmask_b32 v44, v1, v6, s[92:93]
s_add_u32 m0, s23, 24576
s_xor_b32 s38, s22, 163840
buffer_load_dwordx4 v44, s[4:7], s38 offen offset:0 sc1 lds
buffer_load_dwordx4 v44, s[4:7], s38 offen offset:1024 sc1 lds
s_waitcnt lgkmcnt(5)
v_mfma_f32_16x16x32_bf16 v[48:51], a[224:227], v[112:115], v[48:51]
ds_read_b128 v[140:143], v23 offset:39168
ds_read_b128 v[112:115], v23 offset:0
v_mfma_f32_16x16x32_bf16 v[52:55], a[224:227], v[116:119], v[52:55]
ds_read_b128 v[116:119], v23 offset:256
s_waitcnt lgkmcnt(6)
v_mfma_f32_16x16x32_bf16 v[48:51], a[228:231], v[120:123], v[48:51]
ds_read_b128 v[120:123], v23 offset:2048
s_waitcnt vmcnt(4)
ds_read2st64_b32 v[20:21], v0 offset0:32 offset1:36
v_mfma_f32_16x16x32_bf16 v[52:55], a[228:231], v[124:127], v[52:55]
ds_read_b128 v[124:127], v23 offset:2304
s_waitcnt lgkmcnt(7)
v_mfma_f32_16x16x32_bf16 v[48:51], a[232:235], v[128:131], v[48:51]
ds_read_b128 v[128:131], v23 offset:4096
v_mfma_f32_16x16x32_bf16 v[52:55], a[232:235], v[132:135], v[52:55]
ds_read_b128 v[132:135], v23 offset:4352
s_waitcnt lgkmcnt(7)
v_mfma_f32_16x16x32_bf16 v[48:51], a[236:239], v[136:139], v[48:51]
ds_read_b128 v[136:139], v23 offset:6144
v_mfma_f32_16x16x32_bf16 v[52:55], a[236:239], v[140:143], v[52:55]
ds_read_b128 v[140:143], v23 offset:6400
s_waitcnt lgkmcnt(7)
v_mfma_f32_16x16x32_bf16 v[48:51], a[240:243], v[112:115], v[48:51]
v_mfma_f32_16x16x32_bf16 v[52:55], a[240:243], v[116:119], v[52:55]
s_waitcnt lgkmcnt(4)
v_mfma_f32_16x16x32_bf16 v[48:51], a[244:247], v[120:123], v[48:51]
v_mfma_f32_16x16x32_bf16 v[52:55], a[244:247], v[124:127], v[52:55]
s_waitcnt lgkmcnt(2)
v_mfma_f32_16x16x32_bf16 v[48:51], a[248:251], v[128:131], v[48:51]
s_waitcnt vmcnt(2)
ds_read2st64_b32 v[46:47], v0 offset0:64 offset1:68
v_mfma_f32_16x16x32_bf16 v[52:55], a[248:251], v[132:135], v[52:55]
s_waitcnt lgkmcnt(1)
v_mfma_f32_16x16x32_bf16 v[48:51], a[252:255], v[136:139], v[48:51]
v_mfma_f32_16x16x32_bf16 v[52:55], a[252:255], v[140:143], v[52:55]
s_nop 4
v_cvt_pk_bf16_f32 v56, v48, v49
v_cvt_pk_bf16_f32 v57, v50, v51
v_xor_b32 v48, s24, v1
v_cvt_pk_bf16_f32 v58, v52, v53
v_cvt_pk_bf16_f32 v59, v54, v55
s_nop 0
v_permlane16_swap_b32 v56, v58
v_permlane16_swap_b32 v57, v59
s_add_u32 s62, s34, 1966080
buffer_store_dwordx4 v[56:59], v1, s[4:7], s62 offen sc1
ds_write_b128 v48, v[56:59]
s_waitcnt lgkmcnt(1)
v_max3_u32 v20, v20, v21, v46
v_max_u32 v20, v20, v47
v_cmp_eq_u32 vcc, -1, v20
s_cbranch_vccnz re_98
re_98b:
s_waitcnt lgkmcnt(0)
s_barrier
ds_read_b128 v[52:55], v12 offset:40960
s_add_u32 m0, s23, 32768
s_xor_b32 s38, s22, 180224
buffer_load_dwordx4 v6, s[4:7], s38 offen offset:0 sc1 lds
buffer_load_dwordx4 v6, s[4:7], s38 offen offset:1024 sc1 lds
s_waitcnt lgkmcnt(0)
v_lshlrev_b32 v48, 16, v52
v_and_b32 v49, s36, v52
v_lshlrev_b32 v50, 16, v53
v_and_b32 v51, s36, v53
v_lshlrev_b32 v52, 16, v54
v_and_b32 v53, s36, v54
v_lshlrev_b32 v54, 16, v55
v_and_b32 v55, s36, v55
v_pk_add_f32 v[60:61], v[48:49], v[50:51]
v_pk_mul_f32 v[62:63], v[48:49], v[48:49]
v_pk_fma_f32 v[62:63], v[50:51], v[50:51], v[62:63] op_sel:[0,0,0] op_sel_hi:[1,1,1]
v_pk_add_f32 v[60:61], v[60:61], v[52:53]
v_pk_fma_f32 v[62:63], v[52:53], v[52:53], v[62:63] op_sel:[0,0,0] op_sel_hi:[1,1,1]
v_pk_add_f32 v[60:61], v[60:61], v[54:55]
v_pk_fma_f32 v[62:63], v[54:55], v[54:55], v[62:63] op_sel:[0,0,0] op_sel_hi:[1,1,1]
v_add_f32 v60, v60, v61
v_add_f32 v62, v62, v63
s_waitcnt vmcnt(2)
s_barrier
v_permlane32_swap_b32 v60, v62
v_add_f32 v60, v60, v62
v_mov_b32 v62, v60
v_pk_add_f32 v[24:25], v[24:25], v[48:49]
v_pk_add_f32 v[26:27], v[26:27], v[50:51]
v_permlane16_swap_b32 v60, v62
v_add_f32 v60, v60, v62
v_pk_add_f32 v[28:29], v[28:29], v[52:53]
v_pk_add_f32 v[30:31], v[30:31], v[54:55]
v_add_f32_dpp v60, v60, v60 row_ror:8 row_mask:0xf bank_mask:0xf
s_add_u32 s62, s42, 557056
buffer_store_dword v60, v8, s[4:7], s62 offen offset:0 sc1
s_barrier
ds_read_b128 v[88:91], v23 offset:8192
ds_read_b128 v[92:95], v23 offset:8448
ds_read_b128 v[96:99], v23 offset:10240
ds_read_b128 v[100:103], v23 offset:10496
ds_read2st64_b32 v[20:21], v0 offset0:96 offset1:100
s_waitcnt lgkmcnt(3)
v_mfma_f32_16x16x32_bf16 v[80:83], v[224:227], v[88:91], v[104:107]
ds_read_b128 v[88:91], v23 offset:12288
v_mfma_f32_16x16x32_bf16 v[84:87], v[224:227], v[92:95], v[108:111]
ds_read_b128 v[92:95], v23 offset:12544
s_nop 1
v_mov_b32 v110, 0
s_waitcnt lgkmcnt(3)
v_mfma_f32_16x16x32_bf16 v[80:83], v[228:231], v[96:99], v[80:83]
ds_read_b128 v[96:99], v23 offset:14336
v_mov_b32 v111, 0
v_mfma_f32_16x16x32_bf16 v[84:87], v[228:231], v[100:103], v[84:87]
ds_read_b128 v[100:103], v23 offset:14592
s_mov_b64 vcc, 0xffff
s_lshl_b64 vcc, vcc, 0
v_cndmask_b32 v108, 0, v16, vcc
v_cndmask_b32 v109, 0, v17, vcc
s_waitcnt lgkmcnt(2)
v_mfma_f32_16x16x32_bf16 v[80:83], v[232:235], v[88:91], v[80:83]
ds_read_b128 v[88:91], v23 offset:16384
v_mfma_f32_16x16x32_bf16 v[84:87], v[232:235], v[92:95], v[84:87]
ds_read_b128 v[92:95], v23 offset:16640
s_waitcnt vmcnt(1)
ds_read2st64_b32 v[46:47], v0 offset0:128 offset1:132
s_waitcnt lgkmcnt(3)
v_mfma_f32_16x16x32_bf16 v[80:83], v[236:239], v[96:99], v[80:83]
ds_read_b128 v[96:99], v23 offset:18432
v_mfma_f32_16x16x32_bf16 v[84:87], v[236:239], v[100:103], v[84:87]
ds_read_b128 v[100:103], v23 offset:18688
s_waitcnt lgkmcnt(3)
v_mfma_f32_16x16x32_bf16 v[80:83], v[240:243], v[88:91], v[80:83]
ds_read_b128 v[88:91], v23 offset:20480
v_mfma_f32_16x16x32_bf16 v[84:87], v[240:243], v[92:95], v[84:87]
ds_read_b128 v[92:95], v23 offset:20736
s_waitcnt lgkmcnt(2)
v_mfma_f32_16x16x32_bf16 v[80:83], v[244:247], v[96:99], v[80:83]
ds_read_b128 v[96:99], v23 offset:22528
v_mfma_f32_16x16x32_bf16 v[84:87], v[244:247], v[100:103], v[84:87]
ds_read_b128 v[100:103], v23 offset:22784
s_waitcnt lgkmcnt(2)
v_mfma_f32_16x16x32_bf16 v[80:83], v[248:251], v[88:91], v[80:83]
v_max3_u32 v20, v20, v21, v46
v_max_u32 v20, v20, v47
v_cmp_eq_u32 vcc, -1, v20
s_cbranch_vccnz re_99
re_99b:
v_mfma_f32_16x16x32_bf16 v[84:87], v[248:251], v[92:95], v[84:87]
s_waitcnt lgkmcnt(0)
s_barrier
v_mfma_f32_16x16x32_bf16 v[80:83], v[252:255], v[96:99], v[80:83]
ds_read_b128 v[88:91], v23 offset:24576
ds_read_b128 v[92:95], v23 offset:24832
v_mfma_f32_16x16x32_bf16 v[84:87], v[252:255], v[100:103], v[84:87]
ds_read_b128 v[96:99], v23 offset:26624
ds_read_b128 v[100:103], v23 offset:26880
s_lshl_b32 s60, s71, 8
v_xor_b32 v112, s60, v1
s_add_u32 s62, s51, 557056
buffer_load_dwordx4 v[116:119], v112, s[4:7], s62 offen offset:1024 sc1
buffer_load_dwordx4 v[112:115], v112, s[4:7], s62 offen offset:0 sc1
s_waitcnt lgkmcnt(2)
v_mfma_f32_16x16x32_bf16 v[80:83], a[224:227], v[88:91], v[80:83]
ds_read_b128 v[88:91], v23 offset:28672
v_mfma_f32_16x16x32_bf16 v[84:87], a[224:227], v[92:95], v[84:87]
ds_read_b128 v[92:95], v23 offset:28928
s_waitcnt lgkmcnt(2)
v_mfma_f32_16x16x32_bf16 v[80:83], a[228:231], v[96:99], v[80:83]
ds_read_b128 v[96:99], v23 offset:30720
v_mfma_f32_16x16x32_bf16 v[84:87], a[228:231], v[100:103], v[84:87]
ds_read_b128 v[100:103], v23 offset:30976
s_waitcnt lgkmcnt(2)
v_mfma_f32_16x16x32_bf16 v[80:83], a[232:235], v[88:91], v[80:83]
ds_read_b128 v[88:91], v23 offset:32768
v_mfma_f32_16x16x32_bf16 v[84:87], a[232:235], v[92:95], v[84:87]
ds_read_b128 v[92:95], v23 offset:33024
s_waitcnt lgkmcnt(2)
v_mfma_f32_16x16x32_bf16 v[80:83], a[236:239], v[96:99], v[80:83]
ds_read_b128 v[96:99], v23 offset:34816
v_mfma_f32_16x16x32_bf16 v[84:87], a[236:239], v[100:103], v[84:87]
ds_read_b128 v[100:103], v23 offset:35072
s_waitcnt lgkmcnt(2)
v_mfma_f32_16x16x32_bf16 v[80:83], a[240:243], v[88:91], v[80:83]
ds_read_b128 v[88:91], v23 offset:36864
v_mfma_f32_16x16x32_bf16 v[84:87], a[240:243], v[92:95], v[84:87]
ds_read_b128 v[92:95], v23 offset:37120
s_waitcnt lgkmcnt(2)
v_mfma_f32_16x16x32_bf16 v[80:83], a[244:247], v[96:99], v[80:83]
ds_read_b128 v[96:99], v23 offset:38912
v_mfma_f32_16x16x32_bf16 v[84:87], a[244:247], v[100:103], v[84:87]
ds_read_b128 v[100:103], v23 offset:39168
s_waitcnt lgkmcnt(2)
v_mfma_f32_16x16x32_bf16 v[80:83], a[248:251], v[88:91], v[80:83]
s_waitcnt vmcnt(0)
v_add_f32 v112, v112, v116
v_add_f32 v113, v113, v117
v_pk_add_f32 v[114:115], v[114:115], v[118:119]
v_pk_add_f32 v[112:113], v[112:113], v[114:115]
v_mfma_f32_16x16x32_bf16 v[84:87], a[248:251], v[92:95], v[84:87]
s_nop 0
v_permlane32_swap_b32 v112, v113
v_add_f32 v112, v112, v113
v_cmp_u_f32 vcc, v112, v112
s_cbranch_vccnz re_100
re_100b:
v_mul_f32 v112, 0x3b000000, v112
v_mov_b32 v113, v112
s_waitcnt lgkmcnt(0)
v_mfma_f32_16x16x32_bf16 v[80:83], a[252:255], v[96:99], v[80:83]
s_xor_b32 s64, s50, 1966080
s_sub_u32 s64, s64, 114688
buffer_load_dwordx4 v[120:123], v23, s[4:7], s64 offen offset:0 sc1
v_permlane32_swap_b32 v112, v113
v_fma_f32 v113, -v112, v112, v113
v_max_f32 v113, 0, v113
v_add_f32 v114, 0x3727c5ac, v113
v_rsq_f32 v114, v114
v_mfma_f32_16x16x32_bf16 v[84:87], a[252:255], v[100:103], v[84:87]
s_xor_b32 s67, s64, 256
buffer_load_dwordx4 v[124:127], v23, s[4:7], s67 offen offset:0 sc1
v_cvt_pk_bf16_f32 v113, -v112, -v112
v_lshlrev_b32 v113, 16, v113
v_sub_f32 v113, -v112, v113
v_mul_f32 v19, 0xc0135761, v114
v_mul_f32 v18, v114, v114
v_rcp_f32 v40, v114
v_mul_f32 v18, v18, v19
v_mul_f32 v18, 0x3d372713, v18
v_cvt_pk_bf16_f32 v22, -v112, v113
buffer_load_dwordx4 v[128:131], v23, s[4:7], s64 offen offset:2048 sc1
buffer_load_dwordx4 v[132:135], v23, s[4:7], s67 offen offset:2048 sc1
s_xor_b32 s64, s50, 1970176
s_sub_u32 s64, s64, 114688
buffer_load_dwordx4 v[136:139], v23, s[4:7], s64 offen offset:0 sc1
v_cvt_pk_bf16_f32 v88, v80, v81
v_cvt_pk_bf16_f32 v89, v82, v83
v_cvt_pk_bf16_f32 v90, v84, v85
v_cvt_pk_bf16_f32 v91, v86, v87
s_xor_b32 s67, s64, 256
buffer_load_dwordx4 v[140:143], v23, s[4:7], s67 offen offset:0 sc1
v_permlane16_swap_b32 v88, v90
v_permlane16_swap_b32 v89, v91
v_xor_b32 v80, s24, v1
ds_write_b128 v80, v[88:91]
s_add_u32 s62, s34, 1998848
buffer_store_dwordx4 v[88:91], v1, s[4:7], s62 offen sc1
s_waitcnt vmcnt(6)
v_mfma_f32_16x16x32_bf16 v[48:51], v[144:147], v[120:123], 0
s_waitcnt lgkmcnt(0)
s_barrier
buffer_load_dwordx4 v[112:115], v23, s[4:7], s64 offen offset:2048 sc1
ds_read_b128 v[84:87], v12 offset:40960
s_waitcnt vmcnt(6)
v_mfma_f32_16x16x32_bf16 v[52:55], v[144:147], v[124:127], 0
ds_read_b64_tr_b16 v[144:145], v13 offset:7168
buffer_load_dwordx4 v[116:119], v23, s[4:7], s67 offen offset:2048 sc1
v_mfma_f32_16x16x32_bf16 v[56:59], v[148:151], v[120:123], 0
ds_read_b64_tr_b16 v[146:147], v13 offset:8960
v_mfma_f32_16x16x32_bf16 v[60:63], v[148:151], v[124:127], 0
ds_read_b64_tr_b16 v[148:149], v13 offset:7200
v_mfma_f32_16x16x32_bf16 v[64:67], v[152:155], v[120:123], 0
ds_read_b64_tr_b16 v[150:151], v13 offset:8992
s_waitcnt lgkmcnt(4)
v_lshlrev_b32 v80, 16, v84
v_mfma_f32_16x16x32_bf16 v[68:71], v[152:155], v[124:127], 0
ds_read_b64_tr_b16 v[152:153], v13 offset:7232
v_mov_b32 v124, v22
v_mov_b32 v126, 0
v_mfma_f32_16x16x32_bf16 v[72:75], v[156:159], v[120:123], 0
ds_read_b64_tr_b16 v[154:155], v13 offset:9024
ds_read_b64_tr_b16 v[156:157], v14 offset:7168
v_mov_b32 v120, v22
s_waitcnt vmcnt(6) lgkmcnt(5)
v_mfma_f32_16x16x32_bf16 v[48:51], v[144:147], v[128:131], v[48:51]
ds_read_b64_tr_b16 v[158:159], v14 offset:8960
v_permlane16_swap_b32 v120, v124
v_mov_b32 v122, 0
s_waitcnt vmcnt(5)
v_mfma_f32_16x16x32_bf16 v[52:55], v[144:147], v[132:135], v[52:55]
ds_read_b64_tr_b16 v[144:145], v13 offset:14336
v_mov_b32 v123, 0
v_mov_b32 v127, 0
s_waitcnt lgkmcnt(5)
v_mfma_f32_16x16x32_bf16 v[56:59], v[148:151], v[128:131], v[56:59]
ds_read_b64_tr_b16 v[146:147], v13 offset:16128
v_mov_b32 v121, v120
v_mov_b32 v125, v124
v_mfma_f32_16x16x32_bf16 v[60:63], v[148:151], v[132:135], v[60:63]
ds_read_b64_tr_b16 v[148:149], v13 offset:14368
v_and_b32 v81, s36, v84
v_lshlrev_b32 v82, 16, v85
s_waitcnt lgkmcnt(5)
v_mfma_f32_16x16x32_bf16 v[64:67], v[152:155], v[128:131], v[64:67]
ds_read_b64_tr_b16 v[150:151], v13 offset:16160
v_and_b32 v83, s36, v85
v_lshlrev_b32 v84, 16, v86
v_mfma_f32_16x16x32_bf16 v[68:71], v[152:155], v[132:135], v[68:71]
ds_read_b64_tr_b16 v[152:153], v13 offset:14400
v_and_b32 v85, s36, v86
v_lshlrev_b32 v86, 16, v87
s_waitcnt lgkmcnt(5)
v_mfma_f32_16x16x32_bf16 v[72:75], v[156:159], v[128:131], v[72:75]
ds_read_b64_tr_b16 v[154:155], v13 offset:16192
ds_read_b64_tr_b16 v[156:157], v14 offset:14336
s_xor_b32 s64, s50, 1974272
s_sub_u32 s64, s64, 114688
buffer_load_dwordx4 v[128:131], v23, s[4:7], s64 offen offset:0 sc1
s_waitcnt vmcnt(5) lgkmcnt(5)
v_mfma_f32_16x16x32_bf16 v[48:51], v[144:147], v[136:139], v[48:51]
ds_read_b64_tr_b16 v[158:159], v14 offset:16128
s_xor_b32 s67, s64, 256
buffer_load_dwordx4 v[132:135], v23, s[4:7], s67 offen offset:0 sc1
s_waitcnt vmcnt(5)
v_mfma_f32_16x16x32_bf16 v[52:55], v[144:147], v[140:143], v[52:55]
ds_read_b64_tr_b16 v[144:145], v13 offset:21504
v_and_b32 v87, s36, v87
v_add_f32 v92, v80, v82
v_add_f32 v93, v81, v83
s_waitcnt lgkmcnt(5)
v_mfma_f32_16x16x32_bf16 v[56:59], v[148:151], v[136:139], v[56:59]
ds_read_b64_tr_b16 v[146:147], v13 offset:23296
v_mul_f32 v94, v80, v80
v_mul_f32 v95, v81, v81
v_mfma_f32_16x16x32_bf16 v[60:63], v[148:151], v[140:143], v[60:63]
ds_read_b64_tr_b16 v[148:149], v13 offset:21536
v_fmac_f32 v94, v82, v82
v_fmac_f32 v95, v83, v83
s_waitcnt lgkmcnt(5)
v_mfma_f32_16x16x32_bf16 v[64:67], v[152:155], v[136:139], v[64:67]
ds_read_b64_tr_b16 v[150:151], v13 offset:23328
v_add_f32 v92, v92, v84
v_add_f32 v93, v93, v85
v_mfma_f32_16x16x32_bf16 v[68:71], v[152:155], v[140:143], v[68:71]
ds_read_b64_tr_b16 v[152:153], v13 offset:21568
buffer_load_dwordx4 v[140:143], v23, s[4:7], s67 offen offset:2048 sc1
s_waitcnt lgkmcnt(5)
v_mfma_f32_16x16x32_bf16 v[72:75], v[156:159], v[136:139], v[72:75]
ds_read_b64_tr_b16 v[154:155], v13 offset:23360
ds_read_b64_tr_b16 v[156:157], v14 offset:21504
buffer_load_dwordx4 v[136:139], v23, s[4:7], s64 offen offset:2048 sc1
s_waitcnt vmcnt(5) lgkmcnt(5)
v_mfma_f32_16x16x32_bf16 v[48:51], v[144:147], v[112:115], v[48:51]
ds_read_b64_tr_b16 v[158:159], v14 offset:23296
v_fmac_f32 v94, v84, v84
v_fmac_f32 v95, v85, v85
v_mfma_f32_16x16x32_bf16 v[48:51], v[76:79], v[120:123], v[48:51]
s_barrier
v_pk_add_f32 v[92:93], v[92:93], v[86:87]
v_pk_fma_f32 v[94:95], v[86:87], v[86:87], v[94:95] op_sel:[0,0,0] op_sel_hi:[1,1,1]
s_waitcnt vmcnt(4)
v_mfma_f32_16x16x32_bf16 v[52:55], v[144:147], v[116:119], v[52:55]
ds_read_b64_tr_b16 v[144:145], v13 offset:28672
v_add_f32 v92, v92, v93
v_add_f32 v94, v94, v95
s_waitcnt lgkmcnt(5)
v_mfma_f32_16x16x32_bf16 v[56:59], v[148:151], v[112:115], v[56:59]
ds_read_b64_tr_b16 v[146:147], v13 offset:30464
v_permlane32_swap_b32 v92, v94
v_mfma_f32_16x16x32_bf16 v[60:63], v[148:151], v[116:119], v[60:63]
ds_read_b64_tr_b16 v[148:149], v13 offset:28704
v_add_f32 v92, v92, v94
v_mov_b32 v94, v92
s_waitcnt lgkmcnt(5)
v_mfma_f32_16x16x32_bf16 v[64:67], v[152:155], v[112:115], v[64:67]
ds_read_b64_tr_b16 v[150:151], v13 offset:30496
v_permlane16_swap_b32 v92, v94
v_mfma_f32_16x16x32_bf16 v[68:71], v[152:155], v[116:119], v[68:71]
ds_read_b64_tr_b16 v[152:153], v13 offset:28736
v_add_f32 v92, v92, v94
v_add_f32 v32, v32, v80
v_add_f32 v33, v33, v81
s_waitcnt lgkmcnt(5)
v_mfma_f32_16x16x32_bf16 v[72:75], v[156:159], v[112:115], v[72:75]
ds_read_b64_tr_b16 v[154:155], v13 offset:30528
ds_read_b64_tr_b16 v[156:157], v14 offset:28672
s_xor_b32 s64, s50, 1978368
s_sub_u32 s64, s64, 114688
buffer_load_dwordx4 v[112:115], v23, s[4:7], s64 offen offset:0 sc1
v_mfma_f32_16x16x32_bf16 v[52:55], v[76:79], v[124:127], v[52:55]
s_mov_b64 vcc, 0xffff
s_lshl_b64 vcc, vcc, 16
v_cndmask_b32 v76, 0, v16, vcc
v_cndmask_b32 v77, 0, v17, vcc
s_waitcnt vmcnt(4) lgkmcnt(5)
v_mfma_f32_16x16x32_bf16 v[48:51], v[144:147], v[128:131], v[48:51]
ds_read_b64_tr_b16 v[158:159], v14 offset:30464
s_xor_b32 s67, s64, 256
buffer_load_dwordx4 v[116:119], v23, s[4:7], s67 offen offset:0 sc1
v_mfma_f32_16x16x32_bf16 v[56:59], v[76:79], v[120:123], v[56:59]
v_add_f32_dpp v92, v92, v92 row_ror:8 row_mask:0xf bank_mask:0xf
s_add_u32 s62, s42, 557056
buffer_store_dword v92, v8, s[4:7], s62 offen offset:2048 sc1
v_mfma_f32_16x16x32_bf16 v[60:63], v[76:79], v[124:127], v[60:63]
s_mov_b64 vcc, 0xffff
s_lshl_b64 vcc, vcc, 32
v_cndmask_b32 v76, 0, v16, vcc
v_cndmask_b32 v77, 0, v17, vcc
s_waitcnt vmcnt(5)
v_mfma_f32_16x16x32_bf16 v[52:55], v[144:147], v[132:135], v[52:55]
ds_read_b64_tr_b16 v[144:145], v13 offset:35840
v_add_f32 v34, v34, v82
v_add_f32 v35, v35, v83
v_mfma_f32_16x16x32_bf16 v[64:67], v[76:79], v[120:123], v[64:67]
v_add_f32 v36, v36, v84
v_add_f32 v37, v37, v85
v_mfma_f32_16x16x32_bf16 v[68:71], v[76:79], v[124:127], v[68:71]
s_mov_b64 vcc, 0xffff
s_lshl_b64 vcc, vcc, 48
v_cndmask_b32 v76, 0, v16, vcc
v_cndmask_b32 v77, 0, v17, vcc
s_waitcnt lgkmcnt(5)
v_mfma_f32_16x16x32_bf16 v[56:59], v[148:151], v[128:131], v[56:59]
ds_read_b64_tr_b16 v[146:147], v13 offset:37632
buffer_load_dwordx4 v[124:127], v23, s[4:7], s67 offen offset:2048 sc1
v_mfma_f32_16x16x32_bf16 v[72:75], v[76:79], v[120:123], v[72:75]
buffer_load_dwordx4 v[120:123], v23, s[4:7], s64 offen offset:2048 sc1
v_mfma_f32_16x16x32_bf16 v[60:63], v[148:151], v[132:135], v[60:63]
ds_read_b64_tr_b16 v[148:149], v13 offset:35872
v_add_f32 v38, v38, v86
v_add_f32 v39, v39, v87
s_waitcnt lgkmcnt(5)
v_mfma_f32_16x16x32_bf16 v[64:67], v[152:155], v[128:131], v[64:67]
ds_read_b64_tr_b16 v[150:151], v13 offset:37664
v_mfma_f32_16x16x32_bf16 v[68:71], v[152:155], v[132:135], v[68:71]
ds_read_b64_tr_b16 v[152:153], v13 offset:35904
s_waitcnt lgkmcnt(5)
v_mfma_f32_16x16x32_bf16 v[72:75], v[156:159], v[128:131], v[72:75]
ds_read_b64_tr_b16 v[154:155], v13 offset:37696
ds_read_b64_tr_b16 v[156:157], v14 offset:35840
s_xor_b32 s64, s50, 1982464
s_sub_u32 s64, s64, 114688
buffer_load_dwordx4 v[128:131], v23, s[4:7], s64 offen offset:0 sc1
s_waitcnt vmcnt(6) lgkmcnt(5)
v_mfma_f32_16x16x32_bf16 v[48:51], v[144:147], v[136:139], v[48:51]
ds_read_b64_tr_b16 v[158:159], v14 offset:37632
s_xor_b32 s67, s64, 256
buffer_load_dwordx4 v[132:135], v23, s[4:7], s67 offen offset:0 sc1
v_mfma_f32_16x16x32_bf16 v[52:55], v[144:147], v[140:143], v[52:55]
ds_read_b64_tr_b16 v[144:145], v13 offset:43008
s_waitcnt lgkmcnt(5)
v_mfma_f32_16x16x32_bf16 v[56:59], v[148:151], v[136:139], v[56:59]
ds_read_b64_tr_b16 v[146:147], v13 offset:44800
v_mfma_f32_16x16x32_bf16 v[60:63], v[148:151], v[140:143], v[60:63]
ds_read_b64_tr_b16 v[148:149], v13 offset:43040
s_waitcnt lgkmcnt(5)
v_mfma_f32_16x16x32_bf16 v[64:67], v[152:155], v[136:139], v[64:67]
ds_read_b64_tr_b16 v[150:151], v13 offset:44832
v_mfma_f32_16x16x32_bf16 v[68:71], v[152:155], v[140:143], v[68:71]
ds_read_b64_tr_b16 v[152:153], v13 offset:43072
buffer_load_dwordx4 v[140:143], v23, s[4:7], s67 offen offset:2048 sc1
s_waitcnt lgkmcnt(5)
v_mfma_f32_16x16x32_bf16 v[72:75], v[156:159], v[136:139], v[72:75]
ds_read_b64_tr_b16 v[154:155], v13 offset:44864
ds_read_b64_tr_b16 v[156:157], v14 offset:43008
buffer_load_dwordx4 v[136:139], v23, s[4:7], s64 offen offset:2048 sc1
s_waitcnt vmcnt(8) lgkmcnt(5)
v_mfma_f32_16x16x32_bf16 v[48:51], v[144:147], v[112:115], v[48:51]
ds_read_b64_tr_b16 v[158:159], v14 offset:44800
s_waitcnt vmcnt(7)
v_mfma_f32_16x16x32_bf16 v[52:55], v[144:147], v[116:119], v[52:55]
ds_read_b64_tr_b16 v[144:145], v13 offset:50176
s_waitcnt lgkmcnt(5)
v_mfma_f32_16x16x32_bf16 v[56:59], v[148:151], v[112:115], v[56:59]
ds_read_b64_tr_b16 v[146:147], v13 offset:51968
v_mfma_f32_16x16x32_bf16 v[60:63], v[148:151], v[116:119], v[60:63]
ds_read_b64_tr_b16 v[148:149], v13 offset:50208
s_waitcnt lgkmcnt(5)
v_mfma_f32_16x16x32_bf16 v[64:67], v[152:155], v[112:115], v[64:67]
ds_read_b64_tr_b16 v[150:151], v13 offset:52000
v_mfma_f32_16x16x32_bf16 v[68:71], v[152:155], v[116:119], v[68:71]
ds_read_b64_tr_b16 v[152:153], v13 offset:50240
s_waitcnt lgkmcnt(5)
v_mfma_f32_16x16x32_bf16 v[72:75], v[156:159], v[112:115], v[72:75]
ds_read_b64_tr_b16 v[154:155], v13 offset:52032
ds_read_b64_tr_b16 v[156:157], v14 offset:50176
s_xor_b32 s64, s50, 1986560
s_sub_u32 s64, s64, 114688
buffer_load_dwordx4 v[112:115], v23, s[4:7], s64 offen offset:0 sc1
s_waitcnt vmcnt(5) lgkmcnt(5)
v_mfma_f32_16x16x32_bf16 v[48:51], v[144:147], v[120:123], v[48:51]
ds_read_b64_tr_b16 v[158:159], v14 offset:51968
s_xor_b32 s67, s64, 256
buffer_load_dwordx4 v[116:119], v23, s[4:7], s67 offen offset:0 sc1
v_mfma_f32_16x16x32_bf16 v[52:55], v[144:147], v[124:127], v[52:55]
v_add_u32 v13, s65, v13
ds_read_b64_tr_b16 v[144:145], v13 offset:0
s_waitcnt lgkmcnt(5)
v_mfma_f32_16x16x32_bf16 v[56:59], v[148:151], v[120:123], v[56:59]
ds_read_b64_tr_b16 v[146:147], v13 offset:1792
v_mfma_f32_16x16x32_bf16 v[60:63], v[148:151], v[124:127], v[60:63]
ds_read_b64_tr_b16 v[148:149], v13 offset:32
s_waitcnt lgkmcnt(5)
v_mfma_f32_16x16x32_bf16 v[64:67], v[152:155], v[120:123], v[64:67]
ds_read_b64_tr_b16 v[150:151], v13 offset:1824
v_mfma_f32_16x16x32_bf16 v[68:71], v[152:155], v[124:127], v[68:71]
ds_read_b64_tr_b16 v[152:153], v13 offset:64
s_waitcnt lgkmcnt(5)
v_mfma_f32_16x16x32_bf16 v[72:75], v[156:159], v[120:123], v[72:75]
ds_read_b64_tr_b16 v[154:155], v13 offset:1856
v_add_u32 v14, s65, v14
ds_read_b64_tr_b16 v[156:157], v14 offset:0
s_waitcnt vmcnt(5) lgkmcnt(5)
v_mfma_f32_16x16x32_bf16 v[48:51], v[144:147], v[128:131], v[48:51]
ds_read_b64_tr_b16 v[158:159], v14 offset:1792
s_waitcnt vmcnt(4)
v_mfma_f32_16x16x32_bf16 v[52:55], v[144:147], v[132:135], v[52:55]
ds_read_b64_tr_b16 v[144:145], v13 offset:7168
s_lshl_b32 s60, s71, 8
v_xor_b32 v120, s60, v1
s_add_u32 s62, s51, 557056
buffer_load_dwordx4 v[124:127], v120, s[4:7], s62 offen offset:3072 sc1
buffer_load_dwordx4 v[120:123], v120, s[4:7], s62 offen offset:2048 sc1
s_waitcnt lgkmcnt(5)
v_mfma_f32_16x16x32_bf16 v[56:59], v[148:151], v[128:131], v[56:59]
ds_read_b64_tr_b16 v[146:147], v13 offset:8960
v_mfma_f32_16x16x32_bf16 v[60:63], v[148:151], v[132:135], v[60:63]
ds_read_b64_tr_b16 v[148:149], v13 offset:7200
s_waitcnt lgkmcnt(5)
v_mfma_f32_16x16x32_bf16 v[64:67], v[152:155], v[128:131], v[64:67]
ds_read_b64_tr_b16 v[150:151], v13 offset:8992
v_mfma_f32_16x16x32_bf16 v[68:71], v[152:155], v[132:135], v[68:71]
ds_read_b64_tr_b16 v[152:153], v13 offset:7232
buffer_load_dwordx4 v[132:135], v23, s[4:7], s67 offen offset:2048 sc1
s_waitcnt lgkmcnt(5)
v_mfma_f32_16x16x32_bf16 v[72:75], v[156:159], v[128:131], v[72:75]
ds_read_b64_tr_b16 v[154:155], v13 offset:9024
ds_read_b64_tr_b16 v[156:157], v14 offset:7168
buffer_load_dwordx4 v[128:131], v23, s[4:7], s64 offen offset:2048 sc1
s_waitcnt vmcnt(6) lgkmcnt(5)
v_mfma_f32_16x16x32_bf16 v[48:51], v[144:147], v[136:139], v[48:51]
ds_read_b64_tr_b16 v[158:159], v14 offset:8960
v_mfma_f32_16x16x32_bf16 v[52:55], v[144:147], v[140:143], v[52:55]
ds_read_b64_tr_b16 v[144:145], v13 offset:14336
s_waitcnt lgkmcnt(5)
v_mfma_f32_16x16x32_bf16 v[56:59], v[148:151], v[136:139], v[56:59]
ds_read_b64_tr_b16 v[146:147], v13 offset:16128
v_mfma_f32_16x16x32_bf16 v[60:63], v[148:151], v[140:143], v[60:63]
ds_read_b64_tr_b16 v[148:149], v13 offset:14368
s_waitcnt lgkmcnt(5)
v_mfma_f32_16x16x32_bf16 v[64:67], v[152:155], v[136:139], v[64:67]
ds_read_b64_tr_b16 v[150:151], v13 offset:16160
v_mfma_f32_16x16x32_bf16 v[68:71], v[152:155], v[140:143], v[68:71]
ds_read_b64_tr_b16 v[152:153], v13 offset:14400
s_waitcnt lgkmcnt(5)
v_mfma_f32_16x16x32_bf16 v[72:75], v[156:159], v[136:139], v[72:75]
ds_read_b64_tr_b16 v[154:155], v13 offset:16192
ds_read_b64_tr_b16 v[156:157], v14 offset:14336
s_xor_b32 s64, s50, 1990656
s_sub_u32 s64, s64, 114688
buffer_load_dwordx4 v[136:139], v23, s[4:7], s64 offen offset:0 sc1
s_waitcnt vmcnt(6) lgkmcnt(5)
v_mfma_f32_16x16x32_bf16 v[48:51], v[144:147], v[112:115], v[48:51]
ds_read_b64_tr_b16 v[158:159], v14 offset:16128
s_xor_b32 s67, s64, 256
buffer_load_dwordx4 v[140:143], v23, s[4:7], s67 offen offset:0 sc1
s_waitcnt vmcnt(6)
v_mfma_f32_16x16x32_bf16 v[52:55], v[144:147], v[116:119], v[52:55]
ds_read_b64_tr_b16 v[144:145], v13 offset:21504
s_waitcnt lgkmcnt(5)
v_mfma_f32_16x16x32_bf16 v[56:59], v[148:151], v[112:115], v[56:59]
ds_read_b64_tr_b16 v[146:147], v13 offset:23296
v_mfma_f32_16x16x32_bf16 v[60:63], v[148:151], v[116:119], v[60:63]
ds_read_b64_tr_b16 v[148:149], v13 offset:21536
s_waitcnt vmcnt(4)
v_add_f32 v120, v120, v124
v_add_f32 v121, v121, v125
s_waitcnt lgkmcnt(5)
v_mfma_f32_16x16x32_bf16 v[64:67], v[152:155], v[112:115], v[64:67]
ds_read_b64_tr_b16 v[150:151], v13 offset:23328
v_add_f32 v122, v122, v126
v_add_f32 v123, v123, v127
v_mfma_f32_16x16x32_bf16 v[68:71], v[152:155], v[116:119], v[68:71]
ds_read_b64_tr_b16 v[152:153], v13 offset:21568
v_add_f32 v120, v120, v122
v_add_f32 v121, v121, v123
s_waitcnt lgkmcnt(5)
v_mfma_f32_16x16x32_bf16 v[72:75], v[156:159], v[112:115], v[72:75]
ds_read_b64_tr_b16 v[154:155], v13 offset:23360
ds_read_b64_tr_b16 v[156:157], v14 offset:21504
v_permlane32_swap_b32 v120, v121
v_add_f32 v120, v120, v121
v_cmp_u_f32 vcc, v120, v120
s_cbranch_vccnz re_101
re_101b:
v_mul_f32 v120, 0x3b000000, v120
v_mov_b32 v121, v120
buffer_load_dwordx4 v[112:115], v23, s[4:7], s64 offen offset:2048 sc1
s_nop 0
v_permlane32_swap_b32 v120, v121
v_fma_f32 v121, -v120, v120, v121
v_max_f32 v121, 0, v121
v_add_f32 v122, 0x3727c5ac, v121
v_rsq_f32 v122, v122
v_cvt_pk_bf16_f32 v121, -v120, -v120
v_lshlrev_b32 v121, 16, v121
v_sub_f32 v121, -v120, v121
v_mul_f32 v21, 0xc0135761, v122
v_mul_f32 v20, v122, v122
v_rcp_f32 v41, v122
v_mul_f32 v20, v20, v21
v_mul_f32 v20, 0x3d372713, v20
v_cvt_pk_bf16_f32 v2, -v120, v121
s_waitcnt vmcnt(3) lgkmcnt(5)
v_mfma_f32_16x16x32_bf16 v[48:51], v[144:147], v[128:131], v[48:51]
ds_read_b64_tr_b16 v[158:159], v14 offset:23296
buffer_load_dwordx4 v[116:119], v23, s[4:7], s67 offen offset:2048 sc1
v_mfma_f32_16x16x32_bf16 v[52:55], v[144:147], v[132:135], v[52:55]
ds_read_b64_tr_b16 v[144:145], v13 offset:28672
s_xor_b32 s64, s50, 1994752
s_sub_u32 s64, s64, 114688
buffer_load_dwordx4 v[120:123], v23, s[4:7], s64 offen offset:0 sc1
s_waitcnt lgkmcnt(5)
v_mfma_f32_16x16x32_bf16 v[56:59], v[148:151], v[128:131], v[56:59]
ds_read_b64_tr_b16 v[146:147], v13 offset:30464
s_xor_b32 s67, s64, 256
buffer_load_dwordx4 v[124:127], v23, s[4:7], s67 offen offset:0 sc1
v_mfma_f32_16x16x32_bf16 v[60:63], v[148:151], v[132:135], v[60:63]
ds_read_b64_tr_b16 v[148:149], v13 offset:28704
s_waitcnt lgkmcnt(5)
v_mfma_f32_16x16x32_bf16 v[64:67], v[152:155], v[128:131], v[64:67]
ds_read_b64_tr_b16 v[150:151], v13 offset:30496
v_mfma_f32_16x16x32_bf16 v[68:71], v[152:155], v[132:135], v[68:71]
ds_read_b64_tr_b16 v[152:153], v13 offset:28736
buffer_load_dwordx4 v[132:135], v23, s[4:7], s67 offen offset:2048 sc1
s_waitcnt lgkmcnt(5)
v_mfma_f32_16x16x32_bf16 v[72:75], v[156:159], v[128:131], v[72:75]
ds_read_b64_tr_b16 v[154:155], v13 offset:30528
ds_read_b64_tr_b16 v[156:157], v14 offset:28672
buffer_load_dwordx4 v[128:131], v23, s[4:7], s64 offen offset:2048 sc1
s_waitcnt vmcnt(7) lgkmcnt(5)
v_mfma_f32_16x16x32_bf16 v[48:51], v[144:147], v[136:139], v[48:51]
ds_read_b64_tr_b16 v[158:159], v14 offset:30464
s_waitcnt vmcnt(6)
v_mfma_f32_16x16x32_bf16 v[52:55], v[144:147], v[140:143], v[52:55]
ds_read_b64_tr_b16 v[144:145], v13 offset:35840
s_waitcnt lgkmcnt(5)
v_mfma_f32_16x16x32_bf16 v[56:59], v[148:151], v[136:139], v[56:59]
ds_read_b64_tr_b16 v[146:147], v13 offset:37632
v_mfma_f32_16x16x32_bf16 v[60:63], v[148:151], v[140:143], v[60:63]
ds_read_b64_tr_b16 v[148:149], v13 offset:35872
s_waitcnt lgkmcnt(5)
v_mfma_f32_16x16x32_bf16 v[64:67], v[152:155], v[136:139], v[64:67]
ds_read_b64_tr_b16 v[150:151], v13 offset:37664
v_mfma_f32_16x16x32_bf16 v[68:71], v[152:155], v[140:143], v[68:71]
ds_read_b64_tr_b16 v[152:153], v13 offset:35904
s_waitcnt lgkmcnt(5)
v_mfma_f32_16x16x32_bf16 v[72:75], v[156:159], v[136:139], v[72:75]
ds_read_b64_tr_b16 v[154:155], v13 offset:37696
ds_read_b64_tr_b16 v[156:157], v14 offset:35840
s_xor_b32 s64, s50, 1998848
s_sub_u32 s64, s64, 114688
buffer_load_dwordx4 v[136:139], v23, s[4:7], s64 offen offset:0 sc1
s_waitcnt vmcnt(6) lgkmcnt(5)
v_mfma_f32_16x16x32_bf16 v[48:51], v[144:147], v[112:115], v[48:51]
ds_read_b64_tr_b16 v[158:159], v14 offset:37632
s_xor_b32 s67, s64, 256
buffer_load_dwordx4 v[140:143], v23, s[4:7], s67 offen offset:0 sc1
s_waitcnt vmcnt(6)
v_mfma_f32_16x16x32_bf16 v[52:55], v[144:147], v[116:119], v[52:55]
ds_read_b64_tr_b16 v[144:145], v13 offset:43008
s_waitcnt lgkmcnt(5)
v_mfma_f32_16x16x32_bf16 v[56:59], v[148:151], v[112:115], v[56:59]
ds_read_b64_tr_b16 v[146:147], v13 offset:44800
v_mfma_f32_16x16x32_bf16 v[60:63], v[148:151], v[116:119], v[60:63]
ds_read_b64_tr_b16 v[148:149], v13 offset:43040
s_waitcnt lgkmcnt(5)
v_mfma_f32_16x16x32_bf16 v[64:67], v[152:155], v[112:115], v[64:67]
ds_read_b64_tr_b16 v[150:151], v13 offset:44832
v_mfma_f32_16x16x32_bf16 v[68:71], v[152:155], v[116:119], v[68:71]
ds_read_b64_tr_b16 v[152:153], v13 offset:43072
buffer_load_dwordx4 v[116:119], v23, s[4:7], s67 offen offset:2048 sc1
s_waitcnt lgkmcnt(5)
v_mfma_f32_16x16x32_bf16 v[72:75], v[156:159], v[112:115], v[72:75]
ds_read_b64_tr_b16 v[154:155], v13 offset:44864
ds_read_b64_tr_b16 v[156:157], v14 offset:43008
buffer_load_dwordx4 v[112:115], v23, s[4:7], s64 offen offset:2048 sc1
s_waitcnt vmcnt(7) lgkmcnt(5)
v_mfma_f32_16x16x32_bf16 v[48:51], v[144:147], v[120:123], v[48:51]
ds_read_b64_tr_b16 v[158:159], v14 offset:44800
s_waitcnt vmcnt(6)
v_mfma_f32_16x16x32_bf16 v[52:55], v[144:147], v[124:127], v[52:55]
ds_read_b64_tr_b16 v[144:145], v13 offset:50176
s_waitcnt lgkmcnt(5)
v_mfma_f32_16x16x32_bf16 v[56:59], v[148:151], v[120:123], v[56:59]
ds_read_b64_tr_b16 v[146:147], v13 offset:51968
v_mfma_f32_16x16x32_bf16 v[60:63], v[148:151], v[124:127], v[60:63]
ds_read_b64_tr_b16 v[148:149], v13 offset:50208
s_waitcnt lgkmcnt(5)
v_mfma_f32_16x16x32_bf16 v[64:67], v[152:155], v[120:123], v[64:67]
ds_read_b64_tr_b16 v[150:151], v13 offset:52000
v_mfma_f32_16x16x32_bf16 v[68:71], v[152:155], v[124:127], v[68:71]
ds_read_b64_tr_b16 v[152:153], v13 offset:50240
v_mov_b32 v124, v2
v_mov_b32 v126, 0
s_waitcnt lgkmcnt(5)
v_mfma_f32_16x16x32_bf16 v[72:75], v[156:159], v[120:123], v[72:75]
ds_read_b64_tr_b16 v[154:155], v13 offset:52032
ds_read_b64_tr_b16 v[156:157], v14 offset:50176
v_subrev_u32 v13, s65, v13
s_waitcnt vmcnt(4) lgkmcnt(5)
v_mfma_f32_16x16x32_bf16 v[48:51], v[144:147], v[128:131], v[48:51]
ds_read_b64_tr_b16 v[158:159], v14 offset:51968
v_subrev_u32 v14, s65, v14
v_mov_b32 v120, v2
v_mfma_f32_16x16x32_bf16 v[52:55], v[144:147], v[132:135], v[52:55]
ds_read_b64_tr_b16 v[144:145], v13 offset:0
ds_read_b64_tr_b16 v[146:147], v13 offset:1792
v_permlane16_swap_b32 v120, v124
s_waitcnt lgkmcnt(6)
v_mfma_f32_16x16x32_bf16 v[56:59], v[148:151], v[128:131], v[56:59]
v_mov_b32 v122, 0
v_mov_b32 v123, 0
v_mfma_f32_16x16x32_bf16 v[60:63], v[148:151], v[132:135], v[60:63]
ds_read_b64_tr_b16 v[148:149], v13 offset:32
ds_read_b64_tr_b16 v[150:151], v13 offset:1824
v_permlane16_swap_b32 v48, v52
s_waitcnt lgkmcnt(6)
v_mfma_f32_16x16x32_bf16 v[64:67], v[152:155], v[128:131], v[64:67]
v_permlane16_swap_b32 v49, v53
s_waitcnt vmcnt(3) lgkmcnt(2)
v_mfma_f32_16x16x32_bf16 v[80:83], v[144:147], v[136:139], 0
v_permlane16_swap_b32 v50, v54
v_mfma_f32_16x16x32_bf16 v[68:71], v[152:155], v[132:135], v[68:71]
ds_read_b64_tr_b16 v[152:153], v13 offset:64
ds_read_b64_tr_b16 v[154:155], v13 offset:1856
v_permlane16_swap_b32 v51, v55
s_waitcnt vmcnt(2)
v_mfma_f32_16x16x32_bf16 v[84:87], v[144:147], v[140:143], 0
ds_read_b64_tr_b16 v[144:145], v13 offset:7168
v_mul_f32 v44, v48, v48
v_mul_f32 v45, v49, v49
s_waitcnt lgkmcnt(3)
v_mfma_f32_16x16x32_bf16 v[88:91], v[148:151], v[136:139], 0
ds_read_b64_tr_b16 v[146:147], v13 offset:8960
v_mul_f32 v46, v50, v50
v_mul_f32 v47, v51, v51
v_mfma_f32_16x16x32_bf16 v[92:95], v[148:151], v[140:143], 0
ds_read_b64_tr_b16 v[148:149], v13 offset:7200
v_fma_f32 v44, v44, v18, v19
v_fma_f32 v45, v45, v18, v19
s_waitcnt lgkmcnt(3)
v_mfma_f32_16x16x32_bf16 v[96:99], v[152:155], v[136:139], 0
ds_read_b64_tr_b16 v[150:151], v13 offset:8992
v_fma_f32 v46, v46, v18, v19
v_fma_f32 v47, v47, v18, v19
v_mfma_f32_16x16x32_bf16 v[100:103], v[152:155], v[140:143], 0
ds_read_b64_tr_b16 v[152:153], v13 offset:7232
v_mul_f32 v44, v44, v48
v_mul_f32 v45, v45, v49
v_mfma_f32_16x16x32_bf16 v[72:75], v[156:159], v[128:131], v[72:75]
ds_read_b64_tr_b16 v[156:157], v14 offset:0
ds_read_b64_tr_b16 v[158:159], v14 offset:1792
s_xor_b32 s64, s50, 2002944
s_sub_u32 s64, s64, 114688
buffer_load_dwordx4 v[128:131], v23, s[4:7], s64 offen offset:0 sc1
s_xor_b32 s67, s64, 256
buffer_load_dwordx4 v[132:135], v23, s[4:7], s67 offen offset:0 sc1
v_pk_mul_f32 v[46:47], v[46:47], v[50:51]
buffer_load_dwordx4 v[140:143], v23, s[4:7], s67 offen offset:2048 sc1
v_exp_f32 v44, v44
s_waitcnt lgkmcnt(0)
v_mfma_f32_16x16x32_bf16 v[104:107], v[156:159], v[136:139], 0
ds_read_b64_tr_b16 v[154:155], v13 offset:9024
ds_read_b64_tr_b16 v[156:157], v14 offset:7168
buffer_load_dwordx4 v[136:139], v23, s[4:7], s64 offen offset:2048 sc1
s_waitcnt vmcnt(4)
v_mfma_f32_16x16x32_bf16 v[80:83], v[144:147], v[112:115], v[80:83]
ds_read_b64_tr_b16 v[158:159], v14 offset:8960
v_exp_f32 v45, v45
v_mfma_f32_16x16x32_bf16 v[84:87], v[144:147], v[116:119], v[84:87]
ds_read_b64_tr_b16 v[144:145], v13 offset:14336
v_exp_f32 v46, v46
v_mfma_f32_16x16x32_bf16 v[88:91], v[148:151], v[112:115], v[88:91]
ds_read_b64_tr_b16 v[146:147], v13 offset:16128
v_exp_f32 v47, v47
v_mfma_f32_16x16x32_bf16 v[92:95], v[148:151], v[116:119], v[92:95]
ds_read_b64_tr_b16 v[148:149], v13 offset:14368
v_fma_f32 v44, v44, v40, v40
v_fma_f32 v45, v45, v40, v40
s_waitcnt lgkmcnt(5)
v_mfma_f32_16x16x32_bf16 v[96:99], v[152:155], v[112:115], v[96:99]
ds_read_b64_tr_b16 v[150:151], v13 offset:16160
v_fma_f32 v46, v46, v40, v40
v_fma_f32 v47, v47, v40, v40
v_mfma_f32_16x16x32_bf16 v[100:103], v[152:155], v[116:119], v[100:103]
ds_read_b64_tr_b16 v[152:153], v13 offset:14400
v_rcp_f32 v44, v44
s_waitcnt lgkmcnt(5)
v_mfma_f32_16x16x32_bf16 v[104:107], v[156:159], v[112:115], v[104:107]
ds_read_b64_tr_b16 v[154:155], v13 offset:16192
ds_read_b64_tr_b16 v[156:157], v14 offset:14336
s_xor_b32 s64, s50, 2007040
s_sub_u32 s64, s64, 114688
buffer_load_dwordx4 v[112:115], v23, s[4:7], s64 offen offset:0 sc1
s_xor_b32 s67, s64, 256
buffer_load_dwordx4 v[116:119], v23, s[4:7], s67 offen offset:0 sc1
v_rcp_f32 v45, v45
v_rcp_f32 v46, v46
v_rcp_f32 v47, v47
v_pk_mul_f32 v[44:45], v[44:45], v[48:49]
v_pk_mul_f32 v[46:47], v[46:47], v[50:51]
v_cvt_pk_bf16_f32 v48, v44, v45
v_cvt_pk_bf16_f32 v49, v46, v47
v_pk_mul_f32 v[76:77], v[52:53], v[52:53]
v_pk_mul_f32 v[78:79], v[54:55], v[54:55]
v_pk_fma_f32 v[76:77], v[76:77], v[18:19], v[18:19] op_sel:[0,0,1] op_sel_hi:[1,0,1]
v_pk_fma_f32 v[78:79], v[78:79], v[18:19], v[18:19] op_sel:[0,0,1] op_sel_hi:[1,0,1]
v_pk_mul_f32 v[76:77], v[76:77], v[52:53]
v_pk_mul_f32 v[78:79], v[78:79], v[54:55]
v_exp_f32 v76, v76
v_exp_f32 v77, v77
v_exp_f32 v78, v78
v_exp_f32 v79, v79
v_pk_fma_f32 v[76:77], v[76:77], v[40:41], v[40:41] op_sel:[0,0,0] op_sel_hi:[1,0,0]
v_pk_fma_f32 v[78:79], v[78:79], v[40:41], v[40:41] op_sel:[0,0,0] op_sel_hi:[1,0,0]
v_rcp_f32 v76, v76
v_rcp_f32 v77, v77
v_rcp_f32 v78, v78
v_rcp_f32 v79, v79
v_pk_mul_f32 v[76:77], v[76:77], v[52:53]
v_pk_mul_f32 v[78:79], v[78:79], v[54:55]
v_cvt_pk_bf16_f32 v50, v76, v77
v_cvt_pk_bf16_f32 v51, v78, v79
s_lshl_b32 s60, s71, 8
v_xor_b32 v52, s60, v1
s_add_u32 s62, s72, 0
buffer_store_dwordx4 v[48:51], v52, s[4:7], s62 offen offset:0 sc1
v_permlane16_swap_b32 v56, v60
v_permlane16_swap_b32 v57, v61
v_permlane16_swap_b32 v58, v62
v_permlane16_swap_b32 v59, v63
v_pk_mul_f32 v[44:45], v[56:57], v[56:57]
v_pk_mul_f32 v[46:47], v[58:59], v[58:59]
v_pk_fma_f32 v[44:45], v[44:45], v[18:19], v[18:19] op_sel:[0,0,1] op_sel_hi:[1,0,1]
v_pk_fma_f32 v[46:47], v[46:47], v[18:19], v[18:19] op_sel:[0,0,1] op_sel_hi:[1,0,1]
v_pk_mul_f32 v[44:45], v[44:45], v[56:57]
v_pk_mul_f32 v[46:47], v[46:47], v[58:59]
v_exp_f32 v44, v44
v_exp_f32 v45, v45
v_exp_f32 v46, v46
v_exp_f32 v47, v47
v_pk_fma_f32 v[44:45], v[44:45], v[40:41], v[40:41] op_sel:[0,0,0] op_sel_hi:[1,0,0]
v_pk_fma_f32 v[46:47], v[46:47], v[40:41], v[40:41] op_sel:[0,0,0] op_sel_hi:[1,0,0]
v_rcp_f32 v44, v44
v_rcp_f32 v45, v45
v_rcp_f32 v46, v46
v_rcp_f32 v47, v47
v_pk_mul_f32 v[44:45], v[44:45], v[56:57]
v_pk_mul_f32 v[46:47], v[46:47], v[58:59]
v_cvt_pk_bf16_f32 v56, v44, v45
v_cvt_pk_bf16_f32 v57, v46, v47
v_pk_mul_f32 v[76:77], v[60:61], v[60:61]
v_pk_mul_f32 v[78:79], v[62:63], v[62:63]
v_pk_fma_f32 v[76:77], v[76:77], v[18:19], v[18:19] op_sel:[0,0,1] op_sel_hi:[1,0,1]
v_pk_fma_f32 v[78:79], v[78:79], v[18:19], v[18:19] op_sel:[0,0,1] op_sel_hi:[1,0,1]
v_pk_mul_f32 v[76:77], v[76:77], v[60:61]
v_pk_mul_f32 v[78:79], v[78:79], v[62:63]
v_exp_f32 v76, v76
v_exp_f32 v77, v77
v_exp_f32 v78, v78
v_exp_f32 v79, v79
v_pk_fma_f32 v[76:77], v[76:77], v[40:41], v[40:41] op_sel:[0,0,0] op_sel_hi:[1,0,0]
v_pk_fma_f32 v[78:79], v[78:79], v[40:41], v[40:41] op_sel:[0,0,0] op_sel_hi:[1,0,0]
v_rcp_f32 v76, v76
v_rcp_f32 v77, v77
v_rcp_f32 v78, v78
v_rcp_f32 v79, v79
v_pk_mul_f32 v[76:77], v[76:77], v[60:61]
v_pk_mul_f32 v[78:79], v[78:79], v[62:63]
v_cvt_pk_bf16_f32 v58, v76, v77
v_cvt_pk_bf16_f32 v59, v78, v79
s_lshl_b32 s60, s71, 8
v_xor_b32 v60, s60, v1
s_add_u32 s62, s72, 0
buffer_store_dwordx4 v[56:59], v60, s[4:7], s62 offen offset:1024 sc1
v_permlane16_swap_b32 v64, v68
v_permlane16_swap_b32 v65, v69
v_permlane16_swap_b32 v66, v70
v_permlane16_swap_b32 v67, v71
v_pk_mul_f32 v[44:45], v[64:65], v[64:65]
v_pk_mul_f32 v[46:47], v[66:67], v[66:67]
v_pk_fma_f32 v[44:45], v[44:45], v[18:19], v[18:19] op_sel:[0,0,1] op_sel_hi:[1,0,1]
v_pk_fma_f32 v[46:47], v[46:47], v[18:19], v[18:19] op_sel:[0,0,1] op_sel_hi:[1,0,1]
v_pk_mul_f32 v[44:45], v[44:45], v[64:65]
v_pk_mul_f32 v[46:47], v[46:47], v[66:67]
v_exp_f32 v44, v44
v_exp_f32 v45, v45
v_exp_f32 v46, v46
v_exp_f32 v47, v47
v_pk_fma_f32 v[44:45], v[44:45], v[40:41], v[40:41] op_sel:[0,0,0] op_sel_hi:[1,0,0]
v_pk_fma_f32 v[46:47], v[46:47], v[40:41], v[40:41] op_sel:[0,0,0] op_sel_hi:[1,0,0]
v_rcp_f32 v44, v44
v_rcp_f32 v45, v45
v_rcp_f32 v46, v46
v_rcp_f32 v47, v47
v_pk_mul_f32 v[44:45], v[44:45], v[64:65]
v_pk_mul_f32 v[46:47], v[46:47], v[66:67]
v_cvt_pk_bf16_f32 v64, v44, v45
v_cvt_pk_bf16_f32 v65, v46, v47
v_pk_mul_f32 v[76:77], v[68:69], v[68:69]
v_pk_mul_f32 v[78:79], v[70:71], v[70:71]
v_pk_fma_f32 v[76:77], v[76:77], v[18:19], v[18:19] op_sel:[0,0,1] op_sel_hi:[1,0,1]
v_pk_fma_f32 v[78:79], v[78:79], v[18:19], v[18:19] op_sel:[0,0,1] op_sel_hi:[1,0,1]
v_pk_mul_f32 v[76:77], v[76:77], v[68:69]
v_pk_mul_f32 v[78:79], v[78:79], v[70:71]
v_exp_f32 v76, v76
v_exp_f32 v77, v77
v_exp_f32 v78, v78
v_exp_f32 v79, v79
v_pk_fma_f32 v[76:77], v[76:77], v[40:41], v[40:41] op_sel:[0,0,0] op_sel_hi:[1,0,0]
v_pk_fma_f32 v[78:79], v[78:79], v[40:41], v[40:41] op_sel:[0,0,0] op_sel_hi:[1,0,0]
v_rcp_f32 v76, v76
v_rcp_f32 v77, v77
v_rcp_f32 v78, v78
v_rcp_f32 v79, v79
v_pk_mul_f32 v[76:77], v[76:77], v[68:69]
v_pk_mul_f32 v[78:79], v[78:79], v[70:71]
v_cvt_pk_bf16_f32 v66, v76, v77
v_cvt_pk_bf16_f32 v67, v78, v79
s_lshl_b32 s60, s71, 8
v_xor_b32 v68, s60, v1
s_add_u32 s62, s72, 0
buffer_store_dwordx4 v[64:67], v68, s[4:7], s62 offen offset:2048 sc1
v_mov_b32 v127, 0
v_mov_b32 v121, v120
v_mov_b32 v125, v124
v_mov_b32 v76, v18
v_mfma_f32_16x16x32_bf16 v[80:83], v[108:111], v[120:123], v[80:83]
s_nop 0
v_permlane16_swap_b32 v18, v76
v_mfma_f32_16x16x32_bf16 v[84:87], v[108:111], v[124:127], v[84:87]
s_mov_b64 vcc, 0xffff
s_lshl_b64 vcc, vcc, 16
v_cndmask_b32 v108, 0, v16, vcc
v_cndmask_b32 v109, 0, v17, vcc
s_waitcnt vmcnt(8) lgkmcnt(5)
v_mfma_f32_16x16x32_bf16 v[80:83], v[144:147], v[128:131], v[80:83]
ds_read_b64_tr_b16 v[158:159], v14 offset:16128
v_mov_b32 v76, v19
v_mul_f32 v44, v72, v72
v_mul_f32 v45, v73, v73
v_mfma_f32_16x16x32_bf16 v[88:91], v[108:111], v[120:123], v[88:91]
v_permlane16_swap_b32 v19, v76
v_mfma_f32_16x16x32_bf16 v[92:95], v[108:111], v[124:127], v[92:95]
s_mov_b64 vcc, 0xffff
s_lshl_b64 vcc, vcc, 32
v_cndmask_b32 v108, 0, v16, vcc
v_cndmask_b32 v109, 0, v17, vcc
s_waitcnt vmcnt(7)
v_mfma_f32_16x16x32_bf16 v[84:87], v[144:147], v[132:135], v[84:87]
ds_read_b64_tr_b16 v[144:145], v13 offset:21504
v_mov_b32 v76, v40
v_mul_f32 v46, v74, v74
v_mul_f32 v47, v75, v75
v_mfma_f32_16x16x32_bf16 v[96:99], v[108:111], v[120:123], v[96:99]
v_permlane16_swap_b32 v40, v76
v_mfma_f32_16x16x32_bf16 v[100:103], v[108:111], v[124:127], v[100:103]
buffer_load_dwordx4 v[124:127], v23, s[4:7], s67 offen offset:2048 sc1
s_waitcnt lgkmcnt(5)
v_mfma_f32_16x16x32_bf16 v[88:91], v[148:151], v[128:131], v[88:91]
ds_read_b64_tr_b16 v[146:147], v13 offset:23296
v_fma_f32 v44, v44, v18, v19
v_fma_f32 v45, v45, v18, v19
v_mfma_f32_16x16x32_bf16 v[92:95], v[148:151], v[132:135], v[92:95]
ds_read_b64_tr_b16 v[148:149], v13 offset:21536
v_fma_f32 v46, v46, v18, v19
v_fma_f32 v47, v47, v18, v19
s_waitcnt lgkmcnt(5)
v_mfma_f32_16x16x32_bf16 v[96:99], v[152:155], v[128:131], v[96:99]
ds_read_b64_tr_b16 v[150:151], v13 offset:23328
v_mul_f32 v44, v44, v72
v_mul_f32 v45, v45, v73
v_mfma_f32_16x16x32_bf16 v[100:103], v[152:155], v[132:135], v[100:103]
ds_read_b64_tr_b16 v[152:153], v13 offset:21568
v_mul_f32 v46, v46, v74
v_mul_f32 v47, v47, v75
v_exp_f32 v44, v44
v_exp_f32 v45, v45
v_exp_f32 v46, v46
v_exp_f32 v47, v47
v_pk_fma_f32 v[44:45], v[44:45], v[40:41], v[40:41] op_sel:[0,0,0] op_sel_hi:[1,0,0]
v_pk_fma_f32 v[46:47], v[46:47], v[40:41], v[40:41] op_sel:[0,0,0] op_sel_hi:[1,0,0]
v_rcp_f32 v44, v44
v_rcp_f32 v45, v45
s_mov_b64 vcc, 0xffff
s_lshl_b64 vcc, vcc, 48
v_cndmask_b32 v108, 0, v16, vcc
v_cndmask_b32 v109, 0, v17, vcc
v_rcp_f32 v46, v46
s_nop 0
v_mfma_f32_16x16x32_bf16 v[104:107], v[108:111], v[120:123], v[104:107]
buffer_load_dwordx4 v[120:123], v23, s[4:7], s64 offen offset:2048 sc1
s_waitcnt lgkmcnt(5)
v_mfma_f32_16x16x32_bf16 v[104:107], v[156:159], v[128:131], v[104:107]
ds_read_b64_tr_b16 v[154:155], v13 offset:23360
ds_read_b64_tr_b16 v[156:157], v14 offset:21504
s_xor_b32 s64, s50, 2011136
s_sub_u32 s64, s64, 114688
buffer_load_dwordx4 v[128:131], v23, s[4:7], s64 offen offset:0 sc1
s_waitcnt vmcnt(8) lgkmcnt(5)
v_mfma_f32_16x16x32_bf16 v[80:83], v[144:147], v[136:139], v[80:83]
ds_read_b64_tr_b16 v[158:159], v14 offset:23296
s_xor_b32 s67, s64, 256
buffer_load_dwordx4 v[132:135], v23, s[4:7], s67 offen offset:0 sc1
v_mfma_f32_16x16x32_bf16 v[84:87], v[144:147], v[140:143], v[84:87]
ds_read_b64_tr_b16 v[144:145], v13 offset:28672
v_rcp_f32 v47, v47
s_waitcnt lgkmcnt(5)
v_mfma_f32_16x16x32_bf16 v[88:91], v[148:151], v[136:139], v[88:91]
ds_read_b64_tr_b16 v[146:147], v13 offset:30464
v_mul_f32 v44, v44, v72
v_mul_f32 v45, v45, v73
v_mfma_f32_16x16x32_bf16 v[92:95], v[148:151], v[140:143], v[92:95]
ds_read_b64_tr_b16 v[148:149], v13 offset:28704
v_mul_f32 v46, v46, v74
v_mul_f32 v47, v47, v75
s_waitcnt lgkmcnt(5)
v_mfma_f32_16x16x32_bf16 v[96:99], v[152:155], v[136:139], v[96:99]
ds_read_b64_tr_b16 v[150:151], v13 offset:30496
v_cvt_pk_bf16_f32 v72, v44, v45
v_cvt_pk_bf16_f32 v73, v46, v47
v_mfma_f32_16x16x32_bf16 v[100:103], v[152:155], v[140:143], v[100:103]
ds_read_b64_tr_b16 v[152:153], v13 offset:28736
buffer_load_dwordx4 v[140:143], v23, s[4:7], s67 offen offset:2048 sc1
s_waitcnt lgkmcnt(5)
v_mfma_f32_16x16x32_bf16 v[104:107], v[156:159], v[136:139], v[104:107]
ds_read_b64_tr_b16 v[154:155], v13 offset:30528
ds_read_b64_tr_b16 v[156:157], v14 offset:28672
buffer_load_dwordx4 v[136:139], v23, s[4:7], s64 offen offset:2048 sc1
s_waitcnt vmcnt(10) lgkmcnt(5)
v_mfma_f32_16x16x32_bf16 v[80:83], v[144:147], v[112:115], v[80:83]
ds_read_b64_tr_b16 v[158:159], v14 offset:30464
v_mov_b32 v74, v72
v_mov_b32 v75, v73
s_waitcnt vmcnt(9)
v_mfma_f32_16x16x32_bf16 v[84:87], v[144:147], v[116:119], v[84:87]
ds_read_b64_tr_b16 v[144:145], v13 offset:35840
v_permlane16_swap_b32 v72, v74
s_waitcnt lgkmcnt(5)
v_mfma_f32_16x16x32_bf16 v[88:91], v[148:151], v[112:115], v[88:91]
ds_read_b64_tr_b16 v[146:147], v13 offset:37632
v_permlane16_swap_b32 v73, v75
s_lshl_b32 s60, s71, 8
v_xor_b32 v77, s60, v1
s_add_u32 s62, s73, 0
s_mov_b32 exec_lo, 0xffff
s_mov_b32 exec_hi, 0xffff
buffer_store_dwordx4 v[72:75], v77, s[4:7], s62 offen sc1
s_mov_b64 exec, -1
v_mfma_f32_16x16x32_bf16 v[92:95], v[148:151], v[116:119], v[92:95]
ds_read_b64_tr_b16 v[148:149], v13 offset:35872
s_waitcnt lgkmcnt(5)
v_mfma_f32_16x16x32_bf16 v[96:99], v[152:155], v[112:115], v[96:99]
ds_read_b64_tr_b16 v[150:151], v13 offset:37664
v_mfma_f32_16x16x32_bf16 v[100:103], v[152:155], v[116:119], v[100:103]
ds_read_b64_tr_b16 v[152:153], v13 offset:35904
s_waitcnt lgkmcnt(5)
v_mfma_f32_16x16x32_bf16 v[104:107], v[156:159], v[112:115], v[104:107]
ds_read_b64_tr_b16 v[154:155], v13 offset:37696
ds_read_b64_tr_b16 v[156:157], v14 offset:35840
s_xor_b32 s64, s50, 2015232
s_sub_u32 s64, s64, 114688
buffer_load_dwordx4 v[112:115], v23, s[4:7], s64 offen offset:0 sc1
s_xor_b32 s67, s64, 256
buffer_load_dwordx4 v[116:119], v23, s[4:7], s67 offen offset:0 sc1
s_waitcnt vmcnt(7) lgkmcnt(5)
v_mfma_f32_16x16x32_bf16 v[80:83], v[144:147], v[120:123], v[80:83]
ds_read_b64_tr_b16 v[158:159], v14 offset:37632
v_mfma_f32_16x16x32_bf16 v[84:87], v[144:147], v[124:127], v[84:87]
ds_read_b64_tr_b16 v[144:145], v13 offset:43008
s_waitcnt lgkmcnt(5)
v_mfma_f32_16x16x32_bf16 v[88:91], v[148:151], v[120:123], v[88:91]
ds_read_b64_tr_b16 v[146:147], v13 offset:44800
v_mfma_f32_16x16x32_bf16 v[92:95], v[148:151], v[124:127], v[92:95]
ds_read_b64_tr_b16 v[148:149], v13 offset:43040
s_waitcnt lgkmcnt(5)
v_mfma_f32_16x16x32_bf16 v[96:99], v[152:155], v[120:123], v[96:99]
ds_read_b64_tr_b16 v[150:151], v13 offset:44832
v_mfma_f32_16x16x32_bf16 v[100:103], v[152:155], v[124:127], v[100:103]
ds_read_b64_tr_b16 v[152:153], v13 offset:43072
buffer_load_dwordx4 v[124:127], v23, s[4:7], s67 offen offset:2048 sc1
s_waitcnt lgkmcnt(5)
v_mfma_f32_16x16x32_bf16 v[104:107], v[156:159], v[120:123], v[104:107]
ds_read_b64_tr_b16 v[154:155], v13 offset:44864
ds_read_b64_tr_b16 v[156:157], v14 offset:43008
buffer_load_dwordx4 v[120:123], v23, s[4:7], s64 offen offset:2048 sc1
s_waitcnt vmcnt(8) lgkmcnt(5)
v_mfma_f32_16x16x32_bf16 v[80:83], v[144:147], v[128:131], v[80:83]
ds_read_b64_tr_b16 v[158:159], v14 offset:44800
s_waitcnt vmcnt(7)
v_mfma_f32_16x16x32_bf16 v[84:87], v[144:147], v[132:135], v[84:87]
ds_read_b64_tr_b16 v[144:145], v13 offset:50176
s_waitcnt lgkmcnt(5)
v_mfma_f32_16x16x32_bf16 v[88:91], v[148:151], v[128:131], v[88:91]
ds_read_b64_tr_b16 v[146:147], v13 offset:51968
v_mfma_f32_16x16x32_bf16 v[92:95], v[148:151], v[132:135], v[92:95]
ds_read_b64_tr_b16 v[148:149], v13 offset:50208
s_waitcnt lgkmcnt(5)
v_mfma_f32_16x16x32_bf16 v[96:99], v[152:155], v[128:131], v[96:99]
ds_read_b64_tr_b16 v[150:151], v13 offset:52000
v_mfma_f32_16x16x32_bf16 v[100:103], v[152:155], v[132:135], v[100:103]
ds_read_b64_tr_b16 v[152:153], v13 offset:50240
s_waitcnt lgkmcnt(5)
v_mfma_f32_16x16x32_bf16 v[104:107], v[156:159], v[128:131], v[104:107]
ds_read_b64_tr_b16 v[154:155], v13 offset:52032
ds_read_b64_tr_b16 v[156:157], v14 offset:50176
s_xor_b32 s64, s50, 2019328
s_sub_u32 s64, s64, 114688
buffer_load_dwordx4 v[128:131], v23, s[4:7], s64 offen offset:0 sc1
s_waitcnt vmcnt(6) lgkmcnt(5)
v_mfma_f32_16x16x32_bf16 v[80:83], v[144:147], v[136:139], v[80:83]
ds_read_b64_tr_b16 v[158:159], v14 offset:51968
s_xor_b32 s67, s64, 256
buffer_load_dwordx4 v[132:135], v23, s[4:7], s67 offen offset:0 sc1
v_mfma_f32_16x16x32_bf16 v[84:87], v[144:147], v[140:143], v[84:87]
v_add_u32 v13, s65, v13
ds_read_b64_tr_b16 v[144:145], v13 offset:0
s_waitcnt lgkmcnt(5)
v_mfma_f32_16x16x32_bf16 v[88:91], v[148:151], v[136:139], v[88:91]
ds_read_b64_tr_b16 v[146:147], v13 offset:1792
v_mfma_f32_16x16x32_bf16 v[92:95], v[148:151], v[140:143], v[92:95]
ds_read_b64_tr_b16 v[148:149], v13 offset:32
s_waitcnt lgkmcnt(5)
v_mfma_f32_16x16x32_bf16 v[96:99], v[152:155], v[136:139], v[96:99]
ds_read_b64_tr_b16 v[150:151], v13 offset:1824
v_mfma_f32_16x16x32_bf16 v[100:103], v[152:155], v[140:143], v[100:103]
ds_read_b64_tr_b16 v[152:153], v13 offset:64
buffer_load_dwordx4 v[140:143], v23, s[4:7], s67 offen offset:2048 sc1
s_waitcnt lgkmcnt(5)
v_mfma_f32_16x16x32_bf16 v[104:107], v[156:159], v[136:139], v[104:107]
ds_read_b64_tr_b16 v[154:155], v13 offset:1856
v_add_u32 v14, s65, v14
ds_read_b64_tr_b16 v[156:157], v14 offset:0
buffer_load_dwordx4 v[136:139], v23, s[4:7], s64 offen offset:2048 sc1
v_mov_b32 v76, 3
s_waitcnt vmcnt(8)
s_mov_b64 exec, 1
buffer_store_dword v76, v1, s[4:7], s45 offen sc1
s_mov_b64 exec, -1
s_waitcnt vmcnt(8) lgkmcnt(5)
v_mfma_f32_16x16x32_bf16 v[80:83], v[144:147], v[112:115], v[80:83]
ds_read_b64_tr_b16 v[158:159], v14 offset:1792
s_waitcnt vmcnt(7)
v_mfma_f32_16x16x32_bf16 v[84:87], v[144:147], v[116:119], v[84:87]
ds_read_b64_tr_b16 v[144:145], v13 offset:7168
s_waitcnt lgkmcnt(5)
v_mfma_f32_16x16x32_bf16 v[88:91], v[148:151], v[112:115], v[88:91]
ds_read_b64_tr_b16 v[146:147], v13 offset:8960
v_mfma_f32_16x16x32_bf16 v[92:95], v[148:151], v[116:119], v[92:95]
ds_read_b64_tr_b16 v[148:149], v13 offset:7200
s_waitcnt lgkmcnt(5)
v_mfma_f32_16x16x32_bf16 v[96:99], v[152:155], v[112:115], v[96:99]
ds_read_b64_tr_b16 v[150:151], v13 offset:8992
v_mfma_f32_16x16x32_bf16 v[100:103], v[152:155], v[116:119], v[100:103]
ds_read_b64_tr_b16 v[152:153], v13 offset:7232
s_waitcnt lgkmcnt(5)
v_mfma_f32_16x16x32_bf16 v[104:107], v[156:159], v[112:115], v[104:107]
ds_read_b64_tr_b16 v[154:155], v13 offset:9024
ds_read_b64_tr_b16 v[156:157], v14 offset:7168
s_xor_b32 s64, s50, 2023424
s_sub_u32 s64, s64, 114688
buffer_load_dwordx4 v[112:115], v23, s[4:7], s64 offen offset:0 sc1
s_waitcnt vmcnt(6) lgkmcnt(5)
v_mfma_f32_16x16x32_bf16 v[80:83], v[144:147], v[120:123], v[80:83]
ds_read_b64_tr_b16 v[158:159], v14 offset:8960
s_xor_b32 s67, s64, 256
buffer_load_dwordx4 v[116:119], v23, s[4:7], s67 offen offset:0 sc1
v_mfma_f32_16x16x32_bf16 v[84:87], v[144:147], v[124:127], v[84:87]
ds_read_b64_tr_b16 v[144:145], v13 offset:14336
s_waitcnt lgkmcnt(5)
v_mfma_f32_16x16x32_bf16 v[88:91], v[148:151], v[120:123], v[88:91]
ds_read_b64_tr_b16 v[146:147], v13 offset:16128
v_mfma_f32_16x16x32_bf16 v[92:95], v[148:151], v[124:127], v[92:95]
ds_read_b64_tr_b16 v[148:149], v13 offset:14368
s_waitcnt lgkmcnt(5)
v_mfma_f32_16x16x32_bf16 v[96:99], v[152:155], v[120:123], v[96:99]
ds_read_b64_tr_b16 v[150:151], v13 offset:16160
v_mfma_f32_16x16x32_bf16 v[100:103], v[152:155], v[124:127], v[100:103]
ds_read_b64_tr_b16 v[152:153], v13 offset:14400
buffer_load_dwordx4 v[124:127], v23, s[4:7], s67 offen offset:2048 sc1
s_waitcnt lgkmcnt(5)
v_mfma_f32_16x16x32_bf16 v[104:107], v[156:159], v[120:123], v[104:107]
ds_read_b64_tr_b16 v[154:155], v13 offset:16192
ds_read_b64_tr_b16 v[156:157], v14 offset:14336
buffer_load_dwordx4 v[120:123], v23, s[4:7], s64 offen offset:2048 sc1
s_waitcnt vmcnt(8) lgkmcnt(5)
v_mfma_f32_16x16x32_bf16 v[80:83], v[144:147], v[128:131], v[80:83]
ds_read_b64_tr_b16 v[158:159], v14 offset:16128
s_waitcnt vmcnt(7)
v_mfma_f32_16x16x32_bf16 v[84:87], v[144:147], v[132:135], v[84:87]
ds_read_b64_tr_b16 v[144:145], v13 offset:21504
s_waitcnt lgkmcnt(5)
v_mfma_f32_16x16x32_bf16 v[88:91], v[148:151], v[128:131], v[88:91]
ds_read_b64_tr_b16 v[146:147], v13 offset:23296
v_mfma_f32_16x16x32_bf16 v[92:95], v[148:151], v[132:135], v[92:95]
ds_read_b64_tr_b16 v[148:149], v13 offset:21536
s_waitcnt lgkmcnt(5)
v_mfma_f32_16x16x32_bf16 v[96:99], v[152:155], v[128:131], v[96:99]
ds_read_b64_tr_b16 v[150:151], v13 offset:23328
v_mfma_f32_16x16x32_bf16 v[100:103], v[152:155], v[132:135], v[100:103]
ds_read_b64_tr_b16 v[152:153], v13 offset:21568
s_waitcnt lgkmcnt(5)
v_mfma_f32_16x16x32_bf16 v[104:107], v[156:159], v[128:131], v[104:107]
ds_read_b64_tr_b16 v[154:155], v13 offset:23360
ds_read_b64_tr_b16 v[156:157], v14 offset:21504
s_xor_b32 s64, s50, 2027520
s_sub_u32 s64, s64, 114688
buffer_load_dwordx4 v[128:131], v23, s[4:7], s64 offen offset:0 sc1
s_waitcnt vmcnt(6) lgkmcnt(5)
v_mfma_f32_16x16x32_bf16 v[80:83], v[144:147], v[136:139], v[80:83]
ds_read_b64_tr_b16 v[158:159], v14 offset:23296
s_xor_b32 s67, s64, 256
buffer_load_dwordx4 v[132:135], v23, s[4:7], s67 offen offset:0 sc1
v_mfma_f32_16x16x32_bf16 v[84:87], v[144:147], v[140:143], v[84:87]
ds_read_b64_tr_b16 v[144:145], v13 offset:28672
s_waitcnt lgkmcnt(5)
v_mfma_f32_16x16x32_bf16 v[88:91], v[148:151], v[136:139], v[88:91]
ds_read_b64_tr_b16 v[146:147], v13 offset:30464
v_mfma_f32_16x16x32_bf16 v[92:95], v[148:151], v[140:143], v[92:95]
ds_read_b64_tr_b16 v[148:149], v13 offset:28704
s_waitcnt lgkmcnt(5)
v_mfma_f32_16x16x32_bf16 v[96:99], v[152:155], v[136:139], v[96:99]
ds_read_b64_tr_b16 v[150:151], v13 offset:30496
v_mfma_f32_16x16x32_bf16 v[100:103], v[152:155], v[140:143], v[100:103]
ds_read_b64_tr_b16 v[152:153], v13 offset:28736
buffer_load_dwordx4 v[140:143], v23, s[4:7], s67 offen offset:2048 sc1
s_waitcnt lgkmcnt(5)
v_mfma_f32_16x16x32_bf16 v[104:107], v[156:159], v[136:139], v[104:107]
ds_read_b64_tr_b16 v[154:155], v13 offset:30528
ds_read_b64_tr_b16 v[156:157], v14 offset:28672
buffer_load_dwordx4 v[136:139], v23, s[4:7], s64 offen offset:2048 sc1
s_waitcnt vmcnt(7) lgkmcnt(5)
v_mfma_f32_16x16x32_bf16 v[80:83], v[144:147], v[112:115], v[80:83]
ds_read_b64_tr_b16 v[158:159], v14 offset:30464
s_waitcnt vmcnt(6)
v_mfma_f32_16x16x32_bf16 v[84:87], v[144:147], v[116:119], v[84:87]
ds_read_b64_tr_b16 v[144:145], v13 offset:35840
s_waitcnt lgkmcnt(5)
v_mfma_f32_16x16x32_bf16 v[88:91], v[148:151], v[112:115], v[88:91]
ds_read_b64_tr_b16 v[146:147], v13 offset:37632
v_mfma_f32_16x16x32_bf16 v[92:95], v[148:151], v[116:119], v[92:95]
ds_read_b64_tr_b16 v[148:149], v13 offset:35872
s_waitcnt lgkmcnt(5)
v_mfma_f32_16x16x32_bf16 v[96:99], v[152:155], v[112:115], v[96:99]
ds_read_b64_tr_b16 v[150:151], v13 offset:37664
v_mfma_f32_16x16x32_bf16 v[100:103], v[152:155], v[116:119], v[100:103]
ds_read_b64_tr_b16 v[152:153], v13 offset:35904
s_waitcnt lgkmcnt(5)
v_mfma_f32_16x16x32_bf16 v[104:107], v[156:159], v[112:115], v[104:107]
ds_read_b64_tr_b16 v[154:155], v13 offset:37696
ds_read_b64_tr_b16 v[156:157], v14 offset:35840
s_waitcnt vmcnt(4) lgkmcnt(5)
v_mfma_f32_16x16x32_bf16 v[80:83], v[144:147], v[120:123], v[80:83]
ds_read_b64_tr_b16 v[158:159], v14 offset:37632
v_mfma_f32_16x16x32_bf16 v[84:87], v[144:147], v[124:127], v[84:87]
ds_read_b64_tr_b16 v[144:145], v13 offset:43008
s_waitcnt lgkmcnt(5)
v_mfma_f32_16x16x32_bf16 v[88:91], v[148:151], v[120:123], v[88:91]
ds_read_b64_tr_b16 v[146:147], v13 offset:44800
v_mfma_f32_16x16x32_bf16 v[92:95], v[148:151], v[124:127], v[92:95]
ds_read_b64_tr_b16 v[148:149], v13 offset:43040
s_waitcnt lgkmcnt(5)
v_mfma_f32_16x16x32_bf16 v[96:99], v[152:155], v[120:123], v[96:99]
ds_read_b64_tr_b16 v[150:151], v13 offset:44832
v_mfma_f32_16x16x32_bf16 v[100:103], v[152:155], v[124:127], v[100:103]
ds_read_b64_tr_b16 v[152:153], v13 offset:43072
s_waitcnt lgkmcnt(5)
v_mfma_f32_16x16x32_bf16 v[104:107], v[156:159], v[120:123], v[104:107]
ds_read_b64_tr_b16 v[154:155], v13 offset:44864
ds_read_b64_tr_b16 v[156:157], v14 offset:43008
s_waitcnt vmcnt(3) lgkmcnt(5)
v_mfma_f32_16x16x32_bf16 v[80:83], v[144:147], v[128:131], v[80:83]
ds_read_b64_tr_b16 v[158:159], v14 offset:44800
v_lshrrev_b32 v15, 2, v1
buffer_load_dword v15, v15, s[4:7], s37 offen sc1
s_waitcnt vmcnt(3)
v_mfma_f32_16x16x32_bf16 v[84:87], v[144:147], v[132:135], v[84:87]
ds_read_b64_tr_b16 v[144:145], v13 offset:50176
s_waitcnt lgkmcnt(5)
v_mfma_f32_16x16x32_bf16 v[88:91], v[148:151], v[128:131], v[88:91]
ds_read_b64_tr_b16 v[146:147], v13 offset:51968
v_mfma_f32_16x16x32_bf16 v[92:95], v[148:151], v[132:135], v[92:95]
ds_read_b64_tr_b16 v[148:149], v13 offset:50208
s_waitcnt lgkmcnt(5)
v_mfma_f32_16x16x32_bf16 v[96:99], v[152:155], v[128:131], v[96:99]
ds_read_b64_tr_b16 v[150:151], v13 offset:52000
v_mfma_f32_16x16x32_bf16 v[100:103], v[152:155], v[132:135], v[100:103]
ds_read_b64_tr_b16 v[152:153], v13 offset:50240
s_waitcnt lgkmcnt(5)
v_mfma_f32_16x16x32_bf16 v[104:107], v[156:159], v[128:131], v[104:107]
ds_read_b64_tr_b16 v[154:155], v13 offset:52032
ds_read_b64_tr_b16 v[156:157], v14 offset:50176
v_subrev_u32 v13, s65, v13
s_waitcnt vmcnt(1) lgkmcnt(5)
v_mfma_f32_16x16x32_bf16 v[80:83], v[144:147], v[136:139], v[80:83]
ds_read_b64_tr_b16 v[158:159], v14 offset:51968
v_subrev_u32 v14, s65, v14
v_mfma_f32_16x16x32_bf16 v[84:87], v[144:147], v[140:143], v[84:87]
s_waitcnt lgkmcnt(4)
v_mfma_f32_16x16x32_bf16 v[88:91], v[148:151], v[136:139], v[88:91]
v_mfma_f32_16x16x32_bf16 v[92:95], v[148:151], v[140:143], v[92:95]
s_nop 1
v_permlane16_swap_b32 v80, v84
v_permlane16_swap_b32 v81, v85
v_permlane16_swap_b32 v82, v86
v_permlane16_swap_b32 v83, v87
s_waitcnt lgkmcnt(2)
v_mfma_f32_16x16x32_bf16 v[96:99], v[152:155], v[136:139], v[96:99]
v_mul_f32 v44, v80, v80
v_mul_f32 v45, v81, v81
v_mul_f32 v46, v82, v82
v_mul_f32 v47, v83, v83
s_waitcnt vmcnt(0)
v_cmp_gt_u32 vcc, 3, v15
s_nop 0
s_and_b64 vcc, vcc, s[28:29]
s_cbranch_scc1 re_102
re_102b:
v_pk_fma_f32 v[44:45], v[44:45], v[20:21], v[20:21] op_sel:[0,0,1] op_sel_hi:[1,0,1]
v_pk_fma_f32 v[46:47], v[46:47], v[20:21], v[20:21] op_sel:[0,0,1] op_sel_hi:[1,0,1]
s_nop 0
v_mfma_f32_16x16x32_bf16 v[100:103], v[152:155], v[140:143], v[100:103]
s_add_u32 s67, s74, 0
buffer_load_dwordx4 v[112:115], v1, s[4:7], s67 offen offset:0 sc1
v_pk_mul_f32 v[44:45], v[44:45], v[80:81]
v_pk_mul_f32 v[46:47], v[46:47], v[82:83]
v_exp_f32 v44, v44
v_exp_f32 v45, v45
v_exp_f32 v46, v46
v_exp_f32 v47, v47
v_pk_fma_f32 v[44:45], v[44:45], v[40:41], v[40:41] op_sel:[0,1,1] op_sel_hi:[1,1,1]
v_pk_fma_f32 v[46:47], v[46:47], v[40:41], v[40:41] op_sel:[0,1,1] op_sel_hi:[1,1,1]
v_rcp_f32 v44, v44
v_rcp_f32 v45, v45
v_rcp_f32 v46, v46
v_rcp_f32 v47, v47
v_pk_mul_f32 v[44:45], v[44:45], v[80:81]
v_pk_mul_f32 v[46:47], v[46:47], v[82:83]
v_cvt_pk_bf16_f32 v80, v44, v45
v_cvt_pk_bf16_f32 v81, v46, v47
v_pk_mul_f32 v[108:109], v[84:85], v[84:85]
v_pk_mul_f32 v[110:111], v[86:87], v[86:87]
v_pk_fma_f32 v[108:109], v[108:109], v[20:21], v[20:21] op_sel:[0,0,1] op_sel_hi:[1,0,1]
v_pk_fma_f32 v[110:111], v[110:111], v[20:21], v[20:21] op_sel:[0,0,1] op_sel_hi:[1,0,1]
v_pk_mul_f32 v[108:109], v[108:109], v[84:85]
v_pk_mul_f32 v[110:111], v[110:111], v[86:87]
v_exp_f32 v108, v108
v_exp_f32 v109, v109
v_exp_f32 v110, v110
v_exp_f32 v111, v111
v_pk_fma_f32 v[108:109], v[108:109], v[40:41], v[40:41] op_sel:[0,1,1] op_sel_hi:[1,1,1]
v_pk_fma_f32 v[110:111], v[110:111], v[40:41], v[40:41] op_sel:[0,1,1] op_sel_hi:[1,1,1]
v_rcp_f32 v108, v108
v_rcp_f32 v109, v109
v_rcp_f32 v110, v110
v_rcp_f32 v111, v111
v_pk_mul_f32 v[108:109], v[108:109], v[84:85]
v_pk_mul_f32 v[110:111], v[110:111], v[86:87]
v_cvt_pk_bf16_f32 v82, v108, v109
v_cvt_pk_bf16_f32 v83, v110, v111
s_lshl_b32 s60, s71, 8
v_xor_b32 v84, s60, v1
s_add_u32 s62, s72, 114688
buffer_store_dwordx4 v[80:83], v84, s[4:7], s62 offen offset:0 sc1
v_permlane16_swap_b32 v88, v92
v_permlane16_swap_b32 v89, v93
v_permlane16_swap_b32 v90, v94
v_permlane16_swap_b32 v91, v95
v_pk_mul_f32 v[44:45], v[88:89], v[88:89]
v_pk_mul_f32 v[46:47], v[90:91], v[90:91]
v_pk_fma_f32 v[44:45], v[44:45], v[20:21], v[20:21] op_sel:[0,0,1] op_sel_hi:[1,0,1]
v_pk_fma_f32 v[46:47], v[46:47], v[20:21], v[20:21] op_sel:[0,0,1] op_sel_hi:[1,0,1]
v_pk_mul_f32 v[44:45], v[44:45], v[88:89]
v_pk_mul_f32 v[46:47], v[46:47], v[90:91]
v_exp_f32 v44, v44
v_exp_f32 v45, v45
v_exp_f32 v46, v46
v_exp_f32 v47, v47
s_waitcnt lgkmcnt(0)
v_mfma_f32_16x16x32_bf16 v[104:107], v[156:159], v[136:139], v[104:107]
buffer_load_dwordx4 v[116:119], v1, s[4:7], s67 offen offset:1024 sc1
v_fma_f32 v44, v44, v41, v41
v_fma_f32 v45, v45, v41, v41
v_pk_fma_f32 v[46:47], v[46:47], v[40:41], v[40:41] op_sel:[0,1,1] op_sel_hi:[1,1,1]
v_rcp_f32 v44, v44
v_rcp_f32 v45, v45
v_rcp_f32 v46, v46
v_rcp_f32 v47, v47
v_pk_mul_f32 v[44:45], v[44:45], v[88:89]
v_pk_mul_f32 v[46:47], v[46:47], v[90:91]
v_cvt_pk_bf16_f32 v88, v44, v45
v_cvt_pk_bf16_f32 v89, v46, v47
v_pk_mul_f32 v[108:109], v[92:93], v[92:93]
v_pk_mul_f32 v[110:111], v[94:95], v[94:95]
v_pk_fma_f32 v[108:109], v[108:109], v[20:21], v[20:21] op_sel:[0,0,1] op_sel_hi:[1,0,1]
v_pk_fma_f32 v[110:111], v[110:111], v[20:21], v[20:21] op_sel:[0,0,1] op_sel_hi:[1,0,1]
v_pk_mul_f32 v[108:109], v[108:109], v[92:93]
v_pk_mul_f32 v[110:111], v[110:111], v[94:95]
v_exp_f32 v108, v108
v_exp_f32 v109, v109
v_exp_f32 v110, v110
v_exp_f32 v111, v111
v_pk_fma_f32 v[108:109], v[108:109], v[40:41], v[40:41] op_sel:[0,1,1] op_sel_hi:[1,1,1]
v_pk_fma_f32 v[110:111], v[110:111], v[40:41], v[40:41] op_sel:[0,1,1] op_sel_hi:[1,1,1]
v_rcp_f32 v108, v108
v_rcp_f32 v109, v109
v_rcp_f32 v110, v110
v_rcp_f32 v111, v111
v_pk_mul_f32 v[108:109], v[108:109], v[92:93]
v_pk_mul_f32 v[110:111], v[110:111], v[94:95]
v_cvt_pk_bf16_f32 v90, v108, v109
v_cvt_pk_bf16_f32 v91, v110, v111
s_lshl_b32 s60, s71, 8
v_xor_b32 v92, s60, v1
s_add_u32 s62, s72, 114688
buffer_store_dwordx4 v[88:91], v92, s[4:7], s62 offen offset:1024 sc1
v_permlane16_swap_b32 v96, v100
v_permlane16_swap_b32 v97, v101
v_permlane16_swap_b32 v98, v102
v_permlane16_swap_b32 v99, v103
v_pk_mul_f32 v[44:45], v[96:97], v[96:97]
v_pk_mul_f32 v[46:47], v[98:99], v[98:99]
v_pk_fma_f32 v[44:45], v[44:45], v[20:21], v[20:21] op_sel:[0,0,1] op_sel_hi:[1,0,1]
v_pk_fma_f32 v[46:47], v[46:47], v[20:21], v[20:21] op_sel:[0,0,1] op_sel_hi:[1,0,1]
v_pk_mul_f32 v[44:45], v[44:45], v[96:97]
v_pk_mul_f32 v[46:47], v[46:47], v[98:99]
v_exp_f32 v44, v44
v_exp_f32 v45, v45
v_exp_f32 v46, v46
v_exp_f32 v47, v47
v_pk_fma_f32 v[44:45], v[44:45], v[40:41], v[40:41] op_sel:[0,1,1] op_sel_hi:[1,1,1]
v_pk_fma_f32 v[46:47], v[46:47], v[40:41], v[40:41] op_sel:[0,1,1] op_sel_hi:[1,1,1]
v_rcp_f32 v44, v44
v_rcp_f32 v45, v45
v_rcp_f32 v46, v46
v_rcp_f32 v47, v47
v_pk_mul_f32 v[44:45], v[44:45], v[96:97]
v_pk_mul_f32 v[46:47], v[46:47], v[98:99]
v_cvt_pk_bf16_f32 v96, v44, v45
v_cvt_pk_bf16_f32 v97, v46, v47
v_pk_mul_f32 v[108:109], v[100:101], v[100:101]
v_pk_mul_f32 v[110:111], v[102:103], v[102:103]
v_pk_fma_f32 v[108:109], v[108:109], v[20:21], v[20:21] op_sel:[0,0,1] op_sel_hi:[1,0,1]
v_pk_fma_f32 v[110:111], v[110:111], v[20:21], v[20:21] op_sel:[0,0,1] op_sel_hi:[1,0,1]
v_pk_mul_f32 v[108:109], v[108:109], v[100:101]
v_pk_mul_f32 v[110:111], v[110:111], v[102:103]
v_exp_f32 v108, v108
v_exp_f32 v109, v109
v_exp_f32 v110, v110
v_exp_f32 v111, v111
v_pk_fma_f32 v[108:109], v[108:109], v[40:41], v[40:41] op_sel:[0,1,1] op_sel_hi:[1,1,1]
v_pk_fma_f32 v[110:111], v[110:111], v[40:41], v[40:41] op_sel:[0,1,1] op_sel_hi:[1,1,1]
v_rcp_f32 v108, v108
v_rcp_f32 v109, v109
v_rcp_f32 v110, v110
v_rcp_f32 v111, v111
v_pk_mul_f32 v[108:109], v[108:109], v[100:101]
v_pk_mul_f32 v[110:111], v[110:111], v[102:103]
v_cvt_pk_bf16_f32 v98, v108, v109
v_cvt_pk_bf16_f32 v99, v110, v111
s_lshl_b32 s60, s71, 8
v_xor_b32 v100, s60, v1
s_add_u32 s62, s72, 114688
buffer_store_dwordx4 v[96:99], v100, s[4:7], s62 offen offset:2048 sc1
v_mov_b32 v108, v20
v_pk_mul_f32 v[44:45], v[104:105], v[104:105]
v_pk_mul_f32 v[46:47], v[106:107], v[106:107]
v_permlane16_swap_b32 v20, v108
v_mov_b32 v108, v21
buffer_load_dwordx4 v[120:123], v1, s[4:7], s67 offen offset:2048 sc1
s_nop 0
v_permlane16_swap_b32 v21, v108
v_mov_b32 v108, v41
v_pk_fma_f32 v[44:45], v[44:45], v[20:21], v[20:21] op_sel:[0,0,1] op_sel_hi:[1,0,1]
v_pk_fma_f32 v[46:47], v[46:47], v[20:21], v[20:21] op_sel:[0,0,1] op_sel_hi:[1,0,1]
v_permlane16_swap_b32 v41, v108
v_pk_mul_f32 v[44:45], v[44:45], v[104:105]
v_pk_mul_f32 v[46:47], v[46:47], v[106:107]
v_exp_f32 v44, v44
v_exp_f32 v45, v45
v_exp_f32 v46, v46
v_exp_f32 v47, v47
v_pk_fma_f32 v[44:45], v[44:45], v[40:41], v[40:41] op_sel:[0,1,1] op_sel_hi:[1,1,1]
v_pk_fma_f32 v[46:47], v[46:47], v[40:41], v[40:41] op_sel:[0,1,1] op_sel_hi:[1,1,1]
v_rcp_f32 v44, v44
v_rcp_f32 v45, v45
v_rcp_f32 v46, v46
v_rcp_f32 v47, v47
v_pk_mul_f32 v[44:45], v[44:45], v[104:105]
v_pk_mul_f32 v[46:47], v[46:47], v[106:107]
v_cvt_pk_bf16_f32 v104, v44, v45
v_cvt_pk_bf16_f32 v105, v46, v47
v_mov_b32 v106, v104
v_mov_b32 v107, v105
buffer_load_dwordx4 v[124:127], v1, s[4:7], s67 offen offset:3072 sc1
v_permlane16_swap_b32 v104, v106
v_permlane16_swap_b32 v105, v107
s_lshl_b32 s60, s71, 8
v_xor_b32 v109, s60, v1
s_add_u32 s62, s73, 114688
s_mov_b32 exec_lo, 0xffff
s_mov_b32 exec_hi, 0xffff
buffer_store_dwordx4 v[104:107], v109, s[4:7], s62 offen sc1
s_mov_b64 exec, -1
s_add_u32 s67, s0, 0
buffer_load_dwordx4 v[128:131], v1, s[4:7], s67 offen offset:0 sc1
buffer_load_dwordx4 v[132:135], v1, s[4:7], s67 offen offset:1024 sc1
s_waitcnt vmcnt(9)
v_mfma_f32_32x32x16_bf16 v[48:63], a[0:3], v[112:115], 0
buffer_load_dwordx4 v[136:139], v1, s[4:7], s67 offen offset:2048 sc1
v_mfma_f32_32x32x16_bf16 v[64:79], a[4:7], v[112:115], 0
buffer_load_dwordx4 v[140:143], v1, s[4:7], s67 offen offset:3072 sc1
s_waitcnt vmcnt(9)
v_mfma_f32_32x32x16_bf16 v[48:63], a[8:11], v[116:119], v[48:63]
v_mfma_f32_32x32x16_bf16 v[64:79], a[12:15], v[116:119], v[64:79]
s_add_u32 s67, s1, 0
buffer_load_dwordx4 v[144:147], v1, s[4:7], s67 offen offset:0 sc1
buffer_load_dwordx4 v[148:151], v1, s[4:7], s67 offen offset:1024 sc1
buffer_load_dwordx4 v[152:155], v1, s[4:7], s67 offen offset:2048 sc1
buffer_load_dwordx4 v[156:159], v1, s[4:7], s67 offen offset:3072 sc1
s_add_u32 s67, s82, 0
buffer_load_dwordx4 v[112:115], v1, s[4:7], s67 offen offset:0 sc1
s_waitcnt vmcnt(11)
v_mfma_f32_32x32x16_bf16 v[48:63], a[16:19], v[120:123], v[48:63]
buffer_load_dwordx4 v[116:119], v1, s[4:7], s67 offen offset:1024 sc1
v_mfma_f32_32x32x16_bf16 v[64:79], a[20:23], v[120:123], v[64:79]
buffer_load_dwordx4 v[120:123], v1, s[4:7], s67 offen offset:2048 sc1
s_waitcnt vmcnt(12)
v_mfma_f32_32x32x16_bf16 v[48:63], a[24:27], v[124:127], v[48:63]
v_mfma_f32_32x32x16_bf16 v[64:79], a[28:31], v[124:127], v[64:79]
buffer_load_dwordx4 v[124:127], v1, s[4:7], s67 offen offset:3072 sc1
v_mov_b32 v108, 4
s_waitcnt vmcnt(12)
s_mov_b64 exec, 1
buffer_store_dword v108, v1, s[4:7], s45 offen sc1
s_mov_b64 exec, -1
s_waitcnt vmcnt(12)
v_mfma_f32_32x32x16_bf16 v[48:63], a[32:35], v[128:131], v[48:63]
v_mfma_f32_32x32x16_bf16 v[64:79], a[36:39], v[128:131], v[64:79]
s_add_u32 s67, s83, 0
buffer_load_dwordx4 v[128:131], v1, s[4:7], s67 offen offset:0 sc1
s_waitcnt vmcnt(12)
v_mfma_f32_32x32x16_bf16 v[48:63], a[40:43], v[132:135], v[48:63]
v_mfma_f32_32x32x16_bf16 v[64:79], a[44:47], v[132:135], v[64:79]
buffer_load_dwordx4 v[132:135], v1, s[4:7], s67 offen offset:1024 sc1
s_waitcnt vmcnt(12)
v_mfma_f32_32x32x16_bf16 v[48:63], a[48:51], v[136:139], v[48:63]
v_mfma_f32_32x32x16_bf16 v[64:79], a[52:55], v[136:139], v[64:79]
buffer_load_dwordx4 v[136:139], v1, s[4:7], s67 offen offset:2048 sc1
s_waitcnt vmcnt(12)
v_mfma_f32_32x32x16_bf16 v[48:63], a[56:59], v[140:143], v[48:63]
v_mfma_f32_32x32x16_bf16 v[64:79], a[60:63], v[140:143], v[64:79]
buffer_load_dwordx4 v[140:143], v1, s[4:7], s67 offen offset:3072 sc1
s_waitcnt vmcnt(12)
v_mfma_f32_32x32x16_bf16 v[48:63], a[64:67], v[144:147], v[48:63]
v_mfma_f32_32x32x16_bf16 v[64:79], a[68:71], v[144:147], v[64:79]
s_add_u32 s67, s44, 0
buffer_load_dwordx4 v[144:147], v1, s[4:7], s67 offen offset:0 sc1
s_waitcnt vmcnt(12)
v_mfma_f32_32x32x16_bf16 v[48:63], a[72:75], v[148:151], v[48:63]
v_mfma_f32_32x32x16_bf16 v[64:79], a[76:79], v[148:151], v[64:79]
buffer_load_dwordx4 v[148:151], v1, s[4:7], s67 offen offset:1024 sc1
s_waitcnt vmcnt(12)
v_mfma_f32_32x32x16_bf16 v[48:63], a[80:83], v[152:155], v[48:63]
v_mfma_f32_32x32x16_bf16 v[64:79], a[84:87], v[152:155], v[64:79]
buffer_load_dwordx4 v[152:155], v1, s[4:7], s67 offen offset:2048 sc1
s_waitcnt vmcnt(12)
v_mfma_f32_32x32x16_bf16 v[48:63], a[88:91], v[156:159], v[48:63]
v_mfma_f32_32x32x16_bf16 v[64:79], a[92:95], v[156:159], v[64:79]
buffer_load_dwordx4 v[156:159], v1, s[4:7], s67 offen offset:3072 sc1
s_waitcnt vmcnt(12)
v_mfma_f32_32x32x16_bf16 v[48:63], a[96:99], v[112:115], v[48:63]
v_mfma_f32_32x32x16_bf16 v[64:79], a[100:103], v[112:115], v[64:79]
s_add_u32 s67, s100, 0
buffer_load_dwordx4 v[112:115], v1, s[4:7], s67 offen offset:0 sc1
s_waitcnt vmcnt(12)
v_mfma_f32_32x32x16_bf16 v[48:63], a[104:107], v[116:119], v[48:63]
v_mfma_f32_32x32x16_bf16 v[64:79], a[108:111], v[116:119], v[64:79]
buffer_load_dwordx4 v[116:119], v1, s[4:7], s67 offen offset:1024 sc1
s_waitcnt vmcnt(12)
v_mfma_f32_32x32x16_bf16 v[48:63], a[112:115], v[120:123], v[48:63]
v_mfma_f32_32x32x16_bf16 v[64:79], a[116:119], v[120:123], v[64:79]
buffer_load_dwordx4 v[120:123], v1, s[4:7], s67 offen offset:2048 sc1
s_waitcnt vmcnt(12)
v_mfma_f32_32x32x16_bf16 v[48:63], a[120:123], v[124:127], v[48:63]
v_mfma_f32_32x32x16_bf16 v[64:79], a[124:127], v[124:127], v[64:79]
buffer_load_dwordx4 v[124:127], v1, s[4:7], s67 offen offset:3072 sc1
s_waitcnt vmcnt(11)
v_mfma_f32_32x32x16_bf16 v[48:63], a[128:131], v[128:131], v[48:63]
v_mfma_f32_32x32x16_bf16 v[64:79], a[132:135], v[128:131], v[64:79]
s_waitcnt vmcnt(10)
v_mfma_f32_32x32x16_bf16 v[48:63], a[136:139], v[132:135], v[48:63]
v_mfma_f32_32x32x16_bf16 v[64:79], a[140:143], v[132:135], v[64:79]
s_waitcnt vmcnt(9)
v_mfma_f32_32x32x16_bf16 v[48:63], a[144:147], v[136:139], v[48:63]
v_mfma_f32_32x32x16_bf16 v[64:79], a[148:151], v[136:139], v[64:79]
s_waitcnt vmcnt(8)
v_mfma_f32_32x32x16_bf16 v[48:63], a[152:155], v[140:143], v[48:63]
v_mfma_f32_32x32x16_bf16 v[64:79], a[156:159], v[140:143], v[64:79]
v_lshrrev_b32 v15, 2, v1
buffer_load_dword v15, v15, s[4:7], s37 offen sc1
s_waitcnt vmcnt(8)
v_mfma_f32_32x32x16_bf16 v[48:63], a[160:163], v[144:147], v[48:63]
s_waitcnt vmcnt(7)
v_mfma_f32_32x32x16_bf16 v[48:63], a[168:171], v[148:151], v[48:63]
s_waitcnt vmcnt(6)
v_mfma_f32_32x32x16_bf16 v[48:63], a[176:179], v[152:155], v[48:63]
s_waitcnt vmcnt(5)
v_mfma_f32_32x32x16_bf16 v[48:63], a[184:187], v[156:159], v[48:63]
v_mfma_f32_32x32x16_bf16 v[64:79], a[164:167], v[144:147], v[64:79]
s_waitcnt vmcnt(4)
v_mfma_f32_32x32x16_bf16 v[48:63], a[192:195], v[112:115], v[48:63]
v_mfma_f32_32x32x16_bf16 v[64:79], a[172:175], v[148:151], v[64:79]
s_waitcnt vmcnt(3)
v_mfma_f32_32x32x16_bf16 v[48:63], a[200:203], v[116:119], v[48:63]
v_mfma_f32_32x32x16_bf16 v[64:79], a[180:183], v[152:155], v[64:79]
v_mfma_f32_32x32x16_bf16 v[64:79], a[188:191], v[156:159], v[64:79]
s_waitcnt vmcnt(2)
v_mfma_f32_32x32x16_bf16 v[48:63], a[208:211], v[120:123], v[48:63]
v_mfma_f32_32x32x16_bf16 v[64:79], a[196:199], v[112:115], v[64:79]
s_waitcnt vmcnt(0)
v_cmp_gt_u32 vcc, 4, v15
s_nop 0
s_and_b64 vcc, vcc, s[28:29]
s_cbranch_scc1 re_103
re_103b:
s_add_u32 s67, s74, 114688
buffer_load_dwordx4 v[128:131], v1, s[4:7], s67 offen offset:0 sc1
buffer_load_dwordx4 v[132:135], v1, s[4:7], s67 offen offset:1024 sc1
v_mfma_f32_32x32x16_bf16 v[48:63], a[216:219], v[124:127], v[48:63]
buffer_load_dwordx4 v[136:139], v1, s[4:7], s67 offen offset:2048 sc1
v_mfma_f32_32x32x16_bf16 v[64:79], a[204:207], v[116:119], v[64:79]
buffer_load_dwordx4 v[140:143], v1, s[4:7], s67 offen offset:3072 sc1
s_nop 3
ds_write_b128 v10, v[48:51] offset:0
s_add_u32 s67, s0, 114688
buffer_load_dwordx4 v[144:147], v1, s[4:7], s67 offen offset:0 sc1
v_mfma_f32_32x32x16_bf16 v[64:79], a[212:215], v[120:123], v[64:79]
ds_write_b128 v11, v[52:55] offset:1024
buffer_load_dwordx4 v[148:151], v1, s[4:7], s67 offen offset:1024 sc1
v_mfma_f32_32x32x16_bf16 v[64:79], a[220:223], v[124:127], v[64:79]
ds_write_b128 v10, v[56:59] offset:2048
ds_write_b128 v11, v[60:63] offset:3072
buffer_load_dwordx4 v[152:155], v1, s[4:7], s67 offen offset:2048 sc1
s_nop 8
ds_write_b128 v10, v[64:67] offset:16384
buffer_load_dwordx4 v[156:159], v1, s[4:7], s67 offen offset:3072 sc1
ds_write_b128 v11, v[68:71] offset:17408
s_waitcnt lgkmcnt(2)
s_barrier
s_add_u32 s67, s1, 114688
buffer_load_dwordx4 v[112:115], v1, s[4:7], s67 offen offset:0 sc1
ds_read_b128 v[48:51], v12 offset:0
ds_read_b128 v[52:55], v12 offset:4096
ds_read_b128 v[56:59], v12 offset:8192
ds_read_b128 v[60:63], v12 offset:12288
ds_write_b128 v10, v[72:75] offset:18432
buffer_load_dwordx4 v[116:119], v1, s[4:7], s67 offen offset:1024 sc1
ds_write_b128 v11, v[76:79] offset:19456
s_waitcnt lgkmcnt(4)
v_pk_add_f32 v[48:49], v[48:49], v[52:53]
buffer_load_dwordx4 v[120:123], v1, s[4:7], s67 offen offset:2048 sc1
v_pk_add_f32 v[50:51], v[50:51], v[54:55]
s_waitcnt lgkmcnt(2)
v_pk_add_f32 v[56:57], v[56:57], v[60:61]
v_pk_add_f32 v[58:59], v[58:59], v[62:63]
v_pk_add_f32 v[24:25], v[24:25], v[48:49]
v_pk_add_f32 v[26:27], v[26:27], v[50:51]
v_pk_add_f32 v[24:25], v[24:25], v[56:57]
s_waitcnt vmcnt(10)
v_mfma_f32_32x32x16_bf16 v[80:95], a[0:3], v[128:131], 0
buffer_load_dwordx4 v[124:127], v1, s[4:7], s67 offen offset:3072 sc1
v_add_f32 v26, v26, v58
v_add_f32 v27, v27, v59
v_mfma_f32_32x32x16_bf16 v[96:111], a[4:7], v[128:131], 0
v_bfe_u32 v52, v1, 4, 3
v_lshlrev_b32 v52, 10, v52
v_lshrrev_b32 v53, 7, v1
s_add_u32 s67, s82, 114688
buffer_load_dwordx4 v[128:131], v1, s[4:7], s67 offen offset:0 sc1
s_waitcnt vmcnt(11)
v_mfma_f32_32x32x16_bf16 v[80:95], a[8:11], v[132:135], v[80:95]
v_lshl_add_u32 v52, v53, 4, v52
v_cvt_pk_bf16_f32 v48, v24, v25
v_cvt_pk_bf16_f32 v49, v26, v27
s_waitcnt lgkmcnt(0)
s_barrier
v_mfma_f32_32x32x16_bf16 v[96:111], a[12:15], v[132:135], v[96:111]
ds_read_b128 v[64:67], v12 offset:16384
buffer_load_dwordx4 v[132:135], v1, s[4:7], s67 offen offset:1024 sc1
s_waitcnt vmcnt(11)
v_mfma_f32_32x32x16_bf16 v[80:95], a[16:19], v[136:139], v[80:95]
ds_read_b128 v[68:71], v12 offset:20480
ds_read_b128 v[72:75], v12 offset:24576
ds_read_b128 v[76:79], v12 offset:28672
v_mfma_f32_32x32x16_bf16 v[96:111], a[20:23], v[136:139], v[96:111]
buffer_load_dwordx4 v[136:139], v1, s[4:7], s67 offen offset:2048 sc1
s_waitcnt vmcnt(11)
v_mfma_f32_32x32x16_bf16 v[80:95], a[24:27], v[140:143], v[80:95]
s_waitcnt lgkmcnt(2)
v_add_f32 v64, v64, v68
v_add_f32 v65, v65, v69
v_add_f32 v66, v66, v70
v_add_f32 v67, v67, v71
v_mfma_f32_32x32x16_bf16 v[96:111], a[28:31], v[140:143], v[96:111]
buffer_load_dwordx4 v[140:143], v1, s[4:7], s67 offen offset:3072 sc1
s_waitcnt lgkmcnt(0)
v_add_f32 v72, v72, v76
v_add_f32 v73, v73, v77
s_waitcnt vmcnt(11)
v_mfma_f32_32x32x16_bf16 v[80:95], a[32:35], v[144:147], v[80:95]
v_add_f32 v74, v74, v78
v_add_f32 v75, v75, v79
v_add_f32 v28, v28, v64
v_add_f32 v29, v29, v65
v_add_f32 v30, v30, v66
v_add_f32 v31, v31, v67
v_mfma_f32_32x32x16_bf16 v[96:111], a[36:39], v[144:147], v[96:111]
s_add_u32 s67, s83, 114688
buffer_load_dwordx4 v[144:147], v1, s[4:7], s67 offen offset:0 sc1
v_add_f32 v28, v28, v72
v_add_f32 v29, v29, v73
s_waitcnt vmcnt(11)
v_mfma_f32_32x32x16_bf16 v[80:95], a[40:43], v[148:151], v[80:95]
v_add_f32 v30, v30, v74
v_add_f32 v31, v31, v75
v_cvt_pk_bf16_f32 v50, v28, v29
v_cvt_pk_bf16_f32 v51, v30, v31
s_add_u32 s62, s35, 0
buffer_store_dwordx4 v[48:51], v52, s[8:11], s62 offen nt
v_mfma_f32_32x32x16_bf16 v[96:111], a[44:47], v[148:151], v[96:111]
s_waitcnt vmcnt(11)
v_mfma_f32_32x32x16_bf16 v[80:95], a[48:51], v[152:155], v[80:95]
buffer_load_dwordx4 v[148:151], v1, s[4:7], s67 offen offset:1024 sc1
v_mfma_f32_32x32x16_bf16 v[96:111], a[52:55], v[152:155], v[96:111]
s_waitcnt vmcnt(11)
v_mfma_f32_32x32x16_bf16 v[80:95], a[56:59], v[156:159], v[80:95]
buffer_load_dwordx4 v[152:155], v1, s[4:7], s67 offen offset:2048 sc1
v_mfma_f32_32x32x16_bf16 v[96:111], a[60:63], v[156:159], v[96:111]
s_waitcnt vmcnt(11)
v_mfma_f32_32x32x16_bf16 v[80:95], a[64:67], v[112:115], v[80:95]
buffer_load_dwordx4 v[156:159], v1, s[4:7], s67 offen offset:3072 sc1
v_mfma_f32_32x32x16_bf16 v[96:111], a[68:71], v[112:115], v[96:111]
s_waitcnt vmcnt(11)
v_mfma_f32_32x32x16_bf16 v[80:95], a[72:75], v[116:119], v[80:95]
s_add_u32 s67, s44, 114688
buffer_load_dwordx4 v[112:115], v1, s[4:7], s67 offen offset:0 sc1
v_mfma_f32_32x32x16_bf16 v[96:111], a[76:79], v[116:119], v[96:111]
s_waitcnt vmcnt(11)
v_mfma_f32_32x32x16_bf16 v[80:95], a[80:83], v[120:123], v[80:95]
buffer_load_dwordx4 v[116:119], v1, s[4:7], s67 offen offset:1024 sc1
v_mfma_f32_32x32x16_bf16 v[96:111], a[84:87], v[120:123], v[96:111]
s_waitcnt vmcnt(11)
v_mfma_f32_32x32x16_bf16 v[80:95], a[88:91], v[124:127], v[80:95]
buffer_load_dwordx4 v[120:123], v1, s[4:7], s67 offen offset:2048 sc1
v_mfma_f32_32x32x16_bf16 v[96:111], a[92:95], v[124:127], v[96:111]
s_waitcnt vmcnt(11)
v_mfma_f32_32x32x16_bf16 v[80:95], a[96:99], v[128:131], v[80:95]
buffer_load_dwordx4 v[124:127], v1, s[4:7], s67 offen offset:3072 sc1
v_mfma_f32_32x32x16_bf16 v[96:111], a[100:103], v[128:131], v[96:111]
s_waitcnt vmcnt(11)
v_mfma_f32_32x32x16_bf16 v[80:95], a[104:107], v[132:135], v[80:95]
s_add_u32 s67, s100, 114688
buffer_load_dwordx4 v[128:131], v1, s[4:7], s67 offen offset:0 sc1
v_mfma_f32_32x32x16_bf16 v[96:111], a[108:111], v[132:135], v[96:111]
s_waitcnt vmcnt(11)
v_mfma_f32_32x32x16_bf16 v[80:95], a[112:115], v[136:139], v[80:95]
buffer_load_dwordx4 v[132:135], v1, s[4:7], s67 offen offset:1024 sc1
v_mfma_f32_32x32x16_bf16 v[96:111], a[116:119], v[136:139], v[96:111]
s_waitcnt vmcnt(11)
v_mfma_f32_32x32x16_bf16 v[80:95], a[120:123], v[140:143], v[80:95]
buffer_load_dwordx4 v[136:139], v1, s[4:7], s67 offen offset:2048 sc1
v_mfma_f32_32x32x16_bf16 v[96:111], a[124:127], v[140:143], v[96:111]
s_waitcnt vmcnt(11)
v_mfma_f32_32x32x16_bf16 v[80:95], a[128:131], v[144:147], v[80:95]
buffer_load_dwordx4 v[140:143], v1, s[4:7], s67 offen offset:3072 sc1
v_mfma_f32_32x32x16_bf16 v[96:111], a[132:135], v[144:147], v[96:111]
s_waitcnt vmcnt(10)
v_mfma_f32_32x32x16_bf16 v[80:95], a[136:139], v[148:151], v[80:95]
v_mfma_f32_32x32x16_bf16 v[96:111], a[140:143], v[148:151], v[96:111]
s_waitcnt vmcnt(9)
v_mfma_f32_32x32x16_bf16 v[80:95], a[144:147], v[152:155], v[80:95]
v_mfma_f32_32x32x16_bf16 v[96:111], a[148:151], v[152:155], v[96:111]
s_waitcnt vmcnt(8)
v_mfma_f32_32x32x16_bf16 v[80:95], a[152:155], v[156:159], v[80:95]
v_mfma_f32_32x32x16_bf16 v[96:111], a[156:159], v[156:159], v[96:111]
s_waitcnt vmcnt(7)
v_mfma_f32_32x32x16_bf16 v[80:95], a[160:163], v[112:115], v[80:95]
v_mfma_f32_32x32x16_bf16 v[96:111], a[164:167], v[112:115], v[96:111]
s_waitcnt vmcnt(6)
v_mfma_f32_32x32x16_bf16 v[80:95], a[168:171], v[116:119], v[80:95]
v_mfma_f32_32x32x16_bf16 v[96:111], a[172:175], v[116:119], v[96:111]
s_waitcnt vmcnt(5)
v_mfma_f32_32x32x16_bf16 v[80:95], a[176:179], v[120:123], v[80:95]
v_mfma_f32_32x32x16_bf16 v[96:111], a[180:183], v[120:123], v[96:111]
s_waitcnt vmcnt(4)
v_mfma_f32_32x32x16_bf16 v[80:95], a[184:187], v[124:127], v[80:95]
v_mfma_f32_32x32x16_bf16 v[96:111], a[188:191], v[124:127], v[96:111]
s_waitcnt vmcnt(3)
v_mfma_f32_32x32x16_bf16 v[80:95], a[192:195], v[128:131], v[80:95]
v_mfma_f32_32x32x16_bf16 v[96:111], a[196:199], v[128:131], v[96:111]
s_waitcnt vmcnt(2)
v_mfma_f32_32x32x16_bf16 v[80:95], a[200:203], v[132:135], v[80:95]
v_mfma_f32_32x32x16_bf16 v[96:111], a[204:207], v[132:135], v[96:111]
s_waitcnt vmcnt(1)
v_mfma_f32_32x32x16_bf16 v[80:95], a[208:211], v[136:139], v[80:95]
v_mfma_f32_32x32x16_bf16 v[96:111], a[212:215], v[136:139], v[96:111]
s_waitcnt vmcnt(0)
v_mfma_f32_32x32x16_bf16 v[80:95], a[216:219], v[140:143], v[80:95]
v_mfma_f32_32x32x16_bf16 v[96:111], a[220:223], v[140:143], v[96:111]
s_nop 4
ds_write_b128 v10, v[80:83] offset:0
ds_write_b128 v11, v[84:87] offset:1024
ds_write_b128 v10, v[88:91] offset:2048
ds_write_b128 v11, v[92:95] offset:3072
s_waitcnt lgkmcnt(0)
s_barrier
s_nop 0
ds_write_b128 v10, v[96:99] offset:16384
ds_write_b128 v11, v[100:103] offset:17408
ds_read_b128 v[80:83], v12 offset:0
ds_read_b128 v[84:87], v12 offset:4096
ds_read_b128 v[88:91], v12 offset:8192
ds_read_b128 v[92:95], v12 offset:12288
ds_write_b128 v10, v[104:107] offset:18432
ds_write_b128 v11, v[108:111] offset:19456
s_waitcnt lgkmcnt(4)
v_pk_add_f32 v[80:81], v[80:81], v[84:85]
v_pk_add_f32 v[82:83], v[82:83], v[86:87]
s_waitcnt lgkmcnt(2)
v_pk_add_f32 v[88:89], v[88:89], v[92:93]
v_pk_add_f32 v[90:91], v[90:91], v[94:95]
v_pk_add_f32 v[32:33], v[32:33], v[80:81]
v_pk_add_f32 v[34:35], v[34:35], v[82:83]
v_pk_add_f32 v[32:33], v[32:33], v[88:89]
v_pk_add_f32 v[34:35], v[34:35], v[90:91]
s_waitcnt lgkmcnt(0)
s_barrier
ds_read_b128 v[96:99], v12 offset:16384
ds_read_b128 v[100:103], v12 offset:20480
ds_read_b128 v[104:107], v12 offset:24576
ds_read_b128 v[108:111], v12 offset:28672
v_bfe_u32 v84, v1, 4, 3
v_lshlrev_b32 v84, 10, v84
v_lshrrev_b32 v85, 7, v1
v_lshl_add_u32 v84, v85, 4, v84
v_cvt_pk_bf16_f32 v80, v32, v33
v_cvt_pk_bf16_f32 v81, v34, v35
s_waitcnt lgkmcnt(2)
v_pk_add_f32 v[96:97], v[96:97], v[100:101]
v_pk_add_f32 v[98:99], v[98:99], v[102:103]
v_pk_add_f32 v[36:37], v[36:37], v[96:97]
v_pk_add_f32 v[38:39], v[38:39], v[98:99]
s_waitcnt lgkmcnt(0)
v_pk_add_f32 v[104:105], v[104:105], v[108:109]
v_pk_add_f32 v[106:107], v[106:107], v[110:111]
v_pk_add_f32 v[36:37], v[36:37], v[104:105]
v_pk_add_f32 v[38:39], v[38:39], v[106:107]
v_cvt_pk_bf16_f32 v82, v36, v37
v_cvt_pk_bf16_f32 v83, v38, v39
s_add_u32 s62, s35, 1048576
buffer_store_dwordx4 v[80:83], v84, s[8:11], s62 offen nt
end_1:
s_endpgm
ann_8:
s_mov_b32 s61, 0
ann_8l:
s_cmp_lg_u32 s60, 0
s_cbranch_scc1 ann_8d
s_cmp_gt_u32 s61, 200000
s_cbranch_scc1 ann_8d
s_add_u32 s61, s61, 1
s_and_b32 s60, s61, 7
s_cselect_b32 s60, 0, 128
v_add_u32 v148, s60, v86
global_load_dword v148, v148, s[92:93] sc1
s_waitcnt vmcnt(0)
v_readfirstlane_b32 s60, v148
s_branch ann_8l
ann_8d:
s_cmp_eq_u32 s60, s98
s_cbranch_scc1 annx_9
s_mov_b64 exec, 1
global_store_dword v86, v195, s[92:93] offset:192 sc1
s_mov_b64 exec, -1
s_mov_b32 s17, 0
s_add_u32 s3, s3, 1024
s_add_u32 s37, s37, 1024
s_add_u32 s45, s45, 1024
s_add_u32 s69, s69, 1024
s_add_u32 s67, s67, 655360
s_add_u32 s76, s76, 655360
s_add_u32 s68, s68, 655360
buffer_store_dwordx4 v[152:155], v57, s[4:7], s76 offen sc1
buffer_store_dwordx4 v[156:159], v57, s[4:7], s68 offen sc1
s_waitcnt vmcnt(0)
s_mov_b64 exec, 1
buffer_store_dword v195, v194, s[4:7], s69 offen sc1
s_mov_b64 exec, -1
s_waitcnt vmcnt(0)
s_branch annx_9b
uslow_12:
global_load_dword v148, v86, s[92:93] offset:192 sc1
s_waitcnt vmcnt(0)
v_readfirstlane_b32 s60, v148
s_nop 0
s_cmp_eq_u32 s60, 0
s_cbranch_scc1 upoll_10b
s_mov_b32 s17, 0
s_add_u32 s3, s3, 1024
s_add_u32 s37, s37, 1024
s_add_u32 s45, s45, 1024
s_add_u32 s69, s69, 1024
s_add_u32 s67, s67, 655360
s_add_u32 s76, s76, 655360
s_add_u32 s68, s68, 655360
buffer_store_dwordx4 v[152:155], v57, s[4:7], s76 offen sc1
buffer_store_dwordx4 v[156:159], v57, s[4:7], s68 offen sc1
s_waitcnt vmcnt(0)
s_mov_b64 exec, 1
buffer_store_dword v195, v194, s[4:7], s69 offen sc1
s_mov_b64 exec, -1
s_waitcnt vmcnt(0)
s_branch upoll_10b
re_16:
s_mov_b32 s61, 0
re_16l:
v_bfe_u32 v18, v1, 4, 3
v_lshlrev_b32 v18, 7, v18
buffer_load_dword v18, v18, s[4:7], s101 offen offset:2048 sc1
s_add_u32 s61, s61, 1
s_waitcnt vmcnt(0)
v_cmp_eq_u32 vcc, 0, v18
s_cbranch_vccz re_16x
s_cmp_gt_u32 s61, 200000
s_cbranch_scc0 re_16l
re_16x:
s_branch re_16b
re_17:
s_mov_b32 s61, 0
re_17l:
s_add_u32 s62, s43, 540672
buffer_load_dwordx2 v[56:57], v7, s[4:7], s62 offen offset:0 sc1
s_add_u32 s62, s43, 540672
buffer_load_dwordx2 v[48:49], v7, s[4:7], s62 offen offset:2048 sc1
s_add_u32 s61, s61, 1
s_waitcnt vmcnt(0)
v_max3_u32 v58, v56, v57, v48
v_max_u32 v58, v58, v49
v_cmp_eq_u32 vcc, -1, v58
s_cbranch_vccz re_17x
s_cmp_gt_u32 s61, 200000
s_cbranch_scc0 re_17l
re_17x:
s_branch re_17b
re_18:
s_mov_b32 s61, 0
re_18l:
s_add_u32 s60, s34, 1835008
buffer_load_dwordx4 v[60:63], v1, s[4:7], s60 offen sc1
s_add_u32 s61, s61, 1
s_waitcnt vmcnt(0)
v_cmp_eq_u32 vcc, -1, v60
s_cbranch_vccz re_18x
s_cmp_gt_u32 s61, 200000
s_cbranch_scc0 re_18l
re_18x:
s_branch re_18b
re_19:
s_mov_b32 s61, 0
re_19l:
s_add_u32 s60, s34, 1867776
buffer_load_dwordx4 v[108:111], v1, s[4:7], s60 offen sc1
s_add_u32 s61, s61, 1
s_waitcnt vmcnt(0)
v_cmp_eq_u32 vcc, -1, v108
s_cbranch_vccz re_19x
s_cmp_gt_u32 s61, 200000
s_cbranch_scc0 re_19l
re_19x:
s_branch re_19b
re_20:
s_mov_b32 s61, 0
re_20l:
s_add_u32 m0, s23, 16384
s_xor_b32 s38, s47, 393216
buffer_load_dwordx4 v1, s[4:7], s38 offen offset:0 sc1 lds
buffer_load_dwordx4 v1, s[4:7], s38 offen offset:1024 sc1 lds
s_waitcnt vmcnt(0)
ds_read2st64_b32 v[72:73], v0 offset0:64 offset1:68
s_add_u32 s61, s61, 1
s_waitcnt vmcnt(0)
s_waitcnt lgkmcnt(0)
v_max_u32 v72, v72, v73
v_cmp_eq_u32 vcc, -1, v72
s_cbranch_vccz re_20x
s_cmp_gt_u32 s61, 200000
s_cbranch_scc0 re_20l
re_20x:
s_branch re_20b
re_21:
s_mov_b32 s61, 0
re_21l:
s_add_u32 m0, s23, 24576
s_xor_b32 s38, s47, 401408
buffer_load_dwordx4 v1, s[4:7], s38 offen offset:0 sc1 lds
buffer_load_dwordx4 v1, s[4:7], s38 offen offset:1024 sc1 lds
s_add_u32 m0, s23, 0
s_xor_b32 s38, s47, 409600
buffer_load_dwordx4 v1, s[4:7], s38 offen offset:0 sc1 lds
buffer_load_dwordx4 v1, s[4:7], s38 offen offset:1024 sc1 lds
s_waitcnt vmcnt(0)
ds_read2st64_b32 v[72:73], v0 offset0:96 offset1:100
ds_read2st64_b32 v[74:75], v0 offset0:0 offset1:4
s_add_u32 s61, s61, 1
s_waitcnt vmcnt(0)
s_waitcnt lgkmcnt(0)
v_max3_u32 v72, v72, v73, v74
v_max_u32 v72, v72, v75
v_cmp_eq_u32 vcc, -1, v72
s_cbranch_vccz re_21x
s_cmp_gt_u32 s61, 200000
s_cbranch_scc0 re_21l
re_21x:
s_branch re_21b
re_22:
s_mov_b32 s61, 0
re_22l:
s_add_u32 m0, s23, 8192
s_xor_b32 s38, s47, 417792
buffer_load_dwordx4 v1, s[4:7], s38 offen offset:0 sc1 lds
buffer_load_dwordx4 v1, s[4:7], s38 offen offset:1024 sc1 lds
s_waitcnt vmcnt(0)
ds_read2st64_b32 v[72:73], v0 offset0:32 offset1:36
s_add_u32 s61, s61, 1
s_waitcnt vmcnt(0)
s_waitcnt lgkmcnt(0)
v_max_u32 v72, v72, v73
v_cmp_eq_u32 vcc, -1, v72
s_cbranch_vccz re_22x
s_cmp_gt_u32 s61, 200000
s_cbranch_scc0 re_22l
re_22x:
s_branch re_22b
re_23:
s_mov_b32 s61, 0
re_23l:
s_add_u32 s62, s43, 524288
buffer_load_dwordx4 v[56:59], v1, s[4:7], s62 offen offset:0 sc1
buffer_load_dwordx4 v[60:63], v1, s[4:7], s62 offen offset:1024 sc1
s_waitcnt vmcnt(0)
v_add_f32 v56, v56, v60
v_add_f32 v57, v57, v61
v_add_f32 v58, v58, v62
v_add_f32 v59, v59, v63
v_add_f32 v56, v56, v58
v_add_f32 v57, v57, v59
s_nop 1
v_permlane32_swap_b32 v56, v57
v_add_f32 v56, v56, v57
s_add_u32 s61, s61, 1
s_waitcnt vmcnt(0)
v_cmp_u_f32 vcc, v56, v56
s_cbranch_vccz re_23x
s_cmp_gt_u32 s61, 200000
s_cbranch_scc0 re_23l
re_23x:
s_branch re_23b
sh_24:
buffer_store_dwordx4 v[64:67], v5, s[4:7], s32 offen offset:0 sc1
s_branch sh_24b
re_25:
s_mov_b32 s61, 0
re_25l:
s_add_u32 m0, s23, 32768
s_xor_b32 s38, s47, 425984
buffer_load_dwordx4 v1, s[4:7], s38 offen offset:0 sc1 lds
buffer_load_dwordx4 v1, s[4:7], s38 offen offset:1024 sc1 lds
s_waitcnt vmcnt(0)
ds_read2st64_b32 v[104:105], v0 offset0:128 offset1:132
s_add_u32 s61, s61, 1
s_waitcnt vmcnt(0)
s_waitcnt lgkmcnt(0)
v_max_u32 v104, v104, v105
v_cmp_eq_u32 vcc, -1, v104
s_cbranch_vccz re_25x
s_cmp_gt_u32 s61, 200000
s_cbranch_scc0 re_25l
re_25x:
s_branch re_25b
re_26:
s_mov_b32 s61, 0
re_26l:
s_add_u32 m0, s23, 16384
s_xor_b32 s38, s47, 434176
buffer_load_dwordx4 v1, s[4:7], s38 offen offset:0 sc1 lds
buffer_load_dwordx4 v1, s[4:7], s38 offen offset:1024 sc1 lds
s_add_u32 m0, s23, 24576
s_xor_b32 s38, s47, 442368
buffer_load_dwordx4 v1, s[4:7], s38 offen offset:0 sc1 lds
buffer_load_dwordx4 v1, s[4:7], s38 offen offset:1024 sc1 lds
s_waitcnt vmcnt(0)
ds_read2st64_b32 v[104:105], v0 offset0:64 offset1:68
ds_read2st64_b32 v[106:107], v0 offset0:96 offset1:100
s_add_u32 s61, s61, 1
s_waitcnt vmcnt(0)
s_waitcnt lgkmcnt(0)
v_max3_u32 v104, v104, v105, v106
v_max_u32 v104, v104, v107
v_cmp_eq_u32 vcc, -1, v104
s_cbranch_vccz re_26x
s_cmp_gt_u32 s61, 200000
s_cbranch_scc0 re_26l
re_26x:
s_branch re_26b
re_27:
s_mov_b32 s61, 0
re_27l:
s_add_u32 m0, s23, 0
s_xor_b32 s38, s47, 450560
buffer_load_dwordx4 v1, s[4:7], s38 offen offset:0 sc1 lds
buffer_load_dwordx4 v1, s[4:7], s38 offen offset:1024 sc1 lds
s_waitcnt vmcnt(0)
ds_read2st64_b32 v[104:105], v0 offset0:0 offset1:4
s_add_u32 s61, s61, 1
s_waitcnt vmcnt(0)
s_waitcnt lgkmcnt(0)
v_max_u32 v104, v104, v105
v_cmp_eq_u32 vcc, -1, v104
s_cbranch_vccz re_27x
s_cmp_gt_u32 s61, 200000
s_cbranch_scc0 re_27l
re_27x:
s_branch re_27b
re_28:
s_mov_b32 s61, 0
re_28l:
s_add_u32 s62, s43, 524288
buffer_load_dwordx4 v[88:91], v1, s[4:7], s62 offen offset:2048 sc1
buffer_load_dwordx4 v[92:95], v1, s[4:7], s62 offen offset:3072 sc1
s_waitcnt vmcnt(0)
v_add_f32 v88, v88, v92
v_add_f32 v89, v89, v93
v_add_f32 v90, v90, v94
v_add_f32 v91, v91, v95
v_add_f32 v88, v88, v90
v_add_f32 v89, v89, v91
s_nop 1
v_permlane32_swap_b32 v88, v89
v_add_f32 v88, v88, v89
s_add_u32 s61, s61, 1
s_waitcnt vmcnt(0)
v_cmp_u_f32 vcc, v88, v88
s_cbranch_vccz re_28x
s_cmp_gt_u32 s61, 200000
s_cbranch_scc0 re_28l
re_28x:
s_branch re_28b
sh_29:
buffer_store_dwordx4 v[96:99], v5, s[4:7], s33 offen offset:0 sc1
s_branch sh_29b
re_30:
s_mov_b32 s61, 0
re_30l:
s_add_u32 m0, s23, 8192
s_xor_b32 s38, s22, 139264
buffer_load_dwordx4 v1, s[4:7], s38 offen offset:0 sc1 lds
buffer_load_dwordx4 v1, s[4:7], s38 offen offset:1024 sc1 lds
s_add_u32 m0, s23, 32768
s_xor_b32 s38, s22, 155648
buffer_load_dwordx4 v1, s[4:7], s38 offen offset:0 sc1 lds
buffer_load_dwordx4 v1, s[4:7], s38 offen offset:1024 sc1 lds
s_waitcnt vmcnt(0)
ds_read2st64_b32 v[56:57], v0 offset0:32 offset1:36
ds_read2st64_b32 v[58:59], v0 offset0:128 offset1:132
s_add_u32 s61, s61, 1
s_waitcnt vmcnt(0)
s_waitcnt lgkmcnt(0)
v_max3_u32 v56, v56, v57, v58
v_max_u32 v56, v56, v59
v_cmp_eq_u32 vcc, -1, v56
s_cbranch_vccz re_30x
s_cmp_gt_u32 s61, 200000
s_cbranch_scc0 re_30l
re_30x:
s_branch re_30b
re_32:
s_mov_b32 s61, 0
re_32l:
v_cndmask_b32 v44, v1, v6, s[92:93]
s_add_u32 m0, s23, 16384
s_xor_b32 s38, s22, 131072
buffer_load_dwordx4 v44, s[4:7], s38 offen offset:0 sc1 lds
buffer_load_dwordx4 v44, s[4:7], s38 offen offset:1024 sc1 lds
s_add_u32 m0, s23, 24576
s_xor_b32 s38, s22, 147456
buffer_load_dwordx4 v6, s[4:7], s38 offen offset:0 sc1 lds
buffer_load_dwordx4 v6, s[4:7], s38 offen offset:1024 sc1 lds
s_waitcnt vmcnt(0)
ds_read2st64_b32 v[56:57], v0 offset0:64 offset1:68
ds_read2st64_b32 v[58:59], v0 offset0:96 offset1:100
s_add_u32 s61, s61, 1
s_waitcnt vmcnt(0)
s_waitcnt lgkmcnt(0)
v_max3_u32 v56, v56, v57, v58
v_max_u32 v56, v56, v59
v_cmp_eq_u32 vcc, -1, v56
s_cbranch_vccz re_32x
s_cmp_gt_u32 s61, 200000
s_cbranch_scc0 re_32l
re_32x:
s_branch re_32b
re_33:
s_mov_b32 s61, 0
re_33l:
s_add_u32 m0, s23, 0
s_xor_b32 s38, s22, 172032
buffer_load_dwordx4 v1, s[4:7], s38 offen offset:0 sc1 lds
buffer_load_dwordx4 v1, s[4:7], s38 offen offset:1024 sc1 lds
s_waitcnt vmcnt(0)
ds_read2st64_b32 v[20:21], v0 offset0:0 offset1:4
s_add_u32 s61, s61, 1
s_waitcnt vmcnt(0)
s_waitcnt lgkmcnt(0)
v_max_u32 v20, v20, v21
v_cmp_eq_u32 vcc, -1, v20
s_cbranch_vccz re_33x
s_cmp_gt_u32 s61, 200000
s_cbranch_scc0 re_33l
re_33x:
s_branch re_33b
re_34:
s_mov_b32 s61, 0
re_34l:
s_add_u32 m0, s23, 8192
s_xor_b32 s38, s22, 188416
buffer_load_dwordx4 v1, s[4:7], s38 offen offset:0 sc1 lds
buffer_load_dwordx4 v1, s[4:7], s38 offen offset:1024 sc1 lds
s_waitcnt vmcnt(0)
ds_read2st64_b32 v[20:21], v0 offset0:32 offset1:36
s_add_u32 s61, s61, 1
s_waitcnt vmcnt(0)
s_waitcnt lgkmcnt(0)
v_max_u32 v20, v20, v21
v_cmp_eq_u32 vcc, -1, v20
s_cbranch_vccz re_34x
s_cmp_gt_u32 s61, 200000
s_cbranch_scc0 re_34l
re_34x:
s_branch re_34b
re_35:
s_mov_b32 s61, 0
re_35l:
v_cndmask_b32 v44, v1, v6, s[92:93]
s_add_u32 m0, s23, 32768
s_xor_b32 s38, s22, 163840
buffer_load_dwordx4 v44, s[4:7], s38 offen offset:0 sc1 lds
buffer_load_dwordx4 v44, s[4:7], s38 offen offset:1024 sc1 lds
s_add_u32 m0, s23, 16384
s_xor_b32 s38, s22, 180224
buffer_load_dwordx4 v6, s[4:7], s38 offen offset:0 sc1 lds
buffer_load_dwordx4 v6, s[4:7], s38 offen offset:1024 sc1 lds
s_waitcnt vmcnt(0)
ds_read2st64_b32 v[20:21], v0 offset0:128 offset1:132
ds_read2st64_b32 v[46:47], v0 offset0:64 offset1:68
s_add_u32 s61, s61, 1
s_waitcnt vmcnt(0)
s_waitcnt lgkmcnt(0)
v_max3_u32 v20, v20, v21, v46
v_max_u32 v20, v20, v47
v_cmp_eq_u32 vcc, -1, v20
s_cbranch_vccz re_35x
s_cmp_gt_u32 s61, 200000
s_cbranch_scc0 re_35l
re_35x:
s_branch re_35b
re_36:
s_mov_b32 s61, 0
re_36l:
s_lshl_b32 s60, s71, 8
v_xor_b32 v112, s60, v1
s_add_u32 s62, s51, 532480
buffer_load_dwordx4 v[116:119], v112, s[4:7], s62 offen offset:1024 sc1
buffer_load_dwordx4 v[112:115], v112, s[4:7], s62 offen offset:0 sc1
s_waitcnt vmcnt(0)
v_add_f32 v112, v112, v116
v_add_f32 v113, v113, v117
v_add_f32 v114, v114, v118
v_add_f32 v115, v115, v119
v_add_f32 v112, v112, v114
v_add_f32 v113, v113, v115
s_nop 1
v_permlane32_swap_b32 v112, v113
v_add_f32 v112, v112, v113
s_add_u32 s61, s61, 1
s_waitcnt vmcnt(0)
v_cmp_u_f32 vcc, v112, v112
s_cbranch_vccz re_36x
s_cmp_gt_u32 s61, 200000
s_cbranch_scc0 re_36l
re_36x:
s_branch re_36b
re_37:
s_mov_b32 s61, 0
re_37l:
s_lshl_b32 s60, s71, 8
v_xor_b32 v128, s60, v1
s_add_u32 s62, s51, 532480
buffer_load_dwordx4 v[132:135], v128, s[4:7], s62 offen offset:3072 sc1
buffer_load_dwordx4 v[128:131], v128, s[4:7], s62 offen offset:2048 sc1
s_waitcnt vmcnt(0)
v_add_f32 v128, v128, v132
v_add_f32 v129, v129, v133
v_add_f32 v130, v130, v134
v_add_f32 v131, v131, v135
v_add_f32 v128, v128, v130
v_add_f32 v129, v129, v131
s_nop 1
v_permlane32_swap_b32 v128, v129
v_add_f32 v128, v128, v129
s_add_u32 s61, s61, 1
s_waitcnt vmcnt(0)
v_cmp_u_f32 vcc, v128, v128
s_cbranch_vccz re_37x
s_cmp_gt_u32 s61, 200000
s_cbranch_scc0 re_37l
re_37x:
s_branch re_37b
re_38:
s_mov_b32 s61, 0
re_38l:
v_lshrrev_b32 v15, 2, v1
buffer_load_dword v15, v15, s[4:7], s37 offen sc1
s_add_u32 s61, s61, 1
s_waitcnt vmcnt(0)
v_cmp_gt_u32 vcc, 1, v15
s_nop 0
s_and_b64 vcc, vcc, s[28:29]
s_cbranch_scc0 re_38x
s_cmp_gt_u32 s61, 200000
s_cbranch_scc0 re_38l
re_38x:
s_branch re_38b
re_39:
s_mov_b32 s61, 0
re_39l:
v_lshrrev_b32 v15, 2, v1
buffer_load_dword v15, v15, s[4:7], s37 offen sc1
s_add_u32 s61, s61, 1
s_waitcnt vmcnt(0)
v_cmp_gt_u32 vcc, 2, v15
s_nop 0
s_and_b64 vcc, vcc, -1
s_cbranch_scc0 re_39x
s_cmp_gt_u32 s61, 200000
s_cbranch_scc0 re_39l
re_39x:
s_branch re_39b
re_40:
s_mov_b32 s61, 0
re_40l:
s_add_u32 s62, s43, 565248
buffer_load_dwordx2 v[52:53], v7, s[4:7], s62 offen offset:0 sc1
s_add_u32 s61, s61, 1
s_waitcnt vmcnt(0)
v_max_u32 v54, v52, v53
v_cmp_eq_u32 vcc, -1, v54
s_cbranch_vccz re_40x
s_cmp_gt_u32 s61, 200000
s_cbranch_scc0 re_40l
re_40x:
s_branch re_40b
re_41:
s_mov_b32 s61, 0
re_41l:
s_add_u32 s62, s43, 565248
buffer_load_dwordx2 v[84:85], v7, s[4:7], s62 offen offset:2048 sc1
s_add_u32 s61, s61, 1
s_waitcnt vmcnt(0)
v_max_u32 v86, v84, v85
v_cmp_eq_u32 vcc, -1, v86
s_cbranch_vccz re_41x
s_cmp_gt_u32 s61, 200000
s_cbranch_scc0 re_41l
re_41x:
s_branch re_41b
re_42:
s_mov_b32 s61, 0
re_42l:
s_add_u32 m0, s23, 32768
s_xor_b32 s38, s47, 393216
buffer_load_dwordx4 v1, s[4:7], s38 offen offset:0 sc1 lds
buffer_load_dwordx4 v1, s[4:7], s38 offen offset:1024 sc1 lds
s_waitcnt vmcnt(0)
ds_read2st64_b32 v[72:73], v0 offset0:128 offset1:132
s_add_u32 s61, s61, 1
s_waitcnt vmcnt(0)
s_waitcnt lgkmcnt(0)
v_max_u32 v72, v72, v73
v_cmp_eq_u32 vcc, -1, v72
s_cbranch_vccz re_42x
s_cmp_gt_u32 s61, 200000
s_cbranch_scc0 re_42l
re_42x:
s_branch re_42b
re_43:
s_mov_b32 s61, 0
re_43l:
s_add_u32 m0, s23, 0
s_xor_b32 s38, s47, 401408
buffer_load_dwordx4 v1, s[4:7], s38 offen offset:0 sc1 lds
buffer_load_dwordx4 v1, s[4:7], s38 offen offset:1024 sc1 lds
s_add_u32 m0, s23, 8192
s_xor_b32 s38, s47, 409600
buffer_load_dwordx4 v1, s[4:7], s38 offen offset:0 sc1 lds
buffer_load_dwordx4 v1, s[4:7], s38 offen offset:1024 sc1 lds
s_waitcnt vmcnt(0)
ds_read2st64_b32 v[72:73], v0 offset0:0 offset1:4
ds_read2st64_b32 v[74:75], v0 offset0:32 offset1:36
s_add_u32 s61, s61, 1
s_waitcnt vmcnt(0)
s_waitcnt lgkmcnt(0)
v_max3_u32 v72, v72, v73, v74
v_max_u32 v72, v72, v75
v_cmp_eq_u32 vcc, -1, v72
s_cbranch_vccz re_43x
s_cmp_gt_u32 s61, 200000
s_cbranch_scc0 re_43l
re_43x:
s_branch re_43b
re_44:
s_mov_b32 s61, 0
re_44l:
s_add_u32 m0, s23, 16384
s_xor_b32 s38, s47, 417792
buffer_load_dwordx4 v1, s[4:7], s38 offen offset:0 sc1 lds
buffer_load_dwordx4 v1, s[4:7], s38 offen offset:1024 sc1 lds
s_waitcnt vmcnt(0)
ds_read2st64_b32 v[72:73], v0 offset0:64 offset1:68
s_add_u32 s61, s61, 1
s_waitcnt vmcnt(0)
s_waitcnt lgkmcnt(0)
v_max_u32 v72, v72, v73
v_cmp_eq_u32 vcc, -1, v72
s_cbranch_vccz re_44x
s_cmp_gt_u32 s61, 200000
s_cbranch_scc0 re_44l
re_44x:
s_branch re_44b
re_45:
s_mov_b32 s61, 0
re_45l:
s_add_u32 s62, s43, 548864
buffer_load_dwordx4 v[56:59], v1, s[4:7], s62 offen offset:0 sc1
buffer_load_dwordx4 v[60:63], v1, s[4:7], s62 offen offset:1024 sc1
s_waitcnt vmcnt(0)
v_add_f32 v56, v56, v60
v_add_f32 v57, v57, v61
v_add_f32 v58, v58, v62
v_add_f32 v59, v59, v63
v_add_f32 v56, v56, v58
v_add_f32 v57, v57, v59
s_nop 1
v_permlane32_swap_b32 v56, v57
v_add_f32 v56, v56, v57
s_add_u32 s61, s61, 1
s_waitcnt vmcnt(0)
v_cmp_u_f32 vcc, v56, v56
s_cbranch_vccz re_45x
s_cmp_gt_u32 s61, 200000
s_cbranch_scc0 re_45l
re_45x:
s_branch re_45b
sh_46:
buffer_store_dwordx4 v[64:67], v5, s[4:7], s32 offen offset:64 sc1
s_branch sh_46b
re_47:
s_mov_b32 s61, 0
re_47l:
s_add_u32 m0, s23, 24576
s_xor_b32 s38, s47, 425984
buffer_load_dwordx4 v1, s[4:7], s38 offen offset:0 sc1 lds
buffer_load_dwordx4 v1, s[4:7], s38 offen offset:1024 sc1 lds
s_add_u32 m0, s23, 32768
s_xor_b32 s38, s47, 434176
buffer_load_dwordx4 v1, s[4:7], s38 offen offset:0 sc1 lds
buffer_load_dwordx4 v1, s[4:7], s38 offen offset:1024 sc1 lds
s_waitcnt vmcnt(0)
ds_read2st64_b32 v[104:105], v0 offset0:96 offset1:100
ds_read2st64_b32 v[106:107], v0 offset0:128 offset1:132
s_add_u32 s61, s61, 1
s_waitcnt vmcnt(0)
s_waitcnt lgkmcnt(0)
v_max3_u32 v104, v104, v105, v106
v_max_u32 v104, v104, v107
v_cmp_eq_u32 vcc, -1, v104
s_cbranch_vccz re_47x
s_cmp_gt_u32 s61, 200000
s_cbranch_scc0 re_47l
re_47x:
s_branch re_47b
re_48:
s_mov_b32 s61, 0
re_48l:
s_add_u32 m0, s23, 0
s_xor_b32 s38, s47, 442368
buffer_load_dwordx4 v1, s[4:7], s38 offen offset:0 sc1 lds
buffer_load_dwordx4 v1, s[4:7], s38 offen offset:1024 sc1 lds
s_add_u32 m0, s23, 8192
s_xor_b32 s38, s47, 450560
buffer_load_dwordx4 v1, s[4:7], s38 offen offset:0 sc1 lds
buffer_load_dwordx4 v1, s[4:7], s38 offen offset:1024 sc1 lds
s_waitcnt vmcnt(0)
ds_read2st64_b32 v[104:105], v0 offset0:0 offset1:4
ds_read2st64_b32 v[106:107], v0 offset0:32 offset1:36
s_add_u32 s61, s61, 1
s_waitcnt vmcnt(0)
s_waitcnt lgkmcnt(0)
v_max3_u32 v104, v104, v105, v106
v_max_u32 v104, v104, v107
v_cmp_eq_u32 vcc, -1, v104
s_cbranch_vccz re_48x
s_cmp_gt_u32 s61, 200000
s_cbranch_scc0 re_48l
re_48x:
s_branch re_48b
re_49:
s_mov_b32 s61, 0
re_49l:
s_add_u32 s62, s43, 548864
buffer_load_dwordx4 v[88:91], v1, s[4:7], s62 offen offset:2048 sc1
buffer_load_dwordx4 v[92:95], v1, s[4:7], s62 offen offset:3072 sc1
s_waitcnt vmcnt(0)
v_add_f32 v88, v88, v92
v_add_f32 v89, v89, v93
v_add_f32 v90, v90, v94
v_add_f32 v91, v91, v95
v_add_f32 v88, v88, v90
v_add_f32 v89, v89, v91
s_nop 1
v_permlane32_swap_b32 v88, v89
v_add_f32 v88, v88, v89
s_add_u32 s61, s61, 1
s_waitcnt vmcnt(0)
v_cmp_u_f32 vcc, v88, v88
s_cbranch_vccz re_49x
s_cmp_gt_u32 s61, 200000
s_cbranch_scc0 re_49l
re_49x:
s_branch re_49b
sh_50:
buffer_store_dwordx4 v[96:99], v5, s[4:7], s33 offen offset:64 sc1
s_branch sh_50b
re_51:
s_mov_b32 s61, 0
re_51l:
s_add_u32 m0, s23, 16384
s_xor_b32 s38, s22, 139264
buffer_load_dwordx4 v1, s[4:7], s38 offen offset:0 sc1 lds
buffer_load_dwordx4 v1, s[4:7], s38 offen offset:1024 sc1 lds
s_add_u32 m0, s23, 24576
s_xor_b32 s38, s22, 155648
buffer_load_dwordx4 v1, s[4:7], s38 offen offset:0 sc1 lds
buffer_load_dwordx4 v1, s[4:7], s38 offen offset:1024 sc1 lds
s_waitcnt vmcnt(0)
ds_read2st64_b32 v[56:57], v0 offset0:64 offset1:68
ds_read2st64_b32 v[58:59], v0 offset0:96 offset1:100
s_add_u32 s61, s61, 1
s_waitcnt vmcnt(0)
s_waitcnt lgkmcnt(0)
v_max3_u32 v56, v56, v57, v58
v_max_u32 v56, v56, v59
v_cmp_eq_u32 vcc, -1, v56
s_cbranch_vccz re_51x
s_cmp_gt_u32 s61, 200000
s_cbranch_scc0 re_51l
re_51x:
s_branch re_51b
re_53:
s_mov_b32 s61, 0
re_53l:
v_cndmask_b32 v44, v1, v6, s[92:93]
s_add_u32 m0, s23, 32768
s_xor_b32 s38, s22, 131072
buffer_load_dwordx4 v44, s[4:7], s38 offen offset:0 sc1 lds
buffer_load_dwordx4 v44, s[4:7], s38 offen offset:1024 sc1 lds
s_add_u32 m0, s23, 0
s_xor_b32 s38, s22, 147456
buffer_load_dwordx4 v6, s[4:7], s38 offen offset:0 sc1 lds
buffer_load_dwordx4 v6, s[4:7], s38 offen offset:1024 sc1 lds
s_waitcnt vmcnt(0)
ds_read2st64_b32 v[56:57], v0 offset0:128 offset1:132
ds_read2st64_b32 v[58:59], v0 offset0:0 offset1:4
s_add_u32 s61, s61, 1
s_waitcnt vmcnt(0)
s_waitcnt lgkmcnt(0)
v_max3_u32 v56, v56, v57, v58
v_max_u32 v56, v56, v59
v_cmp_eq_u32 vcc, -1, v56
s_cbranch_vccz re_53x
s_cmp_gt_u32 s61, 200000
s_cbranch_scc0 re_53l
re_53x:
s_branch re_53b
re_54:
s_mov_b32 s61, 0
re_54l:
s_add_u32 m0, s23, 8192
s_xor_b32 s38, s22, 172032
buffer_load_dwordx4 v1, s[4:7], s38 offen offset:0 sc1 lds
buffer_load_dwordx4 v1, s[4:7], s38 offen offset:1024 sc1 lds
s_add_u32 m0, s23, 16384
s_xor_b32 s38, s22, 188416
buffer_load_dwordx4 v1, s[4:7], s38 offen offset:0 sc1 lds
buffer_load_dwordx4 v1, s[4:7], s38 offen offset:1024 sc1 lds
s_waitcnt vmcnt(0)
ds_read2st64_b32 v[20:21], v0 offset0:32 offset1:36
ds_read2st64_b32 v[46:47], v0 offset0:64 offset1:68
s_add_u32 s61, s61, 1
s_waitcnt vmcnt(0)
s_waitcnt lgkmcnt(0)
v_max3_u32 v20, v20, v21, v46
v_max_u32 v20, v20, v47
v_cmp_eq_u32 vcc, -1, v20
s_cbranch_vccz re_54x
s_cmp_gt_u32 s61, 200000
s_cbranch_scc0 re_54l
re_54x:
s_branch re_54b
re_55:
s_mov_b32 s61, 0
re_55l:
v_cndmask_b32 v44, v1, v6, s[92:93]
s_add_u32 m0, s23, 24576
s_xor_b32 s38, s22, 163840
buffer_load_dwordx4 v44, s[4:7], s38 offen offset:0 sc1 lds
buffer_load_dwordx4 v44, s[4:7], s38 offen offset:1024 sc1 lds
s_add_u32 m0, s23, 32768
s_xor_b32 s38, s22, 180224
buffer_load_dwordx4 v6, s[4:7], s38 offen offset:0 sc1 lds
buffer_load_dwordx4 v6, s[4:7], s38 offen offset:1024 sc1 lds
s_waitcnt vmcnt(0)
ds_read2st64_b32 v[20:21], v0 offset0:96 offset1:100
ds_read2st64_b32 v[46:47], v0 offset0:128 offset1:132
s_add_u32 s61, s61, 1
s_waitcnt vmcnt(0)
s_waitcnt lgkmcnt(0)
v_max3_u32 v20, v20, v21, v46
v_max_u32 v20, v20, v47
v_cmp_eq_u32 vcc, -1, v20
s_cbranch_vccz re_55x
s_cmp_gt_u32 s61, 200000
s_cbranch_scc0 re_55l
re_55x:
s_branch re_55b
re_56:
s_mov_b32 s61, 0
re_56l:
s_lshl_b32 s60, s71, 8
v_xor_b32 v112, s60, v1
s_add_u32 s62, s51, 557056
buffer_load_dwordx4 v[116:119], v112, s[4:7], s62 offen offset:1024 sc1
buffer_load_dwordx4 v[112:115], v112, s[4:7], s62 offen offset:0 sc1
s_waitcnt vmcnt(0)
v_add_f32 v112, v112, v116
v_add_f32 v113, v113, v117
v_add_f32 v114, v114, v118
v_add_f32 v115, v115, v119
v_add_f32 v112, v112, v114
v_add_f32 v113, v113, v115
s_nop 1
v_permlane32_swap_b32 v112, v113
v_add_f32 v112, v112, v113
s_add_u32 s61, s61, 1
s_waitcnt vmcnt(0)
v_cmp_u_f32 vcc, v112, v112
s_cbranch_vccz re_56x
s_cmp_gt_u32 s61, 200000
s_cbranch_scc0 re_56l
re_56x:
s_branch re_56b
re_57:
s_mov_b32 s61, 0
re_57l:
s_lshl_b32 s60, s71, 8
v_xor_b32 v120, s60, v1
s_add_u32 s62, s51, 557056
buffer_load_dwordx4 v[124:127], v120, s[4:7], s62 offen offset:3072 sc1
buffer_load_dwordx4 v[120:123], v120, s[4:7], s62 offen offset:2048 sc1
s_waitcnt vmcnt(0)
v_add_f32 v120, v120, v124
v_add_f32 v121, v121, v125
v_add_f32 v122, v122, v126
v_add_f32 v123, v123, v127
v_add_f32 v120, v120, v122
v_add_f32 v121, v121, v123
s_nop 1
v_permlane32_swap_b32 v120, v121
v_add_f32 v120, v120, v121
s_add_u32 s61, s61, 1
s_waitcnt vmcnt(0)
v_cmp_u_f32 vcc, v120, v120
s_cbranch_vccz re_57x
s_cmp_gt_u32 s61, 200000
s_cbranch_scc0 re_57l
re_57x:
s_branch re_57b
re_58:
s_mov_b32 s61, 0
re_58l:
v_lshrrev_b32 v15, 2, v1
buffer_load_dword v15, v15, s[4:7], s37 offen sc1
s_add_u32 s61, s61, 1
s_waitcnt vmcnt(0)
v_cmp_gt_u32 vcc, 3, v15
s_nop 0
s_and_b64 vcc, vcc, s[28:29]
s_cbranch_scc0 re_58x
s_cmp_gt_u32 s61, 200000
s_cbranch_scc0 re_58l
re_58x:
s_branch re_58b
re_59:
s_mov_b32 s61, 0
re_59l:
v_lshrrev_b32 v15, 2, v1
buffer_load_dword v15, v15, s[4:7], s37 offen sc1
s_add_u32 s61, s61, 1
s_waitcnt vmcnt(0)
v_cmp_gt_u32 vcc, 4, v15
s_nop 0
s_and_b64 vcc, vcc, s[28:29]
s_cbranch_scc0 re_59x
s_cmp_gt_u32 s61, 200000
s_cbranch_scc0 re_59l
re_59x:
s_branch re_59b
re_60:
s_mov_b32 s61, 0
re_60l:
v_bfe_u32 v18, v1, 4, 3
v_lshlrev_b32 v18, 7, v18
buffer_load_dword v18, v18, s[4:7], s101 offen offset:2048 sc1
s_add_u32 s61, s61, 1
s_waitcnt vmcnt(0)
v_cmp_eq_u32 vcc, 0, v18
s_cbranch_vccz re_60x
s_cmp_gt_u32 s61, 200000
s_cbranch_scc0 re_60l
re_60x:
s_branch re_60b
re_61:
s_mov_b32 s61, 0
re_61l:
s_add_u32 s62, s43, 540672
buffer_load_dwordx2 v[56:57], v7, s[4:7], s62 offen offset:0 sc1
s_add_u32 s62, s43, 540672
buffer_load_dwordx2 v[48:49], v7, s[4:7], s62 offen offset:2048 sc1
s_add_u32 s61, s61, 1
s_waitcnt vmcnt(0)
v_max3_u32 v58, v56, v57, v48
v_max_u32 v58, v58, v49
v_cmp_eq_u32 vcc, -1, v58
s_cbranch_vccz re_61x
s_cmp_gt_u32 s61, 200000
s_cbranch_scc0 re_61l
re_61x:
s_branch re_61b
re_62:
s_mov_b32 s61, 0
re_62l:
s_add_u32 s60, s34, 1835008
buffer_load_dwordx4 v[60:63], v1, s[4:7], s60 offen sc1
s_add_u32 s61, s61, 1
s_waitcnt vmcnt(0)
v_cmp_eq_u32 vcc, -1, v60
s_cbranch_vccz re_62x
s_cmp_gt_u32 s61, 200000
s_cbranch_scc0 re_62l
re_62x:
s_branch re_62b
re_63:
s_mov_b32 s61, 0
re_63l:
s_add_u32 s60, s34, 1867776
buffer_load_dwordx4 v[108:111], v1, s[4:7], s60 offen sc1
s_add_u32 s61, s61, 1
s_waitcnt vmcnt(0)
v_cmp_eq_u32 vcc, -1, v108
s_cbranch_vccz re_63x
s_cmp_gt_u32 s61, 200000
s_cbranch_scc0 re_63l
re_63x:
s_branch re_63b
re_64:
s_mov_b32 s61, 0
re_64l:
s_add_u32 m0, s23, 16384
s_xor_b32 s38, s47, 1966080
buffer_load_dwordx4 v1, s[4:7], s38 offen offset:0 sc1 lds
buffer_load_dwordx4 v1, s[4:7], s38 offen offset:1024 sc1 lds
s_waitcnt vmcnt(0)
ds_read2st64_b32 v[72:73], v0 offset0:64 offset1:68
s_add_u32 s61, s61, 1
s_waitcnt vmcnt(0)
s_waitcnt lgkmcnt(0)
v_max_u32 v72, v72, v73
v_cmp_eq_u32 vcc, -1, v72
s_cbranch_vccz re_64x
s_cmp_gt_u32 s61, 200000
s_cbranch_scc0 re_64l
re_64x:
s_branch re_64b
re_65:
s_mov_b32 s61, 0
re_65l:
s_add_u32 m0, s23, 24576
s_xor_b32 s38, s47, 1974272
buffer_load_dwordx4 v1, s[4:7], s38 offen offset:0 sc1 lds
buffer_load_dwordx4 v1, s[4:7], s38 offen offset:1024 sc1 lds
s_add_u32 m0, s23, 0
s_xor_b32 s38, s47, 1982464
buffer_load_dwordx4 v1, s[4:7], s38 offen offset:0 sc1 lds
buffer_load_dwordx4 v1, s[4:7], s38 offen offset:1024 sc1 lds
s_waitcnt vmcnt(0)
ds_read2st64_b32 v[72:73], v0 offset0:96 offset1:100
ds_read2st64_b32 v[74:75], v0 offset0:0 offset1:4
s_add_u32 s61, s61, 1
s_waitcnt vmcnt(0)
s_waitcnt lgkmcnt(0)
v_max3_u32 v72, v72, v73, v74
v_max_u32 v72, v72, v75
v_cmp_eq_u32 vcc, -1, v72
s_cbranch_vccz re_65x
s_cmp_gt_u32 s61, 200000
s_cbranch_scc0 re_65l
re_65x:
s_branch re_65b
re_66:
s_mov_b32 s61, 0
re_66l:
s_add_u32 m0, s23, 8192
s_xor_b32 s38, s47, 1990656
buffer_load_dwordx4 v1, s[4:7], s38 offen offset:0 sc1 lds
buffer_load_dwordx4 v1, s[4:7], s38 offen offset:1024 sc1 lds
s_waitcnt vmcnt(0)
ds_read2st64_b32 v[72:73], v0 offset0:32 offset1:36
s_add_u32 s61, s61, 1
s_waitcnt vmcnt(0)
s_waitcnt lgkmcnt(0)
v_max_u32 v72, v72, v73
v_cmp_eq_u32 vcc, -1, v72
s_cbranch_vccz re_66x
s_cmp_gt_u32 s61, 200000
s_cbranch_scc0 re_66l
re_66x:
s_branch re_66b
re_67:
s_mov_b32 s61, 0
re_67l:
s_add_u32 s62, s43, 524288
buffer_load_dwordx4 v[56:59], v1, s[4:7], s62 offen offset:0 sc1
buffer_load_dwordx4 v[60:63], v1, s[4:7], s62 offen offset:1024 sc1
s_waitcnt vmcnt(0)
v_add_f32 v56, v56, v60
v_add_f32 v57, v57, v61
v_add_f32 v58, v58, v62
v_add_f32 v59, v59, v63
v_add_f32 v56, v56, v58
v_add_f32 v57, v57, v59
s_nop 1
v_permlane32_swap_b32 v56, v57
v_add_f32 v56, v56, v57
s_add_u32 s61, s61, 1
s_waitcnt vmcnt(0)
v_cmp_u_f32 vcc, v56, v56
s_cbranch_vccz re_67x
s_cmp_gt_u32 s61, 200000
s_cbranch_scc0 re_67l
re_67x:
s_branch re_67b
sh_68:
buffer_store_dwordx4 v[64:67], v5, s[4:7], s32 offen offset:0 sc1
s_branch sh_68b
re_69:
s_mov_b32 s61, 0
re_69l:
s_add_u32 m0, s23, 32768
s_xor_b32 s38, s47, 1998848
buffer_load_dwordx4 v1, s[4:7], s38 offen offset:0 sc1 lds
buffer_load_dwordx4 v1, s[4:7], s38 offen offset:1024 sc1 lds
s_waitcnt vmcnt(0)
ds_read2st64_b32 v[104:105], v0 offset0:128 offset1:132
s_add_u32 s61, s61, 1
s_waitcnt vmcnt(0)
s_waitcnt lgkmcnt(0)
v_max_u32 v104, v104, v105
v_cmp_eq_u32 vcc, -1, v104
s_cbranch_vccz re_69x
s_cmp_gt_u32 s61, 200000
s_cbranch_scc0 re_69l
re_69x:
s_branch re_69b
re_70:
s_mov_b32 s61, 0
re_70l:
s_add_u32 m0, s23, 16384
s_xor_b32 s38, s47, 2007040
buffer_load_dwordx4 v1, s[4:7], s38 offen offset:0 sc1 lds
buffer_load_dwordx4 v1, s[4:7], s38 offen offset:1024 sc1 lds
s_add_u32 m0, s23, 24576
s_xor_b32 s38, s47, 2015232
buffer_load_dwordx4 v1, s[4:7], s38 offen offset:0 sc1 lds
buffer_load_dwordx4 v1, s[4:7], s38 offen offset:1024 sc1 lds
s_waitcnt vmcnt(0)
ds_read2st64_b32 v[104:105], v0 offset0:64 offset1:68
ds_read2st64_b32 v[106:107], v0 offset0:96 offset1:100
s_add_u32 s61, s61, 1
s_waitcnt vmcnt(0)
s_waitcnt lgkmcnt(0)
v_max3_u32 v104, v104, v105, v106
v_max_u32 v104, v104, v107
v_cmp_eq_u32 vcc, -1, v104
s_cbranch_vccz re_70x
s_cmp_gt_u32 s61, 200000
s_cbranch_scc0 re_70l
re_70x:
s_branch re_70b
re_71:
s_mov_b32 s61, 0
re_71l:
s_add_u32 m0, s23, 0
s_xor_b32 s38, s47, 2023424
buffer_load_dwordx4 v1, s[4:7], s38 offen offset:0 sc1 lds
buffer_load_dwordx4 v1, s[4:7], s38 offen offset:1024 sc1 lds
s_waitcnt vmcnt(0)
ds_read2st64_b32 v[104:105], v0 offset0:0 offset1:4
s_add_u32 s61, s61, 1
s_waitcnt vmcnt(0)
s_waitcnt lgkmcnt(0)
v_max_u32 v104, v104, v105
v_cmp_eq_u32 vcc, -1, v104
s_cbranch_vccz re_71x
s_cmp_gt_u32 s61, 200000
s_cbranch_scc0 re_71l
re_71x:
s_branch re_71b
re_72:
s_mov_b32 s61, 0
re_72l:
s_add_u32 s62, s43, 524288
buffer_load_dwordx4 v[88:91], v1, s[4:7], s62 offen offset:2048 sc1
buffer_load_dwordx4 v[92:95], v1, s[4:7], s62 offen offset:3072 sc1
s_waitcnt vmcnt(0)
v_add_f32 v88, v88, v92
v_add_f32 v89, v89, v93
v_add_f32 v90, v90, v94
v_add_f32 v91, v91, v95
v_add_f32 v88, v88, v90
v_add_f32 v89, v89, v91
s_nop 1
v_permlane32_swap_b32 v88, v89
v_add_f32 v88, v88, v89
s_add_u32 s61, s61, 1
s_waitcnt vmcnt(0)
v_cmp_u_f32 vcc, v88, v88
s_cbranch_vccz re_72x
s_cmp_gt_u32 s61, 200000
s_cbranch_scc0 re_72l
re_72x:
s_branch re_72b
sh_73:
buffer_store_dwordx4 v[96:99], v5, s[4:7], s33 offen offset:0 sc1
s_branch sh_73b
re_74:
s_mov_b32 s61, 0
re_74l:
s_add_u32 m0, s23, 8192
s_xor_b32 s38, s22, 139264
buffer_load_dwordx4 v1, s[4:7], s38 offen offset:0 sc1 lds
buffer_load_dwordx4 v1, s[4:7], s38 offen offset:1024 sc1 lds
s_add_u32 m0, s23, 32768
s_xor_b32 s38, s22, 155648
buffer_load_dwordx4 v1, s[4:7], s38 offen offset:0 sc1 lds
buffer_load_dwordx4 v1, s[4:7], s38 offen offset:1024 sc1 lds
s_waitcnt vmcnt(0)
ds_read2st64_b32 v[56:57], v0 offset0:32 offset1:36
ds_read2st64_b32 v[58:59], v0 offset0:128 offset1:132
s_add_u32 s61, s61, 1
s_waitcnt vmcnt(0)
s_waitcnt lgkmcnt(0)
v_max3_u32 v56, v56, v57, v58
v_max_u32 v56, v56, v59
v_cmp_eq_u32 vcc, -1, v56
s_cbranch_vccz re_74x
s_cmp_gt_u32 s61, 200000
s_cbranch_scc0 re_74l
re_74x:
s_branch re_74b
re_76:
s_mov_b32 s61, 0
re_76l:
v_cndmask_b32 v44, v1, v6, s[92:93]
s_add_u32 m0, s23, 16384
s_xor_b32 s38, s22, 131072
buffer_load_dwordx4 v44, s[4:7], s38 offen offset:0 sc1 lds
buffer_load_dwordx4 v44, s[4:7], s38 offen offset:1024 sc1 lds
s_add_u32 m0, s23, 24576
s_xor_b32 s38, s22, 147456
buffer_load_dwordx4 v6, s[4:7], s38 offen offset:0 sc1 lds
buffer_load_dwordx4 v6, s[4:7], s38 offen offset:1024 sc1 lds
s_waitcnt vmcnt(0)
ds_read2st64_b32 v[56:57], v0 offset0:64 offset1:68
ds_read2st64_b32 v[58:59], v0 offset0:96 offset1:100
s_add_u32 s61, s61, 1
s_waitcnt vmcnt(0)
s_waitcnt lgkmcnt(0)
v_max3_u32 v56, v56, v57, v58
v_max_u32 v56, v56, v59
v_cmp_eq_u32 vcc, -1, v56
s_cbranch_vccz re_76x
s_cmp_gt_u32 s61, 200000
s_cbranch_scc0 re_76l
re_76x:
s_branch re_76b
re_77:
s_mov_b32 s61, 0
re_77l:
s_add_u32 m0, s23, 0
s_xor_b32 s38, s22, 172032
buffer_load_dwordx4 v1, s[4:7], s38 offen offset:0 sc1 lds
buffer_load_dwordx4 v1, s[4:7], s38 offen offset:1024 sc1 lds
s_waitcnt vmcnt(0)
ds_read2st64_b32 v[20:21], v0 offset0:0 offset1:4
s_add_u32 s61, s61, 1
s_waitcnt vmcnt(0)
s_waitcnt lgkmcnt(0)
v_max_u32 v20, v20, v21
v_cmp_eq_u32 vcc, -1, v20
s_cbranch_vccz re_77x
s_cmp_gt_u32 s61, 200000
s_cbranch_scc0 re_77l
re_77x:
s_branch re_77b
re_78:
s_mov_b32 s61, 0
re_78l:
s_add_u32 m0, s23, 8192
s_xor_b32 s38, s22, 188416
buffer_load_dwordx4 v1, s[4:7], s38 offen offset:0 sc1 lds
buffer_load_dwordx4 v1, s[4:7], s38 offen offset:1024 sc1 lds
s_waitcnt vmcnt(0)
ds_read2st64_b32 v[20:21], v0 offset0:32 offset1:36
s_add_u32 s61, s61, 1
s_waitcnt vmcnt(0)
s_waitcnt lgkmcnt(0)
v_max_u32 v20, v20, v21
v_cmp_eq_u32 vcc, -1, v20
s_cbranch_vccz re_78x
s_cmp_gt_u32 s61, 200000
s_cbranch_scc0 re_78l
re_78x:
s_branch re_78b
re_79:
s_mov_b32 s61, 0
re_79l:
v_cndmask_b32 v44, v1, v6, s[92:93]
s_add_u32 m0, s23, 32768
s_xor_b32 s38, s22, 163840
buffer_load_dwordx4 v44, s[4:7], s38 offen offset:0 sc1 lds
buffer_load_dwordx4 v44, s[4:7], s38 offen offset:1024 sc1 lds
s_add_u32 m0, s23, 16384
s_xor_b32 s38, s22, 180224
buffer_load_dwordx4 v6, s[4:7], s38 offen offset:0 sc1 lds
buffer_load_dwordx4 v6, s[4:7], s38 offen offset:1024 sc1 lds
s_waitcnt vmcnt(0)
ds_read2st64_b32 v[20:21], v0 offset0:128 offset1:132
ds_read2st64_b32 v[46:47], v0 offset0:64 offset1:68
s_add_u32 s61, s61, 1
s_waitcnt vmcnt(0)
s_waitcnt lgkmcnt(0)
v_max3_u32 v20, v20, v21, v46
v_max_u32 v20, v20, v47
v_cmp_eq_u32 vcc, -1, v20
s_cbranch_vccz re_79x
s_cmp_gt_u32 s61, 200000
s_cbranch_scc0 re_79l
re_79x:
s_branch re_79b
re_80:
s_mov_b32 s61, 0
re_80l:
s_lshl_b32 s60, s71, 8
v_xor_b32 v112, s60, v1
s_add_u32 s62, s51, 532480
buffer_load_dwordx4 v[116:119], v112, s[4:7], s62 offen offset:1024 sc1
buffer_load_dwordx4 v[112:115], v112, s[4:7], s62 offen offset:0 sc1
s_waitcnt vmcnt(0)
v_add_f32 v112, v112, v116
v_add_f32 v113, v113, v117
v_add_f32 v114, v114, v118
v_add_f32 v115, v115, v119
v_add_f32 v112, v112, v114
v_add_f32 v113, v113, v115
s_nop 1
v_permlane32_swap_b32 v112, v113
v_add_f32 v112, v112, v113
s_add_u32 s61, s61, 1
s_waitcnt vmcnt(0)
v_cmp_u_f32 vcc, v112, v112
s_cbranch_vccz re_80x
s_cmp_gt_u32 s61, 200000
s_cbranch_scc0 re_80l
re_80x:
s_branch re_80b
re_81:
s_mov_b32 s61, 0
re_81l:
s_lshl_b32 s60, s71, 8
v_xor_b32 v128, s60, v1
s_add_u32 s62, s51, 532480
buffer_load_dwordx4 v[132:135], v128, s[4:7], s62 offen offset:3072 sc1
buffer_load_dwordx4 v[128:131], v128, s[4:7], s62 offen offset:2048 sc1
s_waitcnt vmcnt(0)
v_add_f32 v128, v128, v132
v_add_f32 v129, v129, v133
v_add_f32 v130, v130, v134
v_add_f32 v131, v131, v135
v_add_f32 v128, v128, v130
v_add_f32 v129, v129, v131
s_nop 1
v_permlane32_swap_b32 v128, v129
v_add_f32 v128, v128, v129
s_add_u32 s61, s61, 1
s_waitcnt vmcnt(0)
v_cmp_u_f32 vcc, v128, v128
s_cbranch_vccz re_81x
s_cmp_gt_u32 s61, 200000
s_cbranch_scc0 re_81l
re_81x:
s_branch re_81b
re_82:
s_mov_b32 s61, 0
re_82l:
v_lshrrev_b32 v15, 2, v1
buffer_load_dword v15, v15, s[4:7], s37 offen sc1
s_add_u32 s61, s61, 1
s_waitcnt vmcnt(0)
v_cmp_gt_u32 vcc, 1, v15
s_nop 0
s_and_b64 vcc, vcc, s[28:29]
s_cbranch_scc0 re_82x
s_cmp_gt_u32 s61, 200000
s_cbranch_scc0 re_82l
re_82x:
s_branch re_82b
re_83:
s_mov_b32 s61, 0
re_83l:
v_lshrrev_b32 v15, 2, v1
buffer_load_dword v15, v15, s[4:7], s37 offen sc1
s_add_u32 s61, s61, 1
s_waitcnt vmcnt(0)
v_cmp_gt_u32 vcc, 2, v15
s_nop 0
s_and_b64 vcc, vcc, -1
s_cbranch_scc0 re_83x
s_cmp_gt_u32 s61, 200000
s_cbranch_scc0 re_83l
re_83x:
s_branch re_83b
re_84:
s_mov_b32 s61, 0
re_84l:
s_add_u32 s62, s43, 565248
buffer_load_dwordx2 v[52:53], v7, s[4:7], s62 offen offset:0 sc1
s_add_u32 s61, s61, 1
s_waitcnt vmcnt(0)
v_max_u32 v54, v52, v53
v_cmp_eq_u32 vcc, -1, v54
s_cbranch_vccz re_84x
s_cmp_gt_u32 s61, 200000
s_cbranch_scc0 re_84l
re_84x:
s_branch re_84b
re_85:
s_mov_b32 s61, 0
re_85l:
s_add_u32 s62, s43, 565248
buffer_load_dwordx2 v[84:85], v7, s[4:7], s62 offen offset:2048 sc1
s_add_u32 s61, s61, 1
s_waitcnt vmcnt(0)
v_max_u32 v86, v84, v85
v_cmp_eq_u32 vcc, -1, v86
s_cbranch_vccz re_85x
s_cmp_gt_u32 s61, 200000
s_cbranch_scc0 re_85l
re_85x:
s_branch re_85b
re_86:
s_mov_b32 s61, 0
re_86l:
s_add_u32 m0, s23, 32768
s_xor_b32 s38, s47, 1966080
buffer_load_dwordx4 v1, s[4:7], s38 offen offset:0 sc1 lds
buffer_load_dwordx4 v1, s[4:7], s38 offen offset:1024 sc1 lds
s_waitcnt vmcnt(0)
ds_read2st64_b32 v[72:73], v0 offset0:128 offset1:132
s_add_u32 s61, s61, 1
s_waitcnt vmcnt(0)
s_waitcnt lgkmcnt(0)
v_max_u32 v72, v72, v73
v_cmp_eq_u32 vcc, -1, v72
s_cbranch_vccz re_86x
s_cmp_gt_u32 s61, 200000
s_cbranch_scc0 re_86l
re_86x:
s_branch re_86b
re_87:
s_mov_b32 s61, 0
re_87l:
s_add_u32 m0, s23, 0
s_xor_b32 s38, s47, 1974272
buffer_load_dwordx4 v1, s[4:7], s38 offen offset:0 sc1 lds
buffer_load_dwordx4 v1, s[4:7], s38 offen offset:1024 sc1 lds
s_add_u32 m0, s23, 8192
s_xor_b32 s38, s47, 1982464
buffer_load_dwordx4 v1, s[4:7], s38 offen offset:0 sc1 lds
buffer_load_dwordx4 v1, s[4:7], s38 offen offset:1024 sc1 lds
s_waitcnt vmcnt(0)
ds_read2st64_b32 v[72:73], v0 offset0:0 offset1:4
ds_read2st64_b32 v[74:75], v0 offset0:32 offset1:36
s_add_u32 s61, s61, 1
s_waitcnt vmcnt(0)
s_waitcnt lgkmcnt(0)
v_max3_u32 v72, v72, v73, v74
v_max_u32 v72, v72, v75
v_cmp_eq_u32 vcc, -1, v72
s_cbranch_vccz re_87x
s_cmp_gt_u32 s61, 200000
s_cbranch_scc0 re_87l
re_87x:
s_branch re_87b
re_88:
s_mov_b32 s61, 0
re_88l:
s_add_u32 m0, s23, 16384
s_xor_b32 s38, s47, 1990656
buffer_load_dwordx4 v1, s[4:7], s38 offen offset:0 sc1 lds
buffer_load_dwordx4 v1, s[4:7], s38 offen offset:1024 sc1 lds
s_waitcnt vmcnt(0)
ds_read2st64_b32 v[72:73], v0 offset0:64 offset1:68
s_add_u32 s61, s61, 1
s_waitcnt vmcnt(0)
s_waitcnt lgkmcnt(0)
v_max_u32 v72, v72, v73
v_cmp_eq_u32 vcc, -1, v72
s_cbranch_vccz re_88x
s_cmp_gt_u32 s61, 200000
s_cbranch_scc0 re_88l
re_88x:
s_branch re_88b
re_89:
s_mov_b32 s61, 0
re_89l:
s_add_u32 s62, s43, 548864
buffer_load_dwordx4 v[56:59], v1, s[4:7], s62 offen offset:0 sc1
buffer_load_dwordx4 v[60:63], v1, s[4:7], s62 offen offset:1024 sc1
s_waitcnt vmcnt(0)
v_add_f32 v56, v56, v60
v_add_f32 v57, v57, v61
v_add_f32 v58, v58, v62
v_add_f32 v59, v59, v63
v_add_f32 v56, v56, v58
v_add_f32 v57, v57, v59
s_nop 1
v_permlane32_swap_b32 v56, v57
v_add_f32 v56, v56, v57
s_add_u32 s61, s61, 1
s_waitcnt vmcnt(0)
v_cmp_u_f32 vcc, v56, v56
s_cbranch_vccz re_89x
s_cmp_gt_u32 s61, 200000
s_cbranch_scc0 re_89l
re_89x:
s_branch re_89b
sh_90:
buffer_store_dwordx4 v[64:67], v5, s[4:7], s32 offen offset:64 sc1
s_branch sh_90b
re_91:
s_mov_b32 s61, 0
re_91l:
s_add_u32 m0, s23, 24576
s_xor_b32 s38, s47, 1998848
buffer_load_dwordx4 v1, s[4:7], s38 offen offset:0 sc1 lds
buffer_load_dwordx4 v1, s[4:7], s38 offen offset:1024 sc1 lds
s_add_u32 m0, s23, 32768
s_xor_b32 s38, s47, 2007040
buffer_load_dwordx4 v1, s[4:7], s38 offen offset:0 sc1 lds
buffer_load_dwordx4 v1, s[4:7], s38 offen offset:1024 sc1 lds
s_waitcnt vmcnt(0)
ds_read2st64_b32 v[104:105], v0 offset0:96 offset1:100
ds_read2st64_b32 v[106:107], v0 offset0:128 offset1:132
s_add_u32 s61, s61, 1
s_waitcnt vmcnt(0)
s_waitcnt lgkmcnt(0)
v_max3_u32 v104, v104, v105, v106
v_max_u32 v104, v104, v107
v_cmp_eq_u32 vcc, -1, v104
s_cbranch_vccz re_91x
s_cmp_gt_u32 s61, 200000
s_cbranch_scc0 re_91l
re_91x:
s_branch re_91b
re_92:
s_mov_b32 s61, 0
re_92l:
s_add_u32 m0, s23, 0
s_xor_b32 s38, s47, 2015232
buffer_load_dwordx4 v1, s[4:7], s38 offen offset:0 sc1 lds
buffer_load_dwordx4 v1, s[4:7], s38 offen offset:1024 sc1 lds
s_add_u32 m0, s23, 8192
s_xor_b32 s38, s47, 2023424
buffer_load_dwordx4 v1, s[4:7], s38 offen offset:0 sc1 lds
buffer_load_dwordx4 v1, s[4:7], s38 offen offset:1024 sc1 lds
s_waitcnt vmcnt(0)
ds_read2st64_b32 v[104:105], v0 offset0:0 offset1:4
ds_read2st64_b32 v[106:107], v0 offset0:32 offset1:36
s_add_u32 s61, s61, 1
s_waitcnt vmcnt(0)
s_waitcnt lgkmcnt(0)
v_max3_u32 v104, v104, v105, v106
v_max_u32 v104, v104, v107
v_cmp_eq_u32 vcc, -1, v104
s_cbranch_vccz re_92x
s_cmp_gt_u32 s61, 200000
s_cbranch_scc0 re_92l
re_92x:
s_branch re_92b
re_93:
s_mov_b32 s61, 0
re_93l:
s_add_u32 s62, s43, 548864
buffer_load_dwordx4 v[88:91], v1, s[4:7], s62 offen offset:2048 sc1
buffer_load_dwordx4 v[92:95], v1, s[4:7], s62 offen offset:3072 sc1
s_waitcnt vmcnt(0)
v_add_f32 v88, v88, v92
v_add_f32 v89, v89, v93
v_add_f32 v90, v90, v94
v_add_f32 v91, v91, v95
v_add_f32 v88, v88, v90
v_add_f32 v89, v89, v91
s_nop 1
v_permlane32_swap_b32 v88, v89
v_add_f32 v88, v88, v89
s_add_u32 s61, s61, 1
s_waitcnt vmcnt(0)
v_cmp_u_f32 vcc, v88, v88
s_cbranch_vccz re_93x
s_cmp_gt_u32 s61, 200000
s_cbranch_scc0 re_93l
re_93x:
s_branch re_93b
sh_94:
buffer_store_dwordx4 v[96:99], v5, s[4:7], s33 offen offset:64 sc1
s_branch sh_94b
re_95:
s_mov_b32 s61, 0
re_95l:
s_add_u32 m0, s23, 16384
s_xor_b32 s38, s22, 139264
buffer_load_dwordx4 v1, s[4:7], s38 offen offset:0 sc1 lds
buffer_load_dwordx4 v1, s[4:7], s38 offen offset:1024 sc1 lds
s_add_u32 m0, s23, 24576
s_xor_b32 s38, s22, 155648
buffer_load_dwordx4 v1, s[4:7], s38 offen offset:0 sc1 lds
buffer_load_dwordx4 v1, s[4:7], s38 offen offset:1024 sc1 lds
s_waitcnt vmcnt(0)
ds_read2st64_b32 v[56:57], v0 offset0:64 offset1:68
ds_read2st64_b32 v[58:59], v0 offset0:96 offset1:100
s_add_u32 s61, s61, 1
s_waitcnt vmcnt(0)
s_waitcnt lgkmcnt(0)
v_max3_u32 v56, v56, v57, v58
v_max_u32 v56, v56, v59
v_cmp_eq_u32 vcc, -1, v56
s_cbranch_vccz re_95x
s_cmp_gt_u32 s61, 200000
s_cbranch_scc0 re_95l
re_95x:
s_branch re_95b
re_97:
s_mov_b32 s61, 0
re_97l:
v_cndmask_b32 v44, v1, v6, s[92:93]
s_add_u32 m0, s23, 32768
s_xor_b32 s38, s22, 131072
buffer_load_dwordx4 v44, s[4:7], s38 offen offset:0 sc1 lds
buffer_load_dwordx4 v44, s[4:7], s38 offen offset:1024 sc1 lds
s_add_u32 m0, s23, 0
s_xor_b32 s38, s22, 147456
buffer_load_dwordx4 v6, s[4:7], s38 offen offset:0 sc1 lds
buffer_load_dwordx4 v6, s[4:7], s38 offen offset:1024 sc1 lds
s_waitcnt vmcnt(0)
ds_read2st64_b32 v[56:57], v0 offset0:128 offset1:132
ds_read2st64_b32 v[58:59], v0 offset0:0 offset1:4
s_add_u32 s61, s61, 1
s_waitcnt vmcnt(0)
s_waitcnt lgkmcnt(0)
v_max3_u32 v56, v56, v57, v58
v_max_u32 v56, v56, v59
v_cmp_eq_u32 vcc, -1, v56
s_cbranch_vccz re_97x
s_cmp_gt_u32 s61, 200000
s_cbranch_scc0 re_97l
re_97x:
s_branch re_97b
re_98:
s_mov_b32 s61, 0
re_98l:
s_add_u32 m0, s23, 8192
s_xor_b32 s38, s22, 172032
buffer_load_dwordx4 v1, s[4:7], s38 offen offset:0 sc1 lds
buffer_load_dwordx4 v1, s[4:7], s38 offen offset:1024 sc1 lds
s_add_u32 m0, s23, 16384
s_xor_b32 s38, s22, 188416
buffer_load_dwordx4 v1, s[4:7], s38 offen offset:0 sc1 lds
buffer_load_dwordx4 v1, s[4:7], s38 offen offset:1024 sc1 lds
s_waitcnt vmcnt(0)
ds_read2st64_b32 v[20:21], v0 offset0:32 offset1:36
ds_read2st64_b32 v[46:47], v0 offset0:64 offset1:68
s_add_u32 s61, s61, 1
s_waitcnt vmcnt(0)
s_waitcnt lgkmcnt(0)
v_max3_u32 v20, v20, v21, v46
v_max_u32 v20, v20, v47
v_cmp_eq_u32 vcc, -1, v20
s_cbranch_vccz re_98x
s_cmp_gt_u32 s61, 200000
s_cbranch_scc0 re_98l
re_98x:
s_branch re_98b
re_99:
s_mov_b32 s61, 0
re_99l:
v_cndmask_b32 v44, v1, v6, s[92:93]
s_add_u32 m0, s23, 24576
s_xor_b32 s38, s22, 163840
buffer_load_dwordx4 v44, s[4:7], s38 offen offset:0 sc1 lds
buffer_load_dwordx4 v44, s[4:7], s38 offen offset:1024 sc1 lds
s_add_u32 m0, s23, 32768
s_xor_b32 s38, s22, 180224
buffer_load_dwordx4 v6, s[4:7], s38 offen offset:0 sc1 lds
buffer_load_dwordx4 v6, s[4:7], s38 offen offset:1024 sc1 lds
s_waitcnt vmcnt(0)
ds_read2st64_b32 v[20:21], v0 offset0:96 offset1:100
ds_read2st64_b32 v[46:47], v0 offset0:128 offset1:132
s_add_u32 s61, s61, 1
s_waitcnt vmcnt(0)
s_waitcnt lgkmcnt(0)
v_max3_u32 v20, v20, v21, v46
v_max_u32 v20, v20, v47
v_cmp_eq_u32 vcc, -1, v20
s_cbranch_vccz re_99x
s_cmp_gt_u32 s61, 200000
s_cbranch_scc0 re_99l
re_99x:
s_branch re_99b
re_100:
s_mov_b32 s61, 0
re_100l:
s_lshl_b32 s60, s71, 8
v_xor_b32 v112, s60, v1
s_add_u32 s62, s51, 557056
buffer_load_dwordx4 v[116:119], v112, s[4:7], s62 offen offset:1024 sc1
buffer_load_dwordx4 v[112:115], v112, s[4:7], s62 offen offset:0 sc1
s_waitcnt vmcnt(0)
v_add_f32 v112, v112, v116
v_add_f32 v113, v113, v117
v_add_f32 v114, v114, v118
v_add_f32 v115, v115, v119
v_add_f32 v112, v112, v114
v_add_f32 v113, v113, v115
s_nop 1
v_permlane32_swap_b32 v112, v113
v_add_f32 v112, v112, v113
s_add_u32 s61, s61, 1
s_waitcnt vmcnt(0)
v_cmp_u_f32 vcc, v112, v112
s_cbranch_vccz re_100x
s_cmp_gt_u32 s61, 200000
s_cbranch_scc0 re_100l
re_100x:
s_branch re_100b
re_101:
s_mov_b32 s61, 0
re_101l:
s_lshl_b32 s60, s71, 8
v_xor_b32 v120, s60, v1
s_add_u32 s62, s51, 557056
buffer_load_dwordx4 v[124:127], v120, s[4:7], s62 offen offset:3072 sc1
buffer_load_dwordx4 v[120:123], v120, s[4:7], s62 offen offset:2048 sc1
s_waitcnt vmcnt(0)
v_add_f32 v120, v120, v124
v_add_f32 v121, v121, v125
v_add_f32 v122, v122, v126
v_add_f32 v123, v123, v127
v_add_f32 v120, v120, v122
v_add_f32 v121, v121, v123
s_nop 1
v_permlane32_swap_b32 v120, v121
v_add_f32 v120, v120, v121
s_add_u32 s61, s61, 1
s_waitcnt vmcnt(0)
v_cmp_u_f32 vcc, v120, v120
s_cbranch_vccz re_101x
s_cmp_gt_u32 s61, 200000
s_cbranch_scc0 re_101l
re_101x:
s_branch re_101b
re_102:
s_mov_b32 s61, 0
re_102l:
v_lshrrev_b32 v15, 2, v1
buffer_load_dword v15, v15, s[4:7], s37 offen sc1
s_add_u32 s61, s61, 1
s_waitcnt vmcnt(0)
v_cmp_gt_u32 vcc, 3, v15
s_nop 0
s_and_b64 vcc, vcc, s[28:29]
s_cbranch_scc0 re_102x
s_cmp_gt_u32 s61, 200000
s_cbranch_scc0 re_102l
re_102x:
s_branch re_102b
re_103:
s_mov_b32 s61, 0
re_103l:
v_lshrrev_b32 v15, 2, v1
buffer_load_dword v15, v15, s[4:7], s37 offen sc1
s_add_u32 s61, s61, 1
s_waitcnt vmcnt(0)
v_cmp_gt_u32 vcc, 4, v15
s_nop 0
s_and_b64 vcc, vcc, s[28:29]
s_cbranch_scc0 re_103x
s_cmp_gt_u32 s61, 200000
s_cbranch_scc0 re_103l
re_103x:
s_branch re_103b
.section .rodata,"a"
.p2align 6
.amdhsa_kernel interleave_layers__ssm_conv_h3__mixer_s_mlp__prompt_kernel
  .amdhsa_next_free_vgpr 512
  .amdhsa_next_free_sgpr 102
  .amdhsa_accum_offset 256
  .amdhsa_group_segment_fixed_size 0
  .amdhsa_kernarg_size 112
  .amdhsa_user_sgpr_count 2
  .amdhsa_user_sgpr_kernarg_segment_ptr 1
  .amdhsa_system_sgpr_workgroup_id_x 1
.end_amdhsa_kernel
```
